```python
import torch

def _softmax(x, axis=-1):
    return torch.softmax(x, dim=axis)
def _gelu(x):
    return torch.nn.functional.gelu(x, approximate="tanh")
def _silu(x):
    return torch.nn.functional.silu(x)
def _sigmoid(x):
    return torch.sigmoid(x)
def _layernorm(x, axis=-1, eps=1e-5):
    m = x.mean(dim=axis, keepdim=True)
    v = x.var(dim=axis, keepdim=True, unbiased=False)
    return (x - m) / torch.sqrt(v + eps)
def _scatter_add(tgt, idx, src, axis=0):
    return tgt.clone().index_add_(axis, idx, src)
def _segment_sum(src, seg, n):
    out = torch.zeros((n,) + src.shape[1:], dtype=src.dtype)
    return out.index_add_(0, seg, src)
def _pad(x, pw):
    flat = tuple(v for pair in reversed(pw) for v in pair)
    return torch.nn.functional.pad(x, flat)

kernel_name = 'standalone__mha_block_cached__near_ridge'

def setup_inputs():

    _w = (lambda a: (lambda t: t.to(torch.bfloat16) if t.is_floating_point() else t)(torch.as_tensor(a)))
    B, Sq, D = 16, 144, 1024
    H, Sk, Dh = 32, 512, 128
    return {
        "x": _w((lambda *s: torch.randn(*s, dtype=torch.bfloat16) * 0.8)(B, Sq, D)),
        "k_cache": _w((lambda *s: torch.randn(*s, dtype=torch.bfloat16) * 0.8)(B, H, Sk, Dh)),
        "v_cache": _w((lambda *s: torch.randn(*s, dtype=torch.bfloat16) * 0.05)(B, H, Sk, Dh)),
        "wq": _w((lambda *s: torch.randn(*s, dtype=torch.bfloat16) * 0.8)(D, H * Dh) * (D ** -0.5)),
        "wo": _w((lambda *s: torch.randn(*s, dtype=torch.bfloat16) * 0.05)(H * Dh, D) * ((H * Dh) ** -0.5)),
    }

def reference(x, k_cache, v_cache, wq, wo):
    B, Sq, D = x.shape
    H, Dh = 32, 128
    q = (lambda x, *d: x.permute(*d))((x @ wq).reshape(B, Sq, H, Dh), 0, 2, 1, 3)
    scores = torch.einsum("bhqd,bhkd->bhqk", q, k_cache) * (Dh ** -0.5)
    p = _softmax(scores, axis=-1)
    o = torch.einsum("bhqk,bhkd->bhqd", p, v_cache)
    return (lambda x, *d: x.permute(*d))(o, 0, 2, 1, 3).reshape(B, Sq, H * Dh) @ wo
```

```asm
; @launch grid=(256,1,1) block=(512,1,1) lds=163840
.amdgcn_target "amdgcn-amd-amdhsa--gfx950"
.text
.globl standalone__mha_block_cached__near_ridge_kernel
.p2align 8
.type standalone__mha_block_cached__near_ridge_kernel,@function
standalone__mha_block_cached__near_ridge_kernel:
    s_cmp_lt_u32 s2, 256
    s_cbranch_scc1 P_go
    s_endpgm
P_go:
    s_load_dwordx4 s[28:31], s[0:1], 0
    s_load_dwordx4 s[32:35], s[0:1], 16
    s_load_dwordx2 s[36:37], s[0:1], 56
    v_lshrrev_b32 v1, 6, v0
    s_and_b32 s25, s2, 1
    v_readfirstlane_b32 s3, v1
    s_lshl_b32 s25, s25, 3
    s_bfe_u32 s26, s2, 0x30003
    s_add_u32 s25, s25, s26
    s_bfe_u32 s26, s2, 0x20001
    s_lshl_b32 s26, s26, 2
    s_lshr_b32 s27, s2, 6
    s_add_u32 s26, s26, s27
    s_lshl_b32 s26, s26, 1
    s_lshl_b32 s27, s25, 5
    s_add_u32 s27, s27, s26
    s_and_b32 s24, s3, 3
    s_cmp_lt_u32 s3, 4
    s_cbranch_scc1 G0_start
    v_and_b32 v239, 63, v0
    v_lshrrev_b32 v244, 4, v239
    v_and_b32 v245, 2, v244
    v_and_b32 v246, 3, v239
    v_xor_b32 v245, v245, v246
    v_lshlrev_b32 v245, 4, v245
    v_lshrrev_b32 v246, 2, v239
    v_lshl_add_u32 v245, v246, 11, v245
    s_lshl_b32 s38, s24, 16
    v_add_u32 v232, s38, v245
    v_add_u32 v233, 31744, v232
    v_add_u32 v234, 262144, v245
    v_and_b32 v245, 15, v239
    v_lshlrev_b32 v246, 1, v244
    v_xor_b32 v245, v245, v246
    s_and_b32 s39, s24, 1
    s_lshl_b32 s40, s39, 3
    v_xor_b32 v246, s40, v245
    v_lshlrev_b32 v246, 4, v246
    v_lshl_add_u32 v247, v244, 13, v246
    v_add_u32 v235, s38, v247
    v_add_u32 v236, 31744, v235
    s_lshl_b32 s41, s24, 12
    v_lshlrev_b32 v245, 4, v245
    v_lshl_add_u32 v245, v244, 8, v245
    v_add_u32 v237, s41, v245
    v_xor_b32 v238, 0x80, v237
    s_lshl_b32 s42, s24, 11
    s_lshr_b32 s53, s26, 1
    s_add_u32 s53, s53, s25
    s_and_b32 s53, s53, 3
    s_and_b32 s47, s2, 1
    s_mul_i32 s47, s47, 8
    s_bfe_u32 s44, s2, 0x20001
    s_mul_i32 s44, s44, 2
    s_add_u32 s47, s47, s44
    s_waitcnt lgkmcnt(0)
    s_mul_i32 s44, s25, 294912
    s_add_u32 s4, s28, s44
    s_addc_u32 s5, s29, 0
    s_mov_b32 s6, 294912
    s_mov_b32 s7, 0x20000
    s_lshl_b32 s44, s26, 8
    s_add_u32 s8, s34, s44
    s_addc_u32 s9, s35, 0
    s_sub_u32 s10, 8388608, s44
    s_mov_b32 s11, 0x20000
    s_mov_b32 s46, 15
    s_add_u32 s46, s46, s47
    s_and_b32 s46, s46, 15
    s_lshl_b32 s50, s46, 7
    s_add_u32 s51, s50, 64
    s_lshl_b32 s46, s46, 19
    s_cmp_eq_u32 s24, 0
    s_cbranch_scc0 G1_x8s0
    s_mov_b32 m0, 106496
    s_nop 0
    buffer_load_dwordx4 v234, s[4:7], s50 offen  lds
    s_mov_b32 m0, 115712
    s_nop 0
    buffer_load_dwordx4 v234, s[4:7], s51 offen  lds
G1_x8s0:
    s_add_u32 m0, s42, 98304
    s_nop 0
    buffer_load_dwordx4 v232, s[4:7], s50 offen  lds
    buffer_load_dwordx4 v233, s[4:7], s50 offen offset:1024  lds
    s_add_u32 m0, s42, 107520
    s_nop 0
    buffer_load_dwordx4 v232, s[4:7], s51 offen  lds
    buffer_load_dwordx4 v233, s[4:7], s51 offen offset:1024  lds
    s_add_u32 m0, s42, 65536
    s_add_u32 s45, s46, 0
    buffer_load_dwordx4 v235, s[8:11], s45 offen  lds
    buffer_load_dwordx4 v236, s[8:11], s45 offen offset:1024  lds
    s_add_u32 m0, s42, 73728
    s_add_u32 s45, s46, 256
    buffer_load_dwordx4 v235, s[8:11], s45 offen  lds
    buffer_load_dwordx4 v236, s[8:11], s45 offen offset:1024  lds
    s_lshl_b32 s44, s27, 17
    s_add_u32 s12, s30, s44
    s_addc_u32 s13, s31, 0
    s_mov_b32 s14, 262144
    s_mov_b32 s15, 0x20000
    s_add_u32 s16, s32, s44
    s_addc_u32 s17, s33, 0
    s_mov_b32 s18, 262144
    s_mov_b32 s19, 0x20000
    v_and_b32 v240, 3, v239
    v_lshlrev_b32 v240, 2, v240
    v_add_u32 v240, 163584, v240
    s_lshl_b32 s44, s24, 2
    v_mov_b32 v241, 163584
    v_add_u32 v241, s44, v241
    s_add_u32 s43, s44, 163584
    s_getpc_b64 s[54:55]
G1_pc:
    s_sub_u32 s54, s54, G1_pc - standalone__mha_block_cached__near_ridge_kernel
    s_subb_u32 s55, s55, 0
    s_add_u32 s48, s54, cnt_table - standalone__mha_block_cached__near_ridge_kernel
    s_addc_u32 s49, s55, 0
    s_lshr_b32 s44, s2, 3
    s_lshl_b32 s44, s44, 2
    s_add_u32 s44, s44, s24
    s_min_u32 s44, s44, CODE_KB_P
    s_lshl_b32 s44, s44, 10
    v_lshl_add_u32 v245, v239, 4, s44
    global_load_dwordx4 v[180:183], v245, s[54:55]
    s_mul_i32 s44, s27, 36864
    s_add_u32 s20, s36, s44
    s_addc_u32 s21, s37, 0
    s_mov_b32 s22, 73728
    s_mov_b32 s23, 0x20000
    s_lshl_b32 s44, s27, 6
    s_lshl_b32 s45, s25, 11
    s_add_u32 s44, s44, s45
    s_add_u32 s44, s44, 50331648
    v_lshlrev_b32 v245, 11, v239
    v_add_u32 v245, s44, v245
    v_mov_b32 v248, 0
    v_mov_b32 v249, 0
    v_mov_b32 v250, 0
    v_mov_b32 v251, 0
    s_cmp_lg_u32 s24, 0
    s_cbranch_scc1 G1_noclr
    s_mov_b64 exec, 3
    global_store_dwordx4 v245, v[248:251], s[36:37] sc1
    s_mov_b64 exec, -1
G1_noclr:
    s_lshl_b32 s44, s24, 6
    s_add_u32 s45, s41, 49152
    v_and_b32 v244, 15, v239
    v_lshrrev_b32 v245, 4, v239
    v_and_b32 v246, 7, v244
    v_lshlrev_b32 v246, 1, v246
    v_xor_b32 v246, v246, v245
    v_lshlrev_b32 v246, 4, v246
    v_lshl_add_u32 v220, v244, 8, v246
    v_add_u32 v220, s41, v220
    v_xor_b32 v221, 64, v220
    v_xor_b32 v222, 128, v220
    v_xor_b32 v223, 192, v220
    v_and_b32 v247, 3, v239
    v_lshlrev_b32 v247, 3, v247
    v_lshrrev_b32 v246, 2, v239
    v_lshl_add_u32 v224, v246, 8, v247
    v_and_b32 v246, 7, v246
    v_lshl_add_u32 v224, v246, 5, v224
    v_xor_b32 v224, s44, v224
    v_add_u32 v224, s45, v224
    v_xor_b32 v225, 32, v224
    v_xor_b32 v226, 64, v224
    v_xor_b32 v227, 96, v224
    v_xor_b32 v228, 128, v224
    v_xor_b32 v229, 160, v224
    v_xor_b32 v230, 192, v224
    v_xor_b32 v231, 224, v224
    v_lshl_add_u32 v243, v239, 4, s41
    s_barrier
    v_mov_b32 v242, 4
    s_mov_b32 m0, s43
    s_mov_b64 exec, 1
    global_load_lds_dword v242, s[48:49]
    s_mov_b64 exec, -1
    s_add_u32 m0, s42, 81920
    s_add_u32 s45, s46, 262144
    buffer_load_dwordx4 v235, s[8:11], s45 offen  lds
    buffer_load_dwordx4 v236, s[8:11], s45 offen offset:1024  lds
    s_add_u32 m0, s42, 90112
    s_add_u32 s45, s46, 262400
    buffer_load_dwordx4 v235, s[8:11], s45 offen  lds
    buffer_load_dwordx4 v236, s[8:11], s45 offen offset:1024  lds
    v_mov_b32 v242, 8
    s_mov_b32 m0, s43
    s_mov_b64 exec, 1
    global_load_lds_dword v242, s[48:49]
    s_mov_b64 exec, -1
    s_mov_b32 s46, 0
    s_cmp_eq_u32 s53, 1
    s_cselect_b32 s46, 1, s46
    s_cmp_eq_u32 s53, 2
    s_cselect_b32 s46, 2, s46
    s_cmp_eq_u32 s53, 3
    s_cselect_b32 s46, 3, s46
    s_add_u32 s46, s46, s47
    s_and_b32 s46, s46, 15
    s_lshl_b32 s50, s46, 7
    s_add_u32 s51, s50, 64
    s_lshl_b32 s46, s46, 19
    s_cmp_eq_u32 s24, 1
    s_cbranch_scc0 G1_x8s2
    s_mov_b32 m0, 124928
    s_nop 0
    buffer_load_dwordx4 v234, s[4:7], s50 offen  lds
    s_mov_b32 m0, 134144
    s_nop 0
    buffer_load_dwordx4 v234, s[4:7], s51 offen  lds
G1_x8s2:
    s_add_u32 m0, s42, 116736
    s_nop 0
    buffer_load_dwordx4 v232, s[4:7], s50 offen  lds
    buffer_load_dwordx4 v233, s[4:7], s50 offen offset:1024  lds
    s_add_u32 m0, s42, 125952
    s_nop 0
    buffer_load_dwordx4 v232, s[4:7], s51 offen  lds
    buffer_load_dwordx4 v233, s[4:7], s51 offen offset:1024  lds
    global_load_dword v219, v242, s[48:49]
    s_add_u32 m0, s42, 0
    s_add_u32 s45, s46, 0
    buffer_load_dwordx4 v235, s[8:11], s45 offen  lds
    buffer_load_dwordx4 v236, s[8:11], s45 offen offset:1024  lds
    s_add_u32 m0, s42, 8192
    s_add_u32 s45, s46, 256
    buffer_load_dwordx4 v235, s[8:11], s45 offen  lds
    buffer_load_dwordx4 v236, s[8:11], s45 offen offset:1024  lds
    global_load_dword v219, v242, s[48:49]
    v_mov_b32 v242, 12
    s_mov_b32 m0, s43
    s_mov_b64 exec, 1
    global_load_lds_dword v242, s[48:49]
    s_mov_b64 exec, -1
    s_cmp_eq_u32 s53, 0
    s_cbranch_scc0 G1_pf0_0
    s_mov_b32 s52, 49152
    buffer_load_dwordx4 v[0:3], v238, s[12:15], s52 offen offset:1024 nt
    s_mov_b32 s52, 32768
    buffer_load_dwordx4 v[4:7], v238, s[16:19], s52 offen offset:1024 nt
    s_mov_b32 s52, 65536
    buffer_load_dwordx4 v[8:11], v237, s[12:15], s52 offen offset:0 nt
    s_mov_b32 s52, 65536
    buffer_load_dwordx4 v[12:15], v238, s[12:15], s52 offen offset:3072 nt
    s_mov_b32 s52, 49152
    buffer_load_dwordx4 v[16:19], v238, s[16:19], s52 offen offset:3072 nt
    s_mov_b32 s52, 81920
    buffer_load_dwordx4 v[20:23], v237, s[12:15], s52 offen offset:2048 nt
    s_mov_b32 s52, 65536
    buffer_load_dwordx4 v[24:27], v238, s[16:19], s52 offen offset:1024 nt
    s_mov_b32 s52, 98304
    buffer_load_dwordx4 v[28:31], v238, s[12:15], s52 offen offset:1024 nt
G1_pf0_0:
    s_add_u32 m0, s42, 16384
    s_add_u32 s45, s46, 262144
    buffer_load_dwordx4 v235, s[8:11], s45 offen  lds
    buffer_load_dwordx4 v236, s[8:11], s45 offen offset:1024  lds
    s_add_u32 m0, s42, 24576
    s_add_u32 s45, s46, 262400
    buffer_load_dwordx4 v235, s[8:11], s45 offen  lds
    buffer_load_dwordx4 v236, s[8:11], s45 offen offset:1024  lds
    global_load_dword v219, v242, s[48:49]
    v_mov_b32 v242, 16
    s_mov_b32 m0, s43
    s_mov_b64 exec, 1
    global_load_lds_dword v242, s[48:49]
    s_mov_b64 exec, -1
    s_cmp_eq_u32 s53, 1
    s_cbranch_scc0 G1_pf0_1
    s_mov_b32 s52, 49152
    buffer_load_dwordx4 v[0:3], v238, s[12:15], s52 offen offset:1024 nt
    s_mov_b32 s52, 32768
    buffer_load_dwordx4 v[4:7], v238, s[16:19], s52 offen offset:1024 nt
    s_mov_b32 s52, 65536
    buffer_load_dwordx4 v[8:11], v237, s[12:15], s52 offen offset:0 nt
    s_mov_b32 s52, 65536
    buffer_load_dwordx4 v[12:15], v238, s[12:15], s52 offen offset:3072 nt
    s_mov_b32 s52, 49152
    buffer_load_dwordx4 v[16:19], v238, s[16:19], s52 offen offset:3072 nt
    s_mov_b32 s52, 81920
    buffer_load_dwordx4 v[20:23], v237, s[12:15], s52 offen offset:2048 nt
    s_mov_b32 s52, 65536
    buffer_load_dwordx4 v[24:27], v238, s[16:19], s52 offen offset:1024 nt
    s_mov_b32 s52, 98304
    buffer_load_dwordx4 v[28:31], v238, s[12:15], s52 offen offset:1024 nt
G1_pf0_1:
    s_mov_b32 s46, 4
    s_cmp_eq_u32 s53, 1
    s_cselect_b32 s46, 0, s46
    s_cmp_eq_u32 s53, 2
    s_cselect_b32 s46, 0, s46
    s_cmp_eq_u32 s53, 3
    s_cselect_b32 s46, 0, s46
    s_add_u32 s46, s46, s47
    s_and_b32 s46, s46, 15
    s_lshl_b32 s50, s46, 7
    s_add_u32 s51, s50, 64
    s_lshl_b32 s46, s46, 19
    s_cmp_eq_u32 s24, 2
    s_cbranch_scc0 G1_x8s4
    s_mov_b32 m0, 143360
    s_nop 0
    buffer_load_dwordx4 v234, s[4:7], s50 offen  lds
    s_mov_b32 m0, 152576
    s_nop 0
    buffer_load_dwordx4 v234, s[4:7], s51 offen  lds
G1_x8s4:
    s_add_u32 m0, s42, 135168
    s_nop 0
    buffer_load_dwordx4 v232, s[4:7], s50 offen  lds
    buffer_load_dwordx4 v233, s[4:7], s50 offen offset:1024  lds
    s_add_u32 m0, s42, 144384
    s_nop 0
    buffer_load_dwordx4 v232, s[4:7], s51 offen  lds
    buffer_load_dwordx4 v233, s[4:7], s51 offen offset:1024  lds
    global_load_dword v219, v242, s[48:49]
    s_add_u32 m0, s42, 49152
    s_add_u32 s45, s46, 0
    buffer_load_dwordx4 v235, s[8:11], s45 offen  lds
    buffer_load_dwordx4 v236, s[8:11], s45 offen offset:1024  lds
    s_add_u32 m0, s42, 57344
    s_add_u32 s45, s46, 256
    buffer_load_dwordx4 v235, s[8:11], s45 offen  lds
    buffer_load_dwordx4 v236, s[8:11], s45 offen offset:1024  lds
    global_load_dword v219, v242, s[48:49]
    v_mov_b32 v242, 20
    s_mov_b32 m0, s43
    s_mov_b64 exec, 1
    global_load_lds_dword v242, s[48:49]
    s_mov_b64 exec, -1
    s_cmp_eq_u32 s53, 2
    s_cbranch_scc0 G1_pf0_2
    s_mov_b32 s52, 49152
    buffer_load_dwordx4 v[0:3], v238, s[12:15], s52 offen offset:1024 nt
    s_mov_b32 s52, 32768
    buffer_load_dwordx4 v[4:7], v238, s[16:19], s52 offen offset:1024 nt
    s_mov_b32 s52, 65536
    buffer_load_dwordx4 v[8:11], v237, s[12:15], s52 offen offset:0 nt
    s_mov_b32 s52, 65536
    buffer_load_dwordx4 v[12:15], v238, s[12:15], s52 offen offset:3072 nt
    s_mov_b32 s52, 49152
    buffer_load_dwordx4 v[16:19], v238, s[16:19], s52 offen offset:3072 nt
    s_mov_b32 s52, 81920
    buffer_load_dwordx4 v[20:23], v237, s[12:15], s52 offen offset:2048 nt
    s_mov_b32 s52, 65536
    buffer_load_dwordx4 v[24:27], v238, s[16:19], s52 offen offset:1024 nt
    s_mov_b32 s52, 98304
    buffer_load_dwordx4 v[28:31], v238, s[12:15], s52 offen offset:1024 nt
G1_pf0_2:
    s_add_u32 m0, s42, 32768
    s_add_u32 s45, s46, 262144
    buffer_load_dwordx4 v235, s[8:11], s45 offen  lds
    buffer_load_dwordx4 v236, s[8:11], s45 offen offset:1024  lds
    s_add_u32 m0, s42, 40960
    s_add_u32 s45, s46, 262400
    buffer_load_dwordx4 v235, s[8:11], s45 offen  lds
    buffer_load_dwordx4 v236, s[8:11], s45 offen offset:1024  lds
    global_load_dword v219, v242, s[48:49]
    v_mov_b32 v242, 24
    s_mov_b32 m0, s43
    s_mov_b64 exec, 1
    global_load_lds_dword v242, s[48:49]
    s_mov_b64 exec, -1
    s_mov_b32 s59, 262144
G1_fq6:
    ds_read_b32 v248, v240 offset:16
    s_waitcnt lgkmcnt(0)
    v_cmp_lt_u32 s[56:57], v248, 2
    s_nop 0
    s_cmp_eq_u64 s[56:57], 0
    s_cbranch_scc1 G1_fq6_ok
    s_sleep 1
    s_sub_u32 s59, s59, 1
    s_cmp_lg_u32 s59, 0
    s_cbranch_scc1 G1_fq6
G1_fq6_ok:
    s_mov_b32 s46, 1
    s_cmp_eq_u32 s53, 1
    s_cselect_b32 s46, 5, s46
    s_add_u32 s46, s46, s47
    s_and_b32 s46, s46, 15
    s_lshl_b32 s50, s46, 7
    s_add_u32 s51, s50, 64
    s_lshl_b32 s46, s46, 19
    s_cmp_eq_u32 s24, 3
    s_cbranch_scc0 G1_x8s6
    s_mov_b32 m0, 106496
    s_nop 0
    buffer_load_dwordx4 v234, s[4:7], s50 offen  lds
    s_mov_b32 m0, 115712
    s_nop 0
    buffer_load_dwordx4 v234, s[4:7], s51 offen  lds
G1_x8s6:
    s_add_u32 m0, s42, 98304
    s_nop 0
    buffer_load_dwordx4 v232, s[4:7], s50 offen  lds
    buffer_load_dwordx4 v233, s[4:7], s50 offen offset:1024  lds
    s_add_u32 m0, s42, 107520
    s_nop 0
    buffer_load_dwordx4 v232, s[4:7], s51 offen  lds
    buffer_load_dwordx4 v233, s[4:7], s51 offen offset:1024  lds
    global_load_dword v219, v242, s[48:49]
    s_add_u32 m0, s42, 65536
    s_add_u32 s45, s46, 0
    buffer_load_dwordx4 v235, s[8:11], s45 offen  lds
    buffer_load_dwordx4 v236, s[8:11], s45 offen offset:1024  lds
    s_add_u32 m0, s42, 73728
    s_add_u32 s45, s46, 256
    buffer_load_dwordx4 v235, s[8:11], s45 offen  lds
    buffer_load_dwordx4 v236, s[8:11], s45 offen offset:1024  lds
    global_load_dword v219, v242, s[48:49]
    v_mov_b32 v242, 28
    s_mov_b32 m0, s43
    s_mov_b64 exec, 1
    global_load_lds_dword v242, s[48:49]
    s_mov_b64 exec, -1
    s_cmp_eq_u32 s53, 3
    s_cbranch_scc0 G1_pf0_3
    s_mov_b32 s52, 49152
    buffer_load_dwordx4 v[0:3], v238, s[12:15], s52 offen offset:1024 nt
    s_mov_b32 s52, 32768
    buffer_load_dwordx4 v[4:7], v238, s[16:19], s52 offen offset:1024 nt
    s_mov_b32 s52, 65536
    buffer_load_dwordx4 v[8:11], v237, s[12:15], s52 offen offset:0 nt
    s_mov_b32 s52, 65536
    buffer_load_dwordx4 v[12:15], v238, s[12:15], s52 offen offset:3072 nt
    s_mov_b32 s52, 49152
    buffer_load_dwordx4 v[16:19], v238, s[16:19], s52 offen offset:3072 nt
    s_mov_b32 s52, 81920
    buffer_load_dwordx4 v[20:23], v237, s[12:15], s52 offen offset:2048 nt
    s_mov_b32 s52, 65536
    buffer_load_dwordx4 v[24:27], v238, s[16:19], s52 offen offset:1024 nt
    s_mov_b32 s52, 98304
    buffer_load_dwordx4 v[28:31], v238, s[12:15], s52 offen offset:1024 nt
G1_pf0_3:
    s_add_u32 m0, s42, 81920
    s_add_u32 s45, s46, 262144
    buffer_load_dwordx4 v235, s[8:11], s45 offen  lds
    buffer_load_dwordx4 v236, s[8:11], s45 offen offset:1024  lds
    s_add_u32 m0, s42, 90112
    s_add_u32 s45, s46, 262400
    buffer_load_dwordx4 v235, s[8:11], s45 offen  lds
    buffer_load_dwordx4 v236, s[8:11], s45 offen offset:1024  lds
    global_load_dword v219, v242, s[48:49]
    v_mov_b32 v242, 32
    s_mov_b32 m0, s43
    s_mov_b64 exec, 1
    global_load_lds_dword v242, s[48:49]
    s_mov_b64 exec, -1
    s_mov_b32 s59, 262144
G1_fq8:
    ds_read_b32 v248, v240 offset:16
    s_waitcnt lgkmcnt(0)
    v_cmp_lt_u32 s[56:57], v248, 4
    s_nop 0
    s_cmp_eq_u64 s[56:57], 0
    s_cbranch_scc1 G1_fq8_ok
    s_sleep 1
    s_sub_u32 s59, s59, 1
    s_cmp_lg_u32 s59, 0
    s_cbranch_scc1 G1_fq8
G1_fq8_ok:
    s_mov_b32 s46, 2
    s_cmp_eq_u32 s53, 2
    s_cselect_b32 s46, 6, s46
    s_add_u32 s46, s46, s47
    s_and_b32 s46, s46, 15
    s_lshl_b32 s50, s46, 7
    s_add_u32 s51, s50, 64
    s_lshl_b32 s46, s46, 19
    s_cmp_eq_u32 s24, 0
    s_cbranch_scc0 G1_x8s8
    s_mov_b32 m0, 124928
    s_nop 0
    buffer_load_dwordx4 v234, s[4:7], s50 offen  lds
    s_mov_b32 m0, 134144
    s_nop 0
    buffer_load_dwordx4 v234, s[4:7], s51 offen  lds
G1_x8s8:
    s_add_u32 m0, s42, 116736
    s_nop 0
    buffer_load_dwordx4 v232, s[4:7], s50 offen  lds
    buffer_load_dwordx4 v233, s[4:7], s50 offen offset:1024  lds
    s_add_u32 m0, s42, 125952
    s_nop 0
    buffer_load_dwordx4 v232, s[4:7], s51 offen  lds
    buffer_load_dwordx4 v233, s[4:7], s51 offen offset:1024  lds
    global_load_dword v219, v242, s[48:49]
    s_add_u32 m0, s42, 0
    s_add_u32 s45, s46, 0
    buffer_load_dwordx4 v235, s[8:11], s45 offen  lds
    buffer_load_dwordx4 v236, s[8:11], s45 offen offset:1024  lds
    s_add_u32 m0, s42, 8192
    s_add_u32 s45, s46, 256
    buffer_load_dwordx4 v235, s[8:11], s45 offen  lds
    buffer_load_dwordx4 v236, s[8:11], s45 offen offset:1024  lds
    global_load_dword v219, v242, s[48:49]
    v_mov_b32 v242, 36
    s_mov_b32 m0, s43
    s_mov_b64 exec, 1
    global_load_lds_dword v242, s[48:49]
    s_mov_b64 exec, -1
    s_cmp_eq_u32 s53, 0
    s_cbranch_scc0 G1_pf1_0
    s_mov_b32 s52, 81920
    buffer_load_dwordx4 v[32:35], v237, s[16:19], s52 offen offset:0 nt
    s_mov_b32 s52, 114688
    buffer_load_dwordx4 v[36:39], v237, s[12:15], s52 offen offset:0 nt
    s_mov_b32 s52, 114688
    buffer_load_dwordx4 v[40:43], v238, s[12:15], s52 offen offset:3072 nt
    s_mov_b32 s52, 98304
    buffer_load_dwordx4 v[44:47], v237, s[16:19], s52 offen offset:2048 nt
    s_mov_b32 s52, 131072
    buffer_load_dwordx4 v[48:51], v237, s[12:15], s52 offen offset:2048 nt
    s_mov_b32 s52, 114688
    buffer_load_dwordx4 v[52:55], v238, s[16:19], s52 offen offset:1024 nt
    s_mov_b32 s52, 147456
    buffer_load_dwordx4 v[56:59], v237, s[12:15], s52 offen offset:0 nt
    s_mov_b32 s52, 131072
    buffer_load_dwordx4 v[60:63], v237, s[16:19], s52 offen offset:0 nt
G1_pf1_0:
    s_add_u32 m0, s42, 16384
    s_add_u32 s45, s46, 262144
    buffer_load_dwordx4 v235, s[8:11], s45 offen  lds
    buffer_load_dwordx4 v236, s[8:11], s45 offen offset:1024  lds
    s_add_u32 m0, s42, 24576
    s_add_u32 s45, s46, 262400
    buffer_load_dwordx4 v235, s[8:11], s45 offen  lds
    buffer_load_dwordx4 v236, s[8:11], s45 offen offset:1024  lds
    global_load_dword v219, v242, s[48:49]
    v_mov_b32 v242, 40
    s_mov_b32 m0, s43
    s_mov_b64 exec, 1
    global_load_lds_dword v242, s[48:49]
    s_mov_b64 exec, -1
    s_cmp_eq_u32 s53, 1
    s_cbranch_scc0 G1_pf1_1
    s_mov_b32 s52, 81920
    buffer_load_dwordx4 v[32:35], v237, s[16:19], s52 offen offset:0 nt
    s_mov_b32 s52, 114688
    buffer_load_dwordx4 v[36:39], v237, s[12:15], s52 offen offset:0 nt
    s_mov_b32 s52, 114688
    buffer_load_dwordx4 v[40:43], v238, s[12:15], s52 offen offset:3072 nt
    s_mov_b32 s52, 98304
    buffer_load_dwordx4 v[44:47], v237, s[16:19], s52 offen offset:2048 nt
    s_mov_b32 s52, 131072
    buffer_load_dwordx4 v[48:51], v237, s[12:15], s52 offen offset:2048 nt
    s_mov_b32 s52, 114688
    buffer_load_dwordx4 v[52:55], v238, s[16:19], s52 offen offset:1024 nt
    s_mov_b32 s52, 147456
    buffer_load_dwordx4 v[56:59], v237, s[12:15], s52 offen offset:0 nt
    s_mov_b32 s52, 131072
    buffer_load_dwordx4 v[60:63], v237, s[16:19], s52 offen offset:0 nt
G1_pf1_1:
    s_mov_b32 s59, 262144
G1_fq10:
    ds_read_b32 v248, v240 offset:16
    s_waitcnt lgkmcnt(0)
    v_cmp_lt_u32 s[56:57], v248, 6
    s_nop 0
    s_cmp_eq_u64 s[56:57], 0
    s_cbranch_scc1 G1_fq10_ok
    s_sleep 1
    s_sub_u32 s59, s59, 1
    s_cmp_lg_u32 s59, 0
    s_cbranch_scc1 G1_fq10
G1_fq10_ok:
    s_mov_b32 s46, 3
    s_cmp_eq_u32 s53, 3
    s_cselect_b32 s46, 7, s46
    s_add_u32 s46, s46, s47
    s_and_b32 s46, s46, 15
    s_lshl_b32 s50, s46, 7
    s_add_u32 s51, s50, 64
    s_lshl_b32 s46, s46, 19
    s_cmp_eq_u32 s24, 1
    s_cbranch_scc0 G1_x8s10
    s_mov_b32 m0, 143360
    s_nop 0
    buffer_load_dwordx4 v234, s[4:7], s50 offen  lds
    s_mov_b32 m0, 152576
    s_nop 0
    buffer_load_dwordx4 v234, s[4:7], s51 offen  lds
G1_x8s10:
    s_add_u32 m0, s42, 135168
    s_nop 0
    buffer_load_dwordx4 v232, s[4:7], s50 offen  lds
    buffer_load_dwordx4 v233, s[4:7], s50 offen offset:1024  lds
    s_add_u32 m0, s42, 144384
    s_nop 0
    buffer_load_dwordx4 v232, s[4:7], s51 offen  lds
    buffer_load_dwordx4 v233, s[4:7], s51 offen offset:1024  lds
    global_load_dword v219, v242, s[48:49]
    s_add_u32 m0, s42, 49152
    s_add_u32 s45, s46, 0
    buffer_load_dwordx4 v235, s[8:11], s45 offen  lds
    buffer_load_dwordx4 v236, s[8:11], s45 offen offset:1024  lds
    s_add_u32 m0, s42, 57344
    s_add_u32 s45, s46, 256
    buffer_load_dwordx4 v235, s[8:11], s45 offen  lds
    buffer_load_dwordx4 v236, s[8:11], s45 offen offset:1024  lds
    global_load_dword v219, v242, s[48:49]
    v_mov_b32 v242, 44
    s_mov_b32 m0, s43
    s_mov_b64 exec, 1
    global_load_lds_dword v242, s[48:49]
    s_mov_b64 exec, -1
    s_cmp_eq_u32 s53, 2
    s_cbranch_scc0 G1_pf1_2
    s_mov_b32 s52, 81920
    buffer_load_dwordx4 v[32:35], v237, s[16:19], s52 offen offset:0 nt
    s_mov_b32 s52, 114688
    buffer_load_dwordx4 v[36:39], v237, s[12:15], s52 offen offset:0 nt
    s_mov_b32 s52, 114688
    buffer_load_dwordx4 v[40:43], v238, s[12:15], s52 offen offset:3072 nt
    s_mov_b32 s52, 98304
    buffer_load_dwordx4 v[44:47], v237, s[16:19], s52 offen offset:2048 nt
    s_mov_b32 s52, 131072
    buffer_load_dwordx4 v[48:51], v237, s[12:15], s52 offen offset:2048 nt
    s_mov_b32 s52, 114688
    buffer_load_dwordx4 v[52:55], v238, s[16:19], s52 offen offset:1024 nt
    s_mov_b32 s52, 147456
    buffer_load_dwordx4 v[56:59], v237, s[12:15], s52 offen offset:0 nt
    s_mov_b32 s52, 131072
    buffer_load_dwordx4 v[60:63], v237, s[16:19], s52 offen offset:0 nt
G1_pf1_2:
    s_add_u32 m0, s42, 32768
    s_add_u32 s45, s46, 262144
    buffer_load_dwordx4 v235, s[8:11], s45 offen  lds
    buffer_load_dwordx4 v236, s[8:11], s45 offen offset:1024  lds
    s_add_u32 m0, s42, 40960
    s_add_u32 s45, s46, 262400
    buffer_load_dwordx4 v235, s[8:11], s45 offen  lds
    buffer_load_dwordx4 v236, s[8:11], s45 offen offset:1024  lds
    global_load_dword v219, v242, s[48:49]
    v_mov_b32 v242, 48
    s_mov_b32 m0, s43
    s_mov_b64 exec, 1
    global_load_lds_dword v242, s[48:49]
    s_mov_b64 exec, -1
    s_mov_b32 s59, 262144
G1_fq12:
    ds_read_b32 v248, v240 offset:16
    s_waitcnt lgkmcnt(0)
    v_cmp_lt_u32 s[56:57], v248, 8
    s_nop 0
    s_cmp_eq_u64 s[56:57], 0
    s_cbranch_scc1 G1_fq12_ok
    s_sleep 1
    s_sub_u32 s59, s59, 1
    s_cmp_lg_u32 s59, 0
    s_cbranch_scc1 G1_fq12
G1_fq12_ok:
    s_mov_b32 s46, 8
    s_cmp_eq_u32 s53, 1
    s_cselect_b32 s46, 4, s46
    s_cmp_eq_u32 s53, 2
    s_cselect_b32 s46, 4, s46
    s_cmp_eq_u32 s53, 3
    s_cselect_b32 s46, 4, s46
    s_add_u32 s46, s46, s47
    s_and_b32 s46, s46, 15
    s_lshl_b32 s50, s46, 7
    s_add_u32 s51, s50, 64
    s_lshl_b32 s46, s46, 19
    s_cmp_eq_u32 s24, 2
    s_cbranch_scc0 G1_x8s12
    s_mov_b32 m0, 106496
    s_nop 0
    buffer_load_dwordx4 v234, s[4:7], s50 offen  lds
    s_mov_b32 m0, 115712
    s_nop 0
    buffer_load_dwordx4 v234, s[4:7], s51 offen  lds
G1_x8s12:
    s_add_u32 m0, s42, 98304
    s_nop 0
    buffer_load_dwordx4 v232, s[4:7], s50 offen  lds
    buffer_load_dwordx4 v233, s[4:7], s50 offen offset:1024  lds
    s_add_u32 m0, s42, 107520
    s_nop 0
    buffer_load_dwordx4 v232, s[4:7], s51 offen  lds
    buffer_load_dwordx4 v233, s[4:7], s51 offen offset:1024  lds
    global_load_dword v219, v242, s[48:49]
    s_add_u32 m0, s42, 65536
    s_add_u32 s45, s46, 0
    buffer_load_dwordx4 v235, s[8:11], s45 offen  lds
    buffer_load_dwordx4 v236, s[8:11], s45 offen offset:1024  lds
    s_add_u32 m0, s42, 73728
    s_add_u32 s45, s46, 256
    buffer_load_dwordx4 v235, s[8:11], s45 offen  lds
    buffer_load_dwordx4 v236, s[8:11], s45 offen offset:1024  lds
    global_load_dword v219, v242, s[48:49]
    v_mov_b32 v242, 52
    s_mov_b32 m0, s43
    s_mov_b64 exec, 1
    global_load_lds_dword v242, s[48:49]
    s_mov_b64 exec, -1
    s_cmp_eq_u32 s53, 3
    s_cbranch_scc0 G1_pf1_3
    s_mov_b32 s52, 81920
    buffer_load_dwordx4 v[32:35], v237, s[16:19], s52 offen offset:0 nt
    s_mov_b32 s52, 114688
    buffer_load_dwordx4 v[36:39], v237, s[12:15], s52 offen offset:0 nt
    s_mov_b32 s52, 114688
    buffer_load_dwordx4 v[40:43], v238, s[12:15], s52 offen offset:3072 nt
    s_mov_b32 s52, 98304
    buffer_load_dwordx4 v[44:47], v237, s[16:19], s52 offen offset:2048 nt
    s_mov_b32 s52, 131072
    buffer_load_dwordx4 v[48:51], v237, s[12:15], s52 offen offset:2048 nt
    s_mov_b32 s52, 114688
    buffer_load_dwordx4 v[52:55], v238, s[16:19], s52 offen offset:1024 nt
    s_mov_b32 s52, 147456
    buffer_load_dwordx4 v[56:59], v237, s[12:15], s52 offen offset:0 nt
    s_mov_b32 s52, 131072
    buffer_load_dwordx4 v[60:63], v237, s[16:19], s52 offen offset:0 nt
G1_pf1_3:
    s_add_u32 m0, s42, 81920
    s_add_u32 s45, s46, 262144
    buffer_load_dwordx4 v235, s[8:11], s45 offen  lds
    buffer_load_dwordx4 v236, s[8:11], s45 offen offset:1024  lds
    s_add_u32 m0, s42, 90112
    s_add_u32 s45, s46, 262400
    buffer_load_dwordx4 v235, s[8:11], s45 offen  lds
    buffer_load_dwordx4 v236, s[8:11], s45 offen offset:1024  lds
    global_load_dword v219, v242, s[48:49]
    v_mov_b32 v242, 56
    s_mov_b32 m0, s43
    s_mov_b64 exec, 1
    global_load_lds_dword v242, s[48:49]
    s_mov_b64 exec, -1
    s_mov_b32 s59, 262144
G1_fq14:
    ds_read_b32 v248, v240 offset:16
    s_waitcnt lgkmcnt(0)
    v_cmp_lt_u32 s[56:57], v248, 10
    s_nop 0
    s_cmp_eq_u64 s[56:57], 0
    s_cbranch_scc1 G1_fq14_ok
    s_sleep 1
    s_sub_u32 s59, s59, 1
    s_cmp_lg_u32 s59, 0
    s_cbranch_scc1 G1_fq14
G1_fq14_ok:
    s_mov_b32 s46, 5
    s_cmp_eq_u32 s53, 1
    s_cselect_b32 s46, 9, s46
    s_add_u32 s46, s46, s47
    s_and_b32 s46, s46, 15
    s_lshl_b32 s50, s46, 7
    s_add_u32 s51, s50, 64
    s_lshl_b32 s46, s46, 19
    s_cmp_eq_u32 s24, 3
    s_cbranch_scc0 G1_x8s14
    s_mov_b32 m0, 124928
    s_nop 0
    buffer_load_dwordx4 v234, s[4:7], s50 offen  lds
    s_mov_b32 m0, 134144
    s_nop 0
    buffer_load_dwordx4 v234, s[4:7], s51 offen  lds
G1_x8s14:
    s_add_u32 m0, s42, 116736
    s_nop 0
    buffer_load_dwordx4 v232, s[4:7], s50 offen  lds
    buffer_load_dwordx4 v233, s[4:7], s50 offen offset:1024  lds
    s_add_u32 m0, s42, 125952
    s_nop 0
    buffer_load_dwordx4 v232, s[4:7], s51 offen  lds
    buffer_load_dwordx4 v233, s[4:7], s51 offen offset:1024  lds
    global_load_dword v219, v242, s[48:49]
    s_add_u32 m0, s42, 0
    s_add_u32 s45, s46, 0
    buffer_load_dwordx4 v235, s[8:11], s45 offen  lds
    buffer_load_dwordx4 v236, s[8:11], s45 offen offset:1024  lds
    s_add_u32 m0, s42, 8192
    s_add_u32 s45, s46, 256
    buffer_load_dwordx4 v235, s[8:11], s45 offen  lds
    buffer_load_dwordx4 v236, s[8:11], s45 offen offset:1024  lds
    global_load_dword v219, v242, s[48:49]
    v_mov_b32 v242, 60
    s_mov_b32 m0, s43
    s_mov_b64 exec, 1
    global_load_lds_dword v242, s[48:49]
    s_mov_b64 exec, -1
    s_cmp_eq_u32 s53, 0
    s_cbranch_scc0 G1_pf2_0
    s_mov_b32 s52, 131072
    buffer_load_dwordx4 v[64:67], v238, s[16:19], s52 offen offset:3072 nt
    s_mov_b32 s52, 163840
    buffer_load_dwordx4 v[68:71], v238, s[12:15], s52 offen offset:3072 nt
    s_mov_b32 s52, 147456
    buffer_load_dwordx4 v[72:75], v237, s[16:19], s52 offen offset:2048 nt
    s_mov_b32 s52, 180224
    buffer_load_dwordx4 v[76:79], v238, s[12:15], s52 offen offset:1024 nt
    s_mov_b32 s52, 163840
    buffer_load_dwordx4 v[80:83], v238, s[16:19], s52 offen offset:1024 nt
    s_mov_b32 s52, 196608
    buffer_load_dwordx4 v[84:87], v237, s[12:15], s52 offen offset:0 nt
    s_mov_b32 s52, 196608
    buffer_load_dwordx4 v[88:91], v238, s[12:15], s52 offen offset:3072 nt
    s_mov_b32 s52, 180224
    buffer_load_dwordx4 v[92:95], v238, s[16:19], s52 offen offset:3072 nt
G1_pf2_0:
    s_add_u32 m0, s42, 16384
    s_add_u32 s45, s46, 262144
    buffer_load_dwordx4 v235, s[8:11], s45 offen  lds
    buffer_load_dwordx4 v236, s[8:11], s45 offen offset:1024  lds
    s_add_u32 m0, s42, 24576
    s_add_u32 s45, s46, 262400
    buffer_load_dwordx4 v235, s[8:11], s45 offen  lds
    buffer_load_dwordx4 v236, s[8:11], s45 offen offset:1024  lds
    global_load_dword v219, v242, s[48:49]
    v_mov_b32 v242, 64
    s_mov_b32 m0, s43
    s_mov_b64 exec, 1
    global_load_lds_dword v242, s[48:49]
    s_mov_b64 exec, -1
    s_cmp_eq_u32 s53, 1
    s_cbranch_scc0 G1_pf2_1
    s_mov_b32 s52, 131072
    buffer_load_dwordx4 v[64:67], v238, s[16:19], s52 offen offset:3072 nt
    s_mov_b32 s52, 163840
    buffer_load_dwordx4 v[68:71], v238, s[12:15], s52 offen offset:3072 nt
    s_mov_b32 s52, 147456
    buffer_load_dwordx4 v[72:75], v237, s[16:19], s52 offen offset:2048 nt
    s_mov_b32 s52, 180224
    buffer_load_dwordx4 v[76:79], v238, s[12:15], s52 offen offset:1024 nt
    s_mov_b32 s52, 163840
    buffer_load_dwordx4 v[80:83], v238, s[16:19], s52 offen offset:1024 nt
    s_mov_b32 s52, 196608
    buffer_load_dwordx4 v[84:87], v237, s[12:15], s52 offen offset:0 nt
    s_mov_b32 s52, 196608
    buffer_load_dwordx4 v[88:91], v238, s[12:15], s52 offen offset:3072 nt
    s_mov_b32 s52, 180224
    buffer_load_dwordx4 v[92:95], v238, s[16:19], s52 offen offset:3072 nt
G1_pf2_1:
    s_mov_b32 s59, 262144
G1_fq16:
    ds_read_b32 v248, v240 offset:16
    s_waitcnt lgkmcnt(0)
    v_cmp_lt_u32 s[56:57], v248, 12
    s_nop 0
    s_cmp_eq_u64 s[56:57], 0
    s_cbranch_scc1 G1_fq16_ok
    s_sleep 1
    s_sub_u32 s59, s59, 1
    s_cmp_lg_u32 s59, 0
    s_cbranch_scc1 G1_fq16
G1_fq16_ok:
    s_mov_b32 s46, 6
    s_cmp_eq_u32 s53, 2
    s_cselect_b32 s46, 10, s46
    s_add_u32 s46, s46, s47
    s_and_b32 s46, s46, 15
    s_lshl_b32 s50, s46, 7
    s_add_u32 s51, s50, 64
    s_lshl_b32 s46, s46, 19
    s_cmp_eq_u32 s24, 0
    s_cbranch_scc0 G1_x8s16
    s_mov_b32 m0, 143360
    s_nop 0
    buffer_load_dwordx4 v234, s[4:7], s50 offen  lds
    s_mov_b32 m0, 152576
    s_nop 0
    buffer_load_dwordx4 v234, s[4:7], s51 offen  lds
G1_x8s16:
    s_add_u32 m0, s42, 135168
    s_nop 0
    buffer_load_dwordx4 v232, s[4:7], s50 offen  lds
    buffer_load_dwordx4 v233, s[4:7], s50 offen offset:1024  lds
    s_add_u32 m0, s42, 144384
    s_nop 0
    buffer_load_dwordx4 v232, s[4:7], s51 offen  lds
    buffer_load_dwordx4 v233, s[4:7], s51 offen offset:1024  lds
    global_load_dword v219, v242, s[48:49]
    s_add_u32 m0, s42, 49152
    s_add_u32 s45, s46, 0
    buffer_load_dwordx4 v235, s[8:11], s45 offen  lds
    buffer_load_dwordx4 v236, s[8:11], s45 offen offset:1024  lds
    s_add_u32 m0, s42, 57344
    s_add_u32 s45, s46, 256
    buffer_load_dwordx4 v235, s[8:11], s45 offen  lds
    buffer_load_dwordx4 v236, s[8:11], s45 offen offset:1024  lds
    global_load_dword v219, v242, s[48:49]
    v_mov_b32 v242, 68
    s_mov_b32 m0, s43
    s_mov_b64 exec, 1
    global_load_lds_dword v242, s[48:49]
    s_mov_b64 exec, -1
    s_cmp_eq_u32 s53, 2
    s_cbranch_scc0 G1_pf2_2
    s_mov_b32 s52, 131072
    buffer_load_dwordx4 v[64:67], v238, s[16:19], s52 offen offset:3072 nt
    s_mov_b32 s52, 163840
    buffer_load_dwordx4 v[68:71], v238, s[12:15], s52 offen offset:3072 nt
    s_mov_b32 s52, 147456
    buffer_load_dwordx4 v[72:75], v237, s[16:19], s52 offen offset:2048 nt
    s_mov_b32 s52, 180224
    buffer_load_dwordx4 v[76:79], v238, s[12:15], s52 offen offset:1024 nt
    s_mov_b32 s52, 163840
    buffer_load_dwordx4 v[80:83], v238, s[16:19], s52 offen offset:1024 nt
    s_mov_b32 s52, 196608
    buffer_load_dwordx4 v[84:87], v237, s[12:15], s52 offen offset:0 nt
    s_mov_b32 s52, 196608
    buffer_load_dwordx4 v[88:91], v238, s[12:15], s52 offen offset:3072 nt
    s_mov_b32 s52, 180224
    buffer_load_dwordx4 v[92:95], v238, s[16:19], s52 offen offset:3072 nt
G1_pf2_2:
    s_add_u32 m0, s42, 32768
    s_add_u32 s45, s46, 262144
    buffer_load_dwordx4 v235, s[8:11], s45 offen  lds
    buffer_load_dwordx4 v236, s[8:11], s45 offen offset:1024  lds
    s_add_u32 m0, s42, 40960
    s_add_u32 s45, s46, 262400
    buffer_load_dwordx4 v235, s[8:11], s45 offen  lds
    buffer_load_dwordx4 v236, s[8:11], s45 offen offset:1024  lds
    global_load_dword v219, v242, s[48:49]
    v_mov_b32 v242, 72
    s_mov_b32 m0, s43
    s_mov_b64 exec, 1
    global_load_lds_dword v242, s[48:49]
    s_mov_b64 exec, -1
    s_mov_b32 s59, 262144
G1_fq18:
    ds_read_b32 v248, v240 offset:16
    s_waitcnt lgkmcnt(0)
    v_cmp_lt_u32 s[56:57], v248, 14
    s_nop 0
    s_cmp_eq_u64 s[56:57], 0
    s_cbranch_scc1 G1_fq18_ok
    s_sleep 1
    s_sub_u32 s59, s59, 1
    s_cmp_lg_u32 s59, 0
    s_cbranch_scc1 G1_fq18
G1_fq18_ok:
    s_mov_b32 s46, 7
    s_cmp_eq_u32 s53, 3
    s_cselect_b32 s46, 11, s46
    s_add_u32 s46, s46, s47
    s_and_b32 s46, s46, 15
    s_lshl_b32 s50, s46, 7
    s_add_u32 s51, s50, 64
    s_lshl_b32 s46, s46, 19
    s_cmp_eq_u32 s24, 1
    s_cbranch_scc0 G1_x8s18
    s_mov_b32 m0, 106496
    s_nop 0
    buffer_load_dwordx4 v234, s[4:7], s50 offen  lds
    s_mov_b32 m0, 115712
    s_nop 0
    buffer_load_dwordx4 v234, s[4:7], s51 offen  lds
G1_x8s18:
    s_add_u32 m0, s42, 98304
    s_nop 0
    buffer_load_dwordx4 v232, s[4:7], s50 offen  lds
    buffer_load_dwordx4 v233, s[4:7], s50 offen offset:1024  lds
    s_add_u32 m0, s42, 107520
    s_nop 0
    buffer_load_dwordx4 v232, s[4:7], s51 offen  lds
    buffer_load_dwordx4 v233, s[4:7], s51 offen offset:1024  lds
    global_load_dword v219, v242, s[48:49]
    s_add_u32 m0, s42, 65536
    s_add_u32 s45, s46, 0
    buffer_load_dwordx4 v235, s[8:11], s45 offen  lds
    buffer_load_dwordx4 v236, s[8:11], s45 offen offset:1024  lds
    s_add_u32 m0, s42, 73728
    s_add_u32 s45, s46, 256
    buffer_load_dwordx4 v235, s[8:11], s45 offen  lds
    buffer_load_dwordx4 v236, s[8:11], s45 offen offset:1024  lds
    global_load_dword v219, v242, s[48:49]
    v_mov_b32 v242, 76
    s_mov_b32 m0, s43
    s_mov_b64 exec, 1
    global_load_lds_dword v242, s[48:49]
    s_mov_b64 exec, -1
    s_cmp_eq_u32 s53, 3
    s_cbranch_scc0 G1_pf2_3
    s_mov_b32 s52, 131072
    buffer_load_dwordx4 v[64:67], v238, s[16:19], s52 offen offset:3072 nt
    s_mov_b32 s52, 163840
    buffer_load_dwordx4 v[68:71], v238, s[12:15], s52 offen offset:3072 nt
    s_mov_b32 s52, 147456
    buffer_load_dwordx4 v[72:75], v237, s[16:19], s52 offen offset:2048 nt
    s_mov_b32 s52, 180224
    buffer_load_dwordx4 v[76:79], v238, s[12:15], s52 offen offset:1024 nt
    s_mov_b32 s52, 163840
    buffer_load_dwordx4 v[80:83], v238, s[16:19], s52 offen offset:1024 nt
    s_mov_b32 s52, 196608
    buffer_load_dwordx4 v[84:87], v237, s[12:15], s52 offen offset:0 nt
    s_mov_b32 s52, 196608
    buffer_load_dwordx4 v[88:91], v238, s[12:15], s52 offen offset:3072 nt
    s_mov_b32 s52, 180224
    buffer_load_dwordx4 v[92:95], v238, s[16:19], s52 offen offset:3072 nt
G1_pf2_3:
    s_add_u32 m0, s42, 81920
    s_add_u32 s45, s46, 262144
    buffer_load_dwordx4 v235, s[8:11], s45 offen  lds
    buffer_load_dwordx4 v236, s[8:11], s45 offen offset:1024  lds
    s_add_u32 m0, s42, 90112
    s_add_u32 s45, s46, 262400
    buffer_load_dwordx4 v235, s[8:11], s45 offen  lds
    buffer_load_dwordx4 v236, s[8:11], s45 offen offset:1024  lds
    global_load_dword v219, v242, s[48:49]
    v_mov_b32 v242, 80
    s_mov_b32 m0, s43
    s_mov_b64 exec, 1
    global_load_lds_dword v242, s[48:49]
    s_mov_b64 exec, -1
    s_mov_b32 s59, 262144
G1_fq20:
    ds_read_b32 v248, v240 offset:16
    s_waitcnt lgkmcnt(0)
    v_cmp_lt_u32 s[56:57], v248, 16
    s_nop 0
    s_cmp_eq_u64 s[56:57], 0
    s_cbranch_scc1 G1_fq20_ok
    s_sleep 1
    s_sub_u32 s59, s59, 1
    s_cmp_lg_u32 s59, 0
    s_cbranch_scc1 G1_fq20
G1_fq20_ok:
    s_mov_b32 s46, 12
    s_cmp_eq_u32 s53, 1
    s_cselect_b32 s46, 8, s46
    s_cmp_eq_u32 s53, 2
    s_cselect_b32 s46, 8, s46
    s_cmp_eq_u32 s53, 3
    s_cselect_b32 s46, 8, s46
    s_add_u32 s46, s46, s47
    s_and_b32 s46, s46, 15
    s_lshl_b32 s50, s46, 7
    s_add_u32 s51, s50, 64
    s_lshl_b32 s46, s46, 19
    s_cmp_eq_u32 s24, 2
    s_cbranch_scc0 G1_x8s20
    s_mov_b32 m0, 124928
    s_nop 0
    buffer_load_dwordx4 v234, s[4:7], s50 offen  lds
    s_mov_b32 m0, 134144
    s_nop 0
    buffer_load_dwordx4 v234, s[4:7], s51 offen  lds
G1_x8s20:
    s_add_u32 m0, s42, 116736
    s_nop 0
    buffer_load_dwordx4 v232, s[4:7], s50 offen  lds
    buffer_load_dwordx4 v233, s[4:7], s50 offen offset:1024  lds
    s_add_u32 m0, s42, 125952
    s_nop 0
    buffer_load_dwordx4 v232, s[4:7], s51 offen  lds
    buffer_load_dwordx4 v233, s[4:7], s51 offen offset:1024  lds
    global_load_dword v219, v242, s[48:49]
    s_add_u32 m0, s42, 0
    s_add_u32 s45, s46, 0
    buffer_load_dwordx4 v235, s[8:11], s45 offen  lds
    buffer_load_dwordx4 v236, s[8:11], s45 offen offset:1024  lds
    s_add_u32 m0, s42, 8192
    s_add_u32 s45, s46, 256
    buffer_load_dwordx4 v235, s[8:11], s45 offen  lds
    buffer_load_dwordx4 v236, s[8:11], s45 offen offset:1024  lds
    global_load_dword v219, v242, s[48:49]
    v_mov_b32 v242, 84
    s_mov_b32 m0, s43
    s_mov_b64 exec, 1
    global_load_lds_dword v242, s[48:49]
    s_mov_b64 exec, -1
    s_cmp_eq_u32 s53, 0
    s_cbranch_scc0 G1_pf3_0
    s_mov_b32 s52, 212992
    buffer_load_dwordx4 v[96:99], v237, s[12:15], s52 offen offset:2048 nt
    s_mov_b32 s52, 196608
    buffer_load_dwordx4 v[100:103], v237, s[16:19], s52 offen offset:2048 nt
    s_mov_b32 s52, 229376
    buffer_load_dwordx4 v[104:107], v238, s[12:15], s52 offen offset:1024 nt
    s_mov_b32 s52, 212992
    buffer_load_dwordx4 v[108:111], v237, s[16:19], s52 offen offset:0 nt
    s_mov_b32 s52, 245760
    buffer_load_dwordx4 v[112:115], v237, s[12:15], s52 offen offset:0 nt
    s_mov_b32 s52, 245760
    buffer_load_dwordx4 v[116:119], v238, s[12:15], s52 offen offset:3072 nt
    s_mov_b32 s52, 229376
    buffer_load_dwordx4 v[120:123], v237, s[16:19], s52 offen offset:2048 nt
    s_mov_b32 s52, 245760
    buffer_load_dwordx4 v[124:127], v237, s[16:19], s52 offen offset:2048 nt
G1_pf3_0:
    s_add_u32 m0, s42, 16384
    s_add_u32 s45, s46, 262144
    buffer_load_dwordx4 v235, s[8:11], s45 offen  lds
    buffer_load_dwordx4 v236, s[8:11], s45 offen offset:1024  lds
    s_add_u32 m0, s42, 24576
    s_add_u32 s45, s46, 262400
    buffer_load_dwordx4 v235, s[8:11], s45 offen  lds
    buffer_load_dwordx4 v236, s[8:11], s45 offen offset:1024  lds
    global_load_dword v219, v242, s[48:49]
    v_mov_b32 v242, 88
    s_mov_b32 m0, s43
    s_mov_b64 exec, 1
    global_load_lds_dword v242, s[48:49]
    s_mov_b64 exec, -1
    s_cmp_eq_u32 s53, 1
    s_cbranch_scc0 G1_pf3_1
    s_mov_b32 s52, 212992
    buffer_load_dwordx4 v[96:99], v237, s[12:15], s52 offen offset:2048 nt
    s_mov_b32 s52, 196608
    buffer_load_dwordx4 v[100:103], v237, s[16:19], s52 offen offset:2048 nt
    s_mov_b32 s52, 229376
    buffer_load_dwordx4 v[104:107], v238, s[12:15], s52 offen offset:1024 nt
    s_mov_b32 s52, 212992
    buffer_load_dwordx4 v[108:111], v237, s[16:19], s52 offen offset:0 nt
    s_mov_b32 s52, 245760
    buffer_load_dwordx4 v[112:115], v237, s[12:15], s52 offen offset:0 nt
    s_mov_b32 s52, 245760
    buffer_load_dwordx4 v[116:119], v238, s[12:15], s52 offen offset:3072 nt
    s_mov_b32 s52, 229376
    buffer_load_dwordx4 v[120:123], v237, s[16:19], s52 offen offset:2048 nt
    s_mov_b32 s52, 245760
    buffer_load_dwordx4 v[124:127], v237, s[16:19], s52 offen offset:2048 nt
G1_pf3_1:
    s_mov_b32 s59, 262144
G1_fq22:
    ds_read_b32 v248, v240 offset:16
    s_waitcnt lgkmcnt(0)
    v_cmp_lt_u32 s[56:57], v248, 18
    s_nop 0
    s_cmp_eq_u64 s[56:57], 0
    s_cbranch_scc1 G1_fq22_ok
    s_sleep 1
    s_sub_u32 s59, s59, 1
    s_cmp_lg_u32 s59, 0
    s_cbranch_scc1 G1_fq22
G1_fq22_ok:
    s_mov_b32 s46, 9
    s_cmp_eq_u32 s53, 1
    s_cselect_b32 s46, 13, s46
    s_add_u32 s46, s46, s47
    s_and_b32 s46, s46, 15
    s_lshl_b32 s50, s46, 7
    s_add_u32 s51, s50, 64
    s_lshl_b32 s46, s46, 19
    s_cmp_eq_u32 s24, 3
    s_cbranch_scc0 G1_x8s22
    s_mov_b32 m0, 143360
    s_nop 0
    buffer_load_dwordx4 v234, s[4:7], s50 offen  lds
    s_mov_b32 m0, 152576
    s_nop 0
    buffer_load_dwordx4 v234, s[4:7], s51 offen  lds
G1_x8s22:
    s_add_u32 m0, s42, 135168
    s_nop 0
    buffer_load_dwordx4 v232, s[4:7], s50 offen  lds
    buffer_load_dwordx4 v233, s[4:7], s50 offen offset:1024  lds
    s_add_u32 m0, s42, 144384
    s_nop 0
    buffer_load_dwordx4 v232, s[4:7], s51 offen  lds
    buffer_load_dwordx4 v233, s[4:7], s51 offen offset:1024  lds
    global_load_dword v219, v242, s[48:49]
    s_add_u32 m0, s42, 49152
    s_add_u32 s45, s46, 0
    buffer_load_dwordx4 v235, s[8:11], s45 offen  lds
    buffer_load_dwordx4 v236, s[8:11], s45 offen offset:1024  lds
    s_add_u32 m0, s42, 57344
    s_add_u32 s45, s46, 256
    buffer_load_dwordx4 v235, s[8:11], s45 offen  lds
    buffer_load_dwordx4 v236, s[8:11], s45 offen offset:1024  lds
    global_load_dword v219, v242, s[48:49]
    v_mov_b32 v242, 92
    s_mov_b32 m0, s43
    s_mov_b64 exec, 1
    global_load_lds_dword v242, s[48:49]
    s_mov_b64 exec, -1
    s_cmp_eq_u32 s53, 2
    s_cbranch_scc0 G1_pf3_2
    s_mov_b32 s52, 212992
    buffer_load_dwordx4 v[96:99], v237, s[12:15], s52 offen offset:2048 nt
    s_mov_b32 s52, 196608
    buffer_load_dwordx4 v[100:103], v237, s[16:19], s52 offen offset:2048 nt
    s_mov_b32 s52, 229376
    buffer_load_dwordx4 v[104:107], v238, s[12:15], s52 offen offset:1024 nt
    s_mov_b32 s52, 212992
    buffer_load_dwordx4 v[108:111], v237, s[16:19], s52 offen offset:0 nt
    s_mov_b32 s52, 245760
    buffer_load_dwordx4 v[112:115], v237, s[12:15], s52 offen offset:0 nt
    s_mov_b32 s52, 245760
    buffer_load_dwordx4 v[116:119], v238, s[12:15], s52 offen offset:3072 nt
    s_mov_b32 s52, 229376
    buffer_load_dwordx4 v[120:123], v237, s[16:19], s52 offen offset:2048 nt
    s_mov_b32 s52, 245760
    buffer_load_dwordx4 v[124:127], v237, s[16:19], s52 offen offset:2048 nt
G1_pf3_2:
    s_add_u32 m0, s42, 32768
    s_add_u32 s45, s46, 262144
    buffer_load_dwordx4 v235, s[8:11], s45 offen  lds
    buffer_load_dwordx4 v236, s[8:11], s45 offen offset:1024  lds
    s_add_u32 m0, s42, 40960
    s_add_u32 s45, s46, 262400
    buffer_load_dwordx4 v235, s[8:11], s45 offen  lds
    buffer_load_dwordx4 v236, s[8:11], s45 offen offset:1024  lds
    global_load_dword v219, v242, s[48:49]
    v_mov_b32 v242, 96
    s_mov_b32 m0, s43
    s_mov_b64 exec, 1
    global_load_lds_dword v242, s[48:49]
    s_mov_b64 exec, -1
    s_mov_b32 s59, 262144
G1_fq24:
    ds_read_b32 v248, v240 offset:16
    s_waitcnt lgkmcnt(0)
    v_cmp_lt_u32 s[56:57], v248, 20
    s_nop 0
    s_cmp_eq_u64 s[56:57], 0
    s_cbranch_scc1 G1_fq24_ok
    s_sleep 1
    s_sub_u32 s59, s59, 1
    s_cmp_lg_u32 s59, 0
    s_cbranch_scc1 G1_fq24
G1_fq24_ok:
    s_mov_b32 s46, 10
    s_cmp_eq_u32 s53, 2
    s_cselect_b32 s46, 14, s46
    s_add_u32 s46, s46, s47
    s_and_b32 s46, s46, 15
    s_lshl_b32 s50, s46, 7
    s_add_u32 s51, s50, 64
    s_lshl_b32 s46, s46, 19
    s_cmp_eq_u32 s24, 0
    s_cbranch_scc0 G1_x8s24
    s_mov_b32 m0, 106496
    s_nop 0
    buffer_load_dwordx4 v234, s[4:7], s50 offen  lds
    s_mov_b32 m0, 115712
    s_nop 0
    buffer_load_dwordx4 v234, s[4:7], s51 offen  lds
G1_x8s24:
    s_add_u32 m0, s42, 98304
    s_nop 0
    buffer_load_dwordx4 v232, s[4:7], s50 offen  lds
    buffer_load_dwordx4 v233, s[4:7], s50 offen offset:1024  lds
    s_add_u32 m0, s42, 107520
    s_nop 0
    buffer_load_dwordx4 v232, s[4:7], s51 offen  lds
    buffer_load_dwordx4 v233, s[4:7], s51 offen offset:1024  lds
    global_load_dword v219, v242, s[48:49]
    s_add_u32 m0, s42, 65536
    s_add_u32 s45, s46, 0
    buffer_load_dwordx4 v235, s[8:11], s45 offen  lds
    buffer_load_dwordx4 v236, s[8:11], s45 offen offset:1024  lds
    s_add_u32 m0, s42, 73728
    s_add_u32 s45, s46, 256
    buffer_load_dwordx4 v235, s[8:11], s45 offen  lds
    buffer_load_dwordx4 v236, s[8:11], s45 offen offset:1024  lds
    global_load_dword v219, v242, s[48:49]
    v_mov_b32 v242, 100
    s_mov_b32 m0, s43
    s_mov_b64 exec, 1
    global_load_lds_dword v242, s[48:49]
    s_mov_b64 exec, -1
    s_cmp_eq_u32 s53, 3
    s_cbranch_scc0 G1_pf3_3
    s_mov_b32 s52, 212992
    buffer_load_dwordx4 v[96:99], v237, s[12:15], s52 offen offset:2048 nt
    s_mov_b32 s52, 196608
    buffer_load_dwordx4 v[100:103], v237, s[16:19], s52 offen offset:2048 nt
    s_mov_b32 s52, 229376
    buffer_load_dwordx4 v[104:107], v238, s[12:15], s52 offen offset:1024 nt
    s_mov_b32 s52, 212992
    buffer_load_dwordx4 v[108:111], v237, s[16:19], s52 offen offset:0 nt
    s_mov_b32 s52, 245760
    buffer_load_dwordx4 v[112:115], v237, s[12:15], s52 offen offset:0 nt
    s_mov_b32 s52, 245760
    buffer_load_dwordx4 v[116:119], v238, s[12:15], s52 offen offset:3072 nt
    s_mov_b32 s52, 229376
    buffer_load_dwordx4 v[120:123], v237, s[16:19], s52 offen offset:2048 nt
    s_mov_b32 s52, 245760
    buffer_load_dwordx4 v[124:127], v237, s[16:19], s52 offen offset:2048 nt
G1_pf3_3:
    s_add_u32 m0, s42, 81920
    s_add_u32 s45, s46, 262144
    buffer_load_dwordx4 v235, s[8:11], s45 offen  lds
    buffer_load_dwordx4 v236, s[8:11], s45 offen offset:1024  lds
    s_add_u32 m0, s42, 90112
    s_add_u32 s45, s46, 262400
    buffer_load_dwordx4 v235, s[8:11], s45 offen  lds
    buffer_load_dwordx4 v236, s[8:11], s45 offen offset:1024  lds
    global_load_dword v219, v242, s[48:49]
    v_mov_b32 v242, 104
    s_mov_b32 m0, s43
    s_mov_b64 exec, 1
    global_load_lds_dword v242, s[48:49]
    s_mov_b64 exec, -1
    s_mov_b32 s59, 262144
G1_fq26:
    ds_read_b32 v248, v240 offset:16
    s_waitcnt lgkmcnt(0)
    v_cmp_lt_u32 s[56:57], v248, 22
    s_nop 0
    s_cmp_eq_u64 s[56:57], 0
    s_cbranch_scc1 G1_fq26_ok
    s_sleep 1
    s_sub_u32 s59, s59, 1
    s_cmp_lg_u32 s59, 0
    s_cbranch_scc1 G1_fq26
G1_fq26_ok:
    s_mov_b32 s46, 11
    s_cmp_eq_u32 s53, 3
    s_cselect_b32 s46, 12, s46
    s_add_u32 s46, s46, s47
    s_and_b32 s46, s46, 15
    s_lshl_b32 s50, s46, 7
    s_add_u32 s51, s50, 64
    s_lshl_b32 s46, s46, 19
    s_cmp_eq_u32 s24, 1
    s_cbranch_scc0 G1_x8s26
    s_mov_b32 m0, 124928
    s_nop 0
    buffer_load_dwordx4 v234, s[4:7], s50 offen  lds
    s_mov_b32 m0, 134144
    s_nop 0
    buffer_load_dwordx4 v234, s[4:7], s51 offen  lds
G1_x8s26:
    s_add_u32 m0, s42, 116736
    s_nop 0
    buffer_load_dwordx4 v232, s[4:7], s50 offen  lds
    buffer_load_dwordx4 v233, s[4:7], s50 offen offset:1024  lds
    s_add_u32 m0, s42, 125952
    s_nop 0
    buffer_load_dwordx4 v232, s[4:7], s51 offen  lds
    buffer_load_dwordx4 v233, s[4:7], s51 offen offset:1024  lds
    global_load_dword v219, v242, s[48:49]
    s_add_u32 m0, s42, 0
    s_add_u32 s45, s46, 0
    buffer_load_dwordx4 v235, s[8:11], s45 offen  lds
    buffer_load_dwordx4 v236, s[8:11], s45 offen offset:1024  lds
    s_add_u32 m0, s42, 8192
    s_add_u32 s45, s46, 256
    buffer_load_dwordx4 v235, s[8:11], s45 offen  lds
    buffer_load_dwordx4 v236, s[8:11], s45 offen offset:1024  lds
    global_load_dword v219, v242, s[48:49]
    v_mov_b32 v242, 108
    s_mov_b32 m0, s43
    s_mov_b64 exec, 1
    global_load_lds_dword v242, s[48:49]
    s_mov_b64 exec, -1
    s_add_u32 m0, s42, 16384
    s_add_u32 s45, s46, 262144
    buffer_load_dwordx4 v235, s[8:11], s45 offen  lds
    buffer_load_dwordx4 v236, s[8:11], s45 offen offset:1024  lds
    s_add_u32 m0, s42, 24576
    s_add_u32 s45, s46, 262400
    buffer_load_dwordx4 v235, s[8:11], s45 offen  lds
    buffer_load_dwordx4 v236, s[8:11], s45 offen offset:1024  lds
    global_load_dword v219, v242, s[48:49]
    v_mov_b32 v242, 112
    s_mov_b32 m0, s43
    s_mov_b64 exec, 1
    global_load_lds_dword v242, s[48:49]
    s_mov_b64 exec, -1
    s_mov_b32 s59, 262144
G1_fq28:
    ds_read_b32 v248, v240 offset:16
    s_waitcnt lgkmcnt(0)
    v_cmp_lt_u32 s[56:57], v248, 24
    s_nop 0
    s_cmp_eq_u64 s[56:57], 0
    s_cbranch_scc1 G1_fq28_ok
    s_sleep 1
    s_sub_u32 s59, s59, 1
    s_cmp_lg_u32 s59, 0
    s_cbranch_scc1 G1_fq28
G1_fq28_ok:
    s_mov_b32 s46, 13
    s_cmp_eq_u32 s53, 1
    s_cselect_b32 s46, 12, s46
    s_cmp_eq_u32 s53, 2
    s_cselect_b32 s46, 12, s46
    s_add_u32 s46, s46, s47
    s_and_b32 s46, s46, 15
    s_lshl_b32 s50, s46, 7
    s_add_u32 s51, s50, 64
    s_lshl_b32 s46, s46, 19
    s_cmp_eq_u32 s24, 2
    s_cbranch_scc0 G1_x8s28
    s_mov_b32 m0, 143360
    s_nop 0
    buffer_load_dwordx4 v234, s[4:7], s50 offen  lds
    s_mov_b32 m0, 152576
    s_nop 0
    buffer_load_dwordx4 v234, s[4:7], s51 offen  lds
G1_x8s28:
    s_add_u32 m0, s42, 135168
    s_nop 0
    buffer_load_dwordx4 v232, s[4:7], s50 offen  lds
    buffer_load_dwordx4 v233, s[4:7], s50 offen offset:1024  lds
    s_add_u32 m0, s42, 144384
    s_nop 0
    buffer_load_dwordx4 v232, s[4:7], s51 offen  lds
    buffer_load_dwordx4 v233, s[4:7], s51 offen offset:1024  lds
    global_load_dword v219, v242, s[48:49]
    s_add_u32 m0, s42, 49152
    s_add_u32 s45, s46, 0
    buffer_load_dwordx4 v235, s[8:11], s45 offen  lds
    buffer_load_dwordx4 v236, s[8:11], s45 offen offset:1024  lds
    s_add_u32 m0, s42, 57344
    s_add_u32 s45, s46, 256
    buffer_load_dwordx4 v235, s[8:11], s45 offen  lds
    buffer_load_dwordx4 v236, s[8:11], s45 offen offset:1024  lds
    global_load_dword v219, v242, s[48:49]
    v_mov_b32 v242, 116
    s_mov_b32 m0, s43
    s_mov_b64 exec, 1
    global_load_lds_dword v242, s[48:49]
    s_mov_b64 exec, -1
    s_add_u32 m0, s42, 32768
    s_add_u32 s45, s46, 262144
    buffer_load_dwordx4 v235, s[8:11], s45 offen  lds
    buffer_load_dwordx4 v236, s[8:11], s45 offen offset:1024  lds
    s_add_u32 m0, s42, 40960
    s_add_u32 s45, s46, 262400
    buffer_load_dwordx4 v235, s[8:11], s45 offen  lds
    buffer_load_dwordx4 v236, s[8:11], s45 offen offset:1024  lds
    global_load_dword v219, v242, s[48:49]
    v_mov_b32 v242, 120
    s_mov_b32 m0, s43
    s_mov_b64 exec, 1
    global_load_lds_dword v242, s[48:49]
    s_mov_b64 exec, -1
    s_mov_b32 s59, 262144
G1_fq30:
    ds_read_b32 v248, v240 offset:16
    s_waitcnt lgkmcnt(0)
    v_cmp_lt_u32 s[56:57], v248, 26
    s_nop 0
    s_cmp_eq_u64 s[56:57], 0
    s_cbranch_scc1 G1_fq30_ok
    s_sleep 1
    s_sub_u32 s59, s59, 1
    s_cmp_lg_u32 s59, 0
    s_cbranch_scc1 G1_fq30
G1_fq30_ok:
    s_mov_b32 s46, 14
    s_cmp_eq_u32 s53, 2
    s_cselect_b32 s46, 13, s46
    s_add_u32 s46, s46, s47
    s_and_b32 s46, s46, 15
    s_lshl_b32 s50, s46, 7
    s_add_u32 s51, s50, 64
    s_lshl_b32 s46, s46, 19
    s_cmp_eq_u32 s24, 3
    s_cbranch_scc0 G1_x8s30
    s_mov_b32 m0, 106496
    s_nop 0
    buffer_load_dwordx4 v234, s[4:7], s50 offen  lds
    s_mov_b32 m0, 115712
    s_nop 0
    buffer_load_dwordx4 v234, s[4:7], s51 offen  lds
G1_x8s30:
    s_add_u32 m0, s42, 98304
    s_nop 0
    buffer_load_dwordx4 v232, s[4:7], s50 offen  lds
    buffer_load_dwordx4 v233, s[4:7], s50 offen offset:1024  lds
    s_add_u32 m0, s42, 107520
    s_nop 0
    buffer_load_dwordx4 v232, s[4:7], s51 offen  lds
    buffer_load_dwordx4 v233, s[4:7], s51 offen offset:1024  lds
    global_load_dword v219, v242, s[48:49]
    s_add_u32 m0, s42, 65536
    s_add_u32 s45, s46, 0
    buffer_load_dwordx4 v235, s[8:11], s45 offen  lds
    buffer_load_dwordx4 v236, s[8:11], s45 offen offset:1024  lds
    s_add_u32 m0, s42, 73728
    s_add_u32 s45, s46, 256
    buffer_load_dwordx4 v235, s[8:11], s45 offen  lds
    buffer_load_dwordx4 v236, s[8:11], s45 offen offset:1024  lds
    global_load_dword v219, v242, s[48:49]
    v_mov_b32 v242, 124
    s_mov_b32 m0, s43
    s_mov_b64 exec, 1
    global_load_lds_dword v242, s[48:49]
    s_mov_b64 exec, -1
    s_add_u32 m0, s42, 81920
    s_add_u32 s45, s46, 262144
    buffer_load_dwordx4 v235, s[8:11], s45 offen  lds
    buffer_load_dwordx4 v236, s[8:11], s45 offen offset:1024  lds
    s_add_u32 m0, s42, 90112
    s_add_u32 s45, s46, 262400
    buffer_load_dwordx4 v235, s[8:11], s45 offen  lds
    buffer_load_dwordx4 v236, s[8:11], s45 offen offset:1024  lds
    global_load_dword v219, v242, s[48:49]
    v_mov_b32 v242, 128
    s_mov_b32 m0, s43
    s_mov_b64 exec, 1
    global_load_lds_dword v242, s[48:49]
    s_mov_b64 exec, -1
    v_add_u32 v247, 49152, v243
    s_mov_b32 s59, 262144
G1_fa0:
    ds_read_b32 v248, v240 offset:16
    s_waitcnt lgkmcnt(0)
    v_cmp_lt_u32 s[56:57], v248, 28
    s_nop 0
    s_cmp_eq_u64 s[56:57], 0
    s_cbranch_scc1 G1_fa0_ok
    s_sleep 1
    s_sub_u32 s59, s59, 1
    s_cmp_lg_u32 s59, 0
    s_cbranch_scc1 G1_fa0
G1_fa0_ok:
    s_add_u32 m0, s41, 0
    s_mov_b32 s52, 0
    buffer_load_dwordx4 v237, s[12:15], s52 offen offset:0 nt lds
    buffer_load_dwordx4 v238, s[12:15], s52 offen offset:1024 nt lds
    buffer_load_dwordx4 v237, s[12:15], s52 offen offset:2048 nt lds
    buffer_load_dwordx4 v238, s[12:15], s52 offen offset:3072 nt lds
    s_add_u32 m0, s41, 16384
    s_mov_b32 s52, 16384
    buffer_load_dwordx4 v237, s[12:15], s52 offen offset:0 nt lds
    buffer_load_dwordx4 v238, s[12:15], s52 offen offset:1024 nt lds
    buffer_load_dwordx4 v237, s[12:15], s52 offen offset:2048 nt lds
    buffer_load_dwordx4 v238, s[12:15], s52 offen offset:3072 nt lds
    v_mov_b32 v242, 136
    s_mov_b32 m0, s43
    s_mov_b64 exec, 1
    global_load_lds_dword v242, s[48:49]
    s_mov_b64 exec, -1
    s_mov_b32 s59, 262144
G1_fa2:
    ds_read_b32 v248, v240 offset:16
    s_waitcnt lgkmcnt(0)
    v_cmp_lt_u32 s[56:57], v248, 30
    s_nop 0
    s_cmp_eq_u64 s[56:57], 0
    s_cbranch_scc1 G1_fa2_ok
    s_sleep 1
    s_sub_u32 s59, s59, 1
    s_cmp_lg_u32 s59, 0
    s_cbranch_scc1 G1_fa2
G1_fa2_ok:
    s_add_u32 m0, s41, 49152
    s_mov_b32 s52, 0
    buffer_load_dwordx4 v237, s[16:19], s52 offen offset:0 nt lds
    buffer_load_dwordx4 v238, s[16:19], s52 offen offset:1024 nt lds
    buffer_load_dwordx4 v237, s[16:19], s52 offen offset:2048 nt lds
    buffer_load_dwordx4 v238, s[16:19], s52 offen offset:3072 nt lds
    v_mov_b32 v242, 140
    s_mov_b32 m0, s43
    s_mov_b64 exec, 1
    global_load_lds_dword v242, s[48:49]
    s_mov_b64 exec, -1
    s_add_u32 m0, s41, 32768
    s_mov_b32 s52, 32768
    buffer_load_dwordx4 v237, s[12:15], s52 offen offset:0 nt lds
    buffer_load_dwordx4 v238, s[12:15], s52 offen offset:1024 nt lds
    buffer_load_dwordx4 v237, s[12:15], s52 offen offset:2048 nt lds
    buffer_load_dwordx4 v238, s[12:15], s52 offen offset:3072 nt lds
    v_mov_b32 v242, 144
    s_mov_b32 m0, s43
    s_mov_b64 exec, 1
    global_load_lds_dword v242, s[48:49]
    s_mov_b64 exec, -1
    s_mov_b32 s59, 262144
G1_fa4:
    ds_read_b32 v248, v240 offset:16
    s_waitcnt lgkmcnt(0)
    v_cmp_lt_u32 s[56:57], v248, 32
    s_nop 0
    s_cmp_eq_u64 s[56:57], 0
    s_cbranch_scc1 G1_fa4_ok
    s_sleep 1
    s_sub_u32 s59, s59, 1
    s_cmp_lg_u32 s59, 0
    s_cbranch_scc1 G1_fa4
G1_fa4_ok:
    s_add_u32 m0, s41, 65536
    s_mov_b32 s52, 16384
    buffer_load_dwordx4 v237, s[16:19], s52 offen offset:0 nt lds
    buffer_load_dwordx4 v238, s[16:19], s52 offen offset:1024 nt lds
    buffer_load_dwordx4 v237, s[16:19], s52 offen offset:2048 nt lds
    buffer_load_dwordx4 v238, s[16:19], s52 offen offset:3072 nt lds
    v_mov_b32 v242, 148
    s_mov_b32 m0, s43
    s_mov_b64 exec, 1
    global_load_lds_dword v242, s[48:49]
    s_mov_b64 exec, -1
    s_mov_b32 s50, 0x41200000
    s_setprio 3
    s_mov_b32 s59, 262144
G1_gb0:
    ds_read_b32 v248, v240 offset:32
    s_waitcnt lgkmcnt(0)
    v_cmp_lt_u32 s[56:57], v248, 1
    s_nop 0
    s_cmp_eq_u64 s[56:57], 0
    s_cbranch_scc1 G1_gb0_ok
    s_sleep 1
    s_sub_u32 s59, s59, 1
    s_cmp_lg_u32 s59, 0
    s_cbranch_scc1 G1_gb0
G1_gb0_ok:
    s_sub_u32 s44, 122624, s41
    v_add_u32 v248, s44, v243
    ds_read_b128 v[160:163], v248 offset:0
    ds_read_b128 v[164:167], v248 offset:1024
    ds_read_b128 v[168:171], v248 offset:2048
    ds_read_b128 v[172:175], v248 offset:3072
    v_mov_b32 v212, 0
    v_mov_b32 v213, 0
    v_mov_b32 v214, 0
    v_mov_b32 v215, 0
    s_waitcnt lgkmcnt(0)
    s_waitcnt vmcnt(20)
    ds_read_b128 v[180:183], v220 offset:0
    ds_read_b128 v[184:187], v221 offset:0
    ds_read_b128 v[188:191], v222 offset:0
    ds_read_b128 v[192:195], v223 offset:0
    ds_read_b32 v248, v240 offset:16
    s_waitcnt lgkmcnt(4)
    v_mfma_f32_16x16x32_bf16 v[176:179], v[180:183], v[160:163], v[212:215]
    s_waitcnt lgkmcnt(3)
    v_mfma_f32_16x16x32_bf16 v[176:179], v[184:187], v[164:167], v[176:179]
    s_waitcnt lgkmcnt(2)
    v_mfma_f32_16x16x32_bf16 v[176:179], v[188:191], v[168:171], v[176:179]
    s_waitcnt lgkmcnt(1)
    v_mfma_f32_16x16x32_bf16 v[176:179], v[192:195], v[172:175], v[176:179]
    s_nop 7
    v_max_f32 v217, v176, v177
    v_max3_f32 v217, v178, v179, v217
    v_mov_b32 v218, v217
    s_nop 1
    v_permlane32_swap_b32 v218, v217
    v_max_f32 v217, v217, v218
    v_mov_b32 v218, v217
    s_nop 1
    v_permlane16_swap_b32 v218, v217
    v_max_f32 v217, v217, v218
    v_sub_f32 v212, 0, v217
    v_sub_f32 v176, v176, v217
    v_sub_f32 v213, 0, v217
    v_sub_f32 v177, v177, v217
    v_sub_f32 v214, 0, v217
    v_sub_f32 v178, v178, v217
    v_sub_f32 v215, 0, v217
    v_sub_f32 v179, v179, v217
    v_mov_b32 v216, 0
    v_exp_f32 v176, v176
    v_exp_f32 v177, v177
    v_exp_f32 v178, v178
    v_exp_f32 v179, v179
    v_add_f32 v216, v216, v176
    v_add_f32 v216, v216, v177
    v_add_f32 v216, v216, v178
    v_add_f32 v216, v216, v179
    v_cvt_pk_bf16_f32 v176, v176, v177
    v_cvt_pk_bf16_f32 v177, v178, v179
    s_waitcnt lgkmcnt(0)
    v_cmp_lt_u32 s[56:57], v248, 33
    s_nop 0
    s_cmp_eq_u64 s[56:57], 0
    s_cbranch_scc0 G1_fb5
G1_fb5_ret:
    ds_write_b128 v243, v[0:3] offset:1024
    s_add_u32 m0, s41, 0
    s_mov_b32 s52, 49152
    buffer_load_dwordx4 v237, s[12:15], s52 offen offset:0 nt lds
    buffer_load_dwordx4 v237, s[12:15], s52 offen offset:2048 nt lds
    buffer_load_dwordx4 v238, s[12:15], s52 offen offset:3072 nt lds
    s_waitcnt vmcnt(14)
    ds_read_b64_tr_b16 v[196:197], v224 offset:0
    ds_read_b64_tr_b16 v[198:199], v225 offset:0
    ds_read_b64_tr_b16 v[200:201], v226 offset:0
    ds_read_b64_tr_b16 v[202:203], v227 offset:0
    ds_read_b64_tr_b16 v[204:205], v228 offset:0
    ds_read_b64_tr_b16 v[206:207], v229 offset:0
    ds_read_b64_tr_b16 v[208:209], v230 offset:0
    ds_read_b64_tr_b16 v[210:211], v231 offset:0
    ds_read_b32 v248, v240 offset:16
    s_waitcnt lgkmcnt(9)
    v_mov_b32 v242, 152
    s_mov_b32 m0, s43
    s_mov_b64 exec, 1
    global_load_lds_dword v242, s[48:49]
    s_mov_b64 exec, -1
    s_waitcnt lgkmcnt(0)
    s_setprio 3
    v_mfma_f32_16x16x16_bf16 v[128:131], v[196:197], v[176:177], 0
    v_mfma_f32_16x16x16_bf16 v[132:135], v[198:199], v[176:177], 0
    v_mfma_f32_16x16x16_bf16 v[136:139], v[200:201], v[176:177], 0
    v_mfma_f32_16x16x16_bf16 v[140:143], v[202:203], v[176:177], 0
    v_mfma_f32_16x16x16_bf16 v[144:147], v[204:205], v[176:177], 0
    v_mfma_f32_16x16x16_bf16 v[148:151], v[206:207], v[176:177], 0
    v_mfma_f32_16x16x16_bf16 v[152:155], v[208:209], v[176:177], 0
    v_mfma_f32_16x16x16_bf16 v[156:159], v[210:211], v[176:177], 0
    s_setprio 3
    v_cmp_lt_u32 s[56:57], v248, 33
    s_nop 0
    s_cmp_eq_u64 s[56:57], 0
    s_cbranch_scc0 G1_fb6
G1_fb6_ret:
    ds_write_b128 v247, v[4:7] offset:33792
    s_add_u32 m0, s41, 81920
    s_mov_b32 s52, 32768
    buffer_load_dwordx4 v237, s[16:19], s52 offen offset:0 nt lds
    buffer_load_dwordx4 v237, s[16:19], s52 offen offset:2048 nt lds
    buffer_load_dwordx4 v238, s[16:19], s52 offen offset:3072 nt lds
    ds_read_b128 v[180:183], v220 offset:16384
    ds_read_b128 v[184:187], v221 offset:16384
    ds_read_b128 v[188:191], v222 offset:16384
    ds_read_b128 v[192:195], v223 offset:16384
    ds_read_b32 v248, v240 offset:16
    s_waitcnt lgkmcnt(5)
    v_mov_b32 v242, 156
    s_mov_b32 m0, s43
    s_mov_b64 exec, 1
    global_load_lds_dword v242, s[48:49]
    s_mov_b64 exec, -1
    s_waitcnt lgkmcnt(4)
    v_mfma_f32_16x16x32_bf16 v[176:179], v[180:183], v[160:163], v[212:215]
    s_waitcnt lgkmcnt(3)
    v_mfma_f32_16x16x32_bf16 v[176:179], v[184:187], v[164:167], v[176:179]
    s_waitcnt lgkmcnt(2)
    v_mfma_f32_16x16x32_bf16 v[176:179], v[188:191], v[168:171], v[176:179]
    s_waitcnt lgkmcnt(1)
    v_mfma_f32_16x16x32_bf16 v[176:179], v[192:195], v[172:175], v[176:179]
    s_nop 7
    v_max_f32 v217, v176, v177
    v_max3_f32 v217, v178, v179, v217
    v_cmp_lt_f32 vcc, s50, v217
    s_nop 1
    s_cbranch_vccnz G1_g1
G1_g1_ret:
    v_exp_f32 v176, v176
    v_exp_f32 v177, v177
    v_exp_f32 v178, v178
    v_exp_f32 v179, v179
    v_add_f32 v216, v216, v176
    v_add_f32 v216, v216, v177
    v_add_f32 v216, v216, v178
    v_add_f32 v216, v216, v179
    v_cvt_pk_bf16_f32 v176, v176, v177
    v_cvt_pk_bf16_f32 v177, v178, v179
    s_waitcnt lgkmcnt(0)
    v_cmp_lt_u32 s[56:57], v248, 34
    s_nop 0
    s_cmp_eq_u64 s[56:57], 0
    s_cbranch_scc0 G1_fb7
G1_fb7_ret:
    ds_write_b128 v243, v[8:11] offset:16384
    ds_write_b128 v243, v[12:15] offset:19456
    s_add_u32 m0, s41, 16384
    s_mov_b32 s52, 65536
    buffer_load_dwordx4 v238, s[12:15], s52 offen offset:1024 nt lds
    buffer_load_dwordx4 v237, s[12:15], s52 offen offset:2048 nt lds
    s_waitcnt vmcnt(11)
    ds_read_b64_tr_b16 v[196:197], v224 offset:16384
    ds_read_b64_tr_b16 v[198:199], v225 offset:16384
    ds_read_b64_tr_b16 v[200:201], v226 offset:16384
    ds_read_b64_tr_b16 v[202:203], v227 offset:16384
    ds_read_b64_tr_b16 v[204:205], v228 offset:16384
    ds_read_b64_tr_b16 v[206:207], v229 offset:16384
    ds_read_b64_tr_b16 v[208:209], v230 offset:16384
    ds_read_b64_tr_b16 v[210:211], v231 offset:16384
    ds_read_b32 v248, v240 offset:16
    s_waitcnt lgkmcnt(9)
    v_mov_b32 v242, 160
    s_mov_b32 m0, s43
    s_mov_b64 exec, 1
    global_load_lds_dword v242, s[48:49]
    s_mov_b64 exec, -1
    s_waitcnt lgkmcnt(0)
    s_setprio 3
    v_mfma_f32_16x16x16_bf16 v[128:131], v[196:197], v[176:177], v[128:131]
    v_mfma_f32_16x16x16_bf16 v[132:135], v[198:199], v[176:177], v[132:135]
    v_mfma_f32_16x16x16_bf16 v[136:139], v[200:201], v[176:177], v[136:139]
    v_mfma_f32_16x16x16_bf16 v[140:143], v[202:203], v[176:177], v[140:143]
    v_mfma_f32_16x16x16_bf16 v[144:147], v[204:205], v[176:177], v[144:147]
    v_mfma_f32_16x16x16_bf16 v[148:151], v[206:207], v[176:177], v[148:151]
    v_mfma_f32_16x16x16_bf16 v[152:155], v[208:209], v[176:177], v[152:155]
    v_mfma_f32_16x16x16_bf16 v[156:159], v[210:211], v[176:177], v[156:159]
    s_setprio 3
    v_cmp_lt_u32 s[56:57], v248, 35
    s_nop 0
    s_cmp_eq_u64 s[56:57], 0
    s_cbranch_scc0 G1_fb8
G1_fb8_ret:
    ds_write_b128 v243, v[16:19] offset:52224
    s_add_u32 m0, s41, 49152
    s_mov_b32 s52, 49152
    buffer_load_dwordx4 v237, s[16:19], s52 offen offset:0 nt lds
    buffer_load_dwordx4 v238, s[16:19], s52 offen offset:1024 nt lds
    buffer_load_dwordx4 v237, s[16:19], s52 offen offset:2048 nt lds
    ds_read_b128 v[180:183], v220 offset:32768
    ds_read_b128 v[184:187], v221 offset:32768
    ds_read_b128 v[188:191], v222 offset:32768
    ds_read_b128 v[192:195], v223 offset:32768
    ds_read_b32 v248, v240 offset:16
    s_waitcnt lgkmcnt(5)
    v_mov_b32 v242, 164
    s_mov_b32 m0, s43
    s_mov_b64 exec, 1
    global_load_lds_dword v242, s[48:49]
    s_mov_b64 exec, -1
    s_waitcnt lgkmcnt(4)
    v_mfma_f32_16x16x32_bf16 v[176:179], v[180:183], v[160:163], v[212:215]
    s_waitcnt lgkmcnt(3)
    v_mfma_f32_16x16x32_bf16 v[176:179], v[184:187], v[164:167], v[176:179]
    s_waitcnt lgkmcnt(2)
    v_mfma_f32_16x16x32_bf16 v[176:179], v[188:191], v[168:171], v[176:179]
    s_waitcnt lgkmcnt(1)
    v_mfma_f32_16x16x32_bf16 v[176:179], v[192:195], v[172:175], v[176:179]
    s_nop 7
    v_max_f32 v217, v176, v177
    v_max3_f32 v217, v178, v179, v217
    v_cmp_lt_f32 vcc, s50, v217
    s_nop 1
    s_cbranch_vccnz G1_g2
G1_g2_ret:
    v_exp_f32 v176, v176
    v_exp_f32 v177, v177
    v_exp_f32 v178, v178
    v_exp_f32 v179, v179
    v_add_f32 v216, v216, v176
    v_add_f32 v216, v216, v177
    v_add_f32 v216, v216, v178
    v_add_f32 v216, v216, v179
    v_cvt_pk_bf16_f32 v176, v176, v177
    v_cvt_pk_bf16_f32 v177, v178, v179
    s_waitcnt lgkmcnt(0)
    v_cmp_lt_u32 s[56:57], v248, 36
    s_nop 0
    s_cmp_eq_u64 s[56:57], 0
    s_cbranch_scc0 G1_fb9
G1_fb9_ret:
    ds_write_b128 v243, v[20:23] offset:34816
    s_add_u32 m0, s41, 32768
    s_mov_b32 s52, 81920
    buffer_load_dwordx4 v237, s[12:15], s52 offen offset:0 nt lds
    buffer_load_dwordx4 v238, s[12:15], s52 offen offset:1024 nt lds
    buffer_load_dwordx4 v238, s[12:15], s52 offen offset:3072 nt lds
    s_waitcnt vmcnt(11)
    ds_read_b64_tr_b16 v[196:197], v224 offset:32768
    ds_read_b64_tr_b16 v[198:199], v225 offset:32768
    ds_read_b64_tr_b16 v[200:201], v226 offset:32768
    ds_read_b64_tr_b16 v[202:203], v227 offset:32768
    ds_read_b64_tr_b16 v[204:205], v228 offset:32768
    ds_read_b64_tr_b16 v[206:207], v229 offset:32768
    ds_read_b64_tr_b16 v[208:209], v230 offset:32768
    ds_read_b64_tr_b16 v[210:211], v231 offset:32768
    ds_read_b32 v248, v240 offset:16
    s_waitcnt lgkmcnt(9)
    v_mov_b32 v242, 168
    s_mov_b32 m0, s43
    s_mov_b64 exec, 1
    global_load_lds_dword v242, s[48:49]
    s_mov_b64 exec, -1
    s_waitcnt lgkmcnt(0)
    s_setprio 3
    v_mfma_f32_16x16x16_bf16 v[128:131], v[196:197], v[176:177], v[128:131]
    v_mfma_f32_16x16x16_bf16 v[132:135], v[198:199], v[176:177], v[132:135]
    v_mfma_f32_16x16x16_bf16 v[136:139], v[200:201], v[176:177], v[136:139]
    v_mfma_f32_16x16x16_bf16 v[140:143], v[202:203], v[176:177], v[140:143]
    v_mfma_f32_16x16x16_bf16 v[144:147], v[204:205], v[176:177], v[144:147]
    v_mfma_f32_16x16x16_bf16 v[148:151], v[206:207], v[176:177], v[148:151]
    v_mfma_f32_16x16x16_bf16 v[152:155], v[208:209], v[176:177], v[152:155]
    v_mfma_f32_16x16x16_bf16 v[156:159], v[210:211], v[176:177], v[156:159]
    s_setprio 3
    v_cmp_lt_u32 s[56:57], v248, 37
    s_nop 0
    s_cmp_eq_u64 s[56:57], 0
    s_cbranch_scc0 G1_fb10
G1_fb10_ret:
    ds_write_b128 v247, v[24:27] offset:17408
    s_add_u32 m0, s41, 65536
    s_mov_b32 s52, 65536
    buffer_load_dwordx4 v237, s[16:19], s52 offen offset:0 nt lds
    buffer_load_dwordx4 v237, s[16:19], s52 offen offset:2048 nt lds
    buffer_load_dwordx4 v238, s[16:19], s52 offen offset:3072 nt lds
    ds_read_b128 v[180:183], v220 offset:0
    ds_read_b128 v[184:187], v221 offset:0
    ds_read_b128 v[188:191], v222 offset:0
    ds_read_b128 v[192:195], v223 offset:0
    ds_read_b32 v248, v240 offset:16
    s_waitcnt lgkmcnt(5)
    v_mov_b32 v242, 172
    s_mov_b32 m0, s43
    s_mov_b64 exec, 1
    global_load_lds_dword v242, s[48:49]
    s_mov_b64 exec, -1
    s_waitcnt lgkmcnt(4)
    v_mfma_f32_16x16x32_bf16 v[176:179], v[180:183], v[160:163], v[212:215]
    s_waitcnt lgkmcnt(3)
    v_mfma_f32_16x16x32_bf16 v[176:179], v[184:187], v[164:167], v[176:179]
    s_waitcnt lgkmcnt(2)
    v_mfma_f32_16x16x32_bf16 v[176:179], v[188:191], v[168:171], v[176:179]
    s_waitcnt lgkmcnt(1)
    v_mfma_f32_16x16x32_bf16 v[176:179], v[192:195], v[172:175], v[176:179]
    s_nop 7
    v_max_f32 v217, v176, v177
    v_max3_f32 v217, v178, v179, v217
    v_cmp_lt_f32 vcc, s50, v217
    s_nop 1
    s_cbranch_vccnz G1_g3
G1_g3_ret:
    v_exp_f32 v176, v176
    v_exp_f32 v177, v177
    v_exp_f32 v178, v178
    v_exp_f32 v179, v179
    v_add_f32 v216, v216, v176
    v_add_f32 v216, v216, v177
    v_add_f32 v216, v216, v178
    v_add_f32 v216, v216, v179
    v_cvt_pk_bf16_f32 v176, v176, v177
    v_cvt_pk_bf16_f32 v177, v178, v179
    s_waitcnt lgkmcnt(0)
    v_cmp_lt_u32 s[56:57], v248, 38
    s_nop 0
    s_cmp_eq_u64 s[56:57], 0
    s_cbranch_scc0 G1_fb11
G1_fb11_ret:
    ds_write_b128 v243, v[28:31] offset:1024
    s_add_u32 m0, s41, 0
    s_mov_b32 s52, 98304
    buffer_load_dwordx4 v237, s[12:15], s52 offen offset:0 nt lds
    buffer_load_dwordx4 v237, s[12:15], s52 offen offset:2048 nt lds
    buffer_load_dwordx4 v238, s[12:15], s52 offen offset:3072 nt lds
    s_waitcnt vmcnt(12)
    ds_read_b64_tr_b16 v[196:197], v224 offset:0
    ds_read_b64_tr_b16 v[198:199], v225 offset:0
    ds_read_b64_tr_b16 v[200:201], v226 offset:0
    ds_read_b64_tr_b16 v[202:203], v227 offset:0
    ds_read_b64_tr_b16 v[204:205], v228 offset:0
    ds_read_b64_tr_b16 v[206:207], v229 offset:0
    ds_read_b64_tr_b16 v[208:209], v230 offset:0
    ds_read_b64_tr_b16 v[210:211], v231 offset:0
    ds_read_b32 v248, v240 offset:16
    s_waitcnt lgkmcnt(9)
    v_mov_b32 v242, 176
    s_mov_b32 m0, s43
    s_mov_b64 exec, 1
    global_load_lds_dword v242, s[48:49]
    s_mov_b64 exec, -1
    s_waitcnt lgkmcnt(0)
    s_setprio 3
    v_mfma_f32_16x16x16_bf16 v[128:131], v[196:197], v[176:177], v[128:131]
    v_mfma_f32_16x16x16_bf16 v[132:135], v[198:199], v[176:177], v[132:135]
    v_mfma_f32_16x16x16_bf16 v[136:139], v[200:201], v[176:177], v[136:139]
    v_mfma_f32_16x16x16_bf16 v[140:143], v[202:203], v[176:177], v[140:143]
    v_mfma_f32_16x16x16_bf16 v[144:147], v[204:205], v[176:177], v[144:147]
    v_mfma_f32_16x16x16_bf16 v[148:151], v[206:207], v[176:177], v[148:151]
    v_mfma_f32_16x16x16_bf16 v[152:155], v[208:209], v[176:177], v[152:155]
    v_mfma_f32_16x16x16_bf16 v[156:159], v[210:211], v[176:177], v[156:159]
    s_setprio 3
    v_cmp_lt_u32 s[56:57], v248, 39
    s_nop 0
    s_cmp_eq_u64 s[56:57], 0
    s_cbranch_scc0 G1_fb12
G1_fb12_ret:
    ds_write_b128 v247, v[32:35] offset:32768
    s_add_u32 m0, s41, 81920
    s_mov_b32 s52, 81920
    buffer_load_dwordx4 v238, s[16:19], s52 offen offset:1024 nt lds
    buffer_load_dwordx4 v237, s[16:19], s52 offen offset:2048 nt lds
    buffer_load_dwordx4 v238, s[16:19], s52 offen offset:3072 nt lds
    ds_read_b128 v[180:183], v220 offset:16384
    ds_read_b128 v[184:187], v221 offset:16384
    ds_read_b128 v[188:191], v222 offset:16384
    ds_read_b128 v[192:195], v223 offset:16384
    ds_read_b32 v248, v240 offset:16
    s_waitcnt lgkmcnt(5)
    v_mov_b32 v242, 180
    s_mov_b32 m0, s43
    s_mov_b64 exec, 1
    global_load_lds_dword v242, s[48:49]
    s_mov_b64 exec, -1
    s_waitcnt lgkmcnt(4)
    v_mfma_f32_16x16x32_bf16 v[176:179], v[180:183], v[160:163], v[212:215]
    s_waitcnt lgkmcnt(3)
    v_mfma_f32_16x16x32_bf16 v[176:179], v[184:187], v[164:167], v[176:179]
    s_waitcnt lgkmcnt(2)
    v_mfma_f32_16x16x32_bf16 v[176:179], v[188:191], v[168:171], v[176:179]
    s_waitcnt lgkmcnt(1)
    v_mfma_f32_16x16x32_bf16 v[176:179], v[192:195], v[172:175], v[176:179]
    s_nop 7
    v_max_f32 v217, v176, v177
    v_max3_f32 v217, v178, v179, v217
    v_cmp_lt_f32 vcc, s50, v217
    s_nop 1
    s_cbranch_vccnz G1_g4
G1_g4_ret:
    v_exp_f32 v176, v176
    v_exp_f32 v177, v177
    v_exp_f32 v178, v178
    v_exp_f32 v179, v179
    v_add_f32 v216, v216, v176
    v_add_f32 v216, v216, v177
    v_add_f32 v216, v216, v178
    v_add_f32 v216, v216, v179
    v_cvt_pk_bf16_f32 v176, v176, v177
    v_cvt_pk_bf16_f32 v177, v178, v179
    s_waitcnt lgkmcnt(0)
    v_cmp_lt_u32 s[56:57], v248, 40
    s_nop 0
    s_cmp_eq_u64 s[56:57], 0
    s_cbranch_scc0 G1_fb13
G1_fb13_ret:
    ds_write_b128 v243, v[36:39] offset:16384
    ds_write_b128 v243, v[40:43] offset:19456
    s_add_u32 m0, s41, 16384
    s_mov_b32 s52, 114688
    buffer_load_dwordx4 v238, s[12:15], s52 offen offset:1024 nt lds
    buffer_load_dwordx4 v237, s[12:15], s52 offen offset:2048 nt lds
    s_waitcnt vmcnt(11)
    ds_read_b64_tr_b16 v[196:197], v224 offset:16384
    ds_read_b64_tr_b16 v[198:199], v225 offset:16384
    ds_read_b64_tr_b16 v[200:201], v226 offset:16384
    ds_read_b64_tr_b16 v[202:203], v227 offset:16384
    ds_read_b64_tr_b16 v[204:205], v228 offset:16384
    ds_read_b64_tr_b16 v[206:207], v229 offset:16384
    ds_read_b64_tr_b16 v[208:209], v230 offset:16384
    ds_read_b64_tr_b16 v[210:211], v231 offset:16384
    ds_read_b32 v248, v240 offset:16
    s_waitcnt lgkmcnt(9)
    v_mov_b32 v242, 184
    s_mov_b32 m0, s43
    s_mov_b64 exec, 1
    global_load_lds_dword v242, s[48:49]
    s_mov_b64 exec, -1
    s_waitcnt lgkmcnt(0)
    s_setprio 3
    v_mfma_f32_16x16x16_bf16 v[128:131], v[196:197], v[176:177], v[128:131]
    v_mfma_f32_16x16x16_bf16 v[132:135], v[198:199], v[176:177], v[132:135]
    v_mfma_f32_16x16x16_bf16 v[136:139], v[200:201], v[176:177], v[136:139]
    v_mfma_f32_16x16x16_bf16 v[140:143], v[202:203], v[176:177], v[140:143]
    v_mfma_f32_16x16x16_bf16 v[144:147], v[204:205], v[176:177], v[144:147]
    v_mfma_f32_16x16x16_bf16 v[148:151], v[206:207], v[176:177], v[148:151]
    v_mfma_f32_16x16x16_bf16 v[152:155], v[208:209], v[176:177], v[152:155]
    v_mfma_f32_16x16x16_bf16 v[156:159], v[210:211], v[176:177], v[156:159]
    s_setprio 3
    v_cmp_lt_u32 s[56:57], v248, 41
    s_nop 0
    s_cmp_eq_u64 s[56:57], 0
    s_cbranch_scc0 G1_fb14
G1_fb14_ret:
    ds_write_b128 v243, v[44:47] offset:51200
    s_add_u32 m0, s41, 49152
    s_mov_b32 s52, 98304
    buffer_load_dwordx4 v237, s[16:19], s52 offen offset:0 nt lds
    buffer_load_dwordx4 v238, s[16:19], s52 offen offset:1024 nt lds
    buffer_load_dwordx4 v238, s[16:19], s52 offen offset:3072 nt lds
    ds_read_b128 v[180:183], v220 offset:32768
    ds_read_b128 v[184:187], v221 offset:32768
    ds_read_b128 v[188:191], v222 offset:32768
    ds_read_b128 v[192:195], v223 offset:32768
    ds_read_b32 v248, v240 offset:16
    s_waitcnt lgkmcnt(5)
    v_mov_b32 v242, 188
    s_mov_b32 m0, s43
    s_mov_b64 exec, 1
    global_load_lds_dword v242, s[48:49]
    s_mov_b64 exec, -1
    s_waitcnt lgkmcnt(4)
    v_mfma_f32_16x16x32_bf16 v[176:179], v[180:183], v[160:163], v[212:215]
    s_waitcnt lgkmcnt(3)
    v_mfma_f32_16x16x32_bf16 v[176:179], v[184:187], v[164:167], v[176:179]
    s_waitcnt lgkmcnt(2)
    v_mfma_f32_16x16x32_bf16 v[176:179], v[188:191], v[168:171], v[176:179]
    s_waitcnt lgkmcnt(1)
    v_mfma_f32_16x16x32_bf16 v[176:179], v[192:195], v[172:175], v[176:179]
    s_nop 7
    v_max_f32 v217, v176, v177
    v_max3_f32 v217, v178, v179, v217
    v_cmp_lt_f32 vcc, s50, v217
    s_nop 1
    s_cbranch_vccnz G1_g5
G1_g5_ret:
    v_exp_f32 v176, v176
    v_exp_f32 v177, v177
    v_exp_f32 v178, v178
    v_exp_f32 v179, v179
    v_add_f32 v216, v216, v176
    v_add_f32 v216, v216, v177
    v_add_f32 v216, v216, v178
    v_add_f32 v216, v216, v179
    v_cvt_pk_bf16_f32 v176, v176, v177
    v_cvt_pk_bf16_f32 v177, v178, v179
    s_waitcnt lgkmcnt(0)
    v_cmp_lt_u32 s[56:57], v248, 42
    s_nop 0
    s_cmp_eq_u64 s[56:57], 0
    s_cbranch_scc0 G1_fb15
G1_fb15_ret:
    ds_write_b128 v243, v[48:51] offset:34816
    s_add_u32 m0, s41, 32768
    s_mov_b32 s52, 131072
    buffer_load_dwordx4 v237, s[12:15], s52 offen offset:0 nt lds
    buffer_load_dwordx4 v238, s[12:15], s52 offen offset:1024 nt lds
    buffer_load_dwordx4 v238, s[12:15], s52 offen offset:3072 nt lds
    s_waitcnt vmcnt(11)
    ds_read_b64_tr_b16 v[196:197], v224 offset:32768
    ds_read_b64_tr_b16 v[198:199], v225 offset:32768
    ds_read_b64_tr_b16 v[200:201], v226 offset:32768
    ds_read_b64_tr_b16 v[202:203], v227 offset:32768
    ds_read_b64_tr_b16 v[204:205], v228 offset:32768
    ds_read_b64_tr_b16 v[206:207], v229 offset:32768
    ds_read_b64_tr_b16 v[208:209], v230 offset:32768
    ds_read_b64_tr_b16 v[210:211], v231 offset:32768
    ds_read_b32 v248, v240 offset:16
    s_waitcnt lgkmcnt(9)
    v_mov_b32 v242, 192
    s_mov_b32 m0, s43
    s_mov_b64 exec, 1
    global_load_lds_dword v242, s[48:49]
    s_mov_b64 exec, -1
    s_waitcnt lgkmcnt(0)
    s_setprio 3
    v_mfma_f32_16x16x16_bf16 v[128:131], v[196:197], v[176:177], v[128:131]
    v_mfma_f32_16x16x16_bf16 v[132:135], v[198:199], v[176:177], v[132:135]
    v_mfma_f32_16x16x16_bf16 v[136:139], v[200:201], v[176:177], v[136:139]
    v_mfma_f32_16x16x16_bf16 v[140:143], v[202:203], v[176:177], v[140:143]
    v_mfma_f32_16x16x16_bf16 v[144:147], v[204:205], v[176:177], v[144:147]
    v_mfma_f32_16x16x16_bf16 v[148:151], v[206:207], v[176:177], v[148:151]
    v_mfma_f32_16x16x16_bf16 v[152:155], v[208:209], v[176:177], v[152:155]
    v_mfma_f32_16x16x16_bf16 v[156:159], v[210:211], v[176:177], v[156:159]
    s_setprio 3
    v_cmp_lt_u32 s[56:57], v248, 43
    s_nop 0
    s_cmp_eq_u64 s[56:57], 0
    s_cbranch_scc0 G1_fb16
G1_fb16_ret:
    ds_write_b128 v247, v[52:55] offset:17408
    s_add_u32 m0, s41, 65536
    s_mov_b32 s52, 114688
    buffer_load_dwordx4 v237, s[16:19], s52 offen offset:0 nt lds
    buffer_load_dwordx4 v237, s[16:19], s52 offen offset:2048 nt lds
    buffer_load_dwordx4 v238, s[16:19], s52 offen offset:3072 nt lds
    ds_read_b128 v[180:183], v220 offset:0
    ds_read_b128 v[184:187], v221 offset:0
    ds_read_b128 v[188:191], v222 offset:0
    ds_read_b128 v[192:195], v223 offset:0
    ds_read_b32 v248, v240 offset:16
    s_waitcnt lgkmcnt(5)
    v_mov_b32 v242, 196
    s_mov_b32 m0, s43
    s_mov_b64 exec, 1
    global_load_lds_dword v242, s[48:49]
    s_mov_b64 exec, -1
    s_waitcnt lgkmcnt(4)
    v_mfma_f32_16x16x32_bf16 v[176:179], v[180:183], v[160:163], v[212:215]
    s_waitcnt lgkmcnt(3)
    v_mfma_f32_16x16x32_bf16 v[176:179], v[184:187], v[164:167], v[176:179]
    s_waitcnt lgkmcnt(2)
    v_mfma_f32_16x16x32_bf16 v[176:179], v[188:191], v[168:171], v[176:179]
    s_waitcnt lgkmcnt(1)
    v_mfma_f32_16x16x32_bf16 v[176:179], v[192:195], v[172:175], v[176:179]
    s_nop 7
    v_max_f32 v217, v176, v177
    v_max3_f32 v217, v178, v179, v217
    v_cmp_lt_f32 vcc, s50, v217
    s_nop 1
    s_cbranch_vccnz G1_g6
G1_g6_ret:
    v_exp_f32 v176, v176
    v_exp_f32 v177, v177
    v_exp_f32 v178, v178
    v_exp_f32 v179, v179
    v_add_f32 v216, v216, v176
    v_add_f32 v216, v216, v177
    v_add_f32 v216, v216, v178
    v_add_f32 v216, v216, v179
    v_cvt_pk_bf16_f32 v176, v176, v177
    v_cvt_pk_bf16_f32 v177, v178, v179
    s_waitcnt lgkmcnt(0)
    v_cmp_lt_u32 s[56:57], v248, 44
    s_nop 0
    s_cmp_eq_u64 s[56:57], 0
    s_cbranch_scc0 G1_fb17
G1_fb17_ret:
    ds_write_b128 v243, v[56:59] offset:0
    s_add_u32 m0, s41, 0
    s_mov_b32 s52, 147456
    buffer_load_dwordx4 v238, s[12:15], s52 offen offset:1024 nt lds
    buffer_load_dwordx4 v237, s[12:15], s52 offen offset:2048 nt lds
    buffer_load_dwordx4 v238, s[12:15], s52 offen offset:3072 nt lds
    s_waitcnt vmcnt(12)
    ds_read_b64_tr_b16 v[196:197], v224 offset:0
    ds_read_b64_tr_b16 v[198:199], v225 offset:0
    ds_read_b64_tr_b16 v[200:201], v226 offset:0
    ds_read_b64_tr_b16 v[202:203], v227 offset:0
    ds_read_b64_tr_b16 v[204:205], v228 offset:0
    ds_read_b64_tr_b16 v[206:207], v229 offset:0
    ds_read_b64_tr_b16 v[208:209], v230 offset:0
    ds_read_b64_tr_b16 v[210:211], v231 offset:0
    ds_read_b32 v248, v240 offset:16
    s_waitcnt lgkmcnt(9)
    v_mov_b32 v242, 200
    s_mov_b32 m0, s43
    s_mov_b64 exec, 1
    global_load_lds_dword v242, s[48:49]
    s_mov_b64 exec, -1
    s_waitcnt lgkmcnt(0)
    s_setprio 3
    v_mfma_f32_16x16x16_bf16 v[128:131], v[196:197], v[176:177], v[128:131]
    v_mfma_f32_16x16x16_bf16 v[132:135], v[198:199], v[176:177], v[132:135]
    v_mfma_f32_16x16x16_bf16 v[136:139], v[200:201], v[176:177], v[136:139]
    v_mfma_f32_16x16x16_bf16 v[140:143], v[202:203], v[176:177], v[140:143]
    v_mfma_f32_16x16x16_bf16 v[144:147], v[204:205], v[176:177], v[144:147]
    v_mfma_f32_16x16x16_bf16 v[148:151], v[206:207], v[176:177], v[148:151]
    v_mfma_f32_16x16x16_bf16 v[152:155], v[208:209], v[176:177], v[152:155]
    v_mfma_f32_16x16x16_bf16 v[156:159], v[210:211], v[176:177], v[156:159]
    s_setprio 3
    v_cmp_lt_u32 s[56:57], v248, 45
    s_nop 0
    s_cmp_eq_u64 s[56:57], 0
    s_cbranch_scc0 G1_fb18
G1_fb18_ret:
    ds_write_b128 v247, v[60:63] offset:32768
    ds_write_b128 v247, v[64:67] offset:35840
    s_add_u32 m0, s41, 81920
    s_mov_b32 s52, 131072
    buffer_load_dwordx4 v238, s[16:19], s52 offen offset:1024 nt lds
    buffer_load_dwordx4 v237, s[16:19], s52 offen offset:2048 nt lds
    ds_read_b128 v[180:183], v220 offset:16384
    ds_read_b128 v[184:187], v221 offset:16384
    ds_read_b128 v[188:191], v222 offset:16384
    ds_read_b128 v[192:195], v223 offset:16384
    ds_read_b32 v248, v240 offset:16
    s_waitcnt lgkmcnt(5)
    v_mov_b32 v242, 204
    s_mov_b32 m0, s43
    s_mov_b64 exec, 1
    global_load_lds_dword v242, s[48:49]
    s_mov_b64 exec, -1
    s_waitcnt lgkmcnt(4)
    v_mfma_f32_16x16x32_bf16 v[176:179], v[180:183], v[160:163], v[212:215]
    s_waitcnt lgkmcnt(3)
    v_mfma_f32_16x16x32_bf16 v[176:179], v[184:187], v[164:167], v[176:179]
    s_waitcnt lgkmcnt(2)
    v_mfma_f32_16x16x32_bf16 v[176:179], v[188:191], v[168:171], v[176:179]
    s_waitcnt lgkmcnt(1)
    v_mfma_f32_16x16x32_bf16 v[176:179], v[192:195], v[172:175], v[176:179]
    s_nop 7
    v_max_f32 v217, v176, v177
    v_max3_f32 v217, v178, v179, v217
    v_cmp_lt_f32 vcc, s50, v217
    s_nop 1
    s_cbranch_vccnz G1_g7
G1_g7_ret:
    v_exp_f32 v176, v176
    v_exp_f32 v177, v177
    v_exp_f32 v178, v178
    v_exp_f32 v179, v179
    v_add_f32 v216, v216, v176
    v_add_f32 v216, v216, v177
    v_add_f32 v216, v216, v178
    v_add_f32 v216, v216, v179
    v_cvt_pk_bf16_f32 v176, v176, v177
    v_cvt_pk_bf16_f32 v177, v178, v179
    s_waitcnt lgkmcnt(0)
    v_cmp_lt_u32 s[56:57], v248, 46
    s_nop 0
    s_cmp_eq_u64 s[56:57], 0
    s_cbranch_scc0 G1_fb19
G1_fb19_ret:
    ds_write_b128 v243, v[68:71] offset:19456
    s_add_u32 m0, s41, 16384
    s_mov_b32 s52, 163840
    buffer_load_dwordx4 v237, s[12:15], s52 offen offset:0 nt lds
    buffer_load_dwordx4 v238, s[12:15], s52 offen offset:1024 nt lds
    buffer_load_dwordx4 v237, s[12:15], s52 offen offset:2048 nt lds
    s_waitcnt vmcnt(11)
    ds_read_b64_tr_b16 v[196:197], v224 offset:16384
    ds_read_b64_tr_b16 v[198:199], v225 offset:16384
    ds_read_b64_tr_b16 v[200:201], v226 offset:16384
    ds_read_b64_tr_b16 v[202:203], v227 offset:16384
    ds_read_b64_tr_b16 v[204:205], v228 offset:16384
    ds_read_b64_tr_b16 v[206:207], v229 offset:16384
    ds_read_b64_tr_b16 v[208:209], v230 offset:16384
    ds_read_b64_tr_b16 v[210:211], v231 offset:16384
    ds_read_b32 v248, v240 offset:16
    s_waitcnt lgkmcnt(9)
    v_mov_b32 v242, 208
    s_mov_b32 m0, s43
    s_mov_b64 exec, 1
    global_load_lds_dword v242, s[48:49]
    s_mov_b64 exec, -1
    s_waitcnt lgkmcnt(0)
    s_setprio 3
    v_mfma_f32_16x16x16_bf16 v[128:131], v[196:197], v[176:177], v[128:131]
    v_mfma_f32_16x16x16_bf16 v[132:135], v[198:199], v[176:177], v[132:135]
    v_mfma_f32_16x16x16_bf16 v[136:139], v[200:201], v[176:177], v[136:139]
    v_mfma_f32_16x16x16_bf16 v[140:143], v[202:203], v[176:177], v[140:143]
    v_mfma_f32_16x16x16_bf16 v[144:147], v[204:205], v[176:177], v[144:147]
    v_mfma_f32_16x16x16_bf16 v[148:151], v[206:207], v[176:177], v[148:151]
    v_mfma_f32_16x16x16_bf16 v[152:155], v[208:209], v[176:177], v[152:155]
    v_mfma_f32_16x16x16_bf16 v[156:159], v[210:211], v[176:177], v[156:159]
    s_setprio 3
    v_mov_b32 v217, v216
    s_nop 1
    v_permlane32_swap_b32 v217, v216
    v_add_f32 v216, v216, v217
    v_mov_b32 v217, v216
    s_nop 1
    v_permlane16_swap_b32 v217, v216
    v_add_f32 v216, v216, v217
    v_lshlrev_b32 v246, 4, v239
    s_xor_b32 s44, s24, 1
    s_mul_i32 s44, s44, 6144
    s_add_u32 s44, s44, 98304
    v_add_u32 v244, s44, v246
    ds_write_b128 v244, v[136:139] offset:0
    ds_write_b128 v244, v[140:143] offset:1024
    s_xor_b32 s44, s24, 2
    s_mul_i32 s44, s44, 6144
    s_add_u32 s44, s44, 100352
    v_add_u32 v244, s44, v246
    ds_write_b128 v244, v[144:147] offset:0
    ds_write_b128 v244, v[148:151] offset:1024
    s_xor_b32 s44, s24, 3
    s_mul_i32 s44, s44, 6144
    s_add_u32 s44, s44, 102400
    v_add_u32 v244, s44, v246
    ds_write_b128 v244, v[152:155] offset:0
    ds_write_b128 v244, v[156:159] offset:1024
    s_lshl_b32 s44, s24, 9
    s_add_u32 s44, s44, 122880
    v_lshl_add_u32 v245, v239, 3, s44
    v_mov_b32 v213, v216
    v_mov_b32 v218, 1
    ds_write_b64 v245, v[212:213]
    ds_write_b32 v241, v218 offset:48
    v_mov_b32 v0, v128
    v_mov_b32 v1, v129
    v_mov_b32 v2, v130
    v_mov_b32 v3, v131
    v_mov_b32 v4, v132
    v_mov_b32 v5, v133
    v_mov_b32 v6, v134
    v_mov_b32 v7, v135
    s_waitcnt lgkmcnt(0)
    s_sub_u32 s44, 159488, s41
    v_add_u32 v248, s44, v243
    ds_read_b128 v[160:163], v248 offset:0
    ds_read_b128 v[164:167], v248 offset:1024
    ds_read_b128 v[168:171], v248 offset:2048
    ds_read_b128 v[172:175], v248 offset:3072
    v_mov_b32 v212, 0
    v_mov_b32 v213, 0
    v_mov_b32 v214, 0
    v_mov_b32 v215, 0
    s_waitcnt lgkmcnt(0)
    ds_read_b32 v248, v240 offset:16
    s_waitcnt lgkmcnt(0)
    v_cmp_lt_u32 s[56:57], v248, 47
    s_nop 0
    s_cmp_eq_u64 s[56:57], 0
    s_cbranch_scc0 G1_fb20
G1_fb20_ret:
    ds_write_b128 v243, v[72:75] offset:51200
    s_add_u32 m0, s41, 49152
    s_mov_b32 s52, 147456
    buffer_load_dwordx4 v237, s[16:19], s52 offen offset:0 nt lds
    buffer_load_dwordx4 v238, s[16:19], s52 offen offset:1024 nt lds
    buffer_load_dwordx4 v238, s[16:19], s52 offen offset:3072 nt lds
    ds_read_b128 v[180:183], v220 offset:32768
    ds_read_b128 v[184:187], v221 offset:32768
    ds_read_b128 v[188:191], v222 offset:32768
    ds_read_b128 v[192:195], v223 offset:32768
    ds_read_b32 v248, v240 offset:16
    s_waitcnt lgkmcnt(5)
    v_mov_b32 v242, 212
    s_mov_b32 m0, s43
    s_mov_b64 exec, 1
    global_load_lds_dword v242, s[48:49]
    s_mov_b64 exec, -1
    s_waitcnt lgkmcnt(4)
    v_mfma_f32_16x16x32_bf16 v[176:179], v[180:183], v[160:163], v[212:215]
    s_waitcnt lgkmcnt(3)
    v_mfma_f32_16x16x32_bf16 v[176:179], v[184:187], v[164:167], v[176:179]
    s_waitcnt lgkmcnt(2)
    v_mfma_f32_16x16x32_bf16 v[176:179], v[188:191], v[168:171], v[176:179]
    s_waitcnt lgkmcnt(1)
    v_mfma_f32_16x16x32_bf16 v[176:179], v[192:195], v[172:175], v[176:179]
    s_nop 7
    v_max_f32 v217, v176, v177
    v_max3_f32 v217, v178, v179, v217
    v_mov_b32 v218, v217
    s_nop 1
    v_permlane32_swap_b32 v218, v217
    v_max_f32 v217, v217, v218
    v_mov_b32 v218, v217
    s_nop 1
    v_permlane16_swap_b32 v218, v217
    v_max_f32 v217, v217, v218
    v_sub_f32 v212, 0, v217
    v_sub_f32 v176, v176, v217
    v_sub_f32 v213, 0, v217
    v_sub_f32 v177, v177, v217
    v_sub_f32 v214, 0, v217
    v_sub_f32 v178, v178, v217
    v_sub_f32 v215, 0, v217
    v_sub_f32 v179, v179, v217
    v_mov_b32 v216, 0
    v_exp_f32 v176, v176
    v_exp_f32 v177, v177
    v_exp_f32 v178, v178
    v_exp_f32 v179, v179
    v_add_f32 v216, v216, v176
    v_add_f32 v216, v216, v177
    v_add_f32 v216, v216, v178
    v_add_f32 v216, v216, v179
    v_cvt_pk_bf16_f32 v176, v176, v177
    v_cvt_pk_bf16_f32 v177, v178, v179
    s_waitcnt lgkmcnt(0)
    v_cmp_lt_u32 s[56:57], v248, 48
    s_nop 0
    s_cmp_eq_u64 s[56:57], 0
    s_cbranch_scc0 G1_fb21
G1_fb21_ret:
    ds_write_b128 v243, v[76:79] offset:33792
    s_add_u32 m0, s41, 32768
    s_mov_b32 s52, 180224
    buffer_load_dwordx4 v237, s[12:15], s52 offen offset:0 nt lds
    buffer_load_dwordx4 v237, s[12:15], s52 offen offset:2048 nt lds
    buffer_load_dwordx4 v238, s[12:15], s52 offen offset:3072 nt lds
    s_waitcnt vmcnt(12)
    ds_read_b64_tr_b16 v[196:197], v224 offset:32768
    ds_read_b64_tr_b16 v[198:199], v225 offset:32768
    ds_read_b64_tr_b16 v[200:201], v226 offset:32768
    ds_read_b64_tr_b16 v[202:203], v227 offset:32768
    ds_read_b64_tr_b16 v[204:205], v228 offset:32768
    ds_read_b64_tr_b16 v[206:207], v229 offset:32768
    ds_read_b64_tr_b16 v[208:209], v230 offset:32768
    ds_read_b64_tr_b16 v[210:211], v231 offset:32768
    ds_read_b32 v248, v240 offset:16
    s_waitcnt lgkmcnt(9)
    v_mov_b32 v242, 216
    s_mov_b32 m0, s43
    s_mov_b64 exec, 1
    global_load_lds_dword v242, s[48:49]
    s_mov_b64 exec, -1
    s_waitcnt lgkmcnt(0)
    s_setprio 3
    v_mfma_f32_16x16x16_bf16 v[128:131], v[196:197], v[176:177], 0
    v_mfma_f32_16x16x16_bf16 v[132:135], v[198:199], v[176:177], 0
    v_mfma_f32_16x16x16_bf16 v[136:139], v[200:201], v[176:177], 0
    v_mfma_f32_16x16x16_bf16 v[140:143], v[202:203], v[176:177], 0
    v_mfma_f32_16x16x16_bf16 v[144:147], v[204:205], v[176:177], 0
    v_mfma_f32_16x16x16_bf16 v[148:151], v[206:207], v[176:177], 0
    v_mfma_f32_16x16x16_bf16 v[152:155], v[208:209], v[176:177], 0
    v_mfma_f32_16x16x16_bf16 v[156:159], v[210:211], v[176:177], 0
    s_setprio 3
    v_lshlrev_b32 v246, 4, v239
    s_mov_b32 s59, 262144
G1_gb10:
    ds_read_b32 v249, v240 offset:48
    s_waitcnt lgkmcnt(0)
    v_cmp_lt_u32 s[56:57], v249, 1
    s_nop 0
    s_cmp_eq_u64 s[56:57], 0
    s_cbranch_scc1 G1_gb10_ok
    s_sleep 1
    s_sub_u32 s59, s59, 1
    s_cmp_lg_u32 s59, 0
    s_cbranch_scc1 G1_gb10
G1_gb10_ok:
    s_xor_b32 s44, s24, 0
    s_lshl_b32 s44, s44, 9
    s_add_u32 s44, s44, 122880
    v_lshl_add_u32 v245, v239, 3, s44
    ds_read_b64 v[32:33], v245
    s_xor_b32 s44, s24, 1
    s_lshl_b32 s44, s44, 9
    s_add_u32 s44, s44, 122880
    v_lshl_add_u32 v245, v239, 3, s44
    ds_read_b64 v[34:35], v245
    s_xor_b32 s44, s24, 2
    s_lshl_b32 s44, s44, 9
    s_add_u32 s44, s44, 122880
    v_lshl_add_u32 v245, v239, 3, s44
    ds_read_b64 v[36:37], v245
    s_xor_b32 s44, s24, 3
    s_lshl_b32 s44, s44, 9
    s_add_u32 s44, s44, 122880
    v_lshl_add_u32 v245, v239, 3, s44
    ds_read_b64 v[38:39], v245
    s_mul_i32 s44, s24, 6144
    s_add_u32 s44, s44, 98304
    v_add_u32 v244, s44, v246
    ds_read_b128 v[8:11], v244 offset:0
    ds_read_b128 v[12:15], v244 offset:1024
    ds_read_b128 v[16:19], v244 offset:2048
    ds_read_b128 v[20:23], v244 offset:3072
    ds_read_b128 v[24:27], v244 offset:4096
    ds_read_b128 v[28:31], v244 offset:5120
    s_waitcnt lgkmcnt(8)
    v_min_f32 v217, v32, v34
    s_waitcnt lgkmcnt(6)
    v_min3_f32 v217, v36, v38, v217
    v_sub_f32 v32, v217, v32
    v_sub_f32 v34, v217, v34
    v_sub_f32 v36, v217, v36
    v_sub_f32 v38, v217, v38
    v_exp_f32 v32, v32
    v_exp_f32 v34, v34
    v_exp_f32 v36, v36
    v_exp_f32 v38, v38
    v_mul_f32 v217, v32, v33
    v_fma_f32 v217, v34, v35, v217
    v_fma_f32 v217, v36, v37, v217
    v_fma_f32 v217, v38, v39, v217
    v_rcp_f32 v217, v217
    s_nop 0
    v_mul_f32 v32, v32, v217
    v_mul_f32 v34, v34, v217
    v_mul_f32 v36, v36, v217
    v_mul_f32 v38, v38, v217
    v_mul_f32 v0, v0, v32
    v_mul_f32 v1, v1, v32
    v_mul_f32 v2, v2, v32
    v_mul_f32 v3, v3, v32
    v_mul_f32 v4, v4, v32
    v_mul_f32 v5, v5, v32
    v_mul_f32 v6, v6, v32
    v_mul_f32 v7, v7, v32
    s_waitcnt lgkmcnt(5)
    v_fma_f32 v0, v8, v34, v0
    v_fma_f32 v1, v9, v34, v1
    v_fma_f32 v2, v10, v34, v2
    v_fma_f32 v3, v11, v34, v3
    s_waitcnt lgkmcnt(4)
    v_fma_f32 v4, v12, v34, v4
    v_fma_f32 v5, v13, v34, v5
    v_fma_f32 v6, v14, v34, v6
    v_fma_f32 v7, v15, v34, v7
    s_waitcnt lgkmcnt(3)
    v_fma_f32 v0, v16, v36, v0
    v_fma_f32 v1, v17, v36, v1
    v_fma_f32 v2, v18, v36, v2
    v_fma_f32 v3, v19, v36, v3
    s_waitcnt lgkmcnt(2)
    v_fma_f32 v4, v20, v36, v4
    v_fma_f32 v5, v21, v36, v5
    v_fma_f32 v6, v22, v36, v6
    v_fma_f32 v7, v23, v36, v7
    s_waitcnt lgkmcnt(1)
    v_fma_f32 v0, v24, v38, v0
    v_fma_f32 v1, v25, v38, v1
    v_fma_f32 v2, v26, v38, v2
    v_fma_f32 v3, v27, v38, v3
    s_waitcnt lgkmcnt(0)
    v_fma_f32 v4, v28, v38, v4
    v_fma_f32 v5, v29, v38, v5
    v_fma_f32 v6, v30, v38, v6
    v_fma_f32 v7, v31, v38, v7
    v_cvt_pk_bf16_f32 v0, v0, v1
    v_cvt_pk_bf16_f32 v1, v2, v3
    v_cvt_pk_bf16_f32 v2, v4, v5
    v_cvt_pk_bf16_f32 v3, v6, v7
    s_mul_i32 s45, s24, 9216
    s_add_u32 s45, s45, 8192
    buffer_store_dwordx4 v[0:3], v246, s[20:23], s45 offen sc1
    v_cmp_lt_u32 s[56:57], v248, 49
    s_nop 0
    s_cmp_eq_u64 s[56:57], 0
    s_cbranch_scc0 G1_fb22
G1_fb22_ret:
    ds_write_b128 v247, v[80:83] offset:17408
    s_add_u32 m0, s41, 65536
    s_mov_b32 s52, 163840
    buffer_load_dwordx4 v237, s[16:19], s52 offen offset:0 nt lds
    buffer_load_dwordx4 v237, s[16:19], s52 offen offset:2048 nt lds
    buffer_load_dwordx4 v238, s[16:19], s52 offen offset:3072 nt lds
    ds_read_b128 v[180:183], v220 offset:0
    ds_read_b128 v[184:187], v221 offset:0
    ds_read_b128 v[188:191], v222 offset:0
    ds_read_b128 v[192:195], v223 offset:0
    ds_read_b32 v248, v240 offset:16
    s_waitcnt lgkmcnt(5)
    v_mov_b32 v242, 220
    s_mov_b32 m0, s43
    s_mov_b64 exec, 1
    global_load_lds_dword v242, s[48:49]
    s_mov_b64 exec, -1
    s_waitcnt lgkmcnt(4)
    v_mfma_f32_16x16x32_bf16 v[176:179], v[180:183], v[160:163], v[212:215]
    s_waitcnt lgkmcnt(3)
    v_mfma_f32_16x16x32_bf16 v[176:179], v[184:187], v[164:167], v[176:179]
    s_waitcnt lgkmcnt(2)
    v_mfma_f32_16x16x32_bf16 v[176:179], v[188:191], v[168:171], v[176:179]
    s_waitcnt lgkmcnt(1)
    v_mfma_f32_16x16x32_bf16 v[176:179], v[192:195], v[172:175], v[176:179]
    s_nop 7
    v_max_f32 v217, v176, v177
    v_max3_f32 v217, v178, v179, v217
    v_cmp_lt_f32 vcc, s50, v217
    s_nop 1
    s_cbranch_vccnz G1_g9
G1_g9_ret:
    v_exp_f32 v176, v176
    v_exp_f32 v177, v177
    v_exp_f32 v178, v178
    v_exp_f32 v179, v179
    v_add_f32 v216, v216, v176
    v_add_f32 v216, v216, v177
    v_add_f32 v216, v216, v178
    v_add_f32 v216, v216, v179
    v_cvt_pk_bf16_f32 v176, v176, v177
    v_cvt_pk_bf16_f32 v177, v178, v179
    s_waitcnt lgkmcnt(0)
    v_cmp_lt_u32 s[56:57], v248, 50
    s_nop 0
    s_cmp_eq_u64 s[56:57], 0
    s_cbranch_scc0 G1_fb23
G1_fb23_ret:
    ds_write_b128 v243, v[84:87] offset:0
    ds_write_b128 v243, v[88:91] offset:3072
    s_add_u32 m0, s41, 0
    s_mov_b32 s52, 196608
    buffer_load_dwordx4 v238, s[12:15], s52 offen offset:1024 nt lds
    buffer_load_dwordx4 v237, s[12:15], s52 offen offset:2048 nt lds
    s_waitcnt vmcnt(12)
    ds_read_b64_tr_b16 v[196:197], v224 offset:0
    ds_read_b64_tr_b16 v[198:199], v225 offset:0
    ds_read_b64_tr_b16 v[200:201], v226 offset:0
    ds_read_b64_tr_b16 v[202:203], v227 offset:0
    ds_read_b64_tr_b16 v[204:205], v228 offset:0
    ds_read_b64_tr_b16 v[206:207], v229 offset:0
    ds_read_b64_tr_b16 v[208:209], v230 offset:0
    ds_read_b64_tr_b16 v[210:211], v231 offset:0
    ds_read_b32 v248, v240 offset:16
    s_waitcnt lgkmcnt(9)
    v_mov_b32 v242, 224
    s_mov_b32 m0, s43
    s_mov_b64 exec, 1
    global_load_lds_dword v242, s[48:49]
    s_mov_b64 exec, -1
    s_waitcnt lgkmcnt(0)
    s_setprio 3
    v_mfma_f32_16x16x16_bf16 v[128:131], v[196:197], v[176:177], v[128:131]
    v_mfma_f32_16x16x16_bf16 v[132:135], v[198:199], v[176:177], v[132:135]
    v_mfma_f32_16x16x16_bf16 v[136:139], v[200:201], v[176:177], v[136:139]
    v_mfma_f32_16x16x16_bf16 v[140:143], v[202:203], v[176:177], v[140:143]
    v_mfma_f32_16x16x16_bf16 v[144:147], v[204:205], v[176:177], v[144:147]
    v_mfma_f32_16x16x16_bf16 v[148:151], v[206:207], v[176:177], v[148:151]
    v_mfma_f32_16x16x16_bf16 v[152:155], v[208:209], v[176:177], v[152:155]
    v_mfma_f32_16x16x16_bf16 v[156:159], v[210:211], v[176:177], v[156:159]
    s_setprio 3
    v_cmp_lt_u32 s[56:57], v248, 51
    s_nop 0
    s_cmp_eq_u64 s[56:57], 0
    s_cbranch_scc0 G1_fb24
G1_fb24_ret:
    ds_write_b128 v247, v[92:95] offset:35840
    s_add_u32 m0, s41, 81920
    s_mov_b32 s52, 180224
    buffer_load_dwordx4 v237, s[16:19], s52 offen offset:0 nt lds
    buffer_load_dwordx4 v238, s[16:19], s52 offen offset:1024 nt lds
    buffer_load_dwordx4 v237, s[16:19], s52 offen offset:2048 nt lds
    ds_read_b128 v[180:183], v220 offset:16384
    ds_read_b128 v[184:187], v221 offset:16384
    ds_read_b128 v[188:191], v222 offset:16384
    ds_read_b128 v[192:195], v223 offset:16384
    ds_read_b32 v248, v240 offset:16
    s_waitcnt lgkmcnt(5)
    v_mov_b32 v242, 228
    s_mov_b32 m0, s43
    s_mov_b64 exec, 1
    global_load_lds_dword v242, s[48:49]
    s_mov_b64 exec, -1
    s_waitcnt lgkmcnt(4)
    v_mfma_f32_16x16x32_bf16 v[176:179], v[180:183], v[160:163], v[212:215]
    s_waitcnt lgkmcnt(3)
    v_mfma_f32_16x16x32_bf16 v[176:179], v[184:187], v[164:167], v[176:179]
    s_waitcnt lgkmcnt(2)
    v_mfma_f32_16x16x32_bf16 v[176:179], v[188:191], v[168:171], v[176:179]
    s_waitcnt lgkmcnt(1)
    v_mfma_f32_16x16x32_bf16 v[176:179], v[192:195], v[172:175], v[176:179]
    s_nop 7
    v_max_f32 v217, v176, v177
    v_max3_f32 v217, v178, v179, v217
    v_cmp_lt_f32 vcc, s50, v217
    s_nop 1
    s_cbranch_vccnz G1_g10
G1_g10_ret:
    v_exp_f32 v176, v176
    v_exp_f32 v177, v177
    v_exp_f32 v178, v178
    v_exp_f32 v179, v179
    v_add_f32 v216, v216, v176
    v_add_f32 v216, v216, v177
    v_add_f32 v216, v216, v178
    v_add_f32 v216, v216, v179
    v_cvt_pk_bf16_f32 v176, v176, v177
    v_cvt_pk_bf16_f32 v177, v178, v179
    s_waitcnt vmcnt(11)
    v_mov_b32 v218, 1
    ds_write_b32 v241, v218 offset:80
    s_waitcnt lgkmcnt(1)
    v_cmp_lt_u32 s[56:57], v248, 52
    s_nop 0
    s_cmp_eq_u64 s[56:57], 0
    s_cbranch_scc0 G1_fb25
G1_fb25_ret:
    ds_write_b128 v243, v[96:99] offset:18432
    s_add_u32 m0, s41, 16384
    s_mov_b32 s52, 212992
    buffer_load_dwordx4 v237, s[12:15], s52 offen offset:0 nt lds
    buffer_load_dwordx4 v238, s[12:15], s52 offen offset:1024 nt lds
    buffer_load_dwordx4 v238, s[12:15], s52 offen offset:3072 nt lds
    s_waitcnt vmcnt(11)
    ds_read_b64_tr_b16 v[196:197], v224 offset:16384
    ds_read_b64_tr_b16 v[198:199], v225 offset:16384
    ds_read_b64_tr_b16 v[200:201], v226 offset:16384
    ds_read_b64_tr_b16 v[202:203], v227 offset:16384
    ds_read_b64_tr_b16 v[204:205], v228 offset:16384
    ds_read_b64_tr_b16 v[206:207], v229 offset:16384
    ds_read_b64_tr_b16 v[208:209], v230 offset:16384
    ds_read_b64_tr_b16 v[210:211], v231 offset:16384
    ds_read_b32 v248, v240 offset:16
    s_waitcnt lgkmcnt(9)
    v_mov_b32 v242, 232
    s_mov_b32 m0, s43
    s_mov_b64 exec, 1
    global_load_lds_dword v242, s[48:49]
    s_mov_b64 exec, -1
    s_waitcnt lgkmcnt(0)
    s_setprio 3
    v_mfma_f32_16x16x16_bf16 v[128:131], v[196:197], v[176:177], v[128:131]
    v_mfma_f32_16x16x16_bf16 v[132:135], v[198:199], v[176:177], v[132:135]
    v_mfma_f32_16x16x16_bf16 v[136:139], v[200:201], v[176:177], v[136:139]
    v_mfma_f32_16x16x16_bf16 v[140:143], v[202:203], v[176:177], v[140:143]
    v_mfma_f32_16x16x16_bf16 v[144:147], v[204:205], v[176:177], v[144:147]
    v_mfma_f32_16x16x16_bf16 v[148:151], v[206:207], v[176:177], v[148:151]
    v_mfma_f32_16x16x16_bf16 v[152:155], v[208:209], v[176:177], v[152:155]
    v_mfma_f32_16x16x16_bf16 v[156:159], v[210:211], v[176:177], v[156:159]
    s_setprio 3
    v_cmp_lt_u32 s[56:57], v248, 53
    s_nop 0
    s_cmp_eq_u64 s[56:57], 0
    s_cbranch_scc0 G1_fb26
G1_fb26_ret:
    ds_write_b128 v243, v[100:103] offset:51200
    s_add_u32 m0, s41, 49152
    s_mov_b32 s52, 196608
    buffer_load_dwordx4 v237, s[16:19], s52 offen offset:0 nt lds
    buffer_load_dwordx4 v238, s[16:19], s52 offen offset:1024 nt lds
    buffer_load_dwordx4 v238, s[16:19], s52 offen offset:3072 nt lds
    ds_read_b128 v[180:183], v220 offset:32768
    ds_read_b128 v[184:187], v221 offset:32768
    ds_read_b128 v[188:191], v222 offset:32768
    ds_read_b128 v[192:195], v223 offset:32768
    ds_read_b32 v248, v240 offset:16
    s_waitcnt lgkmcnt(5)
    v_mov_b32 v242, 236
    s_mov_b32 m0, s43
    s_mov_b64 exec, 1
    global_load_lds_dword v242, s[48:49]
    s_mov_b64 exec, -1
    s_waitcnt lgkmcnt(4)
    v_mfma_f32_16x16x32_bf16 v[176:179], v[180:183], v[160:163], v[212:215]
    s_waitcnt lgkmcnt(3)
    v_mfma_f32_16x16x32_bf16 v[176:179], v[184:187], v[164:167], v[176:179]
    s_waitcnt lgkmcnt(2)
    v_mfma_f32_16x16x32_bf16 v[176:179], v[188:191], v[168:171], v[176:179]
    s_waitcnt lgkmcnt(1)
    v_mfma_f32_16x16x32_bf16 v[176:179], v[192:195], v[172:175], v[176:179]
    s_nop 7
    v_max_f32 v217, v176, v177
    v_max3_f32 v217, v178, v179, v217
    v_cmp_lt_f32 vcc, s50, v217
    s_nop 1
    s_cbranch_vccnz G1_g11
G1_g11_ret:
    v_exp_f32 v176, v176
    v_exp_f32 v177, v177
    v_exp_f32 v178, v178
    v_exp_f32 v179, v179
    v_add_f32 v216, v216, v176
    v_add_f32 v216, v216, v177
    v_add_f32 v216, v216, v178
    v_add_f32 v216, v216, v179
    v_cvt_pk_bf16_f32 v176, v176, v177
    v_cvt_pk_bf16_f32 v177, v178, v179
    s_cmp_lg_u32 s24, 0
    s_cbranch_scc1 G1_nosig
    s_mov_b32 s59, 262144
G1_siga:
    ds_read_b32 v250, v240 offset:64
    s_waitcnt lgkmcnt(0)
    v_cmp_lt_u32 s[56:57], v250, 1
    s_nop 0
    s_cmp_eq_u64 s[56:57], 0
    s_cbranch_scc1 G1_siga_ok
    s_sleep 1
    s_sub_u32 s59, s59, 1
    s_cmp_lg_u32 s59, 0
    s_cbranch_scc1 G1_siga
G1_siga_ok:
    s_mov_b32 s59, 262144
G1_sigb:
    ds_read_b32 v250, v240 offset:80
    s_waitcnt lgkmcnt(0)
    v_cmp_lt_u32 s[56:57], v250, 1
    s_nop 0
    s_cmp_eq_u64 s[56:57], 0
    s_cbranch_scc1 G1_sigb_ok
    s_sleep 1
    s_sub_u32 s59, s59, 1
    s_cmp_lg_u32 s59, 0
    s_cbranch_scc1 G1_sigb
G1_sigb_ok:
    s_load_dwordx2 s[56:57], s[0:1], 48
    s_and_b32 s58, s25, 1
    s_lshl_b32 s58, s58, 6
    s_add_u32 s58, s58, s25
    s_and_b32 s58, s58, 0xfe
    s_lshl_b32 s58, s58, 1
    v_mov_b32 v250, s58
    v_mov_b32 v251, 1
    s_waitcnt lgkmcnt(0)
    s_mov_b64 exec, 1
    global_atomic_add v250, v251, s[56:57] sc1
    s_mov_b64 exec, -1
G1_nosig:
    s_waitcnt lgkmcnt(0)
    v_cmp_lt_u32 s[56:57], v248, 54
    s_nop 0
    s_cmp_eq_u64 s[56:57], 0
    s_cbranch_scc0 G1_fb27
G1_fb27_ret:
    ds_write_b128 v243, v[104:107] offset:33792
    s_add_u32 m0, s41, 32768
    s_mov_b32 s52, 229376
    buffer_load_dwordx4 v237, s[12:15], s52 offen offset:0 nt lds
    buffer_load_dwordx4 v237, s[12:15], s52 offen offset:2048 nt lds
    buffer_load_dwordx4 v238, s[12:15], s52 offen offset:3072 nt lds
    s_waitcnt vmcnt(12)
    ds_read_b64_tr_b16 v[196:197], v224 offset:32768
    ds_read_b64_tr_b16 v[198:199], v225 offset:32768
    ds_read_b64_tr_b16 v[200:201], v226 offset:32768
    ds_read_b64_tr_b16 v[202:203], v227 offset:32768
    ds_read_b64_tr_b16 v[204:205], v228 offset:32768
    ds_read_b64_tr_b16 v[206:207], v229 offset:32768
    ds_read_b64_tr_b16 v[208:209], v230 offset:32768
    ds_read_b64_tr_b16 v[210:211], v231 offset:32768
    ds_read_b32 v248, v240 offset:16
    s_waitcnt lgkmcnt(9)
    v_mov_b32 v242, 240
    s_mov_b32 m0, s43
    s_mov_b64 exec, 1
    global_load_lds_dword v242, s[48:49]
    s_mov_b64 exec, -1
    s_waitcnt lgkmcnt(0)
    s_setprio 3
    v_mfma_f32_16x16x16_bf16 v[128:131], v[196:197], v[176:177], v[128:131]
    v_mfma_f32_16x16x16_bf16 v[132:135], v[198:199], v[176:177], v[132:135]
    v_mfma_f32_16x16x16_bf16 v[136:139], v[200:201], v[176:177], v[136:139]
    v_mfma_f32_16x16x16_bf16 v[140:143], v[202:203], v[176:177], v[140:143]
    v_mfma_f32_16x16x16_bf16 v[144:147], v[204:205], v[176:177], v[144:147]
    v_mfma_f32_16x16x16_bf16 v[148:151], v[206:207], v[176:177], v[148:151]
    v_mfma_f32_16x16x16_bf16 v[152:155], v[208:209], v[176:177], v[152:155]
    v_mfma_f32_16x16x16_bf16 v[156:159], v[210:211], v[176:177], v[156:159]
    s_setprio 3
    v_cmp_lt_u32 s[56:57], v248, 55
    s_nop 0
    s_cmp_eq_u64 s[56:57], 0
    s_cbranch_scc0 G1_fb28
G1_fb28_ret:
    ds_write_b128 v247, v[108:111] offset:16384
    s_add_u32 m0, s41, 65536
    s_mov_b32 s52, 212992
    buffer_load_dwordx4 v238, s[16:19], s52 offen offset:1024 nt lds
    buffer_load_dwordx4 v237, s[16:19], s52 offen offset:2048 nt lds
    buffer_load_dwordx4 v238, s[16:19], s52 offen offset:3072 nt lds
    ds_read_b128 v[180:183], v220 offset:0
    ds_read_b128 v[184:187], v221 offset:0
    ds_read_b128 v[188:191], v222 offset:0
    ds_read_b128 v[192:195], v223 offset:0
    ds_read_b32 v248, v240 offset:16
    s_waitcnt lgkmcnt(5)
    v_mov_b32 v242, 244
    s_mov_b32 m0, s43
    s_mov_b64 exec, 1
    global_load_lds_dword v242, s[48:49]
    s_mov_b64 exec, -1
    s_waitcnt lgkmcnt(4)
    v_mfma_f32_16x16x32_bf16 v[176:179], v[180:183], v[160:163], v[212:215]
    s_waitcnt lgkmcnt(3)
    v_mfma_f32_16x16x32_bf16 v[176:179], v[184:187], v[164:167], v[176:179]
    s_waitcnt lgkmcnt(2)
    v_mfma_f32_16x16x32_bf16 v[176:179], v[188:191], v[168:171], v[176:179]
    s_waitcnt lgkmcnt(1)
    v_mfma_f32_16x16x32_bf16 v[176:179], v[192:195], v[172:175], v[176:179]
    s_nop 7
    v_max_f32 v217, v176, v177
    v_max3_f32 v217, v178, v179, v217
    v_cmp_lt_f32 vcc, s50, v217
    s_nop 1
    s_cbranch_vccnz G1_g12
G1_g12_ret:
    v_exp_f32 v176, v176
    v_exp_f32 v177, v177
    v_exp_f32 v178, v178
    v_exp_f32 v179, v179
    v_add_f32 v216, v216, v176
    v_add_f32 v216, v216, v177
    v_add_f32 v216, v216, v178
    v_add_f32 v216, v216, v179
    v_cvt_pk_bf16_f32 v176, v176, v177
    v_cvt_pk_bf16_f32 v177, v178, v179
    s_waitcnt lgkmcnt(0)
    v_cmp_lt_u32 s[56:57], v248, 56
    s_nop 0
    s_cmp_eq_u64 s[56:57], 0
    s_cbranch_scc0 G1_fb29
G1_fb29_ret:
    ds_write_b128 v243, v[112:115] offset:0
    ds_write_b128 v243, v[116:119] offset:3072
    s_add_u32 m0, s41, 0
    s_mov_b32 s52, 245760
    buffer_load_dwordx4 v238, s[12:15], s52 offen offset:1024 nt lds
    buffer_load_dwordx4 v237, s[12:15], s52 offen offset:2048 nt lds
    s_waitcnt vmcnt(11)
    ds_read_b64_tr_b16 v[196:197], v224 offset:0
    ds_read_b64_tr_b16 v[198:199], v225 offset:0
    ds_read_b64_tr_b16 v[200:201], v226 offset:0
    ds_read_b64_tr_b16 v[202:203], v227 offset:0
    ds_read_b64_tr_b16 v[204:205], v228 offset:0
    ds_read_b64_tr_b16 v[206:207], v229 offset:0
    ds_read_b64_tr_b16 v[208:209], v230 offset:0
    ds_read_b64_tr_b16 v[210:211], v231 offset:0
    ds_read_b32 v248, v240 offset:16
    s_waitcnt lgkmcnt(9)
    v_mov_b32 v242, 248
    s_mov_b32 m0, s43
    s_mov_b64 exec, 1
    global_load_lds_dword v242, s[48:49]
    s_mov_b64 exec, -1
    s_waitcnt lgkmcnt(0)
    s_setprio 3
    v_mfma_f32_16x16x16_bf16 v[128:131], v[196:197], v[176:177], v[128:131]
    v_mfma_f32_16x16x16_bf16 v[132:135], v[198:199], v[176:177], v[132:135]
    v_mfma_f32_16x16x16_bf16 v[136:139], v[200:201], v[176:177], v[136:139]
    v_mfma_f32_16x16x16_bf16 v[140:143], v[202:203], v[176:177], v[140:143]
    v_mfma_f32_16x16x16_bf16 v[144:147], v[204:205], v[176:177], v[144:147]
    v_mfma_f32_16x16x16_bf16 v[148:151], v[206:207], v[176:177], v[148:151]
    v_mfma_f32_16x16x16_bf16 v[152:155], v[208:209], v[176:177], v[152:155]
    v_mfma_f32_16x16x16_bf16 v[156:159], v[210:211], v[176:177], v[156:159]
    s_setprio 3
    v_cmp_lt_u32 s[56:57], v248, 57
    s_nop 0
    s_cmp_eq_u64 s[56:57], 0
    s_cbranch_scc0 G1_fb30
G1_fb30_ret:
    ds_write_b128 v247, v[120:123] offset:34816
    s_add_u32 m0, s41, 81920
    s_mov_b32 s52, 229376
    buffer_load_dwordx4 v237, s[16:19], s52 offen offset:0 nt lds
    buffer_load_dwordx4 v238, s[16:19], s52 offen offset:1024 nt lds
    buffer_load_dwordx4 v238, s[16:19], s52 offen offset:3072 nt lds
    ds_read_b128 v[180:183], v220 offset:16384
    ds_read_b128 v[184:187], v221 offset:16384
    ds_read_b128 v[188:191], v222 offset:16384
    ds_read_b128 v[192:195], v223 offset:16384
    ds_read_b32 v248, v240 offset:16
    s_waitcnt lgkmcnt(5)
    v_mov_b32 v242, 252
    s_mov_b32 m0, s43
    s_mov_b64 exec, 1
    global_load_lds_dword v242, s[48:49]
    s_mov_b64 exec, -1
    s_waitcnt lgkmcnt(4)
    v_mfma_f32_16x16x32_bf16 v[176:179], v[180:183], v[160:163], v[212:215]
    s_waitcnt lgkmcnt(3)
    v_mfma_f32_16x16x32_bf16 v[176:179], v[184:187], v[164:167], v[176:179]
    s_waitcnt lgkmcnt(2)
    v_mfma_f32_16x16x32_bf16 v[176:179], v[188:191], v[168:171], v[176:179]
    s_waitcnt lgkmcnt(1)
    v_mfma_f32_16x16x32_bf16 v[176:179], v[192:195], v[172:175], v[176:179]
    s_nop 7
    v_max_f32 v217, v176, v177
    v_max3_f32 v217, v178, v179, v217
    v_cmp_lt_f32 vcc, s50, v217
    s_nop 1
    s_cbranch_vccnz G1_g13
G1_g13_ret:
    v_exp_f32 v176, v176
    v_exp_f32 v177, v177
    v_exp_f32 v178, v178
    v_exp_f32 v179, v179
    v_add_f32 v216, v216, v176
    v_add_f32 v216, v216, v177
    v_add_f32 v216, v216, v178
    v_add_f32 v216, v216, v179
    v_cvt_pk_bf16_f32 v176, v176, v177
    v_cvt_pk_bf16_f32 v177, v178, v179
    s_waitcnt vmcnt(8)
    ds_read_b64_tr_b16 v[196:197], v224 offset:16384
    ds_read_b64_tr_b16 v[198:199], v225 offset:16384
    ds_read_b64_tr_b16 v[200:201], v226 offset:16384
    ds_read_b64_tr_b16 v[202:203], v227 offset:16384
    ds_read_b64_tr_b16 v[204:205], v228 offset:16384
    ds_read_b64_tr_b16 v[206:207], v229 offset:16384
    ds_read_b64_tr_b16 v[208:209], v230 offset:16384
    ds_read_b64_tr_b16 v[210:211], v231 offset:16384
    s_waitcnt lgkmcnt(8)
    ds_read_b32 v248, v240 offset:16
    s_waitcnt lgkmcnt(0)
    s_setprio 3
    v_mfma_f32_16x16x16_bf16 v[128:131], v[196:197], v[176:177], v[128:131]
    v_mfma_f32_16x16x16_bf16 v[132:135], v[198:199], v[176:177], v[132:135]
    v_mfma_f32_16x16x16_bf16 v[136:139], v[200:201], v[176:177], v[136:139]
    v_mfma_f32_16x16x16_bf16 v[140:143], v[202:203], v[176:177], v[140:143]
    v_mfma_f32_16x16x16_bf16 v[144:147], v[204:205], v[176:177], v[144:147]
    v_mfma_f32_16x16x16_bf16 v[148:151], v[206:207], v[176:177], v[148:151]
    v_mfma_f32_16x16x16_bf16 v[152:155], v[208:209], v[176:177], v[152:155]
    v_mfma_f32_16x16x16_bf16 v[156:159], v[210:211], v[176:177], v[156:159]
    s_setprio 3
    v_cmp_lt_u32 s[56:57], v248, 59
    s_nop 0
    s_cmp_eq_u64 s[56:57], 0
    s_cbranch_scc0 G1_fb32
G1_fb32_ret:
    ds_write_b128 v243, v[124:127] offset:51200
    s_add_u32 m0, s41, 49152
    s_mov_b32 s52, 245760
    buffer_load_dwordx4 v237, s[16:19], s52 offen offset:0 nt lds
    buffer_load_dwordx4 v238, s[16:19], s52 offen offset:1024 nt lds
    buffer_load_dwordx4 v238, s[16:19], s52 offen offset:3072 nt lds
    ds_read_b128 v[180:183], v220 offset:32768
    ds_read_b128 v[184:187], v221 offset:32768
    ds_read_b128 v[188:191], v222 offset:32768
    ds_read_b128 v[192:195], v223 offset:32768
    ds_read_b32 v248, v240 offset:16
    s_waitcnt lgkmcnt(5)
    v_mov_b32 v242, 260
    s_mov_b32 m0, s43
    s_mov_b64 exec, 1
    global_load_lds_dword v242, s[48:49]
    s_mov_b64 exec, -1
    s_waitcnt lgkmcnt(4)
    v_mfma_f32_16x16x32_bf16 v[176:179], v[180:183], v[160:163], v[212:215]
    s_waitcnt lgkmcnt(3)
    v_mfma_f32_16x16x32_bf16 v[176:179], v[184:187], v[164:167], v[176:179]
    s_waitcnt lgkmcnt(2)
    v_mfma_f32_16x16x32_bf16 v[176:179], v[188:191], v[168:171], v[176:179]
    s_waitcnt lgkmcnt(1)
    v_mfma_f32_16x16x32_bf16 v[176:179], v[192:195], v[172:175], v[176:179]
    s_nop 7
    v_max_f32 v217, v176, v177
    v_max3_f32 v217, v178, v179, v217
    v_cmp_lt_f32 vcc, s50, v217
    s_nop 1
    s_cbranch_vccnz G1_g14
G1_g14_ret:
    v_exp_f32 v176, v176
    v_exp_f32 v177, v177
    v_exp_f32 v178, v178
    v_exp_f32 v179, v179
    v_add_f32 v216, v216, v176
    v_add_f32 v216, v216, v177
    v_add_f32 v216, v216, v178
    v_add_f32 v216, v216, v179
    v_cvt_pk_bf16_f32 v176, v176, v177
    v_cvt_pk_bf16_f32 v177, v178, v179
    s_load_dwordx4 s[28:31], s[0:1], 32
    s_load_dwordx2 s[32:33], s[0:1], 48
    s_bfe_u32 s34, s2, 0x20001
    s_lshl_b32 s34, s34, 2
    s_bfe_u32 s35, s2, 0x20003
    s_add_u32 s34, s34, s35
    s_bfe_u32 s35, s2, 0x30005
    s_add_u32 s53, s34, s35
    s_and_b32 s53, s53, 3
    s_and_b32 s52, s2, 1
    s_lshl_b32 s35, s35, 1
    s_add_u32 s35, s35, s52
    s_lshl_b32 s52, s52, 1
    s_and_b32 s40, s34, 1
    s_lshl_b32 s40, s40, 6
    s_add_u32 s40, s40, s34
    s_and_b32 s40, s40, 0xfe
    s_lshl_b32 s40, s40, 1
    s_mul_i32 s44, s24, 9216
    v_lshl_add_u32 v252, v239, 4, s44
    v_lshrrev_b32 v244, 4, v239
    v_lshlrev_b32 v244, 1, v244
    v_and_b32 v253, 7, v239
    v_xor_b32 v253, v253, v244
    v_lshlrev_b32 v253, 4, v253
    v_lshrrev_b32 v244, 3, v239
    v_lshl_add_u32 v253, v244, 11, v253
    s_lshl_b32 s44, s24, 16
    v_add_u32 v253, s44, v253
    s_waitcnt lgkmcnt(0)
    s_mul_i32 s44, s34, 1179648
    s_add_u32 s4, s36, s44
    s_addc_u32 s5, s37, 0
    s_mov_b32 s6, 1179648
    s_mov_b32 s7, 0x20000
    s_lshl_b32 s44, s35, 7
    s_add_u32 s8, s28, s44
    s_addc_u32 s9, s29, 0
    s_sub_u32 s10, 8388608, s44
    s_mov_b32 s11, 0x20000
    s_mov_b32 s16, s32
    s_mov_b32 s17, s33
    s_mov_b32 s18, 256
    s_mov_b32 s19, 0x20000
    s_mul_i32 s45, s34, 294912
    s_add_u32 s44, s44, s45
    s_add_u32 s12, s30, s44
    s_addc_u32 s13, s31, 0
    s_sub_u32 s14, 4718592, s44
    s_mov_b32 s15, 0x20000
    buffer_load_dword v254, off, s[16:19], s40 offset:0 sc1
    s_add_u32 m0, s41, 130816
    s_mul_i32 s46, s53, 4
    s_add_u32 s46, s46, 0
    s_add_u32 s46, s46, s52
    s_lshl_b32 s46, s46, 18
    buffer_load_dwordx4 v253, s[8:11], s46 offen offset:0  lds
    s_add_u32 s46, s46, 15360
    buffer_load_dwordx4 v253, s[8:11], s46 offen offset:1024  lds
    s_add_u32 s46, s46, 15360
    buffer_load_dwordx4 v253, s[8:11], s46 offen offset:2048  lds
    s_add_u32 s46, s46, 15360
    buffer_load_dwordx4 v253, s[8:11], s46 offen offset:3072  lds
    s_add_u32 m0, s41, 147200
    s_cmp_eq_u32 s53, 0
    s_cselect_b32 s46, 16, 0
    s_add_u32 s46, s46, s52
    s_lshl_b32 s46, s46, 18
    buffer_load_dwordx4 v253, s[8:11], s46 offen offset:0  lds
    s_add_u32 s46, s46, 15360
    buffer_load_dwordx4 v253, s[8:11], s46 offen offset:1024  lds
    s_add_u32 s46, s46, 15360
    buffer_load_dwordx4 v253, s[8:11], s46 offen offset:2048  lds
    s_add_u32 s46, s46, 15360
    buffer_load_dwordx4 v253, s[8:11], s46 offen offset:3072  lds
    s_waitcnt vmcnt(14)
    ds_read_b64_tr_b16 v[196:197], v224 offset:32768
    ds_read_b64_tr_b16 v[198:199], v225 offset:32768
    ds_read_b64_tr_b16 v[200:201], v226 offset:32768
    ds_read_b64_tr_b16 v[202:203], v227 offset:32768
    ds_read_b64_tr_b16 v[204:205], v228 offset:32768
    ds_read_b64_tr_b16 v[206:207], v229 offset:32768
    ds_read_b64_tr_b16 v[208:209], v230 offset:32768
    ds_read_b64_tr_b16 v[210:211], v231 offset:32768
    s_waitcnt lgkmcnt(0)
    s_setprio 3
    v_mfma_f32_16x16x16_bf16 v[128:131], v[196:197], v[176:177], v[128:131]
    v_mfma_f32_16x16x16_bf16 v[132:135], v[198:199], v[176:177], v[132:135]
    v_mfma_f32_16x16x16_bf16 v[136:139], v[200:201], v[176:177], v[136:139]
    v_mfma_f32_16x16x16_bf16 v[140:143], v[202:203], v[176:177], v[140:143]
    v_mfma_f32_16x16x16_bf16 v[144:147], v[204:205], v[176:177], v[144:147]
    v_mfma_f32_16x16x16_bf16 v[148:151], v[206:207], v[176:177], v[148:151]
    v_mfma_f32_16x16x16_bf16 v[152:155], v[208:209], v[176:177], v[152:155]
    v_mfma_f32_16x16x16_bf16 v[156:159], v[210:211], v[176:177], v[156:159]
    s_setprio 3
    ds_read_b128 v[180:183], v220 offset:0
    ds_read_b128 v[184:187], v221 offset:0
    ds_read_b128 v[188:191], v222 offset:0
    ds_read_b128 v[192:195], v223 offset:0
    s_waitcnt lgkmcnt(3)
    v_mfma_f32_16x16x32_bf16 v[176:179], v[180:183], v[160:163], v[212:215]
    s_waitcnt lgkmcnt(2)
    v_mfma_f32_16x16x32_bf16 v[176:179], v[184:187], v[164:167], v[176:179]
    s_waitcnt lgkmcnt(1)
    v_mfma_f32_16x16x32_bf16 v[176:179], v[188:191], v[168:171], v[176:179]
    s_waitcnt lgkmcnt(0)
    v_mfma_f32_16x16x32_bf16 v[176:179], v[192:195], v[172:175], v[176:179]
    s_nop 7
    v_max_f32 v217, v176, v177
    v_max3_f32 v217, v178, v179, v217
    v_cmp_lt_f32 vcc, s50, v217
    s_nop 1
    s_cbranch_vccnz G1_g15
G1_g15_ret:
    v_exp_f32 v176, v176
    v_exp_f32 v177, v177
    v_exp_f32 v178, v178
    v_exp_f32 v179, v179
    v_add_f32 v216, v216, v176
    v_add_f32 v216, v216, v177
    v_add_f32 v216, v216, v178
    v_add_f32 v216, v216, v179
    v_cvt_pk_bf16_f32 v176, v176, v177
    v_cvt_pk_bf16_f32 v177, v178, v179
    s_waitcnt vmcnt(8)
    v_cmp_gt_u32 vcc, 16, v254
    s_nop 1
    s_cbranch_vccnz G1_gf0
G1_gf0_ret:
    s_mul_i32 s54, s53, 4
    s_add_u32 s54, s54, 0
    s_add_u32 s54, s54, s52
    s_mul_i32 s54, s54, 36864
    s_add_u32 s55, s54, 4096
    s_add_u32 s47, s54, 8192
    buffer_load_dwordx4 v[40:43], v252, s[4:7], s54 offen offset:0 sc1
    buffer_load_dwordx4 v[44:47], v252, s[4:7], s54 offen offset:1024 sc1
    buffer_load_dwordx4 v[48:51], v252, s[4:7], s54 offen offset:2048 sc1
    buffer_load_dwordx4 v[52:55], v252, s[4:7], s54 offen offset:3072 sc1
    buffer_load_dwordx4 v[56:59], v252, s[4:7], s55 offen offset:0 sc1
    buffer_load_dwordx4 v[60:63], v252, s[4:7], s55 offen offset:1024 sc1
    buffer_load_dwordx4 v[64:67], v252, s[4:7], s55 offen offset:2048 sc1
    buffer_load_dwordx4 v[68:71], v252, s[4:7], s55 offen offset:3072 sc1
    buffer_load_dwordx4 v[72:75], v252, s[4:7], s47 offen offset:0 sc1
    ds_read_b64_tr_b16 v[196:197], v224 offset:0
    ds_read_b64_tr_b16 v[198:199], v225 offset:0
    ds_read_b64_tr_b16 v[200:201], v226 offset:0
    ds_read_b64_tr_b16 v[202:203], v227 offset:0
    ds_read_b64_tr_b16 v[204:205], v228 offset:0
    ds_read_b64_tr_b16 v[206:207], v229 offset:0
    ds_read_b64_tr_b16 v[208:209], v230 offset:0
    ds_read_b64_tr_b16 v[210:211], v231 offset:0
    s_waitcnt lgkmcnt(0)
    s_setprio 3
    v_mfma_f32_16x16x16_bf16 v[128:131], v[196:197], v[176:177], v[128:131]
    v_mfma_f32_16x16x16_bf16 v[132:135], v[198:199], v[176:177], v[132:135]
    v_mfma_f32_16x16x16_bf16 v[136:139], v[200:201], v[176:177], v[136:139]
    v_mfma_f32_16x16x16_bf16 v[140:143], v[202:203], v[176:177], v[140:143]
    v_mfma_f32_16x16x16_bf16 v[144:147], v[204:205], v[176:177], v[144:147]
    v_mfma_f32_16x16x16_bf16 v[148:151], v[206:207], v[176:177], v[148:151]
    v_mfma_f32_16x16x16_bf16 v[152:155], v[208:209], v[176:177], v[152:155]
    v_mfma_f32_16x16x16_bf16 v[156:159], v[210:211], v[176:177], v[156:159]
    s_setprio 3
    v_mov_b32 v217, v216
    s_nop 1
    v_permlane32_swap_b32 v217, v216
    v_add_f32 v216, v216, v217
    v_mov_b32 v217, v216
    s_nop 1
    v_permlane16_swap_b32 v217, v216
    v_add_f32 v216, v216, v217
    v_lshlrev_b32 v246, 4, v239
    s_xor_b32 s44, s24, 1
    s_mul_i32 s44, s44, 6144
    s_add_u32 s44, s44, 98304
    v_add_u32 v244, s44, v246
    ds_write_b128 v244, v[136:139] offset:0
    ds_write_b128 v244, v[140:143] offset:1024
    s_xor_b32 s44, s24, 2
    s_mul_i32 s44, s44, 6144
    s_add_u32 s44, s44, 100352
    v_add_u32 v244, s44, v246
    ds_write_b128 v244, v[144:147] offset:0
    ds_write_b128 v244, v[148:151] offset:1024
    s_xor_b32 s44, s24, 3
    s_mul_i32 s44, s44, 6144
    s_add_u32 s44, s44, 102400
    v_add_u32 v244, s44, v246
    ds_write_b128 v244, v[152:155] offset:0
    ds_write_b128 v244, v[156:159] offset:1024
    s_lshl_b32 s44, s24, 9
    s_add_u32 s44, s44, 122880
    v_lshl_add_u32 v245, v239, 3, s44
    v_mov_b32 v213, v216
    v_mov_b32 v218, 2
    ds_write_b64 v245, v[212:213]
    ds_write_b32 v241, v218 offset:48
    v_mov_b32 v0, v128
    v_mov_b32 v1, v129
    v_mov_b32 v2, v130
    v_mov_b32 v3, v131
    v_mov_b32 v4, v132
    v_mov_b32 v5, v133
    v_mov_b32 v6, v134
    v_mov_b32 v7, v135
    s_waitcnt lgkmcnt(0)
    s_cmp_eq_u32 s53, 0
    s_cselect_b32 s54, 16, 0
    s_add_u32 s54, s54, s52
    s_mul_i32 s54, s54, 36864
    s_add_u32 s55, s54, 4096
    s_add_u32 s51, s54, 8192
    buffer_load_dwordx4 v[76:79], v252, s[4:7], s54 offen offset:0 sc1
    buffer_load_dwordx4 v[80:83], v252, s[4:7], s54 offen offset:1024 sc1
    buffer_load_dwordx4 v[84:87], v252, s[4:7], s54 offen offset:2048 sc1
    buffer_load_dwordx4 v[88:91], v252, s[4:7], s54 offen offset:3072 sc1
    buffer_load_dwordx4 v[92:95], v252, s[4:7], s55 offen offset:0 sc1
    buffer_load_dwordx4 v[96:99], v252, s[4:7], s55 offen offset:1024 sc1
    buffer_load_dwordx4 v[100:103], v252, s[4:7], s55 offen offset:2048 sc1
    buffer_load_dwordx4 v[104:107], v252, s[4:7], s55 offen offset:3072 sc1
    buffer_load_dwordx4 v[108:111], v252, s[4:7], s51 offen offset:0 sc1
    v_lshlrev_b32 v246, 4, v239
    s_mov_b32 s59, 262144
G1_gb11:
    ds_read_b32 v249, v240 offset:48
    s_waitcnt lgkmcnt(0)
    v_cmp_lt_u32 s[56:57], v249, 2
    s_nop 0
    s_cmp_eq_u64 s[56:57], 0
    s_cbranch_scc1 G1_gb11_ok
    s_sleep 1
    s_sub_u32 s59, s59, 1
    s_cmp_lg_u32 s59, 0
    s_cbranch_scc1 G1_gb11
G1_gb11_ok:
    s_xor_b32 s44, s24, 0
    s_lshl_b32 s44, s44, 9
    s_add_u32 s44, s44, 122880
    v_lshl_add_u32 v245, v239, 3, s44
    ds_read_b64 v[32:33], v245
    s_xor_b32 s44, s24, 1
    s_lshl_b32 s44, s44, 9
    s_add_u32 s44, s44, 122880
    v_lshl_add_u32 v245, v239, 3, s44
    ds_read_b64 v[34:35], v245
    s_xor_b32 s44, s24, 2
    s_lshl_b32 s44, s44, 9
    s_add_u32 s44, s44, 122880
    v_lshl_add_u32 v245, v239, 3, s44
    ds_read_b64 v[36:37], v245
    s_xor_b32 s44, s24, 3
    s_lshl_b32 s44, s44, 9
    s_add_u32 s44, s44, 122880
    v_lshl_add_u32 v245, v239, 3, s44
    ds_read_b64 v[38:39], v245
    s_mul_i32 s44, s24, 6144
    s_add_u32 s44, s44, 98304
    v_add_u32 v244, s44, v246
    ds_read_b128 v[8:11], v244 offset:0
    ds_read_b128 v[12:15], v244 offset:1024
    ds_read_b128 v[16:19], v244 offset:2048
    ds_read_b128 v[20:23], v244 offset:3072
    ds_read_b128 v[24:27], v244 offset:4096
    ds_read_b128 v[28:31], v244 offset:5120
    v_mov_b32 v218, 3
    ds_write_b32 v241, v218 offset:48
    s_waitcnt lgkmcnt(9)
    v_min_f32 v217, v32, v34
    s_waitcnt lgkmcnt(7)
    v_min3_f32 v217, v36, v38, v217
    v_sub_f32 v32, v217, v32
    v_sub_f32 v34, v217, v34
    v_sub_f32 v36, v217, v36
    v_sub_f32 v38, v217, v38
    v_exp_f32 v32, v32
    v_exp_f32 v34, v34
    v_exp_f32 v36, v36
    v_exp_f32 v38, v38
    v_mul_f32 v217, v32, v33
    v_fma_f32 v217, v34, v35, v217
    v_fma_f32 v217, v36, v37, v217
    v_fma_f32 v217, v38, v39, v217
    v_rcp_f32 v217, v217
    s_nop 0
    v_mul_f32 v32, v32, v217
    v_mul_f32 v34, v34, v217
    v_mul_f32 v36, v36, v217
    v_mul_f32 v38, v38, v217
    v_mul_f32 v0, v0, v32
    v_mul_f32 v1, v1, v32
    v_mul_f32 v2, v2, v32
    v_mul_f32 v3, v3, v32
    v_mul_f32 v4, v4, v32
    v_mul_f32 v5, v5, v32
    v_mul_f32 v6, v6, v32
    v_mul_f32 v7, v7, v32
    s_waitcnt lgkmcnt(6)
    v_fma_f32 v0, v8, v34, v0
    v_fma_f32 v1, v9, v34, v1
    v_fma_f32 v2, v10, v34, v2
    v_fma_f32 v3, v11, v34, v3
    s_waitcnt lgkmcnt(5)
    v_fma_f32 v4, v12, v34, v4
    v_fma_f32 v5, v13, v34, v5
    v_fma_f32 v6, v14, v34, v6
    v_fma_f32 v7, v15, v34, v7
    s_waitcnt lgkmcnt(4)
    v_fma_f32 v0, v16, v36, v0
    v_fma_f32 v1, v17, v36, v1
    v_fma_f32 v2, v18, v36, v2
    v_fma_f32 v3, v19, v36, v3
    s_waitcnt lgkmcnt(3)
    v_fma_f32 v4, v20, v36, v4
    v_fma_f32 v5, v21, v36, v5
    v_fma_f32 v6, v22, v36, v6
    v_fma_f32 v7, v23, v36, v7
    s_waitcnt lgkmcnt(2)
    v_fma_f32 v0, v24, v38, v0
    v_fma_f32 v1, v25, v38, v1
    v_fma_f32 v2, v26, v38, v2
    v_fma_f32 v3, v27, v38, v3
    s_waitcnt lgkmcnt(1)
    v_fma_f32 v4, v28, v38, v4
    v_fma_f32 v5, v29, v38, v5
    v_fma_f32 v6, v30, v38, v6
    v_fma_f32 v7, v31, v38, v7
    v_cvt_pk_bf16_f32 v0, v0, v1
    v_cvt_pk_bf16_f32 v1, v2, v3
    v_cvt_pk_bf16_f32 v2, v4, v5
    v_cvt_pk_bf16_f32 v3, v6, v7
    s_mul_i32 s45, s24, 9216
    s_add_u32 s45, s45, 45056
    buffer_store_dwordx4 v[0:3], v246, s[20:23], s45 offen sc1
    s_mov_b32 s59, 262144
G1_l0:
    ds_read_b32 v248, v240 offset:32
    s_waitcnt lgkmcnt(0)
    v_cmp_lt_u32 s[56:57], v248, 2
    s_nop 0
    s_cmp_eq_u64 s[56:57], 0
    s_cbranch_scc1 G1_l0_ok
    s_sleep 1
    s_sub_u32 s59, s59, 1
    s_cmp_lg_u32 s59, 0
    s_cbranch_scc1 G1_l0
G1_l0_ok:
    s_add_u32 s44, s41, 130816
    v_lshrrev_b32 v244, 2, v239
    v_and_b32 v249, 3, v239
    v_lshlrev_b32 v249, 3, v249
    v_lshl_add_u32 v248, v244, 7, v249
    v_bfe_u32 v244, v239, 3, 2
    v_xor_b32 v244, s24, v244
    v_lshl_add_u32 v248, v244, 5, v248
    v_add_u32 v248, s44, v248
    v_xor_b32 v249, 32, v248
    v_xor_b32 v250, 64, v248
    v_xor_b32 v251, 96, v248
    v_mov_b32 v255, v241
    s_xor_b32 s44, s2, 1
    s_mul_i32 s44, s44, 36864
    s_add_u32 s44, s44, 33554432
    s_add_u32 s20, s36, s44
    s_addc_u32 s21, s37, 0
    s_mov_b32 s22, 36864
    s_mov_b32 s23, 0x20000
    s_waitcnt vmcnt(23)
    ds_read_b64_tr_b16 v[216:217], v248 offset:0
    ds_read_b64_tr_b16 v[218:219], v248 offset:2048
    ds_read_b64_tr_b16 v[220:221], v249 offset:0
    ds_read_b64_tr_b16 v[222:223], v249 offset:2048
    ds_read_b64_tr_b16 v[224:225], v250 offset:0
    ds_read_b64_tr_b16 v[226:227], v250 offset:2048
    ds_read_b64_tr_b16 v[228:229], v251 offset:0
    ds_read_b64_tr_b16 v[230:231], v251 offset:2048
    s_setprio 1
    s_waitcnt lgkmcnt(0)
    s_add_u32 m0, s41, 130816
    s_cmp_eq_u32 s53, 1
    s_cselect_b32 s46, 20, 4
    s_add_u32 s46, s46, s52
    s_lshl_b32 s46, s46, 18
    buffer_load_dwordx4 v253, s[8:11], s46 offen offset:0  lds
    s_add_u32 s46, s46, 15360
    buffer_load_dwordx4 v253, s[8:11], s46 offen offset:1024  lds
    s_add_u32 s46, s46, 15360
    buffer_load_dwordx4 v253, s[8:11], s46 offen offset:2048  lds
    s_add_u32 s46, s46, 15360
    buffer_load_dwordx4 v253, s[8:11], s46 offen offset:3072  lds
    s_cmp_eq_u32 s53, 1
    s_cselect_b32 s54, 20, 4
    s_add_u32 s54, s54, s52
    s_mul_i32 s54, s54, 36864
    s_add_u32 s55, s54, 4096
    s_add_u32 s47, s54, 8192
    s_waitcnt vmcnt(22)
    v_mfma_f32_16x16x32_bf16 v[0:3], v[216:219], v[40:43], 0
    ds_write_b128 v252, v[40:43] offset:0
    v_mfma_f32_16x16x32_bf16 v[4:7], v[220:223], v[40:43], 0
    v_mfma_f32_16x16x32_bf16 v[8:11], v[224:227], v[40:43], 0
    v_mfma_f32_16x16x32_bf16 v[12:15], v[228:231], v[40:43], 0
    s_waitcnt vmcnt(21)
    v_mfma_f32_16x16x32_bf16 v[16:19], v[216:219], v[44:47], 0
    ds_write_b128 v252, v[44:47] offset:1024
    v_mfma_f32_16x16x32_bf16 v[20:23], v[220:223], v[44:47], 0
    v_mfma_f32_16x16x32_bf16 v[24:27], v[224:227], v[44:47], 0
    v_mfma_f32_16x16x32_bf16 v[28:31], v[228:231], v[44:47], 0
    s_waitcnt lgkmcnt(1)
    buffer_load_dwordx4 v[40:43], v252, s[4:7], s54 offen offset:0 sc1
    s_waitcnt vmcnt(21)
    v_mfma_f32_16x16x32_bf16 v[32:35], v[216:219], v[48:51], 0
    ds_write_b128 v252, v[48:51] offset:2048
    v_mfma_f32_16x16x32_bf16 v[36:39], v[220:223], v[48:51], 0
    ds_read_b64_tr_b16 v[232:233], v248 offset:16384
    v_mfma_f32_16x16x32_bf16 v[112:115], v[224:227], v[48:51], 0
    ds_read_b64_tr_b16 v[234:235], v248 offset:18432
    v_mfma_f32_16x16x32_bf16 v[116:119], v[228:231], v[48:51], 0
    s_waitcnt lgkmcnt(3)
    buffer_load_dwordx4 v[44:47], v252, s[4:7], s54 offen offset:1024 sc1
    s_waitcnt vmcnt(21)
    v_mfma_f32_16x16x32_bf16 v[120:123], v[216:219], v[52:55], 0
    ds_write_b128 v252, v[52:55] offset:3072
    v_mfma_f32_16x16x32_bf16 v[124:127], v[220:223], v[52:55], 0
    ds_read_b64_tr_b16 v[236:237], v249 offset:16384
    v_mfma_f32_16x16x32_bf16 v[128:131], v[224:227], v[52:55], 0
    ds_read_b64_tr_b16 v[238:239], v249 offset:18432
    v_mfma_f32_16x16x32_bf16 v[132:135], v[228:231], v[52:55], 0
    s_waitcnt lgkmcnt(5)
    buffer_load_dwordx4 v[48:51], v252, s[4:7], s54 offen offset:2048 sc1
    s_waitcnt vmcnt(21)
    v_mfma_f32_16x16x32_bf16 v[136:139], v[216:219], v[56:59], 0
    ds_write_b128 v252, v[56:59] offset:4096
    v_mfma_f32_16x16x32_bf16 v[140:143], v[220:223], v[56:59], 0
    ds_read_b64_tr_b16 v[240:241], v250 offset:16384
    v_mfma_f32_16x16x32_bf16 v[144:147], v[224:227], v[56:59], 0
    ds_read_b64_tr_b16 v[242:243], v250 offset:18432
    v_mfma_f32_16x16x32_bf16 v[148:151], v[228:231], v[56:59], 0
    s_waitcnt lgkmcnt(5)
    buffer_load_dwordx4 v[52:55], v252, s[4:7], s54 offen offset:3072 sc1
    s_waitcnt vmcnt(21)
    v_mfma_f32_16x16x32_bf16 v[152:155], v[216:219], v[60:63], 0
    ds_write_b128 v252, v[60:63] offset:5120
    v_mfma_f32_16x16x32_bf16 v[156:159], v[220:223], v[60:63], 0
    ds_read_b64_tr_b16 v[244:245], v251 offset:16384
    v_mfma_f32_16x16x32_bf16 v[160:163], v[224:227], v[60:63], 0
    ds_read_b64_tr_b16 v[246:247], v251 offset:18432
    v_mfma_f32_16x16x32_bf16 v[164:167], v[228:231], v[60:63], 0
    s_waitcnt lgkmcnt(5)
    buffer_load_dwordx4 v[56:59], v252, s[4:7], s55 offen offset:0 sc1
    s_waitcnt vmcnt(21)
    v_mfma_f32_16x16x32_bf16 v[168:171], v[216:219], v[64:67], 0
    ds_write_b128 v252, v[64:67] offset:6144
    v_mfma_f32_16x16x32_bf16 v[172:175], v[220:223], v[64:67], 0
    v_mfma_f32_16x16x32_bf16 v[176:179], v[224:227], v[64:67], 0
    v_mfma_f32_16x16x32_bf16 v[180:183], v[228:231], v[64:67], 0
    s_waitcnt lgkmcnt(3)
    buffer_load_dwordx4 v[60:63], v252, s[4:7], s55 offen offset:1024 sc1
    s_waitcnt vmcnt(21)
    v_mfma_f32_16x16x32_bf16 v[184:187], v[216:219], v[68:71], 0
    ds_write_b128 v252, v[68:71] offset:7168
    v_mfma_f32_16x16x32_bf16 v[188:191], v[220:223], v[68:71], 0
    v_mfma_f32_16x16x32_bf16 v[192:195], v[224:227], v[68:71], 0
    v_mfma_f32_16x16x32_bf16 v[196:199], v[228:231], v[68:71], 0
    s_waitcnt lgkmcnt(1)
    buffer_load_dwordx4 v[64:67], v252, s[4:7], s55 offen offset:2048 sc1
    s_waitcnt vmcnt(21)
    v_mfma_f32_16x16x32_bf16 v[200:203], v[216:219], v[72:75], 0
    v_mov_b32 v254, 1
    v_mfma_f32_16x16x32_bf16 v[204:207], v[220:223], v[72:75], 0
    ds_write_b128 v252, v[72:75] offset:8192
    v_mfma_f32_16x16x32_bf16 v[208:211], v[224:227], v[72:75], 0
    ds_write_b32 v255, v254 offset:96
    v_mfma_f32_16x16x32_bf16 v[212:215], v[228:231], v[72:75], 0
    s_waitcnt lgkmcnt(2)
    buffer_load_dwordx4 v[68:71], v252, s[4:7], s55 offen offset:3072 sc1
    s_waitcnt lgkmcnt(2)
    s_add_u32 m0, s41, 147200
    s_cmp_eq_u32 s53, 2
    s_cselect_b32 s46, 24, 8
    s_add_u32 s46, s46, s52
    s_lshl_b32 s46, s46, 18
    buffer_load_dwordx4 v253, s[8:11], s46 offen offset:0  lds
    s_add_u32 s46, s46, 15360
    buffer_load_dwordx4 v253, s[8:11], s46 offen offset:1024  lds
    s_add_u32 s46, s46, 15360
    buffer_load_dwordx4 v253, s[8:11], s46 offen offset:2048  lds
    s_add_u32 s46, s46, 15360
    buffer_load_dwordx4 v253, s[8:11], s46 offen offset:3072  lds
    s_waitcnt vmcnt(16)
    v_mov_b32 v254, 2
    ds_write_b32 v255, v254 offset:80
    s_cmp_eq_u32 s53, 2
    s_cselect_b32 s54, 24, 8
    s_add_u32 s54, s54, s52
    s_mul_i32 s54, s54, 36864
    s_add_u32 s55, s54, 4096
    s_add_u32 s51, s54, 8192
    v_mfma_f32_16x16x32_bf16 v[0:3], v[232:235], v[76:79], v[0:3]
    ds_write_b128 v252, v[76:79] offset:36864
    v_mfma_f32_16x16x32_bf16 v[4:7], v[236:239], v[76:79], v[4:7]
    v_mfma_f32_16x16x32_bf16 v[8:11], v[240:243], v[76:79], v[8:11]
    v_mfma_f32_16x16x32_bf16 v[12:15], v[244:247], v[76:79], v[12:15]
    s_waitcnt lgkmcnt(3)
    buffer_load_dwordx4 v[72:75], v252, s[4:7], s47 offen offset:0 sc1
    v_mfma_f32_16x16x32_bf16 v[16:19], v[232:235], v[80:83], v[16:19]
    ds_write_b128 v252, v[80:83] offset:37888
    v_mfma_f32_16x16x32_bf16 v[20:23], v[236:239], v[80:83], v[20:23]
    v_mfma_f32_16x16x32_bf16 v[24:27], v[240:243], v[80:83], v[24:27]
    v_mfma_f32_16x16x32_bf16 v[28:31], v[244:247], v[80:83], v[28:31]
    s_waitcnt lgkmcnt(1)
    buffer_load_dwordx4 v[76:79], v252, s[4:7], s54 offen offset:0 sc1
    s_waitcnt vmcnt(14)
    v_mfma_f32_16x16x32_bf16 v[32:35], v[232:235], v[84:87], v[32:35]
    ds_write_b128 v252, v[84:87] offset:38912
    v_mfma_f32_16x16x32_bf16 v[36:39], v[236:239], v[84:87], v[36:39]
    ds_read_b64_tr_b16 v[216:217], v248 offset:0
    v_mfma_f32_16x16x32_bf16 v[112:115], v[240:243], v[84:87], v[112:115]
    ds_read_b64_tr_b16 v[218:219], v248 offset:2048
    v_mfma_f32_16x16x32_bf16 v[116:119], v[244:247], v[84:87], v[116:119]
    s_waitcnt lgkmcnt(3)
    buffer_load_dwordx4 v[80:83], v252, s[4:7], s54 offen offset:1024 sc1
    v_mfma_f32_16x16x32_bf16 v[120:123], v[232:235], v[88:91], v[120:123]
    ds_write_b128 v252, v[88:91] offset:39936
    v_mfma_f32_16x16x32_bf16 v[124:127], v[236:239], v[88:91], v[124:127]
    ds_read_b64_tr_b16 v[220:221], v249 offset:0
    v_mfma_f32_16x16x32_bf16 v[128:131], v[240:243], v[88:91], v[128:131]
    ds_read_b64_tr_b16 v[222:223], v249 offset:2048
    v_mfma_f32_16x16x32_bf16 v[132:135], v[244:247], v[88:91], v[132:135]
    s_waitcnt lgkmcnt(5)
    buffer_load_dwordx4 v[84:87], v252, s[4:7], s54 offen offset:2048 sc1
    v_mfma_f32_16x16x32_bf16 v[136:139], v[232:235], v[92:95], v[136:139]
    ds_write_b128 v252, v[92:95] offset:40960
    v_mfma_f32_16x16x32_bf16 v[140:143], v[236:239], v[92:95], v[140:143]
    ds_read_b64_tr_b16 v[224:225], v250 offset:0
    v_mfma_f32_16x16x32_bf16 v[144:147], v[240:243], v[92:95], v[144:147]
    ds_read_b64_tr_b16 v[226:227], v250 offset:2048
    v_mfma_f32_16x16x32_bf16 v[148:151], v[244:247], v[92:95], v[148:151]
    s_waitcnt lgkmcnt(5)
    buffer_load_dwordx4 v[88:91], v252, s[4:7], s54 offen offset:3072 sc1
    v_mfma_f32_16x16x32_bf16 v[152:155], v[232:235], v[96:99], v[152:155]
    ds_write_b128 v252, v[96:99] offset:41984
    v_mfma_f32_16x16x32_bf16 v[156:159], v[236:239], v[96:99], v[156:159]
    ds_read_b64_tr_b16 v[228:229], v251 offset:0
    v_mfma_f32_16x16x32_bf16 v[160:163], v[240:243], v[96:99], v[160:163]
    ds_read_b64_tr_b16 v[230:231], v251 offset:2048
    v_mfma_f32_16x16x32_bf16 v[164:167], v[244:247], v[96:99], v[164:167]
    s_waitcnt lgkmcnt(5)
    buffer_load_dwordx4 v[92:95], v252, s[4:7], s55 offen offset:0 sc1
    v_mfma_f32_16x16x32_bf16 v[168:171], v[232:235], v[100:103], v[168:171]
    ds_write_b128 v252, v[100:103] offset:43008
    v_mfma_f32_16x16x32_bf16 v[172:175], v[236:239], v[100:103], v[172:175]
    v_mfma_f32_16x16x32_bf16 v[176:179], v[240:243], v[100:103], v[176:179]
    ds_read_b32 v254, v255 offset:112
    v_mfma_f32_16x16x32_bf16 v[180:183], v[244:247], v[100:103], v[180:183]
    s_waitcnt lgkmcnt(4)
    buffer_load_dwordx4 v[96:99], v252, s[4:7], s55 offen offset:1024 sc1
    v_mfma_f32_16x16x32_bf16 v[184:187], v[232:235], v[104:107], v[184:187]
    ds_write_b128 v252, v[104:107] offset:44032
    v_mfma_f32_16x16x32_bf16 v[188:191], v[236:239], v[104:107], v[188:191]
    v_mfma_f32_16x16x32_bf16 v[192:195], v[240:243], v[104:107], v[192:195]
    s_waitcnt lgkmcnt(1)
    v_cmp_gt_u32 vcc, 1, v254
    v_mfma_f32_16x16x32_bf16 v[196:199], v[244:247], v[104:107], v[196:199]
    buffer_load_dwordx4 v[100:103], v252, s[4:7], s55 offen offset:2048 sc1
    v_mfma_f32_16x16x32_bf16 v[200:203], v[232:235], v[108:111], v[200:203]
    v_mov_b32 v254, 2
    v_mfma_f32_16x16x32_bf16 v[204:207], v[236:239], v[108:111], v[204:207]
    ds_write_b128 v252, v[108:111] offset:45056
    v_mfma_f32_16x16x32_bf16 v[208:211], v[240:243], v[108:111], v[208:211]
    ds_write_b32 v255, v254 offset:96
    v_mfma_f32_16x16x32_bf16 v[212:215], v[244:247], v[108:111], v[212:215]
    s_cbranch_vccnz G1_fr2
G1_fr2_ret:
    s_waitcnt lgkmcnt(2)
    buffer_load_dwordx4 v[104:107], v252, s[4:7], s55 offen offset:3072 sc1
    s_waitcnt lgkmcnt(2)
    s_add_u32 m0, s41, 130816
    s_cmp_eq_u32 s53, 3
    s_cselect_b32 s46, 28, 12
    s_add_u32 s46, s46, s52
    s_lshl_b32 s46, s46, 18
    buffer_load_dwordx4 v253, s[8:11], s46 offen offset:0  lds
    s_add_u32 s46, s46, 15360
    buffer_load_dwordx4 v253, s[8:11], s46 offen offset:1024  lds
    s_add_u32 s46, s46, 15360
    buffer_load_dwordx4 v253, s[8:11], s46 offen offset:2048  lds
    s_add_u32 s46, s46, 15360
    buffer_load_dwordx4 v253, s[8:11], s46 offen offset:3072  lds
    s_cmp_lg_u32 s24, 0
    s_cbranch_scc1 G1_nosig2
    v_mbcnt_lo_u32_b32 v232, -1, 0
    v_and_b32 v232, 3, v232
    v_lshlrev_b32 v232, 2, v232
    v_add_u32 v232, 163584, v232
    s_mov_b32 s59, 262144
G1_sig2a:
    ds_read_b32 v234, v232 offset:64
    s_waitcnt lgkmcnt(0)
    v_cmp_lt_u32 s[56:57], v234, 2
    s_nop 0
    s_cmp_eq_u64 s[56:57], 0
    s_cbranch_scc1 G1_sig2a_ok
    s_sleep 1
    s_sub_u32 s59, s59, 1
    s_cmp_lg_u32 s59, 0
    s_cbranch_scc1 G1_sig2a
G1_sig2a_ok:
    s_mov_b32 s59, 262144
G1_sig2b:
    ds_read_b32 v234, v232 offset:80
    s_waitcnt lgkmcnt(0)
    v_cmp_lt_u32 s[56:57], v234, 2
    s_nop 0
    s_cmp_eq_u64 s[56:57], 0
    s_cbranch_scc1 G1_sig2b_ok
    s_sleep 1
    s_sub_u32 s59, s59, 1
    s_cmp_lg_u32 s59, 0
    s_cbranch_scc1 G1_sig2b
G1_sig2b_ok:
    s_lshl_b32 s58, s27, 6
    s_lshl_b32 s59, s25, 11
    s_add_u32 s58, s58, s59
    s_add_u32 s58, s58, 50331648
    v_mov_b32 v234, s58
    v_mov_b32 v235, 1
    s_mov_b64 exec, 1
    global_store_dword v234, v235, s[36:37] sc1
    s_mov_b64 exec, -1
    s_nop 4
G1_nosig2:
    s_cmp_eq_u32 s53, 3
    s_cselect_b32 s54, 28, 12
    s_add_u32 s54, s54, s52
    s_mul_i32 s54, s54, 36864
    s_add_u32 s55, s54, 4096
    s_add_u32 s47, s54, 8192
    s_waitcnt vmcnt(24)
    v_mfma_f32_16x16x32_bf16 v[0:3], v[216:219], v[40:43], v[0:3]
    ds_write_b128 v252, v[40:43] offset:0
    v_mfma_f32_16x16x32_bf16 v[4:7], v[220:223], v[40:43], v[4:7]
    v_mfma_f32_16x16x32_bf16 v[8:11], v[224:227], v[40:43], v[8:11]
    v_mfma_f32_16x16x32_bf16 v[12:15], v[228:231], v[40:43], v[12:15]
    s_waitcnt lgkmcnt(2)
    buffer_load_dwordx4 v[108:111], v252, s[4:7], s51 offen offset:0 sc1
    s_waitcnt vmcnt(24)
    v_mfma_f32_16x16x32_bf16 v[16:19], v[216:219], v[44:47], v[16:19]
    ds_write_b128 v252, v[44:47] offset:1024
    v_mfma_f32_16x16x32_bf16 v[20:23], v[220:223], v[44:47], v[20:23]
    v_mfma_f32_16x16x32_bf16 v[24:27], v[224:227], v[44:47], v[24:27]
    v_mfma_f32_16x16x32_bf16 v[28:31], v[228:231], v[44:47], v[28:31]
    s_waitcnt lgkmcnt(1)
    buffer_load_dwordx4 v[40:43], v252, s[4:7], s54 offen offset:0 sc1
    s_waitcnt vmcnt(15)
    v_mfma_f32_16x16x32_bf16 v[32:35], v[216:219], v[48:51], v[32:35]
    ds_write_b128 v252, v[48:51] offset:2048
    v_mfma_f32_16x16x32_bf16 v[36:39], v[220:223], v[48:51], v[36:39]
    ds_read_b64_tr_b16 v[232:233], v248 offset:16384
    v_mfma_f32_16x16x32_bf16 v[112:115], v[224:227], v[48:51], v[112:115]
    ds_read_b64_tr_b16 v[234:235], v248 offset:18432
    v_mfma_f32_16x16x32_bf16 v[116:119], v[228:231], v[48:51], v[116:119]
    s_waitcnt lgkmcnt(3)
    buffer_load_dwordx4 v[44:47], v252, s[4:7], s54 offen offset:1024 sc1
    v_mfma_f32_16x16x32_bf16 v[120:123], v[216:219], v[52:55], v[120:123]
    ds_write_b128 v252, v[52:55] offset:3072
    v_mfma_f32_16x16x32_bf16 v[124:127], v[220:223], v[52:55], v[124:127]
    ds_read_b64_tr_b16 v[236:237], v249 offset:16384
    v_mfma_f32_16x16x32_bf16 v[128:131], v[224:227], v[52:55], v[128:131]
    ds_read_b64_tr_b16 v[238:239], v249 offset:18432
    v_mfma_f32_16x16x32_bf16 v[132:135], v[228:231], v[52:55], v[132:135]
    s_waitcnt lgkmcnt(5)
    buffer_load_dwordx4 v[48:51], v252, s[4:7], s54 offen offset:2048 sc1
    v_mfma_f32_16x16x32_bf16 v[136:139], v[216:219], v[56:59], v[136:139]
    ds_write_b128 v252, v[56:59] offset:4096
    v_mfma_f32_16x16x32_bf16 v[140:143], v[220:223], v[56:59], v[140:143]
    ds_read_b64_tr_b16 v[240:241], v250 offset:16384
    v_mfma_f32_16x16x32_bf16 v[144:147], v[224:227], v[56:59], v[144:147]
    ds_read_b64_tr_b16 v[242:243], v250 offset:18432
    v_mfma_f32_16x16x32_bf16 v[148:151], v[228:231], v[56:59], v[148:151]
    s_waitcnt lgkmcnt(5)
    buffer_load_dwordx4 v[52:55], v252, s[4:7], s54 offen offset:3072 sc1
    v_mfma_f32_16x16x32_bf16 v[152:155], v[216:219], v[60:63], v[152:155]
    ds_write_b128 v252, v[60:63] offset:5120
    v_mfma_f32_16x16x32_bf16 v[156:159], v[220:223], v[60:63], v[156:159]
    ds_read_b64_tr_b16 v[244:245], v251 offset:16384
    v_mfma_f32_16x16x32_bf16 v[160:163], v[224:227], v[60:63], v[160:163]
    ds_read_b64_tr_b16 v[246:247], v251 offset:18432
    v_mfma_f32_16x16x32_bf16 v[164:167], v[228:231], v[60:63], v[164:167]
    s_waitcnt lgkmcnt(5)
    buffer_load_dwordx4 v[56:59], v252, s[4:7], s55 offen offset:0 sc1
    v_mfma_f32_16x16x32_bf16 v[168:171], v[216:219], v[64:67], v[168:171]
    ds_write_b128 v252, v[64:67] offset:6144
    v_mfma_f32_16x16x32_bf16 v[172:175], v[220:223], v[64:67], v[172:175]
    v_mfma_f32_16x16x32_bf16 v[176:179], v[224:227], v[64:67], v[176:179]
    ds_read_b32 v254, v255 offset:112
    v_mfma_f32_16x16x32_bf16 v[180:183], v[228:231], v[64:67], v[180:183]
    s_waitcnt lgkmcnt(4)
    buffer_load_dwordx4 v[60:63], v252, s[4:7], s55 offen offset:1024 sc1
    v_mfma_f32_16x16x32_bf16 v[184:187], v[216:219], v[68:71], v[184:187]
    ds_write_b128 v252, v[68:71] offset:7168
    v_mfma_f32_16x16x32_bf16 v[188:191], v[220:223], v[68:71], v[188:191]
    v_mfma_f32_16x16x32_bf16 v[192:195], v[224:227], v[68:71], v[192:195]
    s_waitcnt lgkmcnt(1)
    v_cmp_gt_u32 vcc, 2, v254
    v_mfma_f32_16x16x32_bf16 v[196:199], v[228:231], v[68:71], v[196:199]
    buffer_load_dwordx4 v[64:67], v252, s[4:7], s55 offen offset:2048 sc1
    s_waitcnt vmcnt(20)
    v_mfma_f32_16x16x32_bf16 v[200:203], v[216:219], v[72:75], v[200:203]
    v_mov_b32 v254, 3
    v_mfma_f32_16x16x32_bf16 v[204:207], v[220:223], v[72:75], v[204:207]
    ds_write_b128 v252, v[72:75] offset:8192
    v_mfma_f32_16x16x32_bf16 v[208:211], v[224:227], v[72:75], v[208:211]
    ds_write_b32 v255, v254 offset:96
    v_mfma_f32_16x16x32_bf16 v[212:215], v[228:231], v[72:75], v[212:215]
    s_cbranch_vccnz G1_fr3
G1_fr3_ret:
    s_waitcnt lgkmcnt(2)
    buffer_load_dwordx4 v[68:71], v252, s[4:7], s55 offen offset:3072 sc1
    s_waitcnt lgkmcnt(2)
    s_add_u32 m0, s41, 147200
    s_cmp_le_u32 s53, 0
    s_cselect_b32 s46, 20, 16
    s_add_u32 s46, s46, s52
    s_lshl_b32 s46, s46, 18
    buffer_load_dwordx4 v253, s[8:11], s46 offen offset:0  lds
    s_add_u32 s46, s46, 15360
    buffer_load_dwordx4 v253, s[8:11], s46 offen offset:1024  lds
    s_add_u32 s46, s46, 15360
    buffer_load_dwordx4 v253, s[8:11], s46 offen offset:2048  lds
    s_add_u32 s46, s46, 15360
    buffer_load_dwordx4 v253, s[8:11], s46 offen offset:3072  lds
    s_cmp_le_u32 s53, 0
    s_cselect_b32 s54, 20, 16
    s_add_u32 s54, s54, s52
    s_mul_i32 s54, s54, 36864
    s_add_u32 s55, s54, 4096
    s_add_u32 s51, s54, 8192
    s_waitcnt vmcnt(24)
    v_mfma_f32_16x16x32_bf16 v[0:3], v[232:235], v[76:79], v[0:3]
    ds_write_b128 v252, v[76:79] offset:36864
    v_mfma_f32_16x16x32_bf16 v[4:7], v[236:239], v[76:79], v[4:7]
    v_mfma_f32_16x16x32_bf16 v[8:11], v[240:243], v[76:79], v[8:11]
    v_mfma_f32_16x16x32_bf16 v[12:15], v[244:247], v[76:79], v[12:15]
    s_waitcnt lgkmcnt(2)
    buffer_load_dwordx4 v[72:75], v252, s[4:7], s47 offen offset:0 sc1
    s_waitcnt vmcnt(24)
    v_mfma_f32_16x16x32_bf16 v[16:19], v[232:235], v[80:83], v[16:19]
    ds_write_b128 v252, v[80:83] offset:37888
    v_mfma_f32_16x16x32_bf16 v[20:23], v[236:239], v[80:83], v[20:23]
    v_mfma_f32_16x16x32_bf16 v[24:27], v[240:243], v[80:83], v[24:27]
    v_mfma_f32_16x16x32_bf16 v[28:31], v[244:247], v[80:83], v[28:31]
    s_waitcnt lgkmcnt(1)
    buffer_load_dwordx4 v[76:79], v252, s[4:7], s54 offen offset:0 sc1
    s_waitcnt vmcnt(15)
    v_mfma_f32_16x16x32_bf16 v[32:35], v[232:235], v[84:87], v[32:35]
    ds_write_b128 v252, v[84:87] offset:38912
    v_mfma_f32_16x16x32_bf16 v[36:39], v[236:239], v[84:87], v[36:39]
    ds_read_b64_tr_b16 v[216:217], v248 offset:0
    v_mfma_f32_16x16x32_bf16 v[112:115], v[240:243], v[84:87], v[112:115]
    ds_read_b64_tr_b16 v[218:219], v248 offset:2048
    v_mfma_f32_16x16x32_bf16 v[116:119], v[244:247], v[84:87], v[116:119]
    s_waitcnt lgkmcnt(3)
    buffer_load_dwordx4 v[80:83], v252, s[4:7], s54 offen offset:1024 sc1
    v_mfma_f32_16x16x32_bf16 v[120:123], v[232:235], v[88:91], v[120:123]
    ds_write_b128 v252, v[88:91] offset:39936
    v_mfma_f32_16x16x32_bf16 v[124:127], v[236:239], v[88:91], v[124:127]
    ds_read_b64_tr_b16 v[220:221], v249 offset:0
    v_mfma_f32_16x16x32_bf16 v[128:131], v[240:243], v[88:91], v[128:131]
    ds_read_b64_tr_b16 v[222:223], v249 offset:2048
    v_mfma_f32_16x16x32_bf16 v[132:135], v[244:247], v[88:91], v[132:135]
    s_waitcnt lgkmcnt(5)
    buffer_load_dwordx4 v[84:87], v252, s[4:7], s54 offen offset:2048 sc1
    v_mfma_f32_16x16x32_bf16 v[136:139], v[232:235], v[92:95], v[136:139]
    ds_write_b128 v252, v[92:95] offset:40960
    v_mfma_f32_16x16x32_bf16 v[140:143], v[236:239], v[92:95], v[140:143]
    ds_read_b64_tr_b16 v[224:225], v250 offset:0
    v_mfma_f32_16x16x32_bf16 v[144:147], v[240:243], v[92:95], v[144:147]
    ds_read_b64_tr_b16 v[226:227], v250 offset:2048
    v_mfma_f32_16x16x32_bf16 v[148:151], v[244:247], v[92:95], v[148:151]
    s_waitcnt lgkmcnt(5)
    buffer_load_dwordx4 v[88:91], v252, s[4:7], s54 offen offset:3072 sc1
    v_mfma_f32_16x16x32_bf16 v[152:155], v[232:235], v[96:99], v[152:155]
    ds_write_b128 v252, v[96:99] offset:41984
    v_mfma_f32_16x16x32_bf16 v[156:159], v[236:239], v[96:99], v[156:159]
    ds_read_b64_tr_b16 v[228:229], v251 offset:0
    v_mfma_f32_16x16x32_bf16 v[160:163], v[240:243], v[96:99], v[160:163]
    ds_read_b64_tr_b16 v[230:231], v251 offset:2048
    v_mfma_f32_16x16x32_bf16 v[164:167], v[244:247], v[96:99], v[164:167]
    s_waitcnt lgkmcnt(5)
    buffer_load_dwordx4 v[92:95], v252, s[4:7], s55 offen offset:0 sc1
    v_mfma_f32_16x16x32_bf16 v[168:171], v[232:235], v[100:103], v[168:171]
    ds_write_b128 v252, v[100:103] offset:43008
    v_mfma_f32_16x16x32_bf16 v[172:175], v[236:239], v[100:103], v[172:175]
    v_mfma_f32_16x16x32_bf16 v[176:179], v[240:243], v[100:103], v[176:179]
    ds_read_b32 v254, v255 offset:112
    v_mfma_f32_16x16x32_bf16 v[180:183], v[244:247], v[100:103], v[180:183]
    s_waitcnt lgkmcnt(4)
    buffer_load_dwordx4 v[96:99], v252, s[4:7], s55 offen offset:1024 sc1
    v_mfma_f32_16x16x32_bf16 v[184:187], v[232:235], v[104:107], v[184:187]
    ds_write_b128 v252, v[104:107] offset:44032
    v_mfma_f32_16x16x32_bf16 v[188:191], v[236:239], v[104:107], v[188:191]
    v_mfma_f32_16x16x32_bf16 v[192:195], v[240:243], v[104:107], v[192:195]
    s_waitcnt lgkmcnt(1)
    v_cmp_gt_u32 vcc, 3, v254
    v_mfma_f32_16x16x32_bf16 v[196:199], v[244:247], v[104:107], v[196:199]
    buffer_load_dwordx4 v[100:103], v252, s[4:7], s55 offen offset:2048 sc1
    s_waitcnt vmcnt(20)
    v_mfma_f32_16x16x32_bf16 v[200:203], v[232:235], v[108:111], v[200:203]
    v_mov_b32 v254, 4
    v_mfma_f32_16x16x32_bf16 v[204:207], v[236:239], v[108:111], v[204:207]
    ds_write_b128 v252, v[108:111] offset:45056
    v_mfma_f32_16x16x32_bf16 v[208:211], v[240:243], v[108:111], v[208:211]
    ds_write_b32 v255, v254 offset:96
    v_mfma_f32_16x16x32_bf16 v[212:215], v[244:247], v[108:111], v[212:215]
    s_cbranch_vccnz G1_fr4
G1_fr4_ret:
    s_waitcnt lgkmcnt(2)
    buffer_load_dwordx4 v[104:107], v252, s[4:7], s55 offen offset:3072 sc1
    s_waitcnt lgkmcnt(2)
    s_add_u32 m0, s41, 130816
    s_cmp_le_u32 s53, 1
    s_cselect_b32 s46, 24, 20
    s_add_u32 s46, s46, s52
    s_lshl_b32 s46, s46, 18
    buffer_load_dwordx4 v253, s[8:11], s46 offen offset:0  lds
    s_add_u32 s46, s46, 15360
    buffer_load_dwordx4 v253, s[8:11], s46 offen offset:1024  lds
    s_add_u32 s46, s46, 15360
    buffer_load_dwordx4 v253, s[8:11], s46 offen offset:2048  lds
    s_add_u32 s46, s46, 15360
    buffer_load_dwordx4 v253, s[8:11], s46 offen offset:3072  lds
    s_cmp_le_u32 s53, 1
    s_cselect_b32 s54, 24, 20
    s_add_u32 s54, s54, s52
    s_mul_i32 s54, s54, 36864
    s_add_u32 s55, s54, 4096
    s_add_u32 s47, s54, 8192
    s_waitcnt vmcnt(24)
    v_mfma_f32_16x16x32_bf16 v[0:3], v[216:219], v[40:43], v[0:3]
    ds_write_b128 v252, v[40:43] offset:0
    v_mfma_f32_16x16x32_bf16 v[4:7], v[220:223], v[40:43], v[4:7]
    v_mfma_f32_16x16x32_bf16 v[8:11], v[224:227], v[40:43], v[8:11]
    v_mfma_f32_16x16x32_bf16 v[12:15], v[228:231], v[40:43], v[12:15]
    s_waitcnt lgkmcnt(2)
    buffer_load_dwordx4 v[108:111], v252, s[4:7], s51 offen offset:0 sc1
    s_waitcnt vmcnt(24)
    v_mfma_f32_16x16x32_bf16 v[16:19], v[216:219], v[44:47], v[16:19]
    ds_write_b128 v252, v[44:47] offset:1024
    v_mfma_f32_16x16x32_bf16 v[20:23], v[220:223], v[44:47], v[20:23]
    v_mfma_f32_16x16x32_bf16 v[24:27], v[224:227], v[44:47], v[24:27]
    v_mfma_f32_16x16x32_bf16 v[28:31], v[228:231], v[44:47], v[28:31]
    s_waitcnt lgkmcnt(1)
    buffer_load_dwordx4 v[40:43], v252, s[4:7], s54 offen offset:0 sc1
    s_waitcnt vmcnt(15)
    v_mfma_f32_16x16x32_bf16 v[32:35], v[216:219], v[48:51], v[32:35]
    ds_write_b128 v252, v[48:51] offset:2048
    v_mfma_f32_16x16x32_bf16 v[36:39], v[220:223], v[48:51], v[36:39]
    ds_read_b64_tr_b16 v[232:233], v248 offset:16384
    v_mfma_f32_16x16x32_bf16 v[112:115], v[224:227], v[48:51], v[112:115]
    ds_read_b64_tr_b16 v[234:235], v248 offset:18432
    v_mfma_f32_16x16x32_bf16 v[116:119], v[228:231], v[48:51], v[116:119]
    s_waitcnt lgkmcnt(3)
    buffer_load_dwordx4 v[44:47], v252, s[4:7], s54 offen offset:1024 sc1
    v_mfma_f32_16x16x32_bf16 v[120:123], v[216:219], v[52:55], v[120:123]
    ds_write_b128 v252, v[52:55] offset:3072
    v_mfma_f32_16x16x32_bf16 v[124:127], v[220:223], v[52:55], v[124:127]
    ds_read_b64_tr_b16 v[236:237], v249 offset:16384
    v_mfma_f32_16x16x32_bf16 v[128:131], v[224:227], v[52:55], v[128:131]
    ds_read_b64_tr_b16 v[238:239], v249 offset:18432
    v_mfma_f32_16x16x32_bf16 v[132:135], v[228:231], v[52:55], v[132:135]
    s_waitcnt lgkmcnt(5)
    buffer_load_dwordx4 v[48:51], v252, s[4:7], s54 offen offset:2048 sc1
    v_mfma_f32_16x16x32_bf16 v[136:139], v[216:219], v[56:59], v[136:139]
    ds_write_b128 v252, v[56:59] offset:4096
    v_mfma_f32_16x16x32_bf16 v[140:143], v[220:223], v[56:59], v[140:143]
    ds_read_b64_tr_b16 v[240:241], v250 offset:16384
    v_mfma_f32_16x16x32_bf16 v[144:147], v[224:227], v[56:59], v[144:147]
    ds_read_b64_tr_b16 v[242:243], v250 offset:18432
    v_mfma_f32_16x16x32_bf16 v[148:151], v[228:231], v[56:59], v[148:151]
    s_waitcnt lgkmcnt(5)
    buffer_load_dwordx4 v[52:55], v252, s[4:7], s54 offen offset:3072 sc1
    v_mfma_f32_16x16x32_bf16 v[152:155], v[216:219], v[60:63], v[152:155]
    ds_write_b128 v252, v[60:63] offset:5120
    v_mfma_f32_16x16x32_bf16 v[156:159], v[220:223], v[60:63], v[156:159]
    ds_read_b64_tr_b16 v[244:245], v251 offset:16384
    v_mfma_f32_16x16x32_bf16 v[160:163], v[224:227], v[60:63], v[160:163]
    ds_read_b64_tr_b16 v[246:247], v251 offset:18432
    v_mfma_f32_16x16x32_bf16 v[164:167], v[228:231], v[60:63], v[164:167]
    s_waitcnt lgkmcnt(5)
    buffer_load_dwordx4 v[56:59], v252, s[4:7], s55 offen offset:0 sc1
    v_mfma_f32_16x16x32_bf16 v[168:171], v[216:219], v[64:67], v[168:171]
    ds_write_b128 v252, v[64:67] offset:6144
    v_mfma_f32_16x16x32_bf16 v[172:175], v[220:223], v[64:67], v[172:175]
    v_mfma_f32_16x16x32_bf16 v[176:179], v[224:227], v[64:67], v[176:179]
    ds_read_b32 v254, v255 offset:112
    v_mfma_f32_16x16x32_bf16 v[180:183], v[228:231], v[64:67], v[180:183]
    s_waitcnt lgkmcnt(4)
    buffer_load_dwordx4 v[60:63], v252, s[4:7], s55 offen offset:1024 sc1
    v_mfma_f32_16x16x32_bf16 v[184:187], v[216:219], v[68:71], v[184:187]
    ds_write_b128 v252, v[68:71] offset:7168
    v_mfma_f32_16x16x32_bf16 v[188:191], v[220:223], v[68:71], v[188:191]
    v_mfma_f32_16x16x32_bf16 v[192:195], v[224:227], v[68:71], v[192:195]
    s_waitcnt lgkmcnt(1)
    v_cmp_gt_u32 vcc, 4, v254
    v_mfma_f32_16x16x32_bf16 v[196:199], v[228:231], v[68:71], v[196:199]
    buffer_load_dwordx4 v[64:67], v252, s[4:7], s55 offen offset:2048 sc1
    s_waitcnt vmcnt(20)
    v_mfma_f32_16x16x32_bf16 v[200:203], v[216:219], v[72:75], v[200:203]
    v_mov_b32 v254, 5
    v_mfma_f32_16x16x32_bf16 v[204:207], v[220:223], v[72:75], v[204:207]
    ds_write_b128 v252, v[72:75] offset:8192
    v_mfma_f32_16x16x32_bf16 v[208:211], v[224:227], v[72:75], v[208:211]
    ds_write_b32 v255, v254 offset:96
    v_mfma_f32_16x16x32_bf16 v[212:215], v[228:231], v[72:75], v[212:215]
    s_cbranch_vccnz G1_fr5
G1_fr5_ret:
    s_waitcnt lgkmcnt(2)
    buffer_load_dwordx4 v[68:71], v252, s[4:7], s55 offen offset:3072 sc1
    s_waitcnt lgkmcnt(2)
    s_add_u32 m0, s41, 147200
    s_cmp_le_u32 s53, 2
    s_cselect_b32 s46, 28, 24
    s_add_u32 s46, s46, s52
    s_lshl_b32 s46, s46, 18
    buffer_load_dwordx4 v253, s[8:11], s46 offen offset:0  lds
    s_add_u32 s46, s46, 15360
    buffer_load_dwordx4 v253, s[8:11], s46 offen offset:1024  lds
    s_add_u32 s46, s46, 15360
    buffer_load_dwordx4 v253, s[8:11], s46 offen offset:2048  lds
    s_add_u32 s46, s46, 15360
    buffer_load_dwordx4 v253, s[8:11], s46 offen offset:3072  lds
    v_mbcnt_lo_u32_b32 v216, -1, 0
    v_and_b32 v216, 15, v216
    s_lshl_b32 s44, s34, 12
    s_add_u32 s44, s44, 50331648
    v_lshl_add_u32 v217, v216, 7, s44
    s_lshl_b32 s44, s24, 6
    s_add_u32 m0, s44, 73728
    s_mov_b64 exec, 0xffff
    global_load_lds_dword v217, s[36:37] sc1
    s_mov_b64 exec, -1
    s_cmp_le_u32 s53, 2
    s_cselect_b32 s54, 28, 24
    s_add_u32 s54, s54, s52
    s_mul_i32 s54, s54, 36864
    s_add_u32 s55, s54, 4096
    s_add_u32 s51, s54, 8192
    s_waitcnt vmcnt(25)
    v_mfma_f32_16x16x32_bf16 v[0:3], v[232:235], v[76:79], v[0:3]
    ds_write_b128 v252, v[76:79] offset:36864
    v_mfma_f32_16x16x32_bf16 v[4:7], v[236:239], v[76:79], v[4:7]
    v_mfma_f32_16x16x32_bf16 v[8:11], v[240:243], v[76:79], v[8:11]
    v_mfma_f32_16x16x32_bf16 v[12:15], v[244:247], v[76:79], v[12:15]
    s_waitcnt lgkmcnt(2)
    buffer_load_dwordx4 v[72:75], v252, s[4:7], s47 offen offset:0 sc1
    s_waitcnt vmcnt(25)
    v_mfma_f32_16x16x32_bf16 v[16:19], v[232:235], v[80:83], v[16:19]
    ds_write_b128 v252, v[80:83] offset:37888
    v_mfma_f32_16x16x32_bf16 v[20:23], v[236:239], v[80:83], v[20:23]
    v_mfma_f32_16x16x32_bf16 v[24:27], v[240:243], v[80:83], v[24:27]
    v_mfma_f32_16x16x32_bf16 v[28:31], v[244:247], v[80:83], v[28:31]
    s_waitcnt lgkmcnt(1)
    buffer_load_dwordx4 v[76:79], v252, s[4:7], s54 offen offset:0 sc1
    s_waitcnt vmcnt(16)
    v_mfma_f32_16x16x32_bf16 v[32:35], v[232:235], v[84:87], v[32:35]
    ds_write_b128 v252, v[84:87] offset:38912
    v_mfma_f32_16x16x32_bf16 v[36:39], v[236:239], v[84:87], v[36:39]
    ds_read_b64_tr_b16 v[216:217], v248 offset:0
    v_mfma_f32_16x16x32_bf16 v[112:115], v[240:243], v[84:87], v[112:115]
    ds_read_b64_tr_b16 v[218:219], v248 offset:2048
    v_mfma_f32_16x16x32_bf16 v[116:119], v[244:247], v[84:87], v[116:119]
    s_waitcnt lgkmcnt(3)
    buffer_load_dwordx4 v[80:83], v252, s[4:7], s54 offen offset:1024 sc1
    v_mfma_f32_16x16x32_bf16 v[120:123], v[232:235], v[88:91], v[120:123]
    ds_write_b128 v252, v[88:91] offset:39936
    v_mfma_f32_16x16x32_bf16 v[124:127], v[236:239], v[88:91], v[124:127]
    ds_read_b64_tr_b16 v[220:221], v249 offset:0
    v_mfma_f32_16x16x32_bf16 v[128:131], v[240:243], v[88:91], v[128:131]
    ds_read_b64_tr_b16 v[222:223], v249 offset:2048
    v_mfma_f32_16x16x32_bf16 v[132:135], v[244:247], v[88:91], v[132:135]
    s_waitcnt lgkmcnt(5)
    buffer_load_dwordx4 v[84:87], v252, s[4:7], s54 offen offset:2048 sc1
    v_mfma_f32_16x16x32_bf16 v[136:139], v[232:235], v[92:95], v[136:139]
    ds_write_b128 v252, v[92:95] offset:40960
    v_mfma_f32_16x16x32_bf16 v[140:143], v[236:239], v[92:95], v[140:143]
    ds_read_b64_tr_b16 v[224:225], v250 offset:0
    v_mfma_f32_16x16x32_bf16 v[144:147], v[240:243], v[92:95], v[144:147]
    ds_read_b64_tr_b16 v[226:227], v250 offset:2048
    v_mfma_f32_16x16x32_bf16 v[148:151], v[244:247], v[92:95], v[148:151]
    s_waitcnt lgkmcnt(5)
    buffer_load_dwordx4 v[88:91], v252, s[4:7], s54 offen offset:3072 sc1
    v_mfma_f32_16x16x32_bf16 v[152:155], v[232:235], v[96:99], v[152:155]
    ds_write_b128 v252, v[96:99] offset:41984
    v_mfma_f32_16x16x32_bf16 v[156:159], v[236:239], v[96:99], v[156:159]
    ds_read_b64_tr_b16 v[228:229], v251 offset:0
    v_mfma_f32_16x16x32_bf16 v[160:163], v[240:243], v[96:99], v[160:163]
    ds_read_b64_tr_b16 v[230:231], v251 offset:2048
    v_mfma_f32_16x16x32_bf16 v[164:167], v[244:247], v[96:99], v[164:167]
    s_waitcnt lgkmcnt(5)
    buffer_load_dwordx4 v[92:95], v252, s[4:7], s55 offen offset:0 sc1
    v_mfma_f32_16x16x32_bf16 v[168:171], v[232:235], v[100:103], v[168:171]
    ds_write_b128 v252, v[100:103] offset:43008
    v_mfma_f32_16x16x32_bf16 v[172:175], v[236:239], v[100:103], v[172:175]
    v_mfma_f32_16x16x32_bf16 v[176:179], v[240:243], v[100:103], v[176:179]
    ds_read_b32 v254, v255 offset:112
    v_mfma_f32_16x16x32_bf16 v[180:183], v[244:247], v[100:103], v[180:183]
    s_waitcnt lgkmcnt(4)
    buffer_load_dwordx4 v[96:99], v252, s[4:7], s55 offen offset:1024 sc1
    v_mfma_f32_16x16x32_bf16 v[184:187], v[232:235], v[104:107], v[184:187]
    ds_write_b128 v252, v[104:107] offset:44032
    v_mfma_f32_16x16x32_bf16 v[188:191], v[236:239], v[104:107], v[188:191]
    v_mfma_f32_16x16x32_bf16 v[192:195], v[240:243], v[104:107], v[192:195]
    s_waitcnt lgkmcnt(1)
    v_cmp_gt_u32 vcc, 5, v254
    v_mfma_f32_16x16x32_bf16 v[196:199], v[244:247], v[104:107], v[196:199]
    buffer_load_dwordx4 v[100:103], v252, s[4:7], s55 offen offset:2048 sc1
    s_waitcnt vmcnt(21)
    v_mfma_f32_16x16x32_bf16 v[200:203], v[232:235], v[108:111], v[200:203]
    v_mov_b32 v254, 6
    v_mfma_f32_16x16x32_bf16 v[204:207], v[236:239], v[108:111], v[204:207]
    ds_write_b128 v252, v[108:111] offset:45056
    v_mfma_f32_16x16x32_bf16 v[208:211], v[240:243], v[108:111], v[208:211]
    ds_write_b32 v255, v254 offset:96
    v_mfma_f32_16x16x32_bf16 v[212:215], v[244:247], v[108:111], v[212:215]
    s_cbranch_vccnz G1_fr6
G1_fr6_ret:
    s_waitcnt lgkmcnt(2)
    buffer_load_dwordx4 v[104:107], v252, s[4:7], s55 offen offset:3072 sc1
    s_waitcnt lgkmcnt(2)
    s_add_u32 m0, s41, 130816
    s_mul_i32 s46, s53, 4
    s_add_u32 s46, s46, 1
    s_add_u32 s46, s46, s52
    s_lshl_b32 s46, s46, 18
    buffer_load_dwordx4 v253, s[8:11], s46 offen offset:0  lds
    s_add_u32 s46, s46, 15360
    buffer_load_dwordx4 v253, s[8:11], s46 offen offset:1024  lds
    s_add_u32 s46, s46, 15360
    buffer_load_dwordx4 v253, s[8:11], s46 offen offset:2048  lds
    s_add_u32 s46, s46, 15360
    buffer_load_dwordx4 v253, s[8:11], s46 offen offset:3072  lds
    v_mbcnt_lo_u32_b32 v232, -1, 0
    v_and_b32 v232, 15, v232
    s_lshl_b32 s44, s34, 12
    s_add_u32 s44, s44, 50331648
    v_lshl_add_u32 v233, v232, 7, s44
    s_lshl_b32 s44, s24, 6
    s_add_u32 s44, s44, 73728
    v_lshl_add_u32 v232, v232, 2, s44
    s_waitcnt vmcnt(13)
    ds_read_b32 v254, v232
    s_waitcnt lgkmcnt(0)
    v_cmp_eq_u32 vcc, 0, v254
    s_nop 1
    s_cbranch_vccnz G1_gwb
G1_gwb_ret:
    s_mul_i32 s54, s53, 4
    s_add_u32 s54, s54, 1
    s_add_u32 s54, s54, s52
    s_mul_i32 s54, s54, 36864
    s_add_u32 s55, s54, 4096
    s_add_u32 s47, s54, 8192
    v_mfma_f32_16x16x32_bf16 v[0:3], v[216:219], v[40:43], v[0:3]
    ds_write_b128 v252, v[40:43] offset:0
    v_mfma_f32_16x16x32_bf16 v[4:7], v[220:223], v[40:43], v[4:7]
    v_mfma_f32_16x16x32_bf16 v[8:11], v[224:227], v[40:43], v[8:11]
    v_mfma_f32_16x16x32_bf16 v[12:15], v[228:231], v[40:43], v[12:15]
    buffer_load_dwordx4 v[108:111], v252, s[4:7], s51 offen offset:0 sc1
    v_mfma_f32_16x16x32_bf16 v[16:19], v[216:219], v[44:47], v[16:19]
    ds_write_b128 v252, v[44:47] offset:1024
    v_mfma_f32_16x16x32_bf16 v[20:23], v[220:223], v[44:47], v[20:23]
    v_mfma_f32_16x16x32_bf16 v[24:27], v[224:227], v[44:47], v[24:27]
    v_mfma_f32_16x16x32_bf16 v[28:31], v[228:231], v[44:47], v[28:31]
    s_waitcnt lgkmcnt(1)
    buffer_load_dwordx4 v[40:43], v252, s[4:7], s54 offen offset:0 sc1
    v_mfma_f32_16x16x32_bf16 v[32:35], v[216:219], v[48:51], v[32:35]
    ds_write_b128 v252, v[48:51] offset:2048
    v_mfma_f32_16x16x32_bf16 v[36:39], v[220:223], v[48:51], v[36:39]
    ds_read_b64_tr_b16 v[232:233], v248 offset:16384
    v_mfma_f32_16x16x32_bf16 v[112:115], v[224:227], v[48:51], v[112:115]
    ds_read_b64_tr_b16 v[234:235], v248 offset:18432
    v_mfma_f32_16x16x32_bf16 v[116:119], v[228:231], v[48:51], v[116:119]
    s_waitcnt lgkmcnt(3)
    buffer_load_dwordx4 v[44:47], v252, s[4:7], s54 offen offset:1024 sc1
    v_mfma_f32_16x16x32_bf16 v[120:123], v[216:219], v[52:55], v[120:123]
    ds_write_b128 v252, v[52:55] offset:3072
    v_mfma_f32_16x16x32_bf16 v[124:127], v[220:223], v[52:55], v[124:127]
    ds_read_b64_tr_b16 v[236:237], v249 offset:16384
    v_mfma_f32_16x16x32_bf16 v[128:131], v[224:227], v[52:55], v[128:131]
    ds_read_b64_tr_b16 v[238:239], v249 offset:18432
    v_mfma_f32_16x16x32_bf16 v[132:135], v[228:231], v[52:55], v[132:135]
    s_waitcnt lgkmcnt(5)
    buffer_load_dwordx4 v[48:51], v252, s[4:7], s54 offen offset:2048 sc1
    v_mfma_f32_16x16x32_bf16 v[136:139], v[216:219], v[56:59], v[136:139]
    ds_write_b128 v252, v[56:59] offset:4096
    v_mfma_f32_16x16x32_bf16 v[140:143], v[220:223], v[56:59], v[140:143]
    ds_read_b64_tr_b16 v[240:241], v250 offset:16384
    v_mfma_f32_16x16x32_bf16 v[144:147], v[224:227], v[56:59], v[144:147]
    ds_read_b64_tr_b16 v[242:243], v250 offset:18432
    v_mfma_f32_16x16x32_bf16 v[148:151], v[228:231], v[56:59], v[148:151]
    s_waitcnt lgkmcnt(5)
    buffer_load_dwordx4 v[52:55], v252, s[4:7], s54 offen offset:3072 sc1
    v_mfma_f32_16x16x32_bf16 v[152:155], v[216:219], v[60:63], v[152:155]
    ds_write_b128 v252, v[60:63] offset:5120
    v_mfma_f32_16x16x32_bf16 v[156:159], v[220:223], v[60:63], v[156:159]
    ds_read_b64_tr_b16 v[244:245], v251 offset:16384
    v_mfma_f32_16x16x32_bf16 v[160:163], v[224:227], v[60:63], v[160:163]
    ds_read_b64_tr_b16 v[246:247], v251 offset:18432
    v_mfma_f32_16x16x32_bf16 v[164:167], v[228:231], v[60:63], v[164:167]
    s_waitcnt lgkmcnt(5)
    buffer_load_dwordx4 v[56:59], v252, s[4:7], s55 offen offset:0 sc1
    v_mfma_f32_16x16x32_bf16 v[168:171], v[216:219], v[64:67], v[168:171]
    ds_write_b128 v252, v[64:67] offset:6144
    v_mfma_f32_16x16x32_bf16 v[172:175], v[220:223], v[64:67], v[172:175]
    v_mfma_f32_16x16x32_bf16 v[176:179], v[224:227], v[64:67], v[176:179]
    ds_read_b32 v254, v255 offset:112
    v_mfma_f32_16x16x32_bf16 v[180:183], v[228:231], v[64:67], v[180:183]
    s_waitcnt lgkmcnt(4)
    buffer_load_dwordx4 v[60:63], v252, s[4:7], s55 offen offset:1024 sc1
    v_mfma_f32_16x16x32_bf16 v[184:187], v[216:219], v[68:71], v[184:187]
    ds_write_b128 v252, v[68:71] offset:7168
    v_mfma_f32_16x16x32_bf16 v[188:191], v[220:223], v[68:71], v[188:191]
    v_mfma_f32_16x16x32_bf16 v[192:195], v[224:227], v[68:71], v[192:195]
    s_waitcnt lgkmcnt(1)
    v_cmp_gt_u32 vcc, 6, v254
    v_mfma_f32_16x16x32_bf16 v[196:199], v[228:231], v[68:71], v[196:199]
    buffer_load_dwordx4 v[64:67], v252, s[4:7], s55 offen offset:2048 sc1
    s_waitcnt vmcnt(20)
    v_mfma_f32_16x16x32_bf16 v[200:203], v[216:219], v[72:75], v[200:203]
    v_mov_b32 v254, 7
    v_mfma_f32_16x16x32_bf16 v[204:207], v[220:223], v[72:75], v[204:207]
    ds_write_b128 v252, v[72:75] offset:8192
    v_mfma_f32_16x16x32_bf16 v[208:211], v[224:227], v[72:75], v[208:211]
    ds_write_b32 v255, v254 offset:96
    v_mfma_f32_16x16x32_bf16 v[212:215], v[228:231], v[72:75], v[212:215]
    s_cbranch_vccnz G1_fr7
G1_fr7_ret:
    s_waitcnt lgkmcnt(2)
    buffer_load_dwordx4 v[68:71], v252, s[4:7], s55 offen offset:3072 sc1
    s_waitcnt lgkmcnt(2)
    s_add_u32 m0, s41, 147200
    s_cmp_le_u32 s53, 0
    s_cselect_b32 s46, 5, 1
    s_add_u32 s46, s46, s52
    s_lshl_b32 s46, s46, 18
    buffer_load_dwordx4 v253, s[8:11], s46 offen offset:0  lds
    s_add_u32 s46, s46, 15360
    buffer_load_dwordx4 v253, s[8:11], s46 offen offset:1024  lds
    s_add_u32 s46, s46, 15360
    buffer_load_dwordx4 v253, s[8:11], s46 offen offset:2048  lds
    s_add_u32 s46, s46, 15360
    buffer_load_dwordx4 v253, s[8:11], s46 offen offset:3072  lds
    s_cmp_le_u32 s53, 0
    s_cselect_b32 s54, 5, 1
    s_add_u32 s54, s54, s52
    s_mul_i32 s54, s54, 36864
    s_add_u32 s55, s54, 4096
    s_add_u32 s51, s54, 8192
    s_waitcnt vmcnt(24)
    v_mfma_f32_16x16x32_bf16 v[0:3], v[232:235], v[76:79], v[0:3]
    ds_write_b128 v252, v[76:79] offset:36864
    v_mfma_f32_16x16x32_bf16 v[4:7], v[236:239], v[76:79], v[4:7]
    v_mfma_f32_16x16x32_bf16 v[8:11], v[240:243], v[76:79], v[8:11]
    v_mfma_f32_16x16x32_bf16 v[12:15], v[244:247], v[76:79], v[12:15]
    s_waitcnt lgkmcnt(2)
    buffer_load_dwordx4 v[72:75], v252, s[4:7], s47 offen offset:0 sc1
    s_waitcnt vmcnt(24)
    v_mfma_f32_16x16x32_bf16 v[16:19], v[232:235], v[80:83], v[16:19]
    ds_write_b128 v252, v[80:83] offset:37888
    v_mfma_f32_16x16x32_bf16 v[20:23], v[236:239], v[80:83], v[20:23]
    v_mfma_f32_16x16x32_bf16 v[24:27], v[240:243], v[80:83], v[24:27]
    v_mfma_f32_16x16x32_bf16 v[28:31], v[244:247], v[80:83], v[28:31]
    s_waitcnt lgkmcnt(1)
    buffer_load_dwordx4 v[76:79], v252, s[4:7], s54 offen offset:0 sc1
    s_waitcnt vmcnt(15)
    v_mfma_f32_16x16x32_bf16 v[32:35], v[232:235], v[84:87], v[32:35]
    ds_write_b128 v252, v[84:87] offset:38912
    v_mfma_f32_16x16x32_bf16 v[36:39], v[236:239], v[84:87], v[36:39]
    ds_read_b64_tr_b16 v[216:217], v248 offset:0
    v_mfma_f32_16x16x32_bf16 v[112:115], v[240:243], v[84:87], v[112:115]
    ds_read_b64_tr_b16 v[218:219], v248 offset:2048
    v_mfma_f32_16x16x32_bf16 v[116:119], v[244:247], v[84:87], v[116:119]
    s_waitcnt lgkmcnt(3)
    buffer_load_dwordx4 v[80:83], v252, s[4:7], s54 offen offset:1024 sc1
    v_mfma_f32_16x16x32_bf16 v[120:123], v[232:235], v[88:91], v[120:123]
    ds_write_b128 v252, v[88:91] offset:39936
    v_mfma_f32_16x16x32_bf16 v[124:127], v[236:239], v[88:91], v[124:127]
    ds_read_b64_tr_b16 v[220:221], v249 offset:0
    v_mfma_f32_16x16x32_bf16 v[128:131], v[240:243], v[88:91], v[128:131]
    ds_read_b64_tr_b16 v[222:223], v249 offset:2048
    v_mfma_f32_16x16x32_bf16 v[132:135], v[244:247], v[88:91], v[132:135]
    s_waitcnt lgkmcnt(5)
    buffer_load_dwordx4 v[84:87], v252, s[4:7], s54 offen offset:2048 sc1
    v_mfma_f32_16x16x32_bf16 v[136:139], v[232:235], v[92:95], v[136:139]
    ds_write_b128 v252, v[92:95] offset:40960
    v_mfma_f32_16x16x32_bf16 v[140:143], v[236:239], v[92:95], v[140:143]
    ds_read_b64_tr_b16 v[224:225], v250 offset:0
    v_mfma_f32_16x16x32_bf16 v[144:147], v[240:243], v[92:95], v[144:147]
    ds_read_b64_tr_b16 v[226:227], v250 offset:2048
    v_mfma_f32_16x16x32_bf16 v[148:151], v[244:247], v[92:95], v[148:151]
    s_waitcnt lgkmcnt(5)
    buffer_load_dwordx4 v[88:91], v252, s[4:7], s54 offen offset:3072 sc1
    v_mfma_f32_16x16x32_bf16 v[152:155], v[232:235], v[96:99], v[152:155]
    ds_write_b128 v252, v[96:99] offset:41984
    v_mfma_f32_16x16x32_bf16 v[156:159], v[236:239], v[96:99], v[156:159]
    ds_read_b64_tr_b16 v[228:229], v251 offset:0
    v_mfma_f32_16x16x32_bf16 v[160:163], v[240:243], v[96:99], v[160:163]
    ds_read_b64_tr_b16 v[230:231], v251 offset:2048
    v_mfma_f32_16x16x32_bf16 v[164:167], v[244:247], v[96:99], v[164:167]
    s_waitcnt lgkmcnt(5)
    buffer_load_dwordx4 v[92:95], v252, s[4:7], s55 offen offset:0 sc1
    v_mfma_f32_16x16x32_bf16 v[168:171], v[232:235], v[100:103], v[168:171]
    ds_write_b128 v252, v[100:103] offset:43008
    v_mfma_f32_16x16x32_bf16 v[172:175], v[236:239], v[100:103], v[172:175]
    v_mfma_f32_16x16x32_bf16 v[176:179], v[240:243], v[100:103], v[176:179]
    ds_read_b32 v254, v255 offset:112
    v_mfma_f32_16x16x32_bf16 v[180:183], v[244:247], v[100:103], v[180:183]
    s_waitcnt lgkmcnt(4)
    buffer_load_dwordx4 v[96:99], v252, s[4:7], s55 offen offset:1024 sc1
    v_mfma_f32_16x16x32_bf16 v[184:187], v[232:235], v[104:107], v[184:187]
    ds_write_b128 v252, v[104:107] offset:44032
    v_mfma_f32_16x16x32_bf16 v[188:191], v[236:239], v[104:107], v[188:191]
    v_mfma_f32_16x16x32_bf16 v[192:195], v[240:243], v[104:107], v[192:195]
    s_waitcnt lgkmcnt(1)
    v_cmp_gt_u32 vcc, 7, v254
    v_mfma_f32_16x16x32_bf16 v[196:199], v[244:247], v[104:107], v[196:199]
    buffer_load_dwordx4 v[100:103], v252, s[4:7], s55 offen offset:2048 sc1
    s_waitcnt vmcnt(20)
    v_mfma_f32_16x16x32_bf16 v[200:203], v[232:235], v[108:111], v[200:203]
    v_mov_b32 v254, 8
    v_mfma_f32_16x16x32_bf16 v[204:207], v[236:239], v[108:111], v[204:207]
    ds_write_b128 v252, v[108:111] offset:45056
    v_mfma_f32_16x16x32_bf16 v[208:211], v[240:243], v[108:111], v[208:211]
    ds_write_b32 v255, v254 offset:96
    v_mfma_f32_16x16x32_bf16 v[212:215], v[244:247], v[108:111], v[212:215]
    s_cbranch_vccnz G1_fr8
G1_fr8_ret:
    s_waitcnt lgkmcnt(2)
    buffer_load_dwordx4 v[104:107], v252, s[4:7], s55 offen offset:3072 sc1
    s_waitcnt lgkmcnt(2)
    s_add_u32 m0, s41, 130816
    s_cmp_le_u32 s53, 1
    s_cselect_b32 s46, 9, 5
    s_add_u32 s46, s46, s52
    s_lshl_b32 s46, s46, 18
    buffer_load_dwordx4 v253, s[8:11], s46 offen offset:0  lds
    s_add_u32 s46, s46, 15360
    buffer_load_dwordx4 v253, s[8:11], s46 offen offset:1024  lds
    s_add_u32 s46, s46, 15360
    buffer_load_dwordx4 v253, s[8:11], s46 offen offset:2048  lds
    s_add_u32 s46, s46, 15360
    buffer_load_dwordx4 v253, s[8:11], s46 offen offset:3072  lds
    s_cmp_le_u32 s53, 1
    s_cselect_b32 s54, 9, 5
    s_add_u32 s54, s54, s52
    s_mul_i32 s54, s54, 36864
    s_add_u32 s55, s54, 4096
    s_add_u32 s47, s54, 8192
    s_waitcnt vmcnt(24)
    v_mfma_f32_16x16x32_bf16 v[0:3], v[216:219], v[40:43], v[0:3]
    ds_write_b128 v252, v[40:43] offset:0
    v_mfma_f32_16x16x32_bf16 v[4:7], v[220:223], v[40:43], v[4:7]
    v_mfma_f32_16x16x32_bf16 v[8:11], v[224:227], v[40:43], v[8:11]
    v_mfma_f32_16x16x32_bf16 v[12:15], v[228:231], v[40:43], v[12:15]
    s_waitcnt lgkmcnt(2)
    buffer_load_dwordx4 v[108:111], v252, s[4:7], s51 offen offset:0 sc1
    s_waitcnt vmcnt(24)
    v_mfma_f32_16x16x32_bf16 v[16:19], v[216:219], v[44:47], v[16:19]
    ds_write_b128 v252, v[44:47] offset:1024
    v_mfma_f32_16x16x32_bf16 v[20:23], v[220:223], v[44:47], v[20:23]
    v_mfma_f32_16x16x32_bf16 v[24:27], v[224:227], v[44:47], v[24:27]
    v_mfma_f32_16x16x32_bf16 v[28:31], v[228:231], v[44:47], v[28:31]
    s_waitcnt lgkmcnt(1)
    buffer_load_dwordx4 v[40:43], v252, s[4:7], s54 offen offset:0 sc1
    s_waitcnt vmcnt(15)
    v_mfma_f32_16x16x32_bf16 v[32:35], v[216:219], v[48:51], v[32:35]
    ds_write_b128 v252, v[48:51] offset:2048
    v_mfma_f32_16x16x32_bf16 v[36:39], v[220:223], v[48:51], v[36:39]
    ds_read_b64_tr_b16 v[232:233], v248 offset:16384
    v_mfma_f32_16x16x32_bf16 v[112:115], v[224:227], v[48:51], v[112:115]
    ds_read_b64_tr_b16 v[234:235], v248 offset:18432
    v_mfma_f32_16x16x32_bf16 v[116:119], v[228:231], v[48:51], v[116:119]
    s_waitcnt lgkmcnt(3)
    buffer_load_dwordx4 v[44:47], v252, s[4:7], s54 offen offset:1024 sc1
    v_mfma_f32_16x16x32_bf16 v[120:123], v[216:219], v[52:55], v[120:123]
    ds_write_b128 v252, v[52:55] offset:3072
    v_mfma_f32_16x16x32_bf16 v[124:127], v[220:223], v[52:55], v[124:127]
    ds_read_b64_tr_b16 v[236:237], v249 offset:16384
    v_mfma_f32_16x16x32_bf16 v[128:131], v[224:227], v[52:55], v[128:131]
    ds_read_b64_tr_b16 v[238:239], v249 offset:18432
    v_mfma_f32_16x16x32_bf16 v[132:135], v[228:231], v[52:55], v[132:135]
    s_waitcnt lgkmcnt(5)
    buffer_load_dwordx4 v[48:51], v252, s[4:7], s54 offen offset:2048 sc1
    v_mfma_f32_16x16x32_bf16 v[136:139], v[216:219], v[56:59], v[136:139]
    ds_write_b128 v252, v[56:59] offset:4096
    v_mfma_f32_16x16x32_bf16 v[140:143], v[220:223], v[56:59], v[140:143]
    ds_read_b64_tr_b16 v[240:241], v250 offset:16384
    v_mfma_f32_16x16x32_bf16 v[144:147], v[224:227], v[56:59], v[144:147]
    ds_read_b64_tr_b16 v[242:243], v250 offset:18432
    v_mfma_f32_16x16x32_bf16 v[148:151], v[228:231], v[56:59], v[148:151]
    s_waitcnt lgkmcnt(5)
    buffer_load_dwordx4 v[52:55], v252, s[4:7], s54 offen offset:3072 sc1
    v_mfma_f32_16x16x32_bf16 v[152:155], v[216:219], v[60:63], v[152:155]
    ds_write_b128 v252, v[60:63] offset:5120
    v_mfma_f32_16x16x32_bf16 v[156:159], v[220:223], v[60:63], v[156:159]
    ds_read_b64_tr_b16 v[244:245], v251 offset:16384
    v_mfma_f32_16x16x32_bf16 v[160:163], v[224:227], v[60:63], v[160:163]
    ds_read_b64_tr_b16 v[246:247], v251 offset:18432
    v_mfma_f32_16x16x32_bf16 v[164:167], v[228:231], v[60:63], v[164:167]
    s_waitcnt lgkmcnt(5)
    buffer_load_dwordx4 v[56:59], v252, s[4:7], s55 offen offset:0 sc1
    v_mfma_f32_16x16x32_bf16 v[168:171], v[216:219], v[64:67], v[168:171]
    ds_write_b128 v252, v[64:67] offset:6144
    v_mfma_f32_16x16x32_bf16 v[172:175], v[220:223], v[64:67], v[172:175]
    v_mfma_f32_16x16x32_bf16 v[176:179], v[224:227], v[64:67], v[176:179]
    ds_read_b32 v254, v255 offset:112
    v_mfma_f32_16x16x32_bf16 v[180:183], v[228:231], v[64:67], v[180:183]
    s_waitcnt lgkmcnt(4)
    buffer_load_dwordx4 v[60:63], v252, s[4:7], s55 offen offset:1024 sc1
    v_mfma_f32_16x16x32_bf16 v[184:187], v[216:219], v[68:71], v[184:187]
    ds_write_b128 v252, v[68:71] offset:7168
    v_mfma_f32_16x16x32_bf16 v[188:191], v[220:223], v[68:71], v[188:191]
    v_mfma_f32_16x16x32_bf16 v[192:195], v[224:227], v[68:71], v[192:195]
    s_waitcnt lgkmcnt(1)
    v_cmp_gt_u32 vcc, 8, v254
    v_mfma_f32_16x16x32_bf16 v[196:199], v[228:231], v[68:71], v[196:199]
    buffer_load_dwordx4 v[64:67], v252, s[4:7], s55 offen offset:2048 sc1
    s_waitcnt vmcnt(20)
    v_mfma_f32_16x16x32_bf16 v[200:203], v[216:219], v[72:75], v[200:203]
    v_mov_b32 v254, 9
    v_mfma_f32_16x16x32_bf16 v[204:207], v[220:223], v[72:75], v[204:207]
    ds_write_b128 v252, v[72:75] offset:8192
    v_mfma_f32_16x16x32_bf16 v[208:211], v[224:227], v[72:75], v[208:211]
    ds_write_b32 v255, v254 offset:96
    v_mfma_f32_16x16x32_bf16 v[212:215], v[228:231], v[72:75], v[212:215]
    s_cbranch_vccnz G1_fr9
G1_fr9_ret:
    s_waitcnt lgkmcnt(2)
    buffer_load_dwordx4 v[68:71], v252, s[4:7], s55 offen offset:3072 sc1
    s_waitcnt lgkmcnt(2)
    s_add_u32 m0, s41, 147200
    s_cmp_le_u32 s53, 2
    s_cselect_b32 s46, 13, 9
    s_add_u32 s46, s46, s52
    s_lshl_b32 s46, s46, 18
    buffer_load_dwordx4 v253, s[8:11], s46 offen offset:0  lds
    s_add_u32 s46, s46, 15360
    buffer_load_dwordx4 v253, s[8:11], s46 offen offset:1024  lds
    s_add_u32 s46, s46, 15360
    buffer_load_dwordx4 v253, s[8:11], s46 offen offset:2048  lds
    s_add_u32 s46, s46, 15360
    buffer_load_dwordx4 v253, s[8:11], s46 offen offset:3072  lds
    s_cmp_le_u32 s53, 2
    s_cselect_b32 s54, 13, 9
    s_add_u32 s54, s54, s52
    s_mul_i32 s54, s54, 36864
    s_add_u32 s55, s54, 4096
    s_add_u32 s51, s54, 8192
    s_waitcnt vmcnt(24)
    v_mfma_f32_16x16x32_bf16 v[0:3], v[232:235], v[76:79], v[0:3]
    ds_write_b128 v252, v[76:79] offset:36864
    v_mfma_f32_16x16x32_bf16 v[4:7], v[236:239], v[76:79], v[4:7]
    v_mfma_f32_16x16x32_bf16 v[8:11], v[240:243], v[76:79], v[8:11]
    v_mfma_f32_16x16x32_bf16 v[12:15], v[244:247], v[76:79], v[12:15]
    s_waitcnt lgkmcnt(2)
    buffer_load_dwordx4 v[72:75], v252, s[4:7], s47 offen offset:0 sc1
    s_waitcnt vmcnt(24)
    v_mfma_f32_16x16x32_bf16 v[16:19], v[232:235], v[80:83], v[16:19]
    ds_write_b128 v252, v[80:83] offset:37888
    v_mfma_f32_16x16x32_bf16 v[20:23], v[236:239], v[80:83], v[20:23]
    v_mfma_f32_16x16x32_bf16 v[24:27], v[240:243], v[80:83], v[24:27]
    v_mfma_f32_16x16x32_bf16 v[28:31], v[244:247], v[80:83], v[28:31]
    s_waitcnt lgkmcnt(1)
    buffer_load_dwordx4 v[76:79], v252, s[4:7], s54 offen offset:0 sc1
    s_waitcnt vmcnt(15)
    v_mfma_f32_16x16x32_bf16 v[32:35], v[232:235], v[84:87], v[32:35]
    ds_write_b128 v252, v[84:87] offset:38912
    v_mfma_f32_16x16x32_bf16 v[36:39], v[236:239], v[84:87], v[36:39]
    ds_read_b64_tr_b16 v[216:217], v248 offset:0
    v_mfma_f32_16x16x32_bf16 v[112:115], v[240:243], v[84:87], v[112:115]
    ds_read_b64_tr_b16 v[218:219], v248 offset:2048
    v_mfma_f32_16x16x32_bf16 v[116:119], v[244:247], v[84:87], v[116:119]
    s_waitcnt lgkmcnt(3)
    buffer_load_dwordx4 v[80:83], v252, s[4:7], s54 offen offset:1024 sc1
    v_mfma_f32_16x16x32_bf16 v[120:123], v[232:235], v[88:91], v[120:123]
    ds_write_b128 v252, v[88:91] offset:39936
    v_mfma_f32_16x16x32_bf16 v[124:127], v[236:239], v[88:91], v[124:127]
    ds_read_b64_tr_b16 v[220:221], v249 offset:0
    v_mfma_f32_16x16x32_bf16 v[128:131], v[240:243], v[88:91], v[128:131]
    ds_read_b64_tr_b16 v[222:223], v249 offset:2048
    v_mfma_f32_16x16x32_bf16 v[132:135], v[244:247], v[88:91], v[132:135]
    s_waitcnt lgkmcnt(5)
    buffer_load_dwordx4 v[84:87], v252, s[4:7], s54 offen offset:2048 sc1
    v_mfma_f32_16x16x32_bf16 v[136:139], v[232:235], v[92:95], v[136:139]
    ds_write_b128 v252, v[92:95] offset:40960
    v_mfma_f32_16x16x32_bf16 v[140:143], v[236:239], v[92:95], v[140:143]
    ds_read_b64_tr_b16 v[224:225], v250 offset:0
    v_mfma_f32_16x16x32_bf16 v[144:147], v[240:243], v[92:95], v[144:147]
    ds_read_b64_tr_b16 v[226:227], v250 offset:2048
    v_mfma_f32_16x16x32_bf16 v[148:151], v[244:247], v[92:95], v[148:151]
    s_waitcnt lgkmcnt(5)
    buffer_load_dwordx4 v[88:91], v252, s[4:7], s54 offen offset:3072 sc1
    v_mfma_f32_16x16x32_bf16 v[152:155], v[232:235], v[96:99], v[152:155]
    ds_write_b128 v252, v[96:99] offset:41984
    v_mfma_f32_16x16x32_bf16 v[156:159], v[236:239], v[96:99], v[156:159]
    ds_read_b64_tr_b16 v[228:229], v251 offset:0
    v_mfma_f32_16x16x32_bf16 v[160:163], v[240:243], v[96:99], v[160:163]
    ds_read_b64_tr_b16 v[230:231], v251 offset:2048
    v_mfma_f32_16x16x32_bf16 v[164:167], v[244:247], v[96:99], v[164:167]
    s_waitcnt lgkmcnt(5)
    buffer_load_dwordx4 v[92:95], v252, s[4:7], s55 offen offset:0 sc1
    v_mfma_f32_16x16x32_bf16 v[168:171], v[232:235], v[100:103], v[168:171]
    ds_write_b128 v252, v[100:103] offset:43008
    v_mfma_f32_16x16x32_bf16 v[172:175], v[236:239], v[100:103], v[172:175]
    v_mfma_f32_16x16x32_bf16 v[176:179], v[240:243], v[100:103], v[176:179]
    ds_read_b32 v254, v255 offset:112
    v_mfma_f32_16x16x32_bf16 v[180:183], v[244:247], v[100:103], v[180:183]
    s_waitcnt lgkmcnt(4)
    buffer_load_dwordx4 v[96:99], v252, s[4:7], s55 offen offset:1024 sc1
    v_mfma_f32_16x16x32_bf16 v[184:187], v[232:235], v[104:107], v[184:187]
    ds_write_b128 v252, v[104:107] offset:44032
    v_mfma_f32_16x16x32_bf16 v[188:191], v[236:239], v[104:107], v[188:191]
    v_mfma_f32_16x16x32_bf16 v[192:195], v[240:243], v[104:107], v[192:195]
    s_waitcnt lgkmcnt(1)
    v_cmp_gt_u32 vcc, 9, v254
    v_mfma_f32_16x16x32_bf16 v[196:199], v[244:247], v[104:107], v[196:199]
    buffer_load_dwordx4 v[100:103], v252, s[4:7], s55 offen offset:2048 sc1
    s_waitcnt vmcnt(20)
    v_mfma_f32_16x16x32_bf16 v[200:203], v[232:235], v[108:111], v[200:203]
    v_mov_b32 v254, 10
    v_mfma_f32_16x16x32_bf16 v[204:207], v[236:239], v[108:111], v[204:207]
    ds_write_b128 v252, v[108:111] offset:45056
    v_mfma_f32_16x16x32_bf16 v[208:211], v[240:243], v[108:111], v[208:211]
    ds_write_b32 v255, v254 offset:96
    v_mfma_f32_16x16x32_bf16 v[212:215], v[244:247], v[108:111], v[212:215]
    s_cbranch_vccnz G1_fr10
G1_fr10_ret:
    s_waitcnt lgkmcnt(2)
    buffer_load_dwordx4 v[104:107], v252, s[4:7], s55 offen offset:3072 sc1
    s_waitcnt lgkmcnt(2)
    s_add_u32 m0, s41, 130816
    s_mul_i32 s46, s53, 2
    s_add_u32 s46, s46, 17
    s_lshl_b32 s46, s46, 18
    buffer_load_dwordx4 v253, s[8:11], s46 offen offset:0  lds
    s_add_u32 s46, s46, 15360
    buffer_load_dwordx4 v253, s[8:11], s46 offen offset:1024  lds
    s_add_u32 s46, s46, 15360
    buffer_load_dwordx4 v253, s[8:11], s46 offen offset:2048  lds
    s_add_u32 s46, s46, 15360
    buffer_load_dwordx4 v253, s[8:11], s46 offen offset:3072  lds
    s_mul_i32 s54, s53, 2
    s_add_u32 s54, s54, 17
    s_mul_i32 s54, s54, 36864
    s_add_u32 s55, s54, 4096
    s_add_u32 s47, s54, 8192
    s_waitcnt vmcnt(24)
    v_mfma_f32_16x16x32_bf16 v[0:3], v[216:219], v[40:43], v[0:3]
    ds_write_b128 v252, v[40:43] offset:0
    v_mfma_f32_16x16x32_bf16 v[4:7], v[220:223], v[40:43], v[4:7]
    v_mfma_f32_16x16x32_bf16 v[8:11], v[224:227], v[40:43], v[8:11]
    v_mfma_f32_16x16x32_bf16 v[12:15], v[228:231], v[40:43], v[12:15]
    s_waitcnt lgkmcnt(2)
    buffer_load_dwordx4 v[108:111], v252, s[4:7], s51 offen offset:0 sc1
    s_waitcnt vmcnt(24)
    v_mfma_f32_16x16x32_bf16 v[16:19], v[216:219], v[44:47], v[16:19]
    ds_write_b128 v252, v[44:47] offset:1024
    v_mfma_f32_16x16x32_bf16 v[20:23], v[220:223], v[44:47], v[20:23]
    v_mfma_f32_16x16x32_bf16 v[24:27], v[224:227], v[44:47], v[24:27]
    v_mfma_f32_16x16x32_bf16 v[28:31], v[228:231], v[44:47], v[28:31]
    s_waitcnt lgkmcnt(1)
    buffer_load_dwordx4 v[40:43], v252, s[4:7], s54 offen offset:0 sc1
    s_waitcnt vmcnt(15)
    v_mfma_f32_16x16x32_bf16 v[32:35], v[216:219], v[48:51], v[32:35]
    ds_write_b128 v252, v[48:51] offset:2048
    v_mfma_f32_16x16x32_bf16 v[36:39], v[220:223], v[48:51], v[36:39]
    ds_read_b64_tr_b16 v[232:233], v248 offset:16384
    v_mfma_f32_16x16x32_bf16 v[112:115], v[224:227], v[48:51], v[112:115]
    ds_read_b64_tr_b16 v[234:235], v248 offset:18432
    v_mfma_f32_16x16x32_bf16 v[116:119], v[228:231], v[48:51], v[116:119]
    s_waitcnt lgkmcnt(3)
    buffer_load_dwordx4 v[44:47], v252, s[4:7], s54 offen offset:1024 sc1
    v_mfma_f32_16x16x32_bf16 v[120:123], v[216:219], v[52:55], v[120:123]
    ds_write_b128 v252, v[52:55] offset:3072
    v_mfma_f32_16x16x32_bf16 v[124:127], v[220:223], v[52:55], v[124:127]
    ds_read_b64_tr_b16 v[236:237], v249 offset:16384
    v_mfma_f32_16x16x32_bf16 v[128:131], v[224:227], v[52:55], v[128:131]
    ds_read_b64_tr_b16 v[238:239], v249 offset:18432
    v_mfma_f32_16x16x32_bf16 v[132:135], v[228:231], v[52:55], v[132:135]
    s_waitcnt lgkmcnt(5)
    buffer_load_dwordx4 v[48:51], v252, s[4:7], s54 offen offset:2048 sc1
    v_mfma_f32_16x16x32_bf16 v[136:139], v[216:219], v[56:59], v[136:139]
    ds_write_b128 v252, v[56:59] offset:4096
    v_mfma_f32_16x16x32_bf16 v[140:143], v[220:223], v[56:59], v[140:143]
    ds_read_b64_tr_b16 v[240:241], v250 offset:16384
    v_mfma_f32_16x16x32_bf16 v[144:147], v[224:227], v[56:59], v[144:147]
    ds_read_b64_tr_b16 v[242:243], v250 offset:18432
    v_mfma_f32_16x16x32_bf16 v[148:151], v[228:231], v[56:59], v[148:151]
    s_waitcnt lgkmcnt(5)
    buffer_load_dwordx4 v[52:55], v252, s[4:7], s54 offen offset:3072 sc1
    v_mfma_f32_16x16x32_bf16 v[152:155], v[216:219], v[60:63], v[152:155]
    ds_write_b128 v252, v[60:63] offset:5120
    v_mfma_f32_16x16x32_bf16 v[156:159], v[220:223], v[60:63], v[156:159]
    ds_read_b64_tr_b16 v[244:245], v251 offset:16384
    v_mfma_f32_16x16x32_bf16 v[160:163], v[224:227], v[60:63], v[160:163]
    ds_read_b64_tr_b16 v[246:247], v251 offset:18432
    v_mfma_f32_16x16x32_bf16 v[164:167], v[228:231], v[60:63], v[164:167]
    s_waitcnt lgkmcnt(5)
    buffer_load_dwordx4 v[56:59], v252, s[4:7], s55 offen offset:0 sc1
    v_mfma_f32_16x16x32_bf16 v[168:171], v[216:219], v[64:67], v[168:171]
    ds_write_b128 v252, v[64:67] offset:6144
    v_mfma_f32_16x16x32_bf16 v[172:175], v[220:223], v[64:67], v[172:175]
    v_mfma_f32_16x16x32_bf16 v[176:179], v[224:227], v[64:67], v[176:179]
    ds_read_b32 v254, v255 offset:112
    v_mfma_f32_16x16x32_bf16 v[180:183], v[228:231], v[64:67], v[180:183]
    s_waitcnt lgkmcnt(4)
    buffer_load_dwordx4 v[60:63], v252, s[4:7], s55 offen offset:1024 sc1
    v_mfma_f32_16x16x32_bf16 v[184:187], v[216:219], v[68:71], v[184:187]
    ds_write_b128 v252, v[68:71] offset:7168
    v_mfma_f32_16x16x32_bf16 v[188:191], v[220:223], v[68:71], v[188:191]
    v_mfma_f32_16x16x32_bf16 v[192:195], v[224:227], v[68:71], v[192:195]
    s_waitcnt lgkmcnt(1)
    v_cmp_gt_u32 vcc, 10, v254
    v_mfma_f32_16x16x32_bf16 v[196:199], v[228:231], v[68:71], v[196:199]
    buffer_load_dwordx4 v[64:67], v252, s[4:7], s55 offen offset:2048 sc1
    s_waitcnt vmcnt(20)
    v_mfma_f32_16x16x32_bf16 v[200:203], v[216:219], v[72:75], v[200:203]
    v_mov_b32 v254, 11
    v_mfma_f32_16x16x32_bf16 v[204:207], v[220:223], v[72:75], v[204:207]
    ds_write_b128 v252, v[72:75] offset:8192
    v_mfma_f32_16x16x32_bf16 v[208:211], v[224:227], v[72:75], v[208:211]
    ds_write_b32 v255, v254 offset:96
    v_mfma_f32_16x16x32_bf16 v[212:215], v[228:231], v[72:75], v[212:215]
    s_cbranch_vccnz G1_fr11
G1_fr11_ret:
    s_waitcnt lgkmcnt(2)
    buffer_load_dwordx4 v[68:71], v252, s[4:7], s55 offen offset:3072 sc1
    s_waitcnt lgkmcnt(2)
    s_add_u32 m0, s41, 147200
    s_cmp_eq_u32 s53, 0
    s_cselect_b32 s46, 25, 17
    s_lshl_b32 s46, s46, 18
    buffer_load_dwordx4 v253, s[8:11], s46 offen offset:0  lds
    s_add_u32 s46, s46, 15360
    buffer_load_dwordx4 v253, s[8:11], s46 offen offset:1024  lds
    s_add_u32 s46, s46, 15360
    buffer_load_dwordx4 v253, s[8:11], s46 offen offset:2048  lds
    s_add_u32 s46, s46, 15360
    buffer_load_dwordx4 v253, s[8:11], s46 offen offset:3072  lds
    s_cmp_eq_u32 s53, 0
    s_cselect_b32 s54, 25, 17
    s_mul_i32 s54, s54, 36864
    s_add_u32 s55, s54, 4096
    s_add_u32 s51, s54, 8192
    s_waitcnt vmcnt(24)
    v_mfma_f32_16x16x32_bf16 v[0:3], v[232:235], v[76:79], v[0:3]
    ds_write_b128 v252, v[76:79] offset:36864
    v_mfma_f32_16x16x32_bf16 v[4:7], v[236:239], v[76:79], v[4:7]
    v_mfma_f32_16x16x32_bf16 v[8:11], v[240:243], v[76:79], v[8:11]
    v_mfma_f32_16x16x32_bf16 v[12:15], v[244:247], v[76:79], v[12:15]
    s_waitcnt lgkmcnt(2)
    buffer_load_dwordx4 v[72:75], v252, s[4:7], s47 offen offset:0 sc1
    s_waitcnt vmcnt(24)
    v_mfma_f32_16x16x32_bf16 v[16:19], v[232:235], v[80:83], v[16:19]
    ds_write_b128 v252, v[80:83] offset:37888
    v_mfma_f32_16x16x32_bf16 v[20:23], v[236:239], v[80:83], v[20:23]
    v_mfma_f32_16x16x32_bf16 v[24:27], v[240:243], v[80:83], v[24:27]
    v_mfma_f32_16x16x32_bf16 v[28:31], v[244:247], v[80:83], v[28:31]
    s_waitcnt lgkmcnt(1)
    buffer_load_dwordx4 v[76:79], v252, s[4:7], s54 offen offset:0 sc1
    s_waitcnt vmcnt(15)
    v_mfma_f32_16x16x32_bf16 v[32:35], v[232:235], v[84:87], v[32:35]
    ds_write_b128 v252, v[84:87] offset:38912
    v_mfma_f32_16x16x32_bf16 v[36:39], v[236:239], v[84:87], v[36:39]
    ds_read_b64_tr_b16 v[216:217], v248 offset:0
    v_mfma_f32_16x16x32_bf16 v[112:115], v[240:243], v[84:87], v[112:115]
    ds_read_b64_tr_b16 v[218:219], v248 offset:2048
    v_mfma_f32_16x16x32_bf16 v[116:119], v[244:247], v[84:87], v[116:119]
    s_waitcnt lgkmcnt(3)
    buffer_load_dwordx4 v[80:83], v252, s[4:7], s54 offen offset:1024 sc1
    v_mfma_f32_16x16x32_bf16 v[120:123], v[232:235], v[88:91], v[120:123]
    ds_write_b128 v252, v[88:91] offset:39936
    v_mfma_f32_16x16x32_bf16 v[124:127], v[236:239], v[88:91], v[124:127]
    ds_read_b64_tr_b16 v[220:221], v249 offset:0
    v_mfma_f32_16x16x32_bf16 v[128:131], v[240:243], v[88:91], v[128:131]
    ds_read_b64_tr_b16 v[222:223], v249 offset:2048
    v_mfma_f32_16x16x32_bf16 v[132:135], v[244:247], v[88:91], v[132:135]
    s_waitcnt lgkmcnt(5)
    buffer_load_dwordx4 v[84:87], v252, s[4:7], s54 offen offset:2048 sc1
    v_mfma_f32_16x16x32_bf16 v[136:139], v[232:235], v[92:95], v[136:139]
    ds_write_b128 v252, v[92:95] offset:40960
    v_mfma_f32_16x16x32_bf16 v[140:143], v[236:239], v[92:95], v[140:143]
    ds_read_b64_tr_b16 v[224:225], v250 offset:0
    v_mfma_f32_16x16x32_bf16 v[144:147], v[240:243], v[92:95], v[144:147]
    ds_read_b64_tr_b16 v[226:227], v250 offset:2048
    v_mfma_f32_16x16x32_bf16 v[148:151], v[244:247], v[92:95], v[148:151]
    s_waitcnt lgkmcnt(5)
    buffer_load_dwordx4 v[88:91], v252, s[4:7], s54 offen offset:3072 sc1
    v_mfma_f32_16x16x32_bf16 v[152:155], v[232:235], v[96:99], v[152:155]
    ds_write_b128 v252, v[96:99] offset:41984
    v_mfma_f32_16x16x32_bf16 v[156:159], v[236:239], v[96:99], v[156:159]
    ds_read_b64_tr_b16 v[228:229], v251 offset:0
    v_mfma_f32_16x16x32_bf16 v[160:163], v[240:243], v[96:99], v[160:163]
    ds_read_b64_tr_b16 v[230:231], v251 offset:2048
    v_mfma_f32_16x16x32_bf16 v[164:167], v[244:247], v[96:99], v[164:167]
    s_waitcnt lgkmcnt(5)
    buffer_load_dwordx4 v[92:95], v252, s[4:7], s55 offen offset:0 sc1
    v_mfma_f32_16x16x32_bf16 v[168:171], v[232:235], v[100:103], v[168:171]
    ds_write_b128 v252, v[100:103] offset:43008
    v_mfma_f32_16x16x32_bf16 v[172:175], v[236:239], v[100:103], v[172:175]
    v_mfma_f32_16x16x32_bf16 v[176:179], v[240:243], v[100:103], v[176:179]
    v_mfma_f32_16x16x32_bf16 v[180:183], v[244:247], v[100:103], v[180:183]
    s_waitcnt lgkmcnt(3)
    buffer_load_dwordx4 v[96:99], v252, s[4:7], s55 offen offset:1024 sc1
    v_mfma_f32_16x16x32_bf16 v[184:187], v[232:235], v[104:107], v[184:187]
    ds_write_b128 v252, v[104:107] offset:44032
    v_mfma_f32_16x16x32_bf16 v[188:191], v[236:239], v[104:107], v[188:191]
    v_mfma_f32_16x16x32_bf16 v[192:195], v[240:243], v[104:107], v[192:195]
    v_mfma_f32_16x16x32_bf16 v[196:199], v[244:247], v[104:107], v[196:199]
    s_waitcnt lgkmcnt(1)
    buffer_load_dwordx4 v[100:103], v252, s[4:7], s55 offen offset:2048 sc1
    s_waitcnt vmcnt(20)
    v_mfma_f32_16x16x32_bf16 v[200:203], v[232:235], v[108:111], v[200:203]
    v_mov_b32 v254, 12
    v_mfma_f32_16x16x32_bf16 v[204:207], v[236:239], v[108:111], v[204:207]
    ds_write_b128 v252, v[108:111] offset:45056
    v_mfma_f32_16x16x32_bf16 v[208:211], v[240:243], v[108:111], v[208:211]
    ds_write_b32 v255, v254 offset:96
    v_mfma_f32_16x16x32_bf16 v[212:215], v[244:247], v[108:111], v[212:215]
    s_waitcnt lgkmcnt(2)
    buffer_load_dwordx4 v[104:107], v252, s[4:7], s55 offen offset:3072 sc1
    s_waitcnt lgkmcnt(2)
    s_add_u32 m0, s41, 130816
    s_cmp_eq_u32 s53, 1
    s_cselect_b32 s46, 27, 19
    s_lshl_b32 s46, s46, 18
    buffer_load_dwordx4 v253, s[8:11], s46 offen offset:0  lds
    s_add_u32 s46, s46, 15360
    buffer_load_dwordx4 v253, s[8:11], s46 offen offset:1024  lds
    s_add_u32 s46, s46, 15360
    buffer_load_dwordx4 v253, s[8:11], s46 offen offset:2048  lds
    s_add_u32 s46, s46, 15360
    buffer_load_dwordx4 v253, s[8:11], s46 offen offset:3072  lds
    s_cmp_eq_u32 s53, 1
    s_cselect_b32 s54, 27, 19
    s_mul_i32 s54, s54, 36864
    s_add_u32 s55, s54, 4096
    s_add_u32 s47, s54, 8192
    s_waitcnt vmcnt(24)
    v_mfma_f32_16x16x32_bf16 v[0:3], v[216:219], v[40:43], v[0:3]
    v_mfma_f32_16x16x32_bf16 v[4:7], v[220:223], v[40:43], v[4:7]
    v_mfma_f32_16x16x32_bf16 v[8:11], v[224:227], v[40:43], v[8:11]
    v_mfma_f32_16x16x32_bf16 v[12:15], v[228:231], v[40:43], v[12:15]
    s_waitcnt lgkmcnt(1)
    buffer_load_dwordx4 v[108:111], v252, s[4:7], s51 offen offset:0 sc1
    buffer_load_dwordx4 v[40:43], v252, s[4:7], s54 offen offset:0 sc1
    s_waitcnt vmcnt(25)
    v_mfma_f32_16x16x32_bf16 v[16:19], v[216:219], v[44:47], v[16:19]
    v_mfma_f32_16x16x32_bf16 v[20:23], v[220:223], v[44:47], v[20:23]
    v_mfma_f32_16x16x32_bf16 v[24:27], v[224:227], v[44:47], v[24:27]
    v_mfma_f32_16x16x32_bf16 v[28:31], v[228:231], v[44:47], v[28:31]
    buffer_load_dwordx4 v[44:47], v252, s[4:7], s54 offen offset:1024 sc1
    s_waitcnt vmcnt(16)
    v_mfma_f32_16x16x32_bf16 v[32:35], v[216:219], v[48:51], v[32:35]
    ds_read_b64_tr_b16 v[232:233], v248 offset:16384
    v_mfma_f32_16x16x32_bf16 v[36:39], v[220:223], v[48:51], v[36:39]
    v_mfma_f32_16x16x32_bf16 v[112:115], v[224:227], v[48:51], v[112:115]
    ds_read_b64_tr_b16 v[234:235], v248 offset:18432
    v_mfma_f32_16x16x32_bf16 v[116:119], v[228:231], v[48:51], v[116:119]
    buffer_load_dwordx4 v[48:51], v252, s[4:7], s54 offen offset:2048 sc1
    v_mfma_f32_16x16x32_bf16 v[120:123], v[216:219], v[52:55], v[120:123]
    ds_read_b64_tr_b16 v[236:237], v249 offset:16384
    v_mfma_f32_16x16x32_bf16 v[124:127], v[220:223], v[52:55], v[124:127]
    v_mfma_f32_16x16x32_bf16 v[128:131], v[224:227], v[52:55], v[128:131]
    ds_read_b64_tr_b16 v[238:239], v249 offset:18432
    v_mfma_f32_16x16x32_bf16 v[132:135], v[228:231], v[52:55], v[132:135]
    buffer_load_dwordx4 v[52:55], v252, s[4:7], s54 offen offset:3072 sc1
    v_mfma_f32_16x16x32_bf16 v[136:139], v[216:219], v[56:59], v[136:139]
    ds_read_b64_tr_b16 v[240:241], v250 offset:16384
    v_mfma_f32_16x16x32_bf16 v[140:143], v[220:223], v[56:59], v[140:143]
    v_mfma_f32_16x16x32_bf16 v[144:147], v[224:227], v[56:59], v[144:147]
    ds_read_b64_tr_b16 v[242:243], v250 offset:18432
    v_mfma_f32_16x16x32_bf16 v[148:151], v[228:231], v[56:59], v[148:151]
    buffer_load_dwordx4 v[56:59], v252, s[4:7], s55 offen offset:0 sc1
    v_mfma_f32_16x16x32_bf16 v[152:155], v[216:219], v[60:63], v[152:155]
    ds_read_b64_tr_b16 v[244:245], v251 offset:16384
    v_mfma_f32_16x16x32_bf16 v[156:159], v[220:223], v[60:63], v[156:159]
    v_mfma_f32_16x16x32_bf16 v[160:163], v[224:227], v[60:63], v[160:163]
    ds_read_b64_tr_b16 v[246:247], v251 offset:18432
    v_mfma_f32_16x16x32_bf16 v[164:167], v[228:231], v[60:63], v[164:167]
    buffer_load_dwordx4 v[60:63], v252, s[4:7], s55 offen offset:1024 sc1
    v_mfma_f32_16x16x32_bf16 v[168:171], v[216:219], v[64:67], v[168:171]
    v_mfma_f32_16x16x32_bf16 v[172:175], v[220:223], v[64:67], v[172:175]
    v_mfma_f32_16x16x32_bf16 v[176:179], v[224:227], v[64:67], v[176:179]
    v_mfma_f32_16x16x32_bf16 v[180:183], v[228:231], v[64:67], v[180:183]
    buffer_load_dwordx4 v[64:67], v252, s[4:7], s55 offen offset:2048 sc1
    v_mfma_f32_16x16x32_bf16 v[184:187], v[216:219], v[68:71], v[184:187]
    v_mfma_f32_16x16x32_bf16 v[188:191], v[220:223], v[68:71], v[188:191]
    v_mfma_f32_16x16x32_bf16 v[192:195], v[224:227], v[68:71], v[192:195]
    v_mfma_f32_16x16x32_bf16 v[196:199], v[228:231], v[68:71], v[196:199]
    buffer_load_dwordx4 v[68:71], v252, s[4:7], s55 offen offset:3072 sc1
    s_waitcnt vmcnt(21)
    v_mfma_f32_16x16x32_bf16 v[200:203], v[216:219], v[72:75], v[200:203]
    v_mfma_f32_16x16x32_bf16 v[204:207], v[220:223], v[72:75], v[204:207]
    v_mfma_f32_16x16x32_bf16 v[208:211], v[224:227], v[72:75], v[208:211]
    v_mfma_f32_16x16x32_bf16 v[212:215], v[228:231], v[72:75], v[212:215]
    buffer_load_dwordx4 v[72:75], v252, s[4:7], s47 offen offset:0 sc1
    s_waitcnt lgkmcnt(0)
    s_add_u32 m0, s41, 147200
    s_cmp_eq_u32 s53, 2
    s_cselect_b32 s46, 29, 21
    s_lshl_b32 s46, s46, 18
    buffer_load_dwordx4 v253, s[8:11], s46 offen offset:0  lds
    s_add_u32 s46, s46, 15360
    buffer_load_dwordx4 v253, s[8:11], s46 offen offset:1024  lds
    s_add_u32 s46, s46, 15360
    buffer_load_dwordx4 v253, s[8:11], s46 offen offset:2048  lds
    s_add_u32 s46, s46, 15360
    buffer_load_dwordx4 v253, s[8:11], s46 offen offset:3072  lds
    s_cmp_eq_u32 s53, 2
    s_cselect_b32 s54, 29, 21
    s_mul_i32 s54, s54, 36864
    s_add_u32 s55, s54, 4096
    s_add_u32 s51, s54, 8192
    s_waitcnt vmcnt(25)
    v_mfma_f32_16x16x32_bf16 v[0:3], v[232:235], v[76:79], v[0:3]
    v_mfma_f32_16x16x32_bf16 v[4:7], v[236:239], v[76:79], v[4:7]
    v_mfma_f32_16x16x32_bf16 v[8:11], v[240:243], v[76:79], v[8:11]
    v_mfma_f32_16x16x32_bf16 v[12:15], v[244:247], v[76:79], v[12:15]
    buffer_load_dwordx4 v[76:79], v252, s[4:7], s54 offen offset:0 sc1
    s_waitcnt vmcnt(25)
    v_mfma_f32_16x16x32_bf16 v[16:19], v[232:235], v[80:83], v[16:19]
    v_mfma_f32_16x16x32_bf16 v[20:23], v[236:239], v[80:83], v[20:23]
    v_mfma_f32_16x16x32_bf16 v[24:27], v[240:243], v[80:83], v[24:27]
    v_mfma_f32_16x16x32_bf16 v[28:31], v[244:247], v[80:83], v[28:31]
    buffer_load_dwordx4 v[80:83], v252, s[4:7], s54 offen offset:1024 sc1
    s_waitcnt vmcnt(16)
    v_mfma_f32_16x16x32_bf16 v[32:35], v[232:235], v[84:87], v[32:35]
    ds_read_b64_tr_b16 v[216:217], v248 offset:0
    v_mfma_f32_16x16x32_bf16 v[36:39], v[236:239], v[84:87], v[36:39]
    v_mfma_f32_16x16x32_bf16 v[112:115], v[240:243], v[84:87], v[112:115]
    ds_read_b64_tr_b16 v[218:219], v248 offset:2048
    v_mfma_f32_16x16x32_bf16 v[116:119], v[244:247], v[84:87], v[116:119]
    buffer_load_dwordx4 v[84:87], v252, s[4:7], s54 offen offset:2048 sc1
    v_mfma_f32_16x16x32_bf16 v[120:123], v[232:235], v[88:91], v[120:123]
    ds_read_b64_tr_b16 v[220:221], v249 offset:0
    v_mfma_f32_16x16x32_bf16 v[124:127], v[236:239], v[88:91], v[124:127]
    v_mfma_f32_16x16x32_bf16 v[128:131], v[240:243], v[88:91], v[128:131]
    ds_read_b64_tr_b16 v[222:223], v249 offset:2048
    v_mfma_f32_16x16x32_bf16 v[132:135], v[244:247], v[88:91], v[132:135]
    buffer_load_dwordx4 v[88:91], v252, s[4:7], s54 offen offset:3072 sc1
    v_mfma_f32_16x16x32_bf16 v[136:139], v[232:235], v[92:95], v[136:139]
    ds_read_b64_tr_b16 v[224:225], v250 offset:0
    v_mfma_f32_16x16x32_bf16 v[140:143], v[236:239], v[92:95], v[140:143]
    v_mfma_f32_16x16x32_bf16 v[144:147], v[240:243], v[92:95], v[144:147]
    ds_read_b64_tr_b16 v[226:227], v250 offset:2048
    v_mfma_f32_16x16x32_bf16 v[148:151], v[244:247], v[92:95], v[148:151]
    buffer_load_dwordx4 v[92:95], v252, s[4:7], s55 offen offset:0 sc1
    v_mfma_f32_16x16x32_bf16 v[152:155], v[232:235], v[96:99], v[152:155]
    ds_read_b64_tr_b16 v[228:229], v251 offset:0
    v_mfma_f32_16x16x32_bf16 v[156:159], v[236:239], v[96:99], v[156:159]
    v_mfma_f32_16x16x32_bf16 v[160:163], v[240:243], v[96:99], v[160:163]
    ds_read_b64_tr_b16 v[230:231], v251 offset:2048
    v_mfma_f32_16x16x32_bf16 v[164:167], v[244:247], v[96:99], v[164:167]
    buffer_load_dwordx4 v[96:99], v252, s[4:7], s55 offen offset:1024 sc1
    v_mfma_f32_16x16x32_bf16 v[168:171], v[232:235], v[100:103], v[168:171]
    v_mfma_f32_16x16x32_bf16 v[172:175], v[236:239], v[100:103], v[172:175]
    v_mfma_f32_16x16x32_bf16 v[176:179], v[240:243], v[100:103], v[176:179]
    v_mfma_f32_16x16x32_bf16 v[180:183], v[244:247], v[100:103], v[180:183]
    buffer_load_dwordx4 v[100:103], v252, s[4:7], s55 offen offset:2048 sc1
    v_mfma_f32_16x16x32_bf16 v[184:187], v[232:235], v[104:107], v[184:187]
    v_mfma_f32_16x16x32_bf16 v[188:191], v[236:239], v[104:107], v[188:191]
    v_mfma_f32_16x16x32_bf16 v[192:195], v[240:243], v[104:107], v[192:195]
    v_mfma_f32_16x16x32_bf16 v[196:199], v[244:247], v[104:107], v[196:199]
    buffer_load_dwordx4 v[104:107], v252, s[4:7], s55 offen offset:3072 sc1
    s_waitcnt vmcnt(21)
    v_mfma_f32_16x16x32_bf16 v[200:203], v[232:235], v[108:111], v[200:203]
    v_mfma_f32_16x16x32_bf16 v[204:207], v[236:239], v[108:111], v[204:207]
    v_mfma_f32_16x16x32_bf16 v[208:211], v[240:243], v[108:111], v[208:211]
    v_mfma_f32_16x16x32_bf16 v[212:215], v[244:247], v[108:111], v[212:215]
    buffer_load_dwordx4 v[108:111], v252, s[4:7], s51 offen offset:0 sc1
    s_waitcnt lgkmcnt(0)
    s_add_u32 m0, s41, 130816
    s_cmp_eq_u32 s53, 3
    s_cselect_b32 s46, 31, 23
    s_lshl_b32 s46, s46, 18
    buffer_load_dwordx4 v253, s[8:11], s46 offen offset:0  lds
    s_add_u32 s46, s46, 15360
    buffer_load_dwordx4 v253, s[8:11], s46 offen offset:1024  lds
    s_add_u32 s46, s46, 15360
    buffer_load_dwordx4 v253, s[8:11], s46 offen offset:2048  lds
    s_add_u32 s46, s46, 15360
    buffer_load_dwordx4 v253, s[8:11], s46 offen offset:3072  lds
    s_cmp_eq_u32 s53, 3
    s_cselect_b32 s54, 31, 23
    s_mul_i32 s54, s54, 36864
    s_add_u32 s55, s54, 4096
    s_add_u32 s47, s54, 8192
    s_waitcnt vmcnt(25)
    v_mfma_f32_16x16x32_bf16 v[0:3], v[216:219], v[40:43], v[0:3]
    v_mfma_f32_16x16x32_bf16 v[4:7], v[220:223], v[40:43], v[4:7]
    v_mfma_f32_16x16x32_bf16 v[8:11], v[224:227], v[40:43], v[8:11]
    v_mfma_f32_16x16x32_bf16 v[12:15], v[228:231], v[40:43], v[12:15]
    buffer_load_dwordx4 v[40:43], v252, s[4:7], s54 offen offset:0 sc1
    s_waitcnt vmcnt(25)
    v_mfma_f32_16x16x32_bf16 v[16:19], v[216:219], v[44:47], v[16:19]
    v_mfma_f32_16x16x32_bf16 v[20:23], v[220:223], v[44:47], v[20:23]
    v_mfma_f32_16x16x32_bf16 v[24:27], v[224:227], v[44:47], v[24:27]
    v_mfma_f32_16x16x32_bf16 v[28:31], v[228:231], v[44:47], v[28:31]
    buffer_load_dwordx4 v[44:47], v252, s[4:7], s54 offen offset:1024 sc1
    s_waitcnt vmcnt(15)
    v_mfma_f32_16x16x32_bf16 v[32:35], v[216:219], v[48:51], v[32:35]
    ds_read_b64_tr_b16 v[232:233], v248 offset:16384
    v_mfma_f32_16x16x32_bf16 v[36:39], v[220:223], v[48:51], v[36:39]
    v_mfma_f32_16x16x32_bf16 v[112:115], v[224:227], v[48:51], v[112:115]
    ds_read_b64_tr_b16 v[234:235], v248 offset:18432
    v_mfma_f32_16x16x32_bf16 v[116:119], v[228:231], v[48:51], v[116:119]
    buffer_load_dwordx4 v[48:51], v252, s[4:7], s54 offen offset:2048 sc1
    v_mfma_f32_16x16x32_bf16 v[120:123], v[216:219], v[52:55], v[120:123]
    ds_read_b64_tr_b16 v[236:237], v249 offset:16384
    v_mfma_f32_16x16x32_bf16 v[124:127], v[220:223], v[52:55], v[124:127]
    v_mfma_f32_16x16x32_bf16 v[128:131], v[224:227], v[52:55], v[128:131]
    ds_read_b64_tr_b16 v[238:239], v249 offset:18432
    v_mfma_f32_16x16x32_bf16 v[132:135], v[228:231], v[52:55], v[132:135]
    buffer_load_dwordx4 v[52:55], v252, s[4:7], s54 offen offset:3072 sc1
    v_mfma_f32_16x16x32_bf16 v[136:139], v[216:219], v[56:59], v[136:139]
    ds_read_b64_tr_b16 v[240:241], v250 offset:16384
    v_mfma_f32_16x16x32_bf16 v[140:143], v[220:223], v[56:59], v[140:143]
    v_mfma_f32_16x16x32_bf16 v[144:147], v[224:227], v[56:59], v[144:147]
    ds_read_b64_tr_b16 v[242:243], v250 offset:18432
    v_mfma_f32_16x16x32_bf16 v[148:151], v[228:231], v[56:59], v[148:151]
    buffer_load_dwordx4 v[56:59], v252, s[4:7], s55 offen offset:0 sc1
    v_mfma_f32_16x16x32_bf16 v[152:155], v[216:219], v[60:63], v[152:155]
    ds_read_b64_tr_b16 v[244:245], v251 offset:16384
    v_mfma_f32_16x16x32_bf16 v[156:159], v[220:223], v[60:63], v[156:159]
    v_mfma_f32_16x16x32_bf16 v[160:163], v[224:227], v[60:63], v[160:163]
    ds_read_b64_tr_b16 v[246:247], v251 offset:18432
    v_mfma_f32_16x16x32_bf16 v[164:167], v[228:231], v[60:63], v[164:167]
    buffer_load_dwordx4 v[60:63], v252, s[4:7], s55 offen offset:1024 sc1
    v_mfma_f32_16x16x32_bf16 v[168:171], v[216:219], v[64:67], v[168:171]
    v_mfma_f32_16x16x32_bf16 v[172:175], v[220:223], v[64:67], v[172:175]
    v_mfma_f32_16x16x32_bf16 v[176:179], v[224:227], v[64:67], v[176:179]
    v_mfma_f32_16x16x32_bf16 v[180:183], v[228:231], v[64:67], v[180:183]
    buffer_load_dwordx4 v[64:67], v252, s[4:7], s55 offen offset:2048 sc1
    v_mfma_f32_16x16x32_bf16 v[184:187], v[216:219], v[68:71], v[184:187]
    v_mfma_f32_16x16x32_bf16 v[188:191], v[220:223], v[68:71], v[188:191]
    v_mfma_f32_16x16x32_bf16 v[192:195], v[224:227], v[68:71], v[192:195]
    v_mfma_f32_16x16x32_bf16 v[196:199], v[228:231], v[68:71], v[196:199]
    buffer_load_dwordx4 v[68:71], v252, s[4:7], s55 offen offset:3072 sc1
    v_mfma_f32_16x16x32_bf16 v[200:203], v[216:219], v[72:75], v[200:203]
    v_mfma_f32_16x16x32_bf16 v[204:207], v[220:223], v[72:75], v[204:207]
    v_mfma_f32_16x16x32_bf16 v[208:211], v[224:227], v[72:75], v[208:211]
    v_mfma_f32_16x16x32_bf16 v[212:215], v[228:231], v[72:75], v[212:215]
    buffer_load_dwordx4 v[72:75], v252, s[4:7], s47 offen offset:0 sc1
    s_waitcnt lgkmcnt(0)
    s_add_u32 m0, s41, 147200
    s_cmp_le_u32 s53, 0
    s_cselect_b32 s46, 27, 25
    s_lshl_b32 s46, s46, 18
    buffer_load_dwordx4 v253, s[8:11], s46 offen offset:0  lds
    s_add_u32 s46, s46, 15360
    buffer_load_dwordx4 v253, s[8:11], s46 offen offset:1024  lds
    s_add_u32 s46, s46, 15360
    buffer_load_dwordx4 v253, s[8:11], s46 offen offset:2048  lds
    s_add_u32 s46, s46, 15360
    buffer_load_dwordx4 v253, s[8:11], s46 offen offset:3072  lds
    s_cmp_le_u32 s53, 0
    s_cselect_b32 s54, 27, 25
    s_mul_i32 s54, s54, 36864
    s_add_u32 s55, s54, 4096
    s_add_u32 s51, s54, 8192
    s_waitcnt vmcnt(25)
    v_mfma_f32_16x16x32_bf16 v[0:3], v[232:235], v[76:79], v[0:3]
    v_mfma_f32_16x16x32_bf16 v[4:7], v[236:239], v[76:79], v[4:7]
    v_mfma_f32_16x16x32_bf16 v[8:11], v[240:243], v[76:79], v[8:11]
    v_mfma_f32_16x16x32_bf16 v[12:15], v[244:247], v[76:79], v[12:15]
    buffer_load_dwordx4 v[76:79], v252, s[4:7], s54 offen offset:0 sc1
    s_waitcnt vmcnt(25)
    v_mfma_f32_16x16x32_bf16 v[16:19], v[232:235], v[80:83], v[16:19]
    v_mfma_f32_16x16x32_bf16 v[20:23], v[236:239], v[80:83], v[20:23]
    v_mfma_f32_16x16x32_bf16 v[24:27], v[240:243], v[80:83], v[24:27]
    v_mfma_f32_16x16x32_bf16 v[28:31], v[244:247], v[80:83], v[28:31]
    buffer_load_dwordx4 v[80:83], v252, s[4:7], s54 offen offset:1024 sc1
    s_waitcnt vmcnt(15)
    v_mfma_f32_16x16x32_bf16 v[32:35], v[232:235], v[84:87], v[32:35]
    ds_read_b64_tr_b16 v[216:217], v248 offset:0
    v_mfma_f32_16x16x32_bf16 v[36:39], v[236:239], v[84:87], v[36:39]
    v_mfma_f32_16x16x32_bf16 v[112:115], v[240:243], v[84:87], v[112:115]
    ds_read_b64_tr_b16 v[218:219], v248 offset:2048
    v_mfma_f32_16x16x32_bf16 v[116:119], v[244:247], v[84:87], v[116:119]
    buffer_load_dwordx4 v[84:87], v252, s[4:7], s54 offen offset:2048 sc1
    v_mfma_f32_16x16x32_bf16 v[120:123], v[232:235], v[88:91], v[120:123]
    ds_read_b64_tr_b16 v[220:221], v249 offset:0
    v_mfma_f32_16x16x32_bf16 v[124:127], v[236:239], v[88:91], v[124:127]
    v_mfma_f32_16x16x32_bf16 v[128:131], v[240:243], v[88:91], v[128:131]
    ds_read_b64_tr_b16 v[222:223], v249 offset:2048
    v_mfma_f32_16x16x32_bf16 v[132:135], v[244:247], v[88:91], v[132:135]
    buffer_load_dwordx4 v[88:91], v252, s[4:7], s54 offen offset:3072 sc1
    v_mfma_f32_16x16x32_bf16 v[136:139], v[232:235], v[92:95], v[136:139]
    ds_read_b64_tr_b16 v[224:225], v250 offset:0
    v_mfma_f32_16x16x32_bf16 v[140:143], v[236:239], v[92:95], v[140:143]
    v_mfma_f32_16x16x32_bf16 v[144:147], v[240:243], v[92:95], v[144:147]
    ds_read_b64_tr_b16 v[226:227], v250 offset:2048
    v_mfma_f32_16x16x32_bf16 v[148:151], v[244:247], v[92:95], v[148:151]
    buffer_load_dwordx4 v[92:95], v252, s[4:7], s55 offen offset:0 sc1
    v_mfma_f32_16x16x32_bf16 v[152:155], v[232:235], v[96:99], v[152:155]
    ds_read_b64_tr_b16 v[228:229], v251 offset:0
    v_mfma_f32_16x16x32_bf16 v[156:159], v[236:239], v[96:99], v[156:159]
    v_mfma_f32_16x16x32_bf16 v[160:163], v[240:243], v[96:99], v[160:163]
    ds_read_b64_tr_b16 v[230:231], v251 offset:2048
    v_mfma_f32_16x16x32_bf16 v[164:167], v[244:247], v[96:99], v[164:167]
    buffer_load_dwordx4 v[96:99], v252, s[4:7], s55 offen offset:1024 sc1
    v_mfma_f32_16x16x32_bf16 v[168:171], v[232:235], v[100:103], v[168:171]
    v_mfma_f32_16x16x32_bf16 v[172:175], v[236:239], v[100:103], v[172:175]
    v_mfma_f32_16x16x32_bf16 v[176:179], v[240:243], v[100:103], v[176:179]
    v_mfma_f32_16x16x32_bf16 v[180:183], v[244:247], v[100:103], v[180:183]
    buffer_load_dwordx4 v[100:103], v252, s[4:7], s55 offen offset:2048 sc1
    v_mfma_f32_16x16x32_bf16 v[184:187], v[232:235], v[104:107], v[184:187]
    v_mfma_f32_16x16x32_bf16 v[188:191], v[236:239], v[104:107], v[188:191]
    v_mfma_f32_16x16x32_bf16 v[192:195], v[240:243], v[104:107], v[192:195]
    v_mfma_f32_16x16x32_bf16 v[196:199], v[244:247], v[104:107], v[196:199]
    buffer_load_dwordx4 v[104:107], v252, s[4:7], s55 offen offset:3072 sc1
    v_mfma_f32_16x16x32_bf16 v[200:203], v[232:235], v[108:111], v[200:203]
    v_mfma_f32_16x16x32_bf16 v[204:207], v[236:239], v[108:111], v[204:207]
    v_mfma_f32_16x16x32_bf16 v[208:211], v[240:243], v[108:111], v[208:211]
    v_mfma_f32_16x16x32_bf16 v[212:215], v[244:247], v[108:111], v[212:215]
    buffer_load_dwordx4 v[108:111], v252, s[4:7], s51 offen offset:0 sc1
    s_waitcnt lgkmcnt(0)
    s_add_u32 m0, s41, 130816
    s_cmp_le_u32 s53, 1
    s_cselect_b32 s46, 29, 27
    s_lshl_b32 s46, s46, 18
    buffer_load_dwordx4 v253, s[8:11], s46 offen offset:0  lds
    s_add_u32 s46, s46, 15360
    buffer_load_dwordx4 v253, s[8:11], s46 offen offset:1024  lds
    s_add_u32 s46, s46, 15360
    buffer_load_dwordx4 v253, s[8:11], s46 offen offset:2048  lds
    s_add_u32 s46, s46, 15360
    buffer_load_dwordx4 v253, s[8:11], s46 offen offset:3072  lds
    s_cmp_le_u32 s53, 1
    s_cselect_b32 s54, 29, 27
    s_mul_i32 s54, s54, 36864
    s_add_u32 s55, s54, 4096
    s_add_u32 s47, s54, 8192
    s_waitcnt vmcnt(25)
    v_mfma_f32_16x16x32_bf16 v[0:3], v[216:219], v[40:43], v[0:3]
    v_mfma_f32_16x16x32_bf16 v[4:7], v[220:223], v[40:43], v[4:7]
    v_mfma_f32_16x16x32_bf16 v[8:11], v[224:227], v[40:43], v[8:11]
    v_mfma_f32_16x16x32_bf16 v[12:15], v[228:231], v[40:43], v[12:15]
    buffer_load_dwordx4 v[40:43], v252, s[4:7], s54 offen offset:0 sc1
    s_waitcnt vmcnt(25)
    v_mfma_f32_16x16x32_bf16 v[16:19], v[216:219], v[44:47], v[16:19]
    v_mfma_f32_16x16x32_bf16 v[20:23], v[220:223], v[44:47], v[20:23]
    v_mfma_f32_16x16x32_bf16 v[24:27], v[224:227], v[44:47], v[24:27]
    v_mfma_f32_16x16x32_bf16 v[28:31], v[228:231], v[44:47], v[28:31]
    buffer_load_dwordx4 v[44:47], v252, s[4:7], s54 offen offset:1024 sc1
    s_waitcnt vmcnt(15)
    v_mfma_f32_16x16x32_bf16 v[32:35], v[216:219], v[48:51], v[32:35]
    ds_read_b64_tr_b16 v[232:233], v248 offset:16384
    v_mfma_f32_16x16x32_bf16 v[36:39], v[220:223], v[48:51], v[36:39]
    v_mfma_f32_16x16x32_bf16 v[112:115], v[224:227], v[48:51], v[112:115]
    ds_read_b64_tr_b16 v[234:235], v248 offset:18432
    v_mfma_f32_16x16x32_bf16 v[116:119], v[228:231], v[48:51], v[116:119]
    buffer_load_dwordx4 v[48:51], v252, s[4:7], s54 offen offset:2048 sc1
    v_mfma_f32_16x16x32_bf16 v[120:123], v[216:219], v[52:55], v[120:123]
    ds_read_b64_tr_b16 v[236:237], v249 offset:16384
    v_mfma_f32_16x16x32_bf16 v[124:127], v[220:223], v[52:55], v[124:127]
    v_mfma_f32_16x16x32_bf16 v[128:131], v[224:227], v[52:55], v[128:131]
    ds_read_b64_tr_b16 v[238:239], v249 offset:18432
    v_mfma_f32_16x16x32_bf16 v[132:135], v[228:231], v[52:55], v[132:135]
    buffer_load_dwordx4 v[52:55], v252, s[4:7], s54 offen offset:3072 sc1
    v_mfma_f32_16x16x32_bf16 v[136:139], v[216:219], v[56:59], v[136:139]
    ds_read_b64_tr_b16 v[240:241], v250 offset:16384
    v_mfma_f32_16x16x32_bf16 v[140:143], v[220:223], v[56:59], v[140:143]
    v_mfma_f32_16x16x32_bf16 v[144:147], v[224:227], v[56:59], v[144:147]
    ds_read_b64_tr_b16 v[242:243], v250 offset:18432
    v_mfma_f32_16x16x32_bf16 v[148:151], v[228:231], v[56:59], v[148:151]
    buffer_load_dwordx4 v[56:59], v252, s[4:7], s55 offen offset:0 sc1
    v_mfma_f32_16x16x32_bf16 v[152:155], v[216:219], v[60:63], v[152:155]
    ds_read_b64_tr_b16 v[244:245], v251 offset:16384
    v_mfma_f32_16x16x32_bf16 v[156:159], v[220:223], v[60:63], v[156:159]
    v_mfma_f32_16x16x32_bf16 v[160:163], v[224:227], v[60:63], v[160:163]
    ds_read_b64_tr_b16 v[246:247], v251 offset:18432
    v_mfma_f32_16x16x32_bf16 v[164:167], v[228:231], v[60:63], v[164:167]
    buffer_load_dwordx4 v[60:63], v252, s[4:7], s55 offen offset:1024 sc1
    v_mfma_f32_16x16x32_bf16 v[168:171], v[216:219], v[64:67], v[168:171]
    v_mfma_f32_16x16x32_bf16 v[172:175], v[220:223], v[64:67], v[172:175]
    v_mfma_f32_16x16x32_bf16 v[176:179], v[224:227], v[64:67], v[176:179]
    v_mfma_f32_16x16x32_bf16 v[180:183], v[228:231], v[64:67], v[180:183]
    buffer_load_dwordx4 v[64:67], v252, s[4:7], s55 offen offset:2048 sc1
    v_mfma_f32_16x16x32_bf16 v[184:187], v[216:219], v[68:71], v[184:187]
    v_mfma_f32_16x16x32_bf16 v[188:191], v[220:223], v[68:71], v[188:191]
    v_mfma_f32_16x16x32_bf16 v[192:195], v[224:227], v[68:71], v[192:195]
    v_mfma_f32_16x16x32_bf16 v[196:199], v[228:231], v[68:71], v[196:199]
    buffer_load_dwordx4 v[68:71], v252, s[4:7], s55 offen offset:3072 sc1
    v_mfma_f32_16x16x32_bf16 v[200:203], v[216:219], v[72:75], v[200:203]
    v_mfma_f32_16x16x32_bf16 v[204:207], v[220:223], v[72:75], v[204:207]
    v_mfma_f32_16x16x32_bf16 v[208:211], v[224:227], v[72:75], v[208:211]
    v_mfma_f32_16x16x32_bf16 v[212:215], v[228:231], v[72:75], v[212:215]
    buffer_load_dwordx4 v[72:75], v252, s[4:7], s47 offen offset:0 sc1
    s_waitcnt lgkmcnt(0)
    s_add_u32 m0, s41, 147200
    s_cmp_le_u32 s53, 2
    s_cselect_b32 s46, 31, 29
    s_lshl_b32 s46, s46, 18
    buffer_load_dwordx4 v253, s[8:11], s46 offen offset:0  lds
    s_add_u32 s46, s46, 15360
    buffer_load_dwordx4 v253, s[8:11], s46 offen offset:1024  lds
    s_add_u32 s46, s46, 15360
    buffer_load_dwordx4 v253, s[8:11], s46 offen offset:2048  lds
    s_add_u32 s46, s46, 15360
    buffer_load_dwordx4 v253, s[8:11], s46 offen offset:3072  lds
    s_cmp_le_u32 s53, 2
    s_cselect_b32 s54, 31, 29
    s_mul_i32 s54, s54, 36864
    s_add_u32 s55, s54, 4096
    s_add_u32 s51, s54, 8192
    s_waitcnt vmcnt(25)
    v_mfma_f32_16x16x32_bf16 v[0:3], v[232:235], v[76:79], v[0:3]
    v_mfma_f32_16x16x32_bf16 v[4:7], v[236:239], v[76:79], v[4:7]
    v_mfma_f32_16x16x32_bf16 v[8:11], v[240:243], v[76:79], v[8:11]
    v_mfma_f32_16x16x32_bf16 v[12:15], v[244:247], v[76:79], v[12:15]
    buffer_load_dwordx4 v[76:79], v252, s[4:7], s54 offen offset:0 sc1
    s_waitcnt vmcnt(25)
    v_mfma_f32_16x16x32_bf16 v[16:19], v[232:235], v[80:83], v[16:19]
    v_mfma_f32_16x16x32_bf16 v[20:23], v[236:239], v[80:83], v[20:23]
    v_mfma_f32_16x16x32_bf16 v[24:27], v[240:243], v[80:83], v[24:27]
    v_mfma_f32_16x16x32_bf16 v[28:31], v[244:247], v[80:83], v[28:31]
    buffer_load_dwordx4 v[80:83], v252, s[4:7], s54 offen offset:1024 sc1
    s_waitcnt vmcnt(15)
    v_mfma_f32_16x16x32_bf16 v[32:35], v[232:235], v[84:87], v[32:35]
    ds_read_b64_tr_b16 v[216:217], v248 offset:0
    v_mfma_f32_16x16x32_bf16 v[36:39], v[236:239], v[84:87], v[36:39]
    v_mfma_f32_16x16x32_bf16 v[112:115], v[240:243], v[84:87], v[112:115]
    ds_read_b64_tr_b16 v[218:219], v248 offset:2048
    v_mfma_f32_16x16x32_bf16 v[116:119], v[244:247], v[84:87], v[116:119]
    buffer_load_dwordx4 v[84:87], v252, s[4:7], s54 offen offset:2048 sc1
    v_mfma_f32_16x16x32_bf16 v[120:123], v[232:235], v[88:91], v[120:123]
    ds_read_b64_tr_b16 v[220:221], v249 offset:0
    v_mfma_f32_16x16x32_bf16 v[124:127], v[236:239], v[88:91], v[124:127]
    v_mfma_f32_16x16x32_bf16 v[128:131], v[240:243], v[88:91], v[128:131]
    ds_read_b64_tr_b16 v[222:223], v249 offset:2048
    v_mfma_f32_16x16x32_bf16 v[132:135], v[244:247], v[88:91], v[132:135]
    buffer_load_dwordx4 v[88:91], v252, s[4:7], s54 offen offset:3072 sc1
    v_mfma_f32_16x16x32_bf16 v[136:139], v[232:235], v[92:95], v[136:139]
    ds_read_b64_tr_b16 v[224:225], v250 offset:0
    v_mfma_f32_16x16x32_bf16 v[140:143], v[236:239], v[92:95], v[140:143]
    v_mfma_f32_16x16x32_bf16 v[144:147], v[240:243], v[92:95], v[144:147]
    ds_read_b64_tr_b16 v[226:227], v250 offset:2048
    v_mfma_f32_16x16x32_bf16 v[148:151], v[244:247], v[92:95], v[148:151]
    buffer_load_dwordx4 v[92:95], v252, s[4:7], s55 offen offset:0 sc1
    v_mfma_f32_16x16x32_bf16 v[152:155], v[232:235], v[96:99], v[152:155]
    ds_read_b64_tr_b16 v[228:229], v251 offset:0
    v_mfma_f32_16x16x32_bf16 v[156:159], v[236:239], v[96:99], v[156:159]
    v_mfma_f32_16x16x32_bf16 v[160:163], v[240:243], v[96:99], v[160:163]
    ds_read_b64_tr_b16 v[230:231], v251 offset:2048
    v_mfma_f32_16x16x32_bf16 v[164:167], v[244:247], v[96:99], v[164:167]
    buffer_load_dwordx4 v[96:99], v252, s[4:7], s55 offen offset:1024 sc1
    v_mfma_f32_16x16x32_bf16 v[168:171], v[232:235], v[100:103], v[168:171]
    v_mfma_f32_16x16x32_bf16 v[172:175], v[236:239], v[100:103], v[172:175]
    v_mfma_f32_16x16x32_bf16 v[176:179], v[240:243], v[100:103], v[176:179]
    v_mfma_f32_16x16x32_bf16 v[180:183], v[244:247], v[100:103], v[180:183]
    buffer_load_dwordx4 v[100:103], v252, s[4:7], s55 offen offset:2048 sc1
    v_mfma_f32_16x16x32_bf16 v[184:187], v[232:235], v[104:107], v[184:187]
    v_mfma_f32_16x16x32_bf16 v[188:191], v[236:239], v[104:107], v[188:191]
    v_mfma_f32_16x16x32_bf16 v[192:195], v[240:243], v[104:107], v[192:195]
    v_mfma_f32_16x16x32_bf16 v[196:199], v[244:247], v[104:107], v[196:199]
    buffer_load_dwordx4 v[104:107], v252, s[4:7], s55 offen offset:3072 sc1
    v_mfma_f32_16x16x32_bf16 v[200:203], v[232:235], v[108:111], v[200:203]
    v_mfma_f32_16x16x32_bf16 v[204:207], v[236:239], v[108:111], v[204:207]
    v_mfma_f32_16x16x32_bf16 v[208:211], v[240:243], v[108:111], v[208:211]
    v_mfma_f32_16x16x32_bf16 v[212:215], v[244:247], v[108:111], v[212:215]
    buffer_load_dwordx4 v[108:111], v252, s[4:7], s51 offen offset:0 sc1
    s_waitcnt lgkmcnt(0)
    s_waitcnt vmcnt(21)
    v_mfma_f32_16x16x32_bf16 v[0:3], v[216:219], v[40:43], v[0:3]
    v_mfma_f32_16x16x32_bf16 v[4:7], v[220:223], v[40:43], v[4:7]
    v_mfma_f32_16x16x32_bf16 v[8:11], v[224:227], v[40:43], v[8:11]
    v_mfma_f32_16x16x32_bf16 v[12:15], v[228:231], v[40:43], v[12:15]
    s_waitcnt vmcnt(20)
    v_mfma_f32_16x16x32_bf16 v[16:19], v[216:219], v[44:47], v[16:19]
    v_mfma_f32_16x16x32_bf16 v[20:23], v[220:223], v[44:47], v[20:23]
    v_mfma_f32_16x16x32_bf16 v[24:27], v[224:227], v[44:47], v[24:27]
    v_mfma_f32_16x16x32_bf16 v[28:31], v[228:231], v[44:47], v[28:31]
    s_waitcnt vmcnt(9)
    v_mfma_f32_16x16x32_bf16 v[32:35], v[216:219], v[48:51], v[32:35]
    ds_read_b64_tr_b16 v[232:233], v248 offset:16384
    v_mfma_f32_16x16x32_bf16 v[36:39], v[220:223], v[48:51], v[36:39]
    v_mfma_f32_16x16x32_bf16 v[112:115], v[224:227], v[48:51], v[112:115]
    ds_read_b64_tr_b16 v[234:235], v248 offset:18432
    v_mfma_f32_16x16x32_bf16 v[116:119], v[228:231], v[48:51], v[116:119]
    v_mfma_f32_16x16x32_bf16 v[120:123], v[216:219], v[52:55], v[120:123]
    ds_read_b64_tr_b16 v[236:237], v249 offset:16384
    v_mfma_f32_16x16x32_bf16 v[124:127], v[220:223], v[52:55], v[124:127]
    v_mfma_f32_16x16x32_bf16 v[128:131], v[224:227], v[52:55], v[128:131]
    ds_read_b64_tr_b16 v[238:239], v249 offset:18432
    v_mfma_f32_16x16x32_bf16 v[132:135], v[228:231], v[52:55], v[132:135]
    v_mfma_f32_16x16x32_bf16 v[136:139], v[216:219], v[56:59], v[136:139]
    ds_read_b64_tr_b16 v[240:241], v250 offset:16384
    v_mfma_f32_16x16x32_bf16 v[140:143], v[220:223], v[56:59], v[140:143]
    v_mfma_f32_16x16x32_bf16 v[144:147], v[224:227], v[56:59], v[144:147]
    ds_read_b64_tr_b16 v[242:243], v250 offset:18432
    v_mfma_f32_16x16x32_bf16 v[148:151], v[228:231], v[56:59], v[148:151]
    v_mfma_f32_16x16x32_bf16 v[152:155], v[216:219], v[60:63], v[152:155]
    ds_read_b64_tr_b16 v[244:245], v251 offset:16384
    v_mfma_f32_16x16x32_bf16 v[156:159], v[220:223], v[60:63], v[156:159]
    v_mfma_f32_16x16x32_bf16 v[160:163], v[224:227], v[60:63], v[160:163]
    ds_read_b64_tr_b16 v[246:247], v251 offset:18432
    v_mfma_f32_16x16x32_bf16 v[164:167], v[228:231], v[60:63], v[164:167]
    v_mfma_f32_16x16x32_bf16 v[168:171], v[216:219], v[64:67], v[168:171]
    v_mfma_f32_16x16x32_bf16 v[172:175], v[220:223], v[64:67], v[172:175]
    v_mfma_f32_16x16x32_bf16 v[176:179], v[224:227], v[64:67], v[176:179]
    v_mfma_f32_16x16x32_bf16 v[180:183], v[228:231], v[64:67], v[180:183]
    v_mfma_f32_16x16x32_bf16 v[184:187], v[216:219], v[68:71], v[184:187]
    v_mfma_f32_16x16x32_bf16 v[188:191], v[220:223], v[68:71], v[188:191]
    v_mfma_f32_16x16x32_bf16 v[192:195], v[224:227], v[68:71], v[192:195]
    v_mfma_f32_16x16x32_bf16 v[196:199], v[228:231], v[68:71], v[196:199]
    v_mfma_f32_16x16x32_bf16 v[200:203], v[216:219], v[72:75], v[200:203]
    v_mfma_f32_16x16x32_bf16 v[204:207], v[220:223], v[72:75], v[204:207]
    v_mfma_f32_16x16x32_bf16 v[208:211], v[224:227], v[72:75], v[208:211]
    v_mfma_f32_16x16x32_bf16 v[212:215], v[228:231], v[72:75], v[212:215]
    s_waitcnt lgkmcnt(0)
    s_waitcnt vmcnt(0)
    ds_read_b32 v254, v255 offset:128
    s_mov_b32 s51, 0
    s_waitcnt lgkmcnt(0)
    v_cmp_eq_u32 vcc, 0, v254
    s_nop 1
    s_cbranch_vccnz G1_xlate
    s_mov_b32 s55, 4096
    s_mov_b32 s51, 1
    buffer_load_dwordx4 v[40:43], v252, s[20:23], 0 offen offset:0 sc1
    buffer_load_dwordx4 v[44:47], v252, s[20:23], 0 offen offset:1024 sc1
    buffer_load_dwordx4 v[48:51], v252, s[20:23], 0 offen offset:2048 sc1
    buffer_load_dwordx4 v[52:55], v252, s[20:23], 0 offen offset:3072 sc1
    buffer_load_dwordx4 v[56:59], v252, s[20:23], s55 offen offset:0 sc1
G1_xlate:
    v_mbcnt_lo_u32_b32 v254, -1, 0
    v_mbcnt_hi_u32_b32 v254, -1, v254
    v_and_b32 v216, 3, v254
    v_lshlrev_b32 v216, 2, v216
    v_add_u32 v216, 163584, v216
    s_mov_b32 s59, 262144
G1_scr:
    ds_read_b32 v217, v216 offset:32
    s_waitcnt lgkmcnt(0)
    v_cmp_lt_u32 s[56:57], v217, 5
    s_nop 0
    s_cmp_eq_u64 s[56:57], 0
    s_cbranch_scc1 G1_scr_ok
    s_sleep 1
    s_sub_u32 s59, s59, 1
    s_cmp_lg_u32 s59, 0
    s_cbranch_scc1 G1_scr
G1_scr_ok:
    s_xor_b32 s44, s24, 1
    s_mul_i32 s44, s44, 27648
    s_add_u32 s44, s44, 0
    v_lshl_add_u32 v249, v254, 4, s44
    s_xor_b32 s44, s24, 2
    s_mul_i32 s44, s44, 27648
    s_add_u32 s44, s44, 9216
    v_lshl_add_u32 v250, v254, 4, s44
    s_xor_b32 s44, s24, 3
    s_mul_i32 s44, s44, 27648
    s_add_u32 s44, s44, 18432
    v_lshl_add_u32 v251, v254, 4, s44
    s_mul_i32 s44, s24, 27648
    v_lshl_add_u32 v248, v254, 4, s44
    v_mfma_f32_16x16x32_bf16 v[0:3], v[232:235], v[76:79], v[0:3]
    v_mfma_f32_16x16x32_bf16 v[4:7], v[236:239], v[76:79], v[4:7]
    v_mfma_f32_16x16x32_bf16 v[8:11], v[240:243], v[76:79], v[8:11]
    v_mfma_f32_16x16x32_bf16 v[12:15], v[244:247], v[76:79], v[12:15]
    v_mfma_f32_16x16x32_bf16 v[16:19], v[232:235], v[80:83], v[16:19]
    v_mfma_f32_16x16x32_bf16 v[20:23], v[236:239], v[80:83], v[20:23]
    v_mfma_f32_16x16x32_bf16 v[24:27], v[240:243], v[80:83], v[24:27]
    v_mfma_f32_16x16x32_bf16 v[28:31], v[244:247], v[80:83], v[28:31]
    v_mfma_f32_16x16x32_bf16 v[32:35], v[232:235], v[84:87], v[32:35]
    s_nop 0
    ds_write_b128 v249, v[4:7] offset:0
    v_mfma_f32_16x16x32_bf16 v[36:39], v[236:239], v[84:87], v[36:39]
    ds_write_b128 v250, v[8:11] offset:0
    v_mfma_f32_16x16x32_bf16 v[112:115], v[240:243], v[84:87], v[112:115]
    ds_write_b128 v251, v[12:15] offset:0
    v_mfma_f32_16x16x32_bf16 v[116:119], v[244:247], v[84:87], v[116:119]
    v_mfma_f32_16x16x32_bf16 v[120:123], v[232:235], v[88:91], v[120:123]
    ds_write_b128 v249, v[20:23] offset:1024
    v_mfma_f32_16x16x32_bf16 v[124:127], v[236:239], v[88:91], v[124:127]
    ds_write_b128 v250, v[24:27] offset:1024
    v_mfma_f32_16x16x32_bf16 v[128:131], v[240:243], v[88:91], v[128:131]
    ds_write_b128 v251, v[28:31] offset:1024
    v_mfma_f32_16x16x32_bf16 v[132:135], v[244:247], v[88:91], v[132:135]
    v_mfma_f32_16x16x32_bf16 v[136:139], v[232:235], v[92:95], v[136:139]
    ds_write_b128 v249, v[36:39] offset:2048
    v_mfma_f32_16x16x32_bf16 v[140:143], v[236:239], v[92:95], v[140:143]
    ds_write_b128 v250, v[112:115] offset:2048
    v_mfma_f32_16x16x32_bf16 v[144:147], v[240:243], v[92:95], v[144:147]
    ds_write_b128 v251, v[116:119] offset:2048
    v_mfma_f32_16x16x32_bf16 v[148:151], v[244:247], v[92:95], v[148:151]
    v_mfma_f32_16x16x32_bf16 v[152:155], v[232:235], v[96:99], v[152:155]
    ds_write_b128 v249, v[124:127] offset:3072
    v_mfma_f32_16x16x32_bf16 v[156:159], v[236:239], v[96:99], v[156:159]
    ds_write_b128 v250, v[128:131] offset:3072
    v_mfma_f32_16x16x32_bf16 v[160:163], v[240:243], v[96:99], v[160:163]
    ds_write_b128 v251, v[132:135] offset:3072
    v_mfma_f32_16x16x32_bf16 v[164:167], v[244:247], v[96:99], v[164:167]
    v_mfma_f32_16x16x32_bf16 v[168:171], v[232:235], v[100:103], v[168:171]
    ds_write_b128 v249, v[140:143] offset:4096
    v_mfma_f32_16x16x32_bf16 v[172:175], v[236:239], v[100:103], v[172:175]
    ds_write_b128 v250, v[144:147] offset:4096
    v_mfma_f32_16x16x32_bf16 v[176:179], v[240:243], v[100:103], v[176:179]
    ds_write_b128 v251, v[148:151] offset:4096
    v_mfma_f32_16x16x32_bf16 v[180:183], v[244:247], v[100:103], v[180:183]
    v_mfma_f32_16x16x32_bf16 v[184:187], v[232:235], v[104:107], v[184:187]
    ds_write_b128 v249, v[156:159] offset:5120
    v_mfma_f32_16x16x32_bf16 v[188:191], v[236:239], v[104:107], v[188:191]
    ds_write_b128 v250, v[160:163] offset:5120
    v_mfma_f32_16x16x32_bf16 v[192:195], v[240:243], v[104:107], v[192:195]
    ds_write_b128 v251, v[164:167] offset:5120
    v_mfma_f32_16x16x32_bf16 v[196:199], v[244:247], v[104:107], v[196:199]
    v_mfma_f32_16x16x32_bf16 v[200:203], v[232:235], v[108:111], v[200:203]
    ds_write_b128 v249, v[172:175] offset:6144
    v_mfma_f32_16x16x32_bf16 v[204:207], v[236:239], v[108:111], v[204:207]
    ds_write_b128 v250, v[176:179] offset:6144
    v_mfma_f32_16x16x32_bf16 v[208:211], v[240:243], v[108:111], v[208:211]
    ds_write_b128 v251, v[180:183] offset:6144
    v_mfma_f32_16x16x32_bf16 v[212:215], v[244:247], v[108:111], v[212:215]
    ds_write_b128 v249, v[188:191] offset:7168
    ds_write_b128 v250, v[192:195] offset:7168
    ds_write_b128 v251, v[196:199] offset:7168
    s_nop 0
    ds_write_b128 v249, v[204:207] offset:8192
    s_nop 0
    ds_write_b128 v250, v[208:211] offset:8192
    s_nop 0
    ds_write_b128 v251, v[212:215] offset:8192
    v_lshrrev_b32 v216, 5, v254
    s_lshl_b32 s44, s24, 1
    v_add_u32 v216, s44, v216
    v_and_b32 v217, 7, v254
    v_xor_b32 v216, v216, v217
    v_lshlrev_b32 v216, 4, v216
    v_bfe_u32 v217, v254, 4, 1
    v_lshl_add_u32 v216, v217, 3, v216
    v_and_b32 v217, 15, v254
    v_lshl_add_u32 v216, v217, 7, v216
    v_add_u32 v216, 110592, v216
    v_lshrrev_b32 v217, 3, v254
    v_and_b32 v218, 7, v254
    v_xor_b32 v218, v218, v217
    v_lshlrev_b32 v218, 4, v218
    v_lshl_add_u32 v218, v217, 11, v218
    s_add_u32 s44, s41, 110592
    v_lshl_add_u32 v219, v254, 4, s44
    s_lshl_b32 s45, s24, 10
    s_add_u32 s45, s45, 110592
    v_lshl_add_u32 v217, v254, 4, s45
    s_waitcnt lgkmcnt(0)
    s_barrier
    s_cmp_lg_u32 s51, 0
    s_cbranch_scc1 G1_xdone
    s_mov_b32 s55, 4096
    s_mov_b32 s51, 1
    buffer_load_dwordx4 v[40:43], v252, s[20:23], 0 offen offset:0 sc1
    buffer_load_dwordx4 v[44:47], v252, s[20:23], 0 offen offset:1024 sc1
    buffer_load_dwordx4 v[48:51], v252, s[20:23], 0 offen offset:2048 sc1
    buffer_load_dwordx4 v[52:55], v252, s[20:23], 0 offen offset:3072 sc1
    buffer_load_dwordx4 v[56:59], v252, s[20:23], s55 offen offset:0 sc1
G1_xdone:
    ds_read_b128 v[4:7], v248 offset:0
    ds_read_b128 v[8:11], v248 offset:9216
    ds_read_b128 v[12:15], v248 offset:18432
    ds_read_b128 v[20:23], v248 offset:1024
    ds_read_b128 v[24:27], v248 offset:10240
    ds_read_b128 v[28:31], v248 offset:19456
    ds_read_b128 v[36:39], v248 offset:2048
    ds_read_b128 v[112:115], v248 offset:11264
    ds_read_b128 v[116:119], v248 offset:20480
    ds_read_b128 v[124:127], v248 offset:3072
    ds_read_b128 v[128:131], v248 offset:12288
    ds_read_b128 v[132:135], v248 offset:21504
    ds_read_b128 v[140:143], v248 offset:4096
    ds_read_b128 v[144:147], v248 offset:13312
    ds_read_b128 v[148:151], v248 offset:22528
    ds_read_b128 v[156:159], v248 offset:5120
    ds_read_b128 v[160:163], v248 offset:14336
    ds_read_b128 v[164:167], v248 offset:23552
    ds_read_b128 v[172:175], v248 offset:6144
    ds_read_b128 v[176:179], v248 offset:15360
    ds_read_b128 v[180:183], v248 offset:24576
    ds_read_b128 v[188:191], v248 offset:7168
    ds_read_b128 v[192:195], v248 offset:16384
    ds_read_b128 v[196:199], v248 offset:25600
    ds_read_b128 v[204:207], v248 offset:8192
    ds_read_b128 v[208:211], v248 offset:17408
    ds_read_b128 v[212:215], v248 offset:26624
    s_waitcnt lgkmcnt(15)
    v_add_f32 v0, v0, v4
    v_add_f32 v8, v8, v12
    v_add_f32 v1, v1, v5
    v_add_f32 v9, v9, v13
    v_add_f32 v2, v2, v6
    v_add_f32 v10, v10, v14
    v_add_f32 v3, v3, v7
    v_add_f32 v11, v11, v15
    v_add_f32 v0, v0, v8
    v_add_f32 v1, v1, v9
    v_add_f32 v2, v2, v10
    v_add_f32 v3, v3, v11
    v_add_f32 v16, v16, v20
    v_add_f32 v24, v24, v28
    v_add_f32 v17, v17, v21
    v_add_f32 v25, v25, v29
    v_add_f32 v18, v18, v22
    v_add_f32 v26, v26, v30
    v_add_f32 v19, v19, v23
    v_add_f32 v27, v27, v31
    v_add_f32 v16, v16, v24
    v_add_f32 v17, v17, v25
    v_add_f32 v18, v18, v26
    v_add_f32 v19, v19, v27
    v_add_f32 v32, v32, v36
    v_add_f32 v112, v112, v116
    v_add_f32 v33, v33, v37
    v_add_f32 v113, v113, v117
    v_add_f32 v34, v34, v38
    v_add_f32 v114, v114, v118
    v_add_f32 v35, v35, v39
    v_add_f32 v115, v115, v119
    v_add_f32 v32, v32, v112
    v_add_f32 v33, v33, v113
    v_add_f32 v34, v34, v114
    v_add_f32 v35, v35, v115
    v_add_f32 v120, v120, v124
    v_add_f32 v128, v128, v132
    v_add_f32 v121, v121, v125
    v_add_f32 v129, v129, v133
    v_add_f32 v122, v122, v126
    v_add_f32 v130, v130, v134
    v_add_f32 v123, v123, v127
    v_add_f32 v131, v131, v135
    v_add_f32 v120, v120, v128
    v_add_f32 v121, v121, v129
    v_add_f32 v122, v122, v130
    v_add_f32 v123, v123, v131
    s_waitcnt lgkmcnt(14)
    v_add_f32 v136, v136, v140
    s_waitcnt lgkmcnt(12)
    v_add_f32 v144, v144, v148
    v_add_f32 v137, v137, v141
    v_add_f32 v145, v145, v149
    v_add_f32 v138, v138, v142
    v_add_f32 v146, v146, v150
    v_add_f32 v139, v139, v143
    v_add_f32 v147, v147, v151
    v_add_f32 v136, v136, v144
    v_add_f32 v137, v137, v145
    v_add_f32 v138, v138, v146
    v_add_f32 v139, v139, v147
    s_waitcnt lgkmcnt(11)
    v_add_f32 v152, v152, v156
    s_waitcnt lgkmcnt(9)
    v_add_f32 v160, v160, v164
    v_add_f32 v153, v153, v157
    v_add_f32 v161, v161, v165
    v_add_f32 v154, v154, v158
    v_add_f32 v162, v162, v166
    v_add_f32 v155, v155, v159
    v_add_f32 v163, v163, v167
    v_add_f32 v152, v152, v160
    v_add_f32 v153, v153, v161
    v_add_f32 v154, v154, v162
    v_add_f32 v155, v155, v163
    s_waitcnt lgkmcnt(8)
    v_add_f32 v168, v168, v172
    s_waitcnt lgkmcnt(6)
    v_add_f32 v176, v176, v180
    v_add_f32 v169, v169, v173
    v_add_f32 v177, v177, v181
    v_add_f32 v170, v170, v174
    v_add_f32 v178, v178, v182
    v_add_f32 v171, v171, v175
    v_add_f32 v179, v179, v183
    v_add_f32 v168, v168, v176
    v_add_f32 v169, v169, v177
    v_add_f32 v170, v170, v178
    v_add_f32 v171, v171, v179
    s_waitcnt lgkmcnt(5)
    v_add_f32 v184, v184, v188
    s_waitcnt lgkmcnt(3)
    v_add_f32 v192, v192, v196
    v_add_f32 v185, v185, v189
    v_add_f32 v193, v193, v197
    v_add_f32 v186, v186, v190
    v_add_f32 v194, v194, v198
    v_add_f32 v187, v187, v191
    v_add_f32 v195, v195, v199
    v_add_f32 v184, v184, v192
    v_add_f32 v185, v185, v193
    v_add_f32 v186, v186, v194
    v_add_f32 v187, v187, v195
    s_waitcnt lgkmcnt(2)
    v_add_f32 v200, v200, v204
    s_waitcnt lgkmcnt(0)
    v_add_f32 v208, v208, v212
    v_add_f32 v201, v201, v205
    v_add_f32 v209, v209, v213
    v_add_f32 v202, v202, v206
    v_add_f32 v210, v210, v214
    v_add_f32 v203, v203, v207
    v_add_f32 v211, v211, v215
    v_add_f32 v200, v200, v208
    v_add_f32 v201, v201, v209
    v_add_f32 v202, v202, v210
    v_add_f32 v203, v203, v211
    s_waitcnt vmcnt(0)
    v_lshlrev_b32 v4, 16, v40
    v_and_b32 v5, 0xffff0000, v40
    v_lshlrev_b32 v6, 16, v41
    v_and_b32 v7, 0xffff0000, v41
    v_add_f32 v0, v0, v4
    v_add_f32 v1, v1, v5
    v_add_f32 v2, v2, v6
    v_add_f32 v3, v3, v7
    v_cvt_pk_bf16_f32 v0, v0, v1
    v_cvt_pk_bf16_f32 v1, v2, v3
    ds_write_b64 v216, v[0:1] offset:0
    v_lshlrev_b32 v20, 16, v42
    v_and_b32 v21, 0xffff0000, v42
    v_lshlrev_b32 v22, 16, v43
    v_and_b32 v23, 0xffff0000, v43
    v_add_f32 v16, v16, v20
    v_add_f32 v17, v17, v21
    v_add_f32 v18, v18, v22
    v_add_f32 v19, v19, v23
    v_cvt_pk_bf16_f32 v16, v16, v17
    v_cvt_pk_bf16_f32 v17, v18, v19
    ds_write_b64 v216, v[16:17] offset:2048
    v_lshlrev_b32 v36, 16, v44
    v_and_b32 v37, 0xffff0000, v44
    v_lshlrev_b32 v38, 16, v45
    v_and_b32 v39, 0xffff0000, v45
    v_add_f32 v32, v32, v36
    v_add_f32 v33, v33, v37
    v_add_f32 v34, v34, v38
    v_add_f32 v35, v35, v39
    v_cvt_pk_bf16_f32 v32, v32, v33
    v_cvt_pk_bf16_f32 v33, v34, v35
    ds_write_b64 v216, v[32:33] offset:4096
    v_lshlrev_b32 v124, 16, v46
    v_and_b32 v125, 0xffff0000, v46
    v_lshlrev_b32 v126, 16, v47
    v_and_b32 v127, 0xffff0000, v47
    v_add_f32 v120, v120, v124
    v_add_f32 v121, v121, v125
    v_add_f32 v122, v122, v126
    v_add_f32 v123, v123, v127
    v_cvt_pk_bf16_f32 v120, v120, v121
    v_cvt_pk_bf16_f32 v121, v122, v123
    ds_write_b64 v216, v[120:121] offset:6144
    v_lshlrev_b32 v140, 16, v48
    v_and_b32 v141, 0xffff0000, v48
    v_lshlrev_b32 v142, 16, v49
    v_and_b32 v143, 0xffff0000, v49
    v_add_f32 v136, v136, v140
    v_add_f32 v137, v137, v141
    v_add_f32 v138, v138, v142
    v_add_f32 v139, v139, v143
    v_cvt_pk_bf16_f32 v136, v136, v137
    v_cvt_pk_bf16_f32 v137, v138, v139
    ds_write_b64 v216, v[136:137] offset:8192
    v_lshlrev_b32 v156, 16, v50
    v_and_b32 v157, 0xffff0000, v50
    v_lshlrev_b32 v158, 16, v51
    v_and_b32 v159, 0xffff0000, v51
    v_add_f32 v152, v152, v156
    v_add_f32 v153, v153, v157
    v_add_f32 v154, v154, v158
    v_add_f32 v155, v155, v159
    v_cvt_pk_bf16_f32 v152, v152, v153
    v_cvt_pk_bf16_f32 v153, v154, v155
    ds_write_b64 v216, v[152:153] offset:10240
    v_lshlrev_b32 v172, 16, v52
    v_and_b32 v173, 0xffff0000, v52
    v_lshlrev_b32 v174, 16, v53
    v_and_b32 v175, 0xffff0000, v53
    v_add_f32 v168, v168, v172
    v_add_f32 v169, v169, v173
    v_add_f32 v170, v170, v174
    v_add_f32 v171, v171, v175
    v_cvt_pk_bf16_f32 v168, v168, v169
    v_cvt_pk_bf16_f32 v169, v170, v171
    ds_write_b64 v216, v[168:169] offset:12288
    v_lshlrev_b32 v188, 16, v54
    v_and_b32 v189, 0xffff0000, v54
    v_lshlrev_b32 v190, 16, v55
    v_and_b32 v191, 0xffff0000, v55
    v_add_f32 v184, v184, v188
    v_add_f32 v185, v185, v189
    v_add_f32 v186, v186, v190
    v_add_f32 v187, v187, v191
    v_cvt_pk_bf16_f32 v184, v184, v185
    v_cvt_pk_bf16_f32 v185, v186, v187
    ds_write_b64 v216, v[184:185] offset:14336
    v_lshlrev_b32 v204, 16, v56
    v_and_b32 v205, 0xffff0000, v56
    v_lshlrev_b32 v206, 16, v57
    v_and_b32 v207, 0xffff0000, v57
    v_add_f32 v200, v200, v204
    v_add_f32 v201, v201, v205
    v_add_f32 v202, v202, v206
    v_add_f32 v203, v203, v207
    v_cvt_pk_bf16_f32 v200, v200, v201
    v_cvt_pk_bf16_f32 v201, v202, v203
    ds_write_b64 v216, v[200:201] offset:16384
    s_waitcnt lgkmcnt(0)
    s_barrier
    ds_read_b128 v[220:223], v219 offset:0
    ds_read_b128 v[224:227], v219 offset:1024
    ds_read_b128 v[228:231], v219 offset:2048
    ds_read_b128 v[232:235], v219 offset:3072
    ds_read_b128 v[236:239], v217 offset:16384
    s_lshl_b32 s44, s24, 16
    s_waitcnt lgkmcnt(4)
    buffer_store_dwordx4 v[220:223], v218, s[12:15], s44 offen sc0 sc1
    s_add_u32 s44, s44, 16384
    s_waitcnt lgkmcnt(3)
    buffer_store_dwordx4 v[224:227], v218, s[12:15], s44 offen sc0 sc1
    s_add_u32 s44, s44, 16384
    s_waitcnt lgkmcnt(2)
    buffer_store_dwordx4 v[228:231], v218, s[12:15], s44 offen sc0 sc1
    s_add_u32 s44, s44, 16384
    s_waitcnt lgkmcnt(1)
    buffer_store_dwordx4 v[232:235], v218, s[12:15], s44 offen sc0 sc1
    s_add_u32 s44, s44, 16384
    s_cmp_ge_u32 s24, 2
    s_cbranch_scc1 G1_done
    s_lshl_b32 s44, s24, 14
    s_add_u32 s44, s44, 262144
    s_waitcnt lgkmcnt(0)
    buffer_store_dwordx4 v[236:239], v218, s[12:15], s44 offen sc0 sc1
G1_done:
    s_endpgm
G1_fb5:
    s_setprio 0
    s_mov_b32 s59, 262144
G1_fb5_p:
    ds_read_b32 v248, v240 offset:16
    s_waitcnt lgkmcnt(0)
    v_cmp_lt_u32 s[56:57], v248, 33
    s_nop 0
    s_cmp_eq_u64 s[56:57], 0
    s_cbranch_scc1 G1_fb5_p_ok
    s_sleep 6
    s_sub_u32 s59, s59, 1
    s_cmp_lg_u32 s59, 0
    s_cbranch_scc1 G1_fb5_p
G1_fb5_p_ok:
    s_setprio 3
    s_branch G1_fb5_ret
G1_fb6:
    s_setprio 0
    s_mov_b32 s59, 262144
G1_fb6_p:
    ds_read_b32 v248, v240 offset:16
    s_waitcnt lgkmcnt(0)
    v_cmp_lt_u32 s[56:57], v248, 33
    s_nop 0
    s_cmp_eq_u64 s[56:57], 0
    s_cbranch_scc1 G1_fb6_p_ok
    s_sleep 6
    s_sub_u32 s59, s59, 1
    s_cmp_lg_u32 s59, 0
    s_cbranch_scc1 G1_fb6_p
G1_fb6_p_ok:
    s_setprio 3
    s_branch G1_fb6_ret
G1_g1:
    s_call_b64 s[38:39], G1_slow
    s_branch G1_g1_ret
G1_fb7:
    s_setprio 0
    s_mov_b32 s59, 262144
G1_fb7_p:
    ds_read_b32 v248, v240 offset:16
    s_waitcnt lgkmcnt(0)
    v_cmp_lt_u32 s[56:57], v248, 34
    s_nop 0
    s_cmp_eq_u64 s[56:57], 0
    s_cbranch_scc1 G1_fb7_p_ok
    s_sleep 6
    s_sub_u32 s59, s59, 1
    s_cmp_lg_u32 s59, 0
    s_cbranch_scc1 G1_fb7_p
G1_fb7_p_ok:
    s_setprio 3
    s_branch G1_fb7_ret
G1_fb8:
    s_setprio 0
    s_mov_b32 s59, 262144
G1_fb8_p:
    ds_read_b32 v248, v240 offset:16
    s_waitcnt lgkmcnt(0)
    v_cmp_lt_u32 s[56:57], v248, 35
    s_nop 0
    s_cmp_eq_u64 s[56:57], 0
    s_cbranch_scc1 G1_fb8_p_ok
    s_sleep 6
    s_sub_u32 s59, s59, 1
    s_cmp_lg_u32 s59, 0
    s_cbranch_scc1 G1_fb8_p
G1_fb8_p_ok:
    s_setprio 3
    s_branch G1_fb8_ret
G1_g2:
    s_call_b64 s[38:39], G1_slow
    s_branch G1_g2_ret
G1_fb9:
    s_setprio 0
    s_mov_b32 s59, 262144
G1_fb9_p:
    ds_read_b32 v248, v240 offset:16
    s_waitcnt lgkmcnt(0)
    v_cmp_lt_u32 s[56:57], v248, 36
    s_nop 0
    s_cmp_eq_u64 s[56:57], 0
    s_cbranch_scc1 G1_fb9_p_ok
    s_sleep 6
    s_sub_u32 s59, s59, 1
    s_cmp_lg_u32 s59, 0
    s_cbranch_scc1 G1_fb9_p
G1_fb9_p_ok:
    s_setprio 3
    s_branch G1_fb9_ret
G1_fb10:
    s_setprio 0
    s_mov_b32 s59, 262144
G1_fb10_p:
    ds_read_b32 v248, v240 offset:16
    s_waitcnt lgkmcnt(0)
    v_cmp_lt_u32 s[56:57], v248, 37
    s_nop 0
    s_cmp_eq_u64 s[56:57], 0
    s_cbranch_scc1 G1_fb10_p_ok
    s_sleep 6
    s_sub_u32 s59, s59, 1
    s_cmp_lg_u32 s59, 0
    s_cbranch_scc1 G1_fb10_p
G1_fb10_p_ok:
    s_setprio 3
    s_branch G1_fb10_ret
G1_g3:
    s_call_b64 s[38:39], G1_slow
    s_branch G1_g3_ret
G1_fb11:
    s_setprio 0
    s_mov_b32 s59, 262144
G1_fb11_p:
    ds_read_b32 v248, v240 offset:16
    s_waitcnt lgkmcnt(0)
    v_cmp_lt_u32 s[56:57], v248, 38
    s_nop 0
    s_cmp_eq_u64 s[56:57], 0
    s_cbranch_scc1 G1_fb11_p_ok
    s_sleep 6
    s_sub_u32 s59, s59, 1
    s_cmp_lg_u32 s59, 0
    s_cbranch_scc1 G1_fb11_p
G1_fb11_p_ok:
    s_setprio 3
    s_branch G1_fb11_ret
G1_fb12:
    s_setprio 0
    s_mov_b32 s59, 262144
G1_fb12_p:
    ds_read_b32 v248, v240 offset:16
    s_waitcnt lgkmcnt(0)
    v_cmp_lt_u32 s[56:57], v248, 39
    s_nop 0
    s_cmp_eq_u64 s[56:57], 0
    s_cbranch_scc1 G1_fb12_p_ok
    s_sleep 6
    s_sub_u32 s59, s59, 1
    s_cmp_lg_u32 s59, 0
    s_cbranch_scc1 G1_fb12_p
G1_fb12_p_ok:
    s_setprio 3
    s_branch G1_fb12_ret
G1_g4:
    s_call_b64 s[38:39], G1_slow
    s_branch G1_g4_ret
G1_fb13:
    s_setprio 0
    s_mov_b32 s59, 262144
G1_fb13_p:
    ds_read_b32 v248, v240 offset:16
    s_waitcnt lgkmcnt(0)
    v_cmp_lt_u32 s[56:57], v248, 40
    s_nop 0
    s_cmp_eq_u64 s[56:57], 0
    s_cbranch_scc1 G1_fb13_p_ok
    s_sleep 6
    s_sub_u32 s59, s59, 1
    s_cmp_lg_u32 s59, 0
    s_cbranch_scc1 G1_fb13_p
G1_fb13_p_ok:
    s_setprio 3
    s_branch G1_fb13_ret
G1_fb14:
    s_setprio 0
    s_mov_b32 s59, 262144
G1_fb14_p:
    ds_read_b32 v248, v240 offset:16
    s_waitcnt lgkmcnt(0)
    v_cmp_lt_u32 s[56:57], v248, 41
    s_nop 0
    s_cmp_eq_u64 s[56:57], 0
    s_cbranch_scc1 G1_fb14_p_ok
    s_sleep 6
    s_sub_u32 s59, s59, 1
    s_cmp_lg_u32 s59, 0
    s_cbranch_scc1 G1_fb14_p
G1_fb14_p_ok:
    s_setprio 3
    s_branch G1_fb14_ret
G1_g5:
    s_call_b64 s[38:39], G1_slow
    s_branch G1_g5_ret
G1_fb15:
    s_setprio 0
    s_mov_b32 s59, 262144
G1_fb15_p:
    ds_read_b32 v248, v240 offset:16
    s_waitcnt lgkmcnt(0)
    v_cmp_lt_u32 s[56:57], v248, 42
    s_nop 0
    s_cmp_eq_u64 s[56:57], 0
    s_cbranch_scc1 G1_fb15_p_ok
    s_sleep 6
    s_sub_u32 s59, s59, 1
    s_cmp_lg_u32 s59, 0
    s_cbranch_scc1 G1_fb15_p
G1_fb15_p_ok:
    s_setprio 3
    s_branch G1_fb15_ret
G1_fb16:
    s_setprio 0
    s_mov_b32 s59, 262144
G1_fb16_p:
    ds_read_b32 v248, v240 offset:16
    s_waitcnt lgkmcnt(0)
    v_cmp_lt_u32 s[56:57], v248, 43
    s_nop 0
    s_cmp_eq_u64 s[56:57], 0
    s_cbranch_scc1 G1_fb16_p_ok
    s_sleep 6
    s_sub_u32 s59, s59, 1
    s_cmp_lg_u32 s59, 0
    s_cbranch_scc1 G1_fb16_p
G1_fb16_p_ok:
    s_setprio 3
    s_branch G1_fb16_ret
G1_g6:
    s_call_b64 s[38:39], G1_slow
    s_branch G1_g6_ret
G1_fb17:
    s_setprio 0
    s_mov_b32 s59, 262144
G1_fb17_p:
    ds_read_b32 v248, v240 offset:16
    s_waitcnt lgkmcnt(0)
    v_cmp_lt_u32 s[56:57], v248, 44
    s_nop 0
    s_cmp_eq_u64 s[56:57], 0
    s_cbranch_scc1 G1_fb17_p_ok
    s_sleep 6
    s_sub_u32 s59, s59, 1
    s_cmp_lg_u32 s59, 0
    s_cbranch_scc1 G1_fb17_p
G1_fb17_p_ok:
    s_setprio 3
    s_branch G1_fb17_ret
G1_fb18:
    s_setprio 0
    s_mov_b32 s59, 262144
G1_fb18_p:
    ds_read_b32 v248, v240 offset:16
    s_waitcnt lgkmcnt(0)
    v_cmp_lt_u32 s[56:57], v248, 45
    s_nop 0
    s_cmp_eq_u64 s[56:57], 0
    s_cbranch_scc1 G1_fb18_p_ok
    s_sleep 6
    s_sub_u32 s59, s59, 1
    s_cmp_lg_u32 s59, 0
    s_cbranch_scc1 G1_fb18_p
G1_fb18_p_ok:
    s_setprio 3
    s_branch G1_fb18_ret
G1_g7:
    s_call_b64 s[38:39], G1_slow
    s_branch G1_g7_ret
G1_fb19:
    s_setprio 0
    s_mov_b32 s59, 262144
G1_fb19_p:
    ds_read_b32 v248, v240 offset:16
    s_waitcnt lgkmcnt(0)
    v_cmp_lt_u32 s[56:57], v248, 46
    s_nop 0
    s_cmp_eq_u64 s[56:57], 0
    s_cbranch_scc1 G1_fb19_p_ok
    s_sleep 6
    s_sub_u32 s59, s59, 1
    s_cmp_lg_u32 s59, 0
    s_cbranch_scc1 G1_fb19_p
G1_fb19_p_ok:
    s_setprio 3
    s_branch G1_fb19_ret
G1_fb20:
    s_setprio 0
    s_mov_b32 s59, 262144
G1_fb20_p:
    ds_read_b32 v248, v240 offset:16
    s_waitcnt lgkmcnt(0)
    v_cmp_lt_u32 s[56:57], v248, 47
    s_nop 0
    s_cmp_eq_u64 s[56:57], 0
    s_cbranch_scc1 G1_fb20_p_ok
    s_sleep 6
    s_sub_u32 s59, s59, 1
    s_cmp_lg_u32 s59, 0
    s_cbranch_scc1 G1_fb20_p
G1_fb20_p_ok:
    s_setprio 3
    s_branch G1_fb20_ret
G1_fb21:
    s_setprio 0
    s_mov_b32 s59, 262144
G1_fb21_p:
    ds_read_b32 v248, v240 offset:16
    s_waitcnt lgkmcnt(0)
    v_cmp_lt_u32 s[56:57], v248, 48
    s_nop 0
    s_cmp_eq_u64 s[56:57], 0
    s_cbranch_scc1 G1_fb21_p_ok
    s_sleep 6
    s_sub_u32 s59, s59, 1
    s_cmp_lg_u32 s59, 0
    s_cbranch_scc1 G1_fb21_p
G1_fb21_p_ok:
    s_setprio 3
    s_branch G1_fb21_ret
G1_fb22:
    s_setprio 0
    s_mov_b32 s59, 262144
G1_fb22_p:
    ds_read_b32 v248, v240 offset:16
    s_waitcnt lgkmcnt(0)
    v_cmp_lt_u32 s[56:57], v248, 49
    s_nop 0
    s_cmp_eq_u64 s[56:57], 0
    s_cbranch_scc1 G1_fb22_p_ok
    s_sleep 6
    s_sub_u32 s59, s59, 1
    s_cmp_lg_u32 s59, 0
    s_cbranch_scc1 G1_fb22_p
G1_fb22_p_ok:
    s_setprio 3
    s_branch G1_fb22_ret
G1_g9:
    s_call_b64 s[38:39], G1_slow
    s_branch G1_g9_ret
G1_fb23:
    s_setprio 0
    s_mov_b32 s59, 262144
G1_fb23_p:
    ds_read_b32 v248, v240 offset:16
    s_waitcnt lgkmcnt(0)
    v_cmp_lt_u32 s[56:57], v248, 50
    s_nop 0
    s_cmp_eq_u64 s[56:57], 0
    s_cbranch_scc1 G1_fb23_p_ok
    s_sleep 6
    s_sub_u32 s59, s59, 1
    s_cmp_lg_u32 s59, 0
    s_cbranch_scc1 G1_fb23_p
G1_fb23_p_ok:
    s_setprio 3
    s_branch G1_fb23_ret
G1_fb24:
    s_setprio 0
    s_mov_b32 s59, 262144
G1_fb24_p:
    ds_read_b32 v248, v240 offset:16
    s_waitcnt lgkmcnt(0)
    v_cmp_lt_u32 s[56:57], v248, 51
    s_nop 0
    s_cmp_eq_u64 s[56:57], 0
    s_cbranch_scc1 G1_fb24_p_ok
    s_sleep 6
    s_sub_u32 s59, s59, 1
    s_cmp_lg_u32 s59, 0
    s_cbranch_scc1 G1_fb24_p
G1_fb24_p_ok:
    s_setprio 3
    s_branch G1_fb24_ret
G1_g10:
    s_call_b64 s[38:39], G1_slow
    s_branch G1_g10_ret
G1_fb25:
    s_setprio 0
    s_mov_b32 s59, 262144
G1_fb25_p:
    ds_read_b32 v248, v240 offset:16
    s_waitcnt lgkmcnt(0)
    v_cmp_lt_u32 s[56:57], v248, 52
    s_nop 0
    s_cmp_eq_u64 s[56:57], 0
    s_cbranch_scc1 G1_fb25_p_ok
    s_sleep 6
    s_sub_u32 s59, s59, 1
    s_cmp_lg_u32 s59, 0
    s_cbranch_scc1 G1_fb25_p
G1_fb25_p_ok:
    s_setprio 3
    s_branch G1_fb25_ret
G1_fb26:
    s_setprio 0
    s_mov_b32 s59, 262144
G1_fb26_p:
    ds_read_b32 v248, v240 offset:16
    s_waitcnt lgkmcnt(0)
    v_cmp_lt_u32 s[56:57], v248, 53
    s_nop 0
    s_cmp_eq_u64 s[56:57], 0
    s_cbranch_scc1 G1_fb26_p_ok
    s_sleep 6
    s_sub_u32 s59, s59, 1
    s_cmp_lg_u32 s59, 0
    s_cbranch_scc1 G1_fb26_p
G1_fb26_p_ok:
    s_setprio 3
    s_branch G1_fb26_ret
G1_g11:
    s_call_b64 s[38:39], G1_slow
    s_branch G1_g11_ret
G1_fb27:
    s_setprio 0
    s_mov_b32 s59, 262144
G1_fb27_p:
    ds_read_b32 v248, v240 offset:16
    s_waitcnt lgkmcnt(0)
    v_cmp_lt_u32 s[56:57], v248, 54
    s_nop 0
    s_cmp_eq_u64 s[56:57], 0
    s_cbranch_scc1 G1_fb27_p_ok
    s_sleep 6
    s_sub_u32 s59, s59, 1
    s_cmp_lg_u32 s59, 0
    s_cbranch_scc1 G1_fb27_p
G1_fb27_p_ok:
    s_setprio 3
    s_branch G1_fb27_ret
G1_fb28:
    s_setprio 0
    s_mov_b32 s59, 262144
G1_fb28_p:
    ds_read_b32 v248, v240 offset:16
    s_waitcnt lgkmcnt(0)
    v_cmp_lt_u32 s[56:57], v248, 55
    s_nop 0
    s_cmp_eq_u64 s[56:57], 0
    s_cbranch_scc1 G1_fb28_p_ok
    s_sleep 6
    s_sub_u32 s59, s59, 1
    s_cmp_lg_u32 s59, 0
    s_cbranch_scc1 G1_fb28_p
G1_fb28_p_ok:
    s_setprio 3
    s_branch G1_fb28_ret
G1_g12:
    s_call_b64 s[38:39], G1_slow
    s_branch G1_g12_ret
G1_fb29:
    s_setprio 0
    s_mov_b32 s59, 262144
G1_fb29_p:
    ds_read_b32 v248, v240 offset:16
    s_waitcnt lgkmcnt(0)
    v_cmp_lt_u32 s[56:57], v248, 56
    s_nop 0
    s_cmp_eq_u64 s[56:57], 0
    s_cbranch_scc1 G1_fb29_p_ok
    s_sleep 6
    s_sub_u32 s59, s59, 1
    s_cmp_lg_u32 s59, 0
    s_cbranch_scc1 G1_fb29_p
G1_fb29_p_ok:
    s_setprio 3
    s_branch G1_fb29_ret
G1_fb30:
    s_setprio 0
    s_mov_b32 s59, 262144
G1_fb30_p:
    ds_read_b32 v248, v240 offset:16
    s_waitcnt lgkmcnt(0)
    v_cmp_lt_u32 s[56:57], v248, 57
    s_nop 0
    s_cmp_eq_u64 s[56:57], 0
    s_cbranch_scc1 G1_fb30_p_ok
    s_sleep 6
    s_sub_u32 s59, s59, 1
    s_cmp_lg_u32 s59, 0
    s_cbranch_scc1 G1_fb30_p
G1_fb30_p_ok:
    s_setprio 3
    s_branch G1_fb30_ret
G1_g13:
    s_call_b64 s[38:39], G1_slow
    s_branch G1_g13_ret
G1_fb32:
    s_setprio 0
    s_mov_b32 s59, 262144
G1_fb32_p:
    ds_read_b32 v248, v240 offset:16
    s_waitcnt lgkmcnt(0)
    v_cmp_lt_u32 s[56:57], v248, 59
    s_nop 0
    s_cmp_eq_u64 s[56:57], 0
    s_cbranch_scc1 G1_fb32_p_ok
    s_sleep 6
    s_sub_u32 s59, s59, 1
    s_cmp_lg_u32 s59, 0
    s_cbranch_scc1 G1_fb32_p
G1_fb32_p_ok:
    s_setprio 3
    s_branch G1_fb32_ret
G1_g14:
    s_call_b64 s[38:39], G1_slow
    s_branch G1_g14_ret
G1_g15:
    s_call_b64 s[38:39], G1_slow
    s_branch G1_g15_ret
G1_gf0:
    s_mov_b32 s59, 65536
G1_gf0_l:
    s_sleep 32
    buffer_load_dword v254, off, s[16:19], s40 offset:0 sc1
    s_waitcnt vmcnt(0)
    v_cmp_gt_u32 vcc, 16, v254
    s_nop 1
    s_cbranch_vccz G1_gf0_ret
    s_sub_u32 s59, s59, 1
    s_cmp_lg_u32 s59, 0
    s_cbranch_scc1 G1_gf0_l
    s_branch G1_gf0_ret
G1_fr2:
    s_mov_b32 s59, 262144
G1_fr2_p:
    ds_read_b32 v254, v255 offset:112
    s_waitcnt lgkmcnt(0)
    v_cmp_lt_u32 s[56:57], v254, 1
    s_nop 0
    s_cmp_eq_u64 s[56:57], 0
    s_cbranch_scc1 G1_fr2_p_ok
    s_sleep 1
    s_sub_u32 s59, s59, 1
    s_cmp_lg_u32 s59, 0
    s_cbranch_scc1 G1_fr2_p
G1_fr2_p_ok:
    s_branch G1_fr2_ret
G1_fr3:
    s_mov_b32 s59, 262144
G1_fr3_p:
    ds_read_b32 v254, v255 offset:112
    s_waitcnt lgkmcnt(0)
    v_cmp_lt_u32 s[56:57], v254, 2
    s_nop 0
    s_cmp_eq_u64 s[56:57], 0
    s_cbranch_scc1 G1_fr3_p_ok
    s_sleep 1
    s_sub_u32 s59, s59, 1
    s_cmp_lg_u32 s59, 0
    s_cbranch_scc1 G1_fr3_p
G1_fr3_p_ok:
    s_branch G1_fr3_ret
G1_fr4:
    s_mov_b32 s59, 262144
G1_fr4_p:
    ds_read_b32 v254, v255 offset:112
    s_waitcnt lgkmcnt(0)
    v_cmp_lt_u32 s[56:57], v254, 3
    s_nop 0
    s_cmp_eq_u64 s[56:57], 0
    s_cbranch_scc1 G1_fr4_p_ok
    s_sleep 1
    s_sub_u32 s59, s59, 1
    s_cmp_lg_u32 s59, 0
    s_cbranch_scc1 G1_fr4_p
G1_fr4_p_ok:
    s_branch G1_fr4_ret
G1_fr5:
    s_mov_b32 s59, 262144
G1_fr5_p:
    ds_read_b32 v254, v255 offset:112
    s_waitcnt lgkmcnt(0)
    v_cmp_lt_u32 s[56:57], v254, 4
    s_nop 0
    s_cmp_eq_u64 s[56:57], 0
    s_cbranch_scc1 G1_fr5_p_ok
    s_sleep 1
    s_sub_u32 s59, s59, 1
    s_cmp_lg_u32 s59, 0
    s_cbranch_scc1 G1_fr5_p
G1_fr5_p_ok:
    s_branch G1_fr5_ret
G1_fr6:
    s_mov_b32 s59, 262144
G1_fr6_p:
    ds_read_b32 v254, v255 offset:112
    s_waitcnt lgkmcnt(0)
    v_cmp_lt_u32 s[56:57], v254, 5
    s_nop 0
    s_cmp_eq_u64 s[56:57], 0
    s_cbranch_scc1 G1_fr6_p_ok
    s_sleep 1
    s_sub_u32 s59, s59, 1
    s_cmp_lg_u32 s59, 0
    s_cbranch_scc1 G1_fr6_p
G1_fr6_p_ok:
    s_branch G1_fr6_ret
G1_gwb:
    s_mov_b32 s59, 65536
G1_gwb_p:
    global_load_dword v254, v233, s[36:37] sc1
    s_waitcnt vmcnt(0)
    v_cmp_eq_u32 vcc, 0, v254
    s_nop 1
    s_cbranch_vccz G1_gwb_p_ok
    s_sleep 8
    s_sub_u32 s59, s59, 1
    s_cmp_lg_u32 s59, 0
    s_cbranch_scc1 G1_gwb_p
G1_gwb_p_ok:
    s_branch G1_gwb_ret
G1_fr7:
    s_mov_b32 s59, 262144
G1_fr7_p:
    ds_read_b32 v254, v255 offset:112
    s_waitcnt lgkmcnt(0)
    v_cmp_lt_u32 s[56:57], v254, 6
    s_nop 0
    s_cmp_eq_u64 s[56:57], 0
    s_cbranch_scc1 G1_fr7_p_ok
    s_sleep 1
    s_sub_u32 s59, s59, 1
    s_cmp_lg_u32 s59, 0
    s_cbranch_scc1 G1_fr7_p
G1_fr7_p_ok:
    s_branch G1_fr7_ret
G1_fr8:
    s_mov_b32 s59, 262144
G1_fr8_p:
    ds_read_b32 v254, v255 offset:112
    s_waitcnt lgkmcnt(0)
    v_cmp_lt_u32 s[56:57], v254, 7
    s_nop 0
    s_cmp_eq_u64 s[56:57], 0
    s_cbranch_scc1 G1_fr8_p_ok
    s_sleep 1
    s_sub_u32 s59, s59, 1
    s_cmp_lg_u32 s59, 0
    s_cbranch_scc1 G1_fr8_p
G1_fr8_p_ok:
    s_branch G1_fr8_ret
G1_fr9:
    s_mov_b32 s59, 262144
G1_fr9_p:
    ds_read_b32 v254, v255 offset:112
    s_waitcnt lgkmcnt(0)
    v_cmp_lt_u32 s[56:57], v254, 8
    s_nop 0
    s_cmp_eq_u64 s[56:57], 0
    s_cbranch_scc1 G1_fr9_p_ok
    s_sleep 1
    s_sub_u32 s59, s59, 1
    s_cmp_lg_u32 s59, 0
    s_cbranch_scc1 G1_fr9_p
G1_fr9_p_ok:
    s_branch G1_fr9_ret
G1_fr10:
    s_mov_b32 s59, 262144
G1_fr10_p:
    ds_read_b32 v254, v255 offset:112
    s_waitcnt lgkmcnt(0)
    v_cmp_lt_u32 s[56:57], v254, 9
    s_nop 0
    s_cmp_eq_u64 s[56:57], 0
    s_cbranch_scc1 G1_fr10_p_ok
    s_sleep 1
    s_sub_u32 s59, s59, 1
    s_cmp_lg_u32 s59, 0
    s_cbranch_scc1 G1_fr10_p
G1_fr10_p_ok:
    s_branch G1_fr10_ret
G1_fr11:
    s_mov_b32 s59, 262144
G1_fr11_p:
    ds_read_b32 v254, v255 offset:112
    s_waitcnt lgkmcnt(0)
    v_cmp_lt_u32 s[56:57], v254, 10
    s_nop 0
    s_cmp_eq_u64 s[56:57], 0
    s_cbranch_scc1 G1_fr11_p_ok
    s_sleep 1
    s_sub_u32 s59, s59, 1
    s_cmp_lg_u32 s59, 0
    s_cbranch_scc1 G1_fr11_p
G1_fr11_p_ok:
    s_branch G1_fr11_ret
G1_slow:
    v_mov_b32 v218, v217
    s_nop 1
    v_permlane32_swap_b32 v218, v217
    v_max_f32 v217, v217, v218
    v_mov_b32 v218, v217
    s_nop 1
    v_permlane16_swap_b32 v218, v217
    v_max_f32 v217, v217, v218
    v_max_f32 v217, 0, v217
    v_sub_f32 v212, v212, v217
    v_sub_f32 v176, v176, v217
    v_sub_f32 v213, v213, v217
    v_sub_f32 v177, v177, v217
    v_sub_f32 v214, v214, v217
    v_sub_f32 v178, v178, v217
    v_sub_f32 v215, v215, v217
    v_sub_f32 v179, v179, v217
    v_exp_f32 v217, -v217
    s_nop 0
    v_mul_f32 v216, v216, v217
    v_mul_f32 v128, v128, v217
    v_mul_f32 v129, v129, v217
    v_mul_f32 v130, v130, v217
    v_mul_f32 v131, v131, v217
    v_mul_f32 v132, v132, v217
    v_mul_f32 v133, v133, v217
    v_mul_f32 v134, v134, v217
    v_mul_f32 v135, v135, v217
    v_mul_f32 v136, v136, v217
    v_mul_f32 v137, v137, v217
    v_mul_f32 v138, v138, v217
    v_mul_f32 v139, v139, v217
    v_mul_f32 v140, v140, v217
    v_mul_f32 v141, v141, v217
    v_mul_f32 v142, v142, v217
    v_mul_f32 v143, v143, v217
    v_mul_f32 v144, v144, v217
    v_mul_f32 v145, v145, v217
    v_mul_f32 v146, v146, v217
    v_mul_f32 v147, v147, v217
    v_mul_f32 v148, v148, v217
    v_mul_f32 v149, v149, v217
    v_mul_f32 v150, v150, v217
    v_mul_f32 v151, v151, v217
    v_mul_f32 v152, v152, v217
    v_mul_f32 v153, v153, v217
    v_mul_f32 v154, v154, v217
    v_mul_f32 v155, v155, v217
    v_mul_f32 v156, v156, v217
    v_mul_f32 v157, v157, v217
    v_mul_f32 v158, v158, v217
    v_mul_f32 v159, v159, v217
    s_nop 1
    s_setpc_b64 s[38:39]
G0_start:
    s_setprio 2
    v_and_b32 v217, 63, v0
    v_mov_b32 v218, 0
    v_lshlrev_b32 v219, 2, v217
    v_add_u32 v219, 163584, v219
    ds_write_b32 v219, v218
    s_lshl_b32 s44, s24, 2
    s_add_u32 s44, s44, 163584
    v_mov_b32 v250, s44
    v_and_b32 v251, 0xfffffe0c, v219
    v_or_b32 v251, 256, v251
    s_waitcnt lgkmcnt(0)
    s_barrier
    s_mul_i32 s44, s27, 36864
    s_add_u32 s20, s36, s44
    s_addc_u32 s21, s37, 0
    s_mov_b32 s22, 73728
    s_mov_b32 s23, 0x20000
    v_and_b32 v218, 15, v217
    v_lshrrev_b32 v219, 4, v217
    v_and_b32 v220, 7, v218
    v_lshlrev_b32 v220, 1, v220
    v_xor_b32 v220, v220, v219
    v_lshlrev_b32 v220, 4, v220
    v_lshl_add_u32 v238, v218, 8, v220
    v_xor_b32 v239, 64, v238
    v_xor_b32 v240, 128, v238
    v_xor_b32 v241, 192, v238
    v_and_b32 v221, 3, v217
    v_lshlrev_b32 v221, 3, v221
    v_lshrrev_b32 v220, 2, v217
    v_lshl_add_u32 v242, v220, 8, v221
    v_and_b32 v220, 7, v220
    v_lshl_add_u32 v242, v220, 5, v242
    v_add_u32 v242, 49152, v242
    v_xor_b32 v243, 32, v242
    v_xor_b32 v244, 64, v242
    v_xor_b32 v245, 96, v242
    v_xor_b32 v246, 128, v242
    v_xor_b32 v247, 160, v242
    v_xor_b32 v248, 192, v242
    v_xor_b32 v249, 224, v242
    v_lshrrev_b32 v220, 2, v218
    v_and_b32 v220, 2, v220
    v_xor_b32 v220, v220, v219
    v_lshlrev_b32 v220, 4, v220
    v_lshl_add_u32 v220, v218, 6, v220
    v_add_u32 v216, 98304, v220
    v_bfe_u32 v220, v217, 2, 2
    v_lshl_add_u32 v218, v219, 3, v220
    v_lshl_add_u32 v218, v218, 8, v221
    v_lshl_add_u32 v218, v220, 5, v218
    v_and_b32 v219, 1, v219
    v_lshl_add_u32 v218, v219, 7, v218
    s_and_b32 s48, s24, 1
    s_lshl_b32 s48, s48, 7
    v_xor_b32 v218, s48, v218
    s_lshr_b32 s49, s24, 1
    s_lshl_b32 s44, s49, 13
    v_add_u32 v208, s44, v218
    v_xor_b32 v209, 32, v208
    v_xor_b32 v210, 64, v208
    v_xor_b32 v211, 96, v208
    v_add_u32 v212, 49152, v208
    v_add_u32 v213, 49152, v209
    v_add_u32 v214, 49152, v210
    v_add_u32 v215, 49152, v211
    s_mov_b32 s59, 262144
G0_first:
    ds_read_b32 v252, v251 offset:0
    s_waitcnt lgkmcnt(0)
    v_cmp_lt_u32 s[56:57], v252, 1
    s_nop 0
    s_cmp_eq_u64 s[56:57], 0
    s_cbranch_scc1 G0_first_ok
    s_sleep 1
    s_sub_u32 s59, s59, 1
    s_cmp_lg_u32 s59, 0
    s_cbranch_scc1 G0_first
G0_first_ok:
    ds_read_b64_tr_b16 v[144:145], v212 offset:16384
    ds_read_b64_tr_b16 v[146:147], v212 offset:17408
    ds_read_b64_tr_b16 v[148:149], v213 offset:16384
    ds_read_b64_tr_b16 v[150:151], v213 offset:17408
    ds_read_b64_tr_b16 v[152:153], v214 offset:16384
    ds_read_b64_tr_b16 v[154:155], v214 offset:17408
    ds_read_b64_tr_b16 v[156:157], v215 offset:16384
    ds_read_b64_tr_b16 v[158:159], v215 offset:17408
    ds_read_b128 v[176:179], v216 offset:0
    ds_read_b128 v[180:183], v216 offset:1024
    ds_read_b128 v[184:187], v216 offset:2048
    ds_read_b128 v[188:191], v216 offset:3072
    ds_read_b128 v[192:195], v216 offset:4096
    ds_read_b128 v[196:199], v216 offset:5120
    s_mov_b32 s50, 0x3e0293ee
    v_and_b32 v219, 15, v217
    v_lshlrev_b32 v222, 4, v219
    v_lshrrev_b32 v219, 5, v217
    v_lshl_add_u32 v222, v219, 8, v222
    v_bfe_u32 v219, v217, 4, 1
    v_lshl_add_u32 v222, v219, 3, v222
    s_mul_i32 s44, s49, 36864
    s_lshl_b32 s45, s48, 4
    s_add_u32 s44, s44, s45
    s_add_u32 s44, s44, 89856
    v_add_u32 v222, s44, v222
    s_waitcnt lgkmcnt(5)
    v_mfma_f32_16x16x32_bf16 v[0:3], v[144:147], v[176:179], 0
    ds_read_b32 v252, v251 offset:0
    v_mfma_f32_16x16x32_bf16 v[4:7], v[148:151], v[176:179], 0
    v_mfma_f32_16x16x32_bf16 v[8:11], v[152:155], v[176:179], 0
    ds_read_b128 v[200:203], v216 offset:6144
    v_mfma_f32_16x16x32_bf16 v[12:15], v[156:159], v[176:179], 0
    s_waitcnt lgkmcnt(6)
    v_mfma_f32_16x16x32_bf16 v[16:19], v[144:147], v[180:183], 0
    ds_read_b128 v[204:207], v216 offset:7168
    v_mfma_f32_16x16x32_bf16 v[20:23], v[148:151], v[180:183], 0
    v_mfma_f32_16x16x32_bf16 v[24:27], v[152:155], v[180:183], 0
    v_mfma_f32_16x16x32_bf16 v[28:31], v[156:159], v[180:183], 0
    s_waitcnt lgkmcnt(6)
    v_mfma_f32_16x16x32_bf16 v[32:35], v[144:147], v[184:187], 0
    ds_read_b128 v[176:179], v216 offset:8192
    v_mfma_f32_16x16x32_bf16 v[36:39], v[148:151], v[184:187], 0
    v_mfma_f32_16x16x32_bf16 v[40:43], v[152:155], v[184:187], 0
    s_waitcnt lgkmcnt(3)
    v_cmp_lt_u32 s[56:57], v252, 2
    v_mfma_f32_16x16x32_bf16 v[44:47], v[156:159], v[184:187], 0
    v_mfma_f32_16x16x32_bf16 v[48:51], v[144:147], v[188:191], 0
    s_cmp_eq_u64 s[56:57], 0
    s_cbranch_scc0 G0_qs1
G0_qs1_ret:
    ds_read_b128 v[180:183], v216 offset:9216
    v_mfma_f32_16x16x32_bf16 v[52:55], v[148:151], v[188:191], 0
    ds_read_b64_tr_b16 v[160:161], v212 offset:32768
    v_mfma_f32_16x16x32_bf16 v[56:59], v[152:155], v[188:191], 0
    ds_read_b64_tr_b16 v[162:163], v212 offset:33792
    v_mfma_f32_16x16x32_bf16 v[60:63], v[156:159], v[188:191], 0
    v_mfma_f32_16x16x32_bf16 v[64:67], v[144:147], v[192:195], 0
    ds_read_b128 v[184:187], v216 offset:10240
    v_mfma_f32_16x16x32_bf16 v[68:71], v[148:151], v[192:195], 0
    ds_read_b64_tr_b16 v[164:165], v213 offset:32768
    v_mfma_f32_16x16x32_bf16 v[72:75], v[152:155], v[192:195], 0
    ds_read_b64_tr_b16 v[166:167], v213 offset:33792
    v_mfma_f32_16x16x32_bf16 v[76:79], v[156:159], v[192:195], 0
    v_mfma_f32_16x16x32_bf16 v[80:83], v[144:147], v[196:199], 0
    ds_read_b128 v[188:191], v216 offset:11264
    v_mfma_f32_16x16x32_bf16 v[84:87], v[148:151], v[196:199], 0
    ds_read_b64_tr_b16 v[168:169], v214 offset:32768
    v_mfma_f32_16x16x32_bf16 v[88:91], v[152:155], v[196:199], 0
    ds_read_b64_tr_b16 v[170:171], v214 offset:33792
    v_mfma_f32_16x16x32_bf16 v[92:95], v[156:159], v[196:199], 0
    s_waitcnt lgkmcnt(11)
    v_mfma_f32_16x16x32_bf16 v[96:99], v[144:147], v[200:203], 0
    ds_read_b128 v[192:195], v216 offset:12288
    v_mfma_f32_16x16x32_bf16 v[100:103], v[148:151], v[200:203], 0
    ds_read_b64_tr_b16 v[172:173], v215 offset:32768
    v_mfma_f32_16x16x32_bf16 v[104:107], v[152:155], v[200:203], 0
    ds_read_b64_tr_b16 v[174:175], v215 offset:33792
    v_mfma_f32_16x16x32_bf16 v[108:111], v[156:159], v[200:203], 0
    s_waitcnt lgkmcnt(13)
    v_mfma_f32_16x16x32_bf16 v[112:115], v[144:147], v[204:207], 0
    ds_read_b128 v[196:199], v216 offset:13312
    v_mfma_f32_16x16x32_bf16 v[116:119], v[148:151], v[204:207], 0
    v_mfma_f32_16x16x32_bf16 v[120:123], v[152:155], v[204:207], 0
    v_mfma_f32_16x16x32_bf16 v[124:127], v[156:159], v[204:207], 0
    s_waitcnt lgkmcnt(13)
    v_mfma_f32_16x16x32_bf16 v[128:131], v[144:147], v[176:179], 0
    ds_read_b128 v[200:203], v216 offset:14336
    v_mfma_f32_16x16x32_bf16 v[132:135], v[148:151], v[176:179], 0
    v_mfma_f32_16x16x32_bf16 v[136:139], v[152:155], v[176:179], 0
    v_mfma_f32_16x16x32_bf16 v[140:143], v[156:159], v[176:179], 0
    s_waitcnt lgkmcnt(11)
    v_mfma_f32_16x16x32_bf16 v[0:3], v[160:163], v[180:183], v[0:3]
    ds_read_b32 v252, v251 offset:0
    s_waitcnt lgkmcnt(9)
    v_mfma_f32_16x16x32_bf16 v[4:7], v[164:167], v[180:183], v[4:7]
    s_waitcnt lgkmcnt(6)
    v_mfma_f32_16x16x32_bf16 v[8:11], v[168:171], v[180:183], v[8:11]
    ds_read_b128 v[204:207], v216 offset:15360
    s_waitcnt lgkmcnt(4)
    v_mfma_f32_16x16x32_bf16 v[12:15], v[172:175], v[180:183], v[12:15]
    v_mfma_f32_16x16x32_bf16 v[16:19], v[160:163], v[184:187], v[16:19]
    ds_read_b128 v[176:179], v216 offset:16384
    v_mfma_f32_16x16x32_bf16 v[20:23], v[164:167], v[184:187], v[20:23]
    v_mfma_f32_16x16x32_bf16 v[24:27], v[168:171], v[184:187], v[24:27]
    v_mov_b32 v237, 2
    v_mfma_f32_16x16x32_bf16 v[28:31], v[172:175], v[184:187], v[28:31]
    v_mfma_f32_16x16x32_bf16 v[32:35], v[160:163], v[188:191], v[32:35]
    ds_read_b128 v[180:183], v216 offset:17408
    v_mfma_f32_16x16x32_bf16 v[36:39], v[164:167], v[188:191], v[36:39]
    s_waitcnt lgkmcnt(3)
    v_cmp_lt_u32 s[56:57], v252, 3
    v_mfma_f32_16x16x32_bf16 v[40:43], v[168:171], v[188:191], v[40:43]
    ds_write_b32 v250, v237 offset:16
    v_mfma_f32_16x16x32_bf16 v[44:47], v[172:175], v[188:191], v[44:47]
    v_mfma_f32_16x16x32_bf16 v[48:51], v[160:163], v[192:195], v[48:51]
    s_cmp_eq_u64 s[56:57], 0
    s_cbranch_scc0 G0_qs2
G0_qs2_ret:
    ds_read_b128 v[184:187], v216 offset:18432
    v_mfma_f32_16x16x32_bf16 v[52:55], v[164:167], v[192:195], v[52:55]
    ds_read_b64_tr_b16 v[144:145], v208 offset:0
    v_mfma_f32_16x16x32_bf16 v[56:59], v[168:171], v[192:195], v[56:59]
    ds_read_b64_tr_b16 v[146:147], v208 offset:1024
    v_mfma_f32_16x16x32_bf16 v[60:63], v[172:175], v[192:195], v[60:63]
    v_mfma_f32_16x16x32_bf16 v[64:67], v[160:163], v[196:199], v[64:67]
    ds_read_b128 v[188:191], v216 offset:19456
    v_mfma_f32_16x16x32_bf16 v[68:71], v[164:167], v[196:199], v[68:71]
    ds_read_b64_tr_b16 v[148:149], v209 offset:0
    v_mfma_f32_16x16x32_bf16 v[72:75], v[168:171], v[196:199], v[72:75]
    ds_read_b64_tr_b16 v[150:151], v209 offset:1024
    v_mfma_f32_16x16x32_bf16 v[76:79], v[172:175], v[196:199], v[76:79]
    v_mfma_f32_16x16x32_bf16 v[80:83], v[160:163], v[200:203], v[80:83]
    ds_read_b128 v[192:195], v216 offset:20480
    v_mfma_f32_16x16x32_bf16 v[84:87], v[164:167], v[200:203], v[84:87]
    ds_read_b64_tr_b16 v[152:153], v210 offset:0
    v_mfma_f32_16x16x32_bf16 v[88:91], v[168:171], v[200:203], v[88:91]
    ds_read_b64_tr_b16 v[154:155], v210 offset:1024
    v_mfma_f32_16x16x32_bf16 v[92:95], v[172:175], v[200:203], v[92:95]
    s_waitcnt lgkmcnt(12)
    v_mfma_f32_16x16x32_bf16 v[96:99], v[160:163], v[204:207], v[96:99]
    ds_read_b128 v[196:199], v216 offset:21504
    v_mfma_f32_16x16x32_bf16 v[100:103], v[164:167], v[204:207], v[100:103]
    ds_read_b64_tr_b16 v[156:157], v211 offset:0
    v_mfma_f32_16x16x32_bf16 v[104:107], v[168:171], v[204:207], v[104:107]
    ds_read_b64_tr_b16 v[158:159], v211 offset:1024
    v_mfma_f32_16x16x32_bf16 v[108:111], v[172:175], v[204:207], v[108:111]
    s_waitcnt lgkmcnt(14)
    v_mfma_f32_16x16x32_bf16 v[112:115], v[160:163], v[176:179], v[112:115]
    ds_read_b128 v[200:203], v216 offset:22528
    v_mfma_f32_16x16x32_bf16 v[116:119], v[164:167], v[176:179], v[116:119]
    v_mfma_f32_16x16x32_bf16 v[120:123], v[168:171], v[176:179], v[120:123]
    v_mfma_f32_16x16x32_bf16 v[124:127], v[172:175], v[176:179], v[124:127]
    s_waitcnt lgkmcnt(14)
    v_mfma_f32_16x16x32_bf16 v[128:131], v[160:163], v[180:183], v[128:131]
    ds_read_b128 v[204:207], v216 offset:23552
    v_mfma_f32_16x16x32_bf16 v[132:135], v[164:167], v[180:183], v[132:135]
    v_mfma_f32_16x16x32_bf16 v[136:139], v[168:171], v[180:183], v[136:139]
    v_mfma_f32_16x16x32_bf16 v[140:143], v[172:175], v[180:183], v[140:143]
    s_waitcnt lgkmcnt(11)
    v_mfma_f32_16x16x32_bf16 v[0:3], v[144:147], v[184:187], v[0:3]
    ds_read_b32 v252, v251 offset:0
    s_waitcnt lgkmcnt(9)
    v_mfma_f32_16x16x32_bf16 v[4:7], v[148:151], v[184:187], v[4:7]
    s_waitcnt lgkmcnt(6)
    v_mfma_f32_16x16x32_bf16 v[8:11], v[152:155], v[184:187], v[8:11]
    ds_read_b128 v[176:179], v216 offset:24576
    s_waitcnt lgkmcnt(4)
    v_mfma_f32_16x16x32_bf16 v[12:15], v[156:159], v[184:187], v[12:15]
    v_mfma_f32_16x16x32_bf16 v[16:19], v[144:147], v[188:191], v[16:19]
    ds_read_b128 v[180:183], v216 offset:25600
    v_mfma_f32_16x16x32_bf16 v[20:23], v[148:151], v[188:191], v[20:23]
    v_mfma_f32_16x16x32_bf16 v[24:27], v[152:155], v[188:191], v[24:27]
    v_mfma_f32_16x16x32_bf16 v[28:31], v[156:159], v[188:191], v[28:31]
    v_mfma_f32_16x16x32_bf16 v[32:35], v[144:147], v[192:195], v[32:35]
    ds_read_b128 v[184:187], v216 offset:26624
    v_mfma_f32_16x16x32_bf16 v[36:39], v[148:151], v[192:195], v[36:39]
    v_mfma_f32_16x16x32_bf16 v[40:43], v[152:155], v[192:195], v[40:43]
    s_waitcnt lgkmcnt(3)
    v_cmp_lt_u32 s[56:57], v252, 4
    v_mfma_f32_16x16x32_bf16 v[44:47], v[156:159], v[192:195], v[44:47]
    v_mfma_f32_16x16x32_bf16 v[48:51], v[144:147], v[196:199], v[48:51]
    s_cmp_eq_u64 s[56:57], 0
    s_cbranch_scc0 G0_qs3
G0_qs3_ret:
    ds_read_b128 v[188:191], v216 offset:27648
    v_mfma_f32_16x16x32_bf16 v[52:55], v[148:151], v[196:199], v[52:55]
    ds_read_b64_tr_b16 v[160:161], v208 offset:16384
    v_mfma_f32_16x16x32_bf16 v[56:59], v[152:155], v[196:199], v[56:59]
    ds_read_b64_tr_b16 v[162:163], v208 offset:17408
    v_mfma_f32_16x16x32_bf16 v[60:63], v[156:159], v[196:199], v[60:63]
    v_mfma_f32_16x16x32_bf16 v[64:67], v[144:147], v[200:203], v[64:67]
    ds_read_b128 v[192:195], v216 offset:28672
    v_mfma_f32_16x16x32_bf16 v[68:71], v[148:151], v[200:203], v[68:71]
    ds_read_b64_tr_b16 v[164:165], v209 offset:16384
    v_mfma_f32_16x16x32_bf16 v[72:75], v[152:155], v[200:203], v[72:75]
    ds_read_b64_tr_b16 v[166:167], v209 offset:17408
    v_mfma_f32_16x16x32_bf16 v[76:79], v[156:159], v[200:203], v[76:79]
    v_mfma_f32_16x16x32_bf16 v[80:83], v[144:147], v[204:207], v[80:83]
    ds_read_b128 v[196:199], v216 offset:29696
    v_mfma_f32_16x16x32_bf16 v[84:87], v[148:151], v[204:207], v[84:87]
    ds_read_b64_tr_b16 v[168:169], v210 offset:16384
    v_mfma_f32_16x16x32_bf16 v[88:91], v[152:155], v[204:207], v[88:91]
    ds_read_b64_tr_b16 v[170:171], v210 offset:17408
    v_mfma_f32_16x16x32_bf16 v[92:95], v[156:159], v[204:207], v[92:95]
    s_waitcnt lgkmcnt(11)
    v_mfma_f32_16x16x32_bf16 v[96:99], v[144:147], v[176:179], v[96:99]
    ds_read_b128 v[200:203], v216 offset:30720
    v_mfma_f32_16x16x32_bf16 v[100:103], v[148:151], v[176:179], v[100:103]
    ds_read_b64_tr_b16 v[172:173], v211 offset:16384
    v_mfma_f32_16x16x32_bf16 v[104:107], v[152:155], v[176:179], v[104:107]
    ds_read_b64_tr_b16 v[174:175], v211 offset:17408
    v_mfma_f32_16x16x32_bf16 v[108:111], v[156:159], v[176:179], v[108:111]
    s_waitcnt lgkmcnt(13)
    v_mfma_f32_16x16x32_bf16 v[112:115], v[144:147], v[180:183], v[112:115]
    ds_read_b128 v[204:207], v216 offset:31744
    v_mfma_f32_16x16x32_bf16 v[116:119], v[148:151], v[180:183], v[116:119]
    v_mfma_f32_16x16x32_bf16 v[120:123], v[152:155], v[180:183], v[120:123]
    v_mfma_f32_16x16x32_bf16 v[124:127], v[156:159], v[180:183], v[124:127]
    s_waitcnt lgkmcnt(13)
    v_mfma_f32_16x16x32_bf16 v[128:131], v[144:147], v[184:187], v[128:131]
    ds_read_b128 v[176:179], v216 offset:32768
    v_mfma_f32_16x16x32_bf16 v[132:135], v[148:151], v[184:187], v[132:135]
    v_mfma_f32_16x16x32_bf16 v[136:139], v[152:155], v[184:187], v[136:139]
    v_mfma_f32_16x16x32_bf16 v[140:143], v[156:159], v[184:187], v[140:143]
    s_waitcnt lgkmcnt(11)
    v_mfma_f32_16x16x32_bf16 v[0:3], v[160:163], v[188:191], v[0:3]
    ds_read_b32 v252, v251 offset:0
    s_waitcnt lgkmcnt(9)
    v_mfma_f32_16x16x32_bf16 v[4:7], v[164:167], v[188:191], v[4:7]
    s_waitcnt lgkmcnt(6)
    v_mfma_f32_16x16x32_bf16 v[8:11], v[168:171], v[188:191], v[8:11]
    ds_read_b128 v[180:183], v216 offset:33792
    s_waitcnt lgkmcnt(4)
    v_mfma_f32_16x16x32_bf16 v[12:15], v[172:175], v[188:191], v[12:15]
    v_mfma_f32_16x16x32_bf16 v[16:19], v[160:163], v[192:195], v[16:19]
    ds_read_b128 v[184:187], v216 offset:34816
    v_mfma_f32_16x16x32_bf16 v[20:23], v[164:167], v[192:195], v[20:23]
    v_mfma_f32_16x16x32_bf16 v[24:27], v[168:171], v[192:195], v[24:27]
    v_mov_b32 v237, 4
    v_mfma_f32_16x16x32_bf16 v[28:31], v[172:175], v[192:195], v[28:31]
    v_mfma_f32_16x16x32_bf16 v[32:35], v[160:163], v[196:199], v[32:35]
    ds_read_b128 v[188:191], v216 offset:35840
    v_mfma_f32_16x16x32_bf16 v[36:39], v[164:167], v[196:199], v[36:39]
    s_waitcnt lgkmcnt(3)
    v_cmp_lt_u32 s[56:57], v252, 5
    v_mfma_f32_16x16x32_bf16 v[40:43], v[168:171], v[196:199], v[40:43]
    ds_write_b32 v250, v237 offset:16
    v_mfma_f32_16x16x32_bf16 v[44:47], v[172:175], v[196:199], v[44:47]
    v_mfma_f32_16x16x32_bf16 v[48:51], v[160:163], v[200:203], v[48:51]
    s_cmp_eq_u64 s[56:57], 0
    s_cbranch_scc0 G0_qs4
G0_qs4_ret:
    ds_read_b128 v[192:195], v216 offset:36864
    v_mfma_f32_16x16x32_bf16 v[52:55], v[164:167], v[200:203], v[52:55]
    ds_read_b64_tr_b16 v[144:145], v208 offset:49152
    v_mfma_f32_16x16x32_bf16 v[56:59], v[168:171], v[200:203], v[56:59]
    ds_read_b64_tr_b16 v[146:147], v208 offset:50176
    v_mfma_f32_16x16x32_bf16 v[60:63], v[172:175], v[200:203], v[60:63]
    v_mfma_f32_16x16x32_bf16 v[64:67], v[160:163], v[204:207], v[64:67]
    ds_read_b128 v[196:199], v216 offset:37888
    v_mfma_f32_16x16x32_bf16 v[68:71], v[164:167], v[204:207], v[68:71]
    ds_read_b64_tr_b16 v[148:149], v209 offset:49152
    v_mfma_f32_16x16x32_bf16 v[72:75], v[168:171], v[204:207], v[72:75]
    ds_read_b64_tr_b16 v[150:151], v209 offset:50176
    v_mfma_f32_16x16x32_bf16 v[76:79], v[172:175], v[204:207], v[76:79]
    v_mfma_f32_16x16x32_bf16 v[80:83], v[160:163], v[176:179], v[80:83]
    ds_read_b128 v[200:203], v216 offset:38912
    v_mfma_f32_16x16x32_bf16 v[84:87], v[164:167], v[176:179], v[84:87]
    ds_read_b64_tr_b16 v[152:153], v210 offset:49152
    v_mfma_f32_16x16x32_bf16 v[88:91], v[168:171], v[176:179], v[88:91]
    ds_read_b64_tr_b16 v[154:155], v210 offset:50176
    v_mfma_f32_16x16x32_bf16 v[92:95], v[172:175], v[176:179], v[92:95]
    s_waitcnt lgkmcnt(12)
    v_mfma_f32_16x16x32_bf16 v[96:99], v[160:163], v[180:183], v[96:99]
    ds_read_b128 v[204:207], v216 offset:39936
    v_mfma_f32_16x16x32_bf16 v[100:103], v[164:167], v[180:183], v[100:103]
    ds_read_b64_tr_b16 v[156:157], v211 offset:49152
    v_mfma_f32_16x16x32_bf16 v[104:107], v[168:171], v[180:183], v[104:107]
    ds_read_b64_tr_b16 v[158:159], v211 offset:50176
    v_mfma_f32_16x16x32_bf16 v[108:111], v[172:175], v[180:183], v[108:111]
    s_waitcnt lgkmcnt(14)
    v_mfma_f32_16x16x32_bf16 v[112:115], v[160:163], v[184:187], v[112:115]
    ds_read_b128 v[176:179], v216 offset:40960
    v_mfma_f32_16x16x32_bf16 v[116:119], v[164:167], v[184:187], v[116:119]
    v_mfma_f32_16x16x32_bf16 v[120:123], v[168:171], v[184:187], v[120:123]
    v_mfma_f32_16x16x32_bf16 v[124:127], v[172:175], v[184:187], v[124:127]
    s_waitcnt lgkmcnt(14)
    v_mfma_f32_16x16x32_bf16 v[128:131], v[160:163], v[188:191], v[128:131]
    ds_read_b128 v[180:183], v216 offset:41984
    v_mfma_f32_16x16x32_bf16 v[132:135], v[164:167], v[188:191], v[132:135]
    v_mfma_f32_16x16x32_bf16 v[136:139], v[168:171], v[188:191], v[136:139]
    v_mfma_f32_16x16x32_bf16 v[140:143], v[172:175], v[188:191], v[140:143]
    s_waitcnt lgkmcnt(11)
    v_mfma_f32_16x16x32_bf16 v[0:3], v[144:147], v[192:195], v[0:3]
    ds_read_b32 v252, v251 offset:0
    s_waitcnt lgkmcnt(9)
    v_mfma_f32_16x16x32_bf16 v[4:7], v[148:151], v[192:195], v[4:7]
    s_waitcnt lgkmcnt(6)
    v_mfma_f32_16x16x32_bf16 v[8:11], v[152:155], v[192:195], v[8:11]
    ds_read_b128 v[184:187], v216 offset:43008
    s_waitcnt lgkmcnt(4)
    v_mfma_f32_16x16x32_bf16 v[12:15], v[156:159], v[192:195], v[12:15]
    v_mfma_f32_16x16x32_bf16 v[16:19], v[144:147], v[196:199], v[16:19]
    ds_read_b128 v[188:191], v216 offset:44032
    v_mfma_f32_16x16x32_bf16 v[20:23], v[148:151], v[196:199], v[20:23]
    v_mfma_f32_16x16x32_bf16 v[24:27], v[152:155], v[196:199], v[24:27]
    v_mfma_f32_16x16x32_bf16 v[28:31], v[156:159], v[196:199], v[28:31]
    v_mfma_f32_16x16x32_bf16 v[32:35], v[144:147], v[200:203], v[32:35]
    ds_read_b128 v[192:195], v216 offset:45056
    v_mfma_f32_16x16x32_bf16 v[36:39], v[148:151], v[200:203], v[36:39]
    v_mfma_f32_16x16x32_bf16 v[40:43], v[152:155], v[200:203], v[40:43]
    s_waitcnt lgkmcnt(3)
    v_cmp_lt_u32 s[56:57], v252, 6
    v_mfma_f32_16x16x32_bf16 v[44:47], v[156:159], v[200:203], v[44:47]
    v_mfma_f32_16x16x32_bf16 v[48:51], v[144:147], v[204:207], v[48:51]
    s_cmp_eq_u64 s[56:57], 0
    s_cbranch_scc0 G0_qs5
G0_qs5_ret:
    ds_read_b128 v[196:199], v216 offset:46080
    v_mfma_f32_16x16x32_bf16 v[52:55], v[148:151], v[204:207], v[52:55]
    ds_read_b64_tr_b16 v[160:161], v208 offset:32768
    v_mfma_f32_16x16x32_bf16 v[56:59], v[152:155], v[204:207], v[56:59]
    ds_read_b64_tr_b16 v[162:163], v208 offset:33792
    v_mfma_f32_16x16x32_bf16 v[60:63], v[156:159], v[204:207], v[60:63]
    v_mfma_f32_16x16x32_bf16 v[64:67], v[144:147], v[176:179], v[64:67]
    ds_read_b128 v[200:203], v216 offset:47104
    v_mfma_f32_16x16x32_bf16 v[68:71], v[148:151], v[176:179], v[68:71]
    ds_read_b64_tr_b16 v[164:165], v209 offset:32768
    v_mfma_f32_16x16x32_bf16 v[72:75], v[152:155], v[176:179], v[72:75]
    ds_read_b64_tr_b16 v[166:167], v209 offset:33792
    v_mfma_f32_16x16x32_bf16 v[76:79], v[156:159], v[176:179], v[76:79]
    v_mfma_f32_16x16x32_bf16 v[80:83], v[144:147], v[180:183], v[80:83]
    ds_read_b128 v[204:207], v216 offset:48128
    v_mfma_f32_16x16x32_bf16 v[84:87], v[148:151], v[180:183], v[84:87]
    ds_read_b64_tr_b16 v[168:169], v210 offset:32768
    v_mfma_f32_16x16x32_bf16 v[88:91], v[152:155], v[180:183], v[88:91]
    ds_read_b64_tr_b16 v[170:171], v210 offset:33792
    v_mfma_f32_16x16x32_bf16 v[92:95], v[156:159], v[180:183], v[92:95]
    s_waitcnt lgkmcnt(11)
    v_mfma_f32_16x16x32_bf16 v[96:99], v[144:147], v[184:187], v[96:99]
    ds_read_b128 v[176:179], v216 offset:49152
    v_mfma_f32_16x16x32_bf16 v[100:103], v[148:151], v[184:187], v[100:103]
    ds_read_b64_tr_b16 v[172:173], v211 offset:32768
    v_mfma_f32_16x16x32_bf16 v[104:107], v[152:155], v[184:187], v[104:107]
    ds_read_b64_tr_b16 v[174:175], v211 offset:33792
    v_mfma_f32_16x16x32_bf16 v[108:111], v[156:159], v[184:187], v[108:111]
    s_waitcnt lgkmcnt(13)
    v_mfma_f32_16x16x32_bf16 v[112:115], v[144:147], v[188:191], v[112:115]
    ds_read_b128 v[180:183], v216 offset:50176
    v_mfma_f32_16x16x32_bf16 v[116:119], v[148:151], v[188:191], v[116:119]
    v_mfma_f32_16x16x32_bf16 v[120:123], v[152:155], v[188:191], v[120:123]
    v_mfma_f32_16x16x32_bf16 v[124:127], v[156:159], v[188:191], v[124:127]
    s_waitcnt lgkmcnt(13)
    v_mfma_f32_16x16x32_bf16 v[128:131], v[144:147], v[192:195], v[128:131]
    ds_read_b128 v[184:187], v216 offset:51200
    v_mfma_f32_16x16x32_bf16 v[132:135], v[148:151], v[192:195], v[132:135]
    v_mfma_f32_16x16x32_bf16 v[136:139], v[152:155], v[192:195], v[136:139]
    v_mfma_f32_16x16x32_bf16 v[140:143], v[156:159], v[192:195], v[140:143]
    s_waitcnt lgkmcnt(11)
    v_mfma_f32_16x16x32_bf16 v[0:3], v[160:163], v[196:199], v[0:3]
    ds_read_b32 v252, v251 offset:0
    s_waitcnt lgkmcnt(9)
    v_mfma_f32_16x16x32_bf16 v[4:7], v[164:167], v[196:199], v[4:7]
    s_waitcnt lgkmcnt(6)
    v_mfma_f32_16x16x32_bf16 v[8:11], v[168:171], v[196:199], v[8:11]
    ds_read_b128 v[188:191], v216 offset:52224
    s_waitcnt lgkmcnt(4)
    v_mfma_f32_16x16x32_bf16 v[12:15], v[172:175], v[196:199], v[12:15]
    v_mfma_f32_16x16x32_bf16 v[16:19], v[160:163], v[200:203], v[16:19]
    ds_read_b128 v[192:195], v216 offset:53248
    v_mfma_f32_16x16x32_bf16 v[20:23], v[164:167], v[200:203], v[20:23]
    v_mfma_f32_16x16x32_bf16 v[24:27], v[168:171], v[200:203], v[24:27]
    v_mov_b32 v237, 6
    v_mfma_f32_16x16x32_bf16 v[28:31], v[172:175], v[200:203], v[28:31]
    v_mfma_f32_16x16x32_bf16 v[32:35], v[160:163], v[204:207], v[32:35]
    ds_read_b128 v[196:199], v216 offset:54272
    v_mfma_f32_16x16x32_bf16 v[36:39], v[164:167], v[204:207], v[36:39]
    s_waitcnt lgkmcnt(3)
    v_cmp_lt_u32 s[56:57], v252, 7
    v_mfma_f32_16x16x32_bf16 v[40:43], v[168:171], v[204:207], v[40:43]
    ds_write_b32 v250, v237 offset:16
    v_mfma_f32_16x16x32_bf16 v[44:47], v[172:175], v[204:207], v[44:47]
    v_mfma_f32_16x16x32_bf16 v[48:51], v[160:163], v[176:179], v[48:51]
    s_cmp_eq_u64 s[56:57], 0
    s_cbranch_scc0 G0_qs6
G0_qs6_ret:
    ds_read_b128 v[200:203], v216 offset:0
    v_mfma_f32_16x16x32_bf16 v[52:55], v[164:167], v[176:179], v[52:55]
    ds_read_b64_tr_b16 v[144:145], v212 offset:16384
    v_mfma_f32_16x16x32_bf16 v[56:59], v[168:171], v[176:179], v[56:59]
    ds_read_b64_tr_b16 v[146:147], v212 offset:17408
    v_mfma_f32_16x16x32_bf16 v[60:63], v[172:175], v[176:179], v[60:63]
    v_mfma_f32_16x16x32_bf16 v[64:67], v[160:163], v[180:183], v[64:67]
    ds_read_b128 v[204:207], v216 offset:1024
    v_mfma_f32_16x16x32_bf16 v[68:71], v[164:167], v[180:183], v[68:71]
    ds_read_b64_tr_b16 v[148:149], v213 offset:16384
    v_mfma_f32_16x16x32_bf16 v[72:75], v[168:171], v[180:183], v[72:75]
    ds_read_b64_tr_b16 v[150:151], v213 offset:17408
    v_mfma_f32_16x16x32_bf16 v[76:79], v[172:175], v[180:183], v[76:79]
    v_mfma_f32_16x16x32_bf16 v[80:83], v[160:163], v[184:187], v[80:83]
    ds_read_b128 v[176:179], v216 offset:2048
    v_mfma_f32_16x16x32_bf16 v[84:87], v[164:167], v[184:187], v[84:87]
    ds_read_b64_tr_b16 v[152:153], v214 offset:16384
    v_mfma_f32_16x16x32_bf16 v[88:91], v[168:171], v[184:187], v[88:91]
    ds_read_b64_tr_b16 v[154:155], v214 offset:17408
    v_mfma_f32_16x16x32_bf16 v[92:95], v[172:175], v[184:187], v[92:95]
    s_waitcnt lgkmcnt(12)
    v_mfma_f32_16x16x32_bf16 v[96:99], v[160:163], v[188:191], v[96:99]
    ds_read_b128 v[180:183], v216 offset:3072
    v_mfma_f32_16x16x32_bf16 v[100:103], v[164:167], v[188:191], v[100:103]
    ds_read_b64_tr_b16 v[156:157], v215 offset:16384
    v_mfma_f32_16x16x32_bf16 v[104:107], v[168:171], v[188:191], v[104:107]
    ds_read_b64_tr_b16 v[158:159], v215 offset:17408
    v_mfma_f32_16x16x32_bf16 v[108:111], v[172:175], v[188:191], v[108:111]
    s_waitcnt lgkmcnt(14)
    v_mfma_f32_16x16x32_bf16 v[112:115], v[160:163], v[192:195], v[112:115]
    ds_read_b128 v[184:187], v216 offset:4096
    v_mfma_f32_16x16x32_bf16 v[116:119], v[164:167], v[192:195], v[116:119]
    v_mfma_f32_16x16x32_bf16 v[120:123], v[168:171], v[192:195], v[120:123]
    v_mfma_f32_16x16x32_bf16 v[124:127], v[172:175], v[192:195], v[124:127]
    s_waitcnt lgkmcnt(14)
    v_mfma_f32_16x16x32_bf16 v[128:131], v[160:163], v[196:199], v[128:131]
    ds_read_b128 v[188:191], v216 offset:5120
    v_mfma_f32_16x16x32_bf16 v[132:135], v[164:167], v[196:199], v[132:135]
    v_mfma_f32_16x16x32_bf16 v[136:139], v[168:171], v[196:199], v[136:139]
    v_mfma_f32_16x16x32_bf16 v[140:143], v[172:175], v[196:199], v[140:143]
    s_waitcnt lgkmcnt(11)
    v_mfma_f32_16x16x32_bf16 v[0:3], v[144:147], v[200:203], v[0:3]
    ds_read_b32 v252, v251 offset:0
    s_waitcnt lgkmcnt(9)
    v_mfma_f32_16x16x32_bf16 v[4:7], v[148:151], v[200:203], v[4:7]
    s_waitcnt lgkmcnt(6)
    v_mfma_f32_16x16x32_bf16 v[8:11], v[152:155], v[200:203], v[8:11]
    ds_read_b128 v[192:195], v216 offset:6144
    s_waitcnt lgkmcnt(4)
    v_mfma_f32_16x16x32_bf16 v[12:15], v[156:159], v[200:203], v[12:15]
    v_mfma_f32_16x16x32_bf16 v[16:19], v[144:147], v[204:207], v[16:19]
    ds_read_b128 v[196:199], v216 offset:7168
    v_mfma_f32_16x16x32_bf16 v[20:23], v[148:151], v[204:207], v[20:23]
    v_mfma_f32_16x16x32_bf16 v[24:27], v[152:155], v[204:207], v[24:27]
    v_mfma_f32_16x16x32_bf16 v[28:31], v[156:159], v[204:207], v[28:31]
    v_mfma_f32_16x16x32_bf16 v[32:35], v[144:147], v[176:179], v[32:35]
    ds_read_b128 v[200:203], v216 offset:8192
    v_mfma_f32_16x16x32_bf16 v[36:39], v[148:151], v[176:179], v[36:39]
    v_mfma_f32_16x16x32_bf16 v[40:43], v[152:155], v[176:179], v[40:43]
    s_waitcnt lgkmcnt(3)
    v_cmp_lt_u32 s[56:57], v252, 8
    v_mfma_f32_16x16x32_bf16 v[44:47], v[156:159], v[176:179], v[44:47]
    v_mfma_f32_16x16x32_bf16 v[48:51], v[144:147], v[180:183], v[48:51]
    s_cmp_eq_u64 s[56:57], 0
    s_cbranch_scc0 G0_qs7
G0_qs7_ret:
    ds_read_b128 v[204:207], v216 offset:9216
    v_mfma_f32_16x16x32_bf16 v[52:55], v[148:151], v[180:183], v[52:55]
    ds_read_b64_tr_b16 v[160:161], v212 offset:32768
    v_mfma_f32_16x16x32_bf16 v[56:59], v[152:155], v[180:183], v[56:59]
    ds_read_b64_tr_b16 v[162:163], v212 offset:33792
    v_mfma_f32_16x16x32_bf16 v[60:63], v[156:159], v[180:183], v[60:63]
    v_mfma_f32_16x16x32_bf16 v[64:67], v[144:147], v[184:187], v[64:67]
    ds_read_b128 v[176:179], v216 offset:10240
    v_mfma_f32_16x16x32_bf16 v[68:71], v[148:151], v[184:187], v[68:71]
    ds_read_b64_tr_b16 v[164:165], v213 offset:32768
    v_mfma_f32_16x16x32_bf16 v[72:75], v[152:155], v[184:187], v[72:75]
    ds_read_b64_tr_b16 v[166:167], v213 offset:33792
    v_mfma_f32_16x16x32_bf16 v[76:79], v[156:159], v[184:187], v[76:79]
    v_mfma_f32_16x16x32_bf16 v[80:83], v[144:147], v[188:191], v[80:83]
    ds_read_b128 v[180:183], v216 offset:11264
    v_mfma_f32_16x16x32_bf16 v[84:87], v[148:151], v[188:191], v[84:87]
    ds_read_b64_tr_b16 v[168:169], v214 offset:32768
    v_mfma_f32_16x16x32_bf16 v[88:91], v[152:155], v[188:191], v[88:91]
    ds_read_b64_tr_b16 v[170:171], v214 offset:33792
    v_mfma_f32_16x16x32_bf16 v[92:95], v[156:159], v[188:191], v[92:95]
    s_waitcnt lgkmcnt(11)
    v_mfma_f32_16x16x32_bf16 v[96:99], v[144:147], v[192:195], v[96:99]
    ds_read_b128 v[184:187], v216 offset:12288
    v_mfma_f32_16x16x32_bf16 v[100:103], v[148:151], v[192:195], v[100:103]
    ds_read_b64_tr_b16 v[172:173], v215 offset:32768
    v_mfma_f32_16x16x32_bf16 v[104:107], v[152:155], v[192:195], v[104:107]
    ds_read_b64_tr_b16 v[174:175], v215 offset:33792
    v_mfma_f32_16x16x32_bf16 v[108:111], v[156:159], v[192:195], v[108:111]
    s_waitcnt lgkmcnt(13)
    v_mfma_f32_16x16x32_bf16 v[112:115], v[144:147], v[196:199], v[112:115]
    ds_read_b128 v[188:191], v216 offset:13312
    v_mfma_f32_16x16x32_bf16 v[116:119], v[148:151], v[196:199], v[116:119]
    v_mfma_f32_16x16x32_bf16 v[120:123], v[152:155], v[196:199], v[120:123]
    v_mfma_f32_16x16x32_bf16 v[124:127], v[156:159], v[196:199], v[124:127]
    s_waitcnt lgkmcnt(13)
    v_mfma_f32_16x16x32_bf16 v[128:131], v[144:147], v[200:203], v[128:131]
    ds_read_b128 v[192:195], v216 offset:14336
    v_mfma_f32_16x16x32_bf16 v[132:135], v[148:151], v[200:203], v[132:135]
    v_mfma_f32_16x16x32_bf16 v[136:139], v[152:155], v[200:203], v[136:139]
    v_mfma_f32_16x16x32_bf16 v[140:143], v[156:159], v[200:203], v[140:143]
    s_waitcnt lgkmcnt(11)
    v_mfma_f32_16x16x32_bf16 v[0:3], v[160:163], v[204:207], v[0:3]
    ds_read_b32 v252, v251 offset:0
    s_waitcnt lgkmcnt(9)
    v_mfma_f32_16x16x32_bf16 v[4:7], v[164:167], v[204:207], v[4:7]
    s_waitcnt lgkmcnt(6)
    v_mfma_f32_16x16x32_bf16 v[8:11], v[168:171], v[204:207], v[8:11]
    ds_read_b128 v[196:199], v216 offset:15360
    s_waitcnt lgkmcnt(4)
    v_mfma_f32_16x16x32_bf16 v[12:15], v[172:175], v[204:207], v[12:15]
    v_mfma_f32_16x16x32_bf16 v[16:19], v[160:163], v[176:179], v[16:19]
    ds_read_b128 v[200:203], v216 offset:16384
    v_mfma_f32_16x16x32_bf16 v[20:23], v[164:167], v[176:179], v[20:23]
    v_mfma_f32_16x16x32_bf16 v[24:27], v[168:171], v[176:179], v[24:27]
    v_mov_b32 v237, 8
    v_mfma_f32_16x16x32_bf16 v[28:31], v[172:175], v[176:179], v[28:31]
    v_mfma_f32_16x16x32_bf16 v[32:35], v[160:163], v[180:183], v[32:35]
    ds_read_b128 v[204:207], v216 offset:17408
    v_mfma_f32_16x16x32_bf16 v[36:39], v[164:167], v[180:183], v[36:39]
    s_waitcnt lgkmcnt(3)
    v_cmp_lt_u32 s[56:57], v252, 9
    v_mfma_f32_16x16x32_bf16 v[40:43], v[168:171], v[180:183], v[40:43]
    ds_write_b32 v250, v237 offset:16
    v_mfma_f32_16x16x32_bf16 v[44:47], v[172:175], v[180:183], v[44:47]
    v_mfma_f32_16x16x32_bf16 v[48:51], v[160:163], v[184:187], v[48:51]
    s_cmp_eq_u64 s[56:57], 0
    s_cbranch_scc0 G0_qs8
G0_qs8_ret:
    ds_read_b128 v[176:179], v216 offset:18432
    v_mfma_f32_16x16x32_bf16 v[52:55], v[164:167], v[184:187], v[52:55]
    ds_read_b64_tr_b16 v[144:145], v208 offset:0
    v_mfma_f32_16x16x32_bf16 v[56:59], v[168:171], v[184:187], v[56:59]
    ds_read_b64_tr_b16 v[146:147], v208 offset:1024
    v_mfma_f32_16x16x32_bf16 v[60:63], v[172:175], v[184:187], v[60:63]
    v_mfma_f32_16x16x32_bf16 v[64:67], v[160:163], v[188:191], v[64:67]
    ds_read_b128 v[180:183], v216 offset:19456
    v_mfma_f32_16x16x32_bf16 v[68:71], v[164:167], v[188:191], v[68:71]
    ds_read_b64_tr_b16 v[148:149], v209 offset:0
    v_mfma_f32_16x16x32_bf16 v[72:75], v[168:171], v[188:191], v[72:75]
    ds_read_b64_tr_b16 v[150:151], v209 offset:1024
    v_mfma_f32_16x16x32_bf16 v[76:79], v[172:175], v[188:191], v[76:79]
    v_mfma_f32_16x16x32_bf16 v[80:83], v[160:163], v[192:195], v[80:83]
    ds_read_b128 v[184:187], v216 offset:20480
    v_mfma_f32_16x16x32_bf16 v[84:87], v[164:167], v[192:195], v[84:87]
    ds_read_b64_tr_b16 v[152:153], v210 offset:0
    v_mfma_f32_16x16x32_bf16 v[88:91], v[168:171], v[192:195], v[88:91]
    ds_read_b64_tr_b16 v[154:155], v210 offset:1024
    v_mfma_f32_16x16x32_bf16 v[92:95], v[172:175], v[192:195], v[92:95]
    s_waitcnt lgkmcnt(12)
    v_mfma_f32_16x16x32_bf16 v[96:99], v[160:163], v[196:199], v[96:99]
    ds_read_b128 v[188:191], v216 offset:21504
    v_mfma_f32_16x16x32_bf16 v[100:103], v[164:167], v[196:199], v[100:103]
    ds_read_b64_tr_b16 v[156:157], v211 offset:0
    v_mfma_f32_16x16x32_bf16 v[104:107], v[168:171], v[196:199], v[104:107]
    ds_read_b64_tr_b16 v[158:159], v211 offset:1024
    v_mfma_f32_16x16x32_bf16 v[108:111], v[172:175], v[196:199], v[108:111]
    s_waitcnt lgkmcnt(14)
    v_mfma_f32_16x16x32_bf16 v[112:115], v[160:163], v[200:203], v[112:115]
    ds_read_b128 v[192:195], v216 offset:22528
    v_mfma_f32_16x16x32_bf16 v[116:119], v[164:167], v[200:203], v[116:119]
    v_mfma_f32_16x16x32_bf16 v[120:123], v[168:171], v[200:203], v[120:123]
    v_mfma_f32_16x16x32_bf16 v[124:127], v[172:175], v[200:203], v[124:127]
    s_waitcnt lgkmcnt(14)
    v_mfma_f32_16x16x32_bf16 v[128:131], v[160:163], v[204:207], v[128:131]
    ds_read_b128 v[196:199], v216 offset:23552
    v_mfma_f32_16x16x32_bf16 v[132:135], v[164:167], v[204:207], v[132:135]
    v_mfma_f32_16x16x32_bf16 v[136:139], v[168:171], v[204:207], v[136:139]
    v_mfma_f32_16x16x32_bf16 v[140:143], v[172:175], v[204:207], v[140:143]
    s_waitcnt lgkmcnt(11)
    v_mfma_f32_16x16x32_bf16 v[0:3], v[144:147], v[176:179], v[0:3]
    ds_read_b32 v252, v251 offset:0
    s_waitcnt lgkmcnt(9)
    v_mfma_f32_16x16x32_bf16 v[4:7], v[148:151], v[176:179], v[4:7]
    s_waitcnt lgkmcnt(6)
    v_mfma_f32_16x16x32_bf16 v[8:11], v[152:155], v[176:179], v[8:11]
    ds_read_b128 v[200:203], v216 offset:24576
    s_waitcnt lgkmcnt(4)
    v_mfma_f32_16x16x32_bf16 v[12:15], v[156:159], v[176:179], v[12:15]
    v_mfma_f32_16x16x32_bf16 v[16:19], v[144:147], v[180:183], v[16:19]
    ds_read_b128 v[204:207], v216 offset:25600
    v_mfma_f32_16x16x32_bf16 v[20:23], v[148:151], v[180:183], v[20:23]
    v_mfma_f32_16x16x32_bf16 v[24:27], v[152:155], v[180:183], v[24:27]
    v_mfma_f32_16x16x32_bf16 v[28:31], v[156:159], v[180:183], v[28:31]
    v_mfma_f32_16x16x32_bf16 v[32:35], v[144:147], v[184:187], v[32:35]
    ds_read_b128 v[176:179], v216 offset:26624
    v_mfma_f32_16x16x32_bf16 v[36:39], v[148:151], v[184:187], v[36:39]
    v_mfma_f32_16x16x32_bf16 v[40:43], v[152:155], v[184:187], v[40:43]
    s_waitcnt lgkmcnt(3)
    v_cmp_lt_u32 s[56:57], v252, 10
    v_mfma_f32_16x16x32_bf16 v[44:47], v[156:159], v[184:187], v[44:47]
    v_mfma_f32_16x16x32_bf16 v[48:51], v[144:147], v[188:191], v[48:51]
    s_cmp_eq_u64 s[56:57], 0
    s_cbranch_scc0 G0_qs9
G0_qs9_ret:
    ds_read_b128 v[180:183], v216 offset:27648
    v_mfma_f32_16x16x32_bf16 v[52:55], v[148:151], v[188:191], v[52:55]
    ds_read_b64_tr_b16 v[160:161], v208 offset:16384
    v_mfma_f32_16x16x32_bf16 v[56:59], v[152:155], v[188:191], v[56:59]
    ds_read_b64_tr_b16 v[162:163], v208 offset:17408
    v_mfma_f32_16x16x32_bf16 v[60:63], v[156:159], v[188:191], v[60:63]
    v_mfma_f32_16x16x32_bf16 v[64:67], v[144:147], v[192:195], v[64:67]
    ds_read_b128 v[184:187], v216 offset:28672
    v_mfma_f32_16x16x32_bf16 v[68:71], v[148:151], v[192:195], v[68:71]
    ds_read_b64_tr_b16 v[164:165], v209 offset:16384
    v_mfma_f32_16x16x32_bf16 v[72:75], v[152:155], v[192:195], v[72:75]
    ds_read_b64_tr_b16 v[166:167], v209 offset:17408
    v_mfma_f32_16x16x32_bf16 v[76:79], v[156:159], v[192:195], v[76:79]
    v_mfma_f32_16x16x32_bf16 v[80:83], v[144:147], v[196:199], v[80:83]
    ds_read_b128 v[188:191], v216 offset:29696
    v_mfma_f32_16x16x32_bf16 v[84:87], v[148:151], v[196:199], v[84:87]
    ds_read_b64_tr_b16 v[168:169], v210 offset:16384
    v_mfma_f32_16x16x32_bf16 v[88:91], v[152:155], v[196:199], v[88:91]
    ds_read_b64_tr_b16 v[170:171], v210 offset:17408
    v_mfma_f32_16x16x32_bf16 v[92:95], v[156:159], v[196:199], v[92:95]
    s_waitcnt lgkmcnt(11)
    v_mfma_f32_16x16x32_bf16 v[96:99], v[144:147], v[200:203], v[96:99]
    ds_read_b128 v[192:195], v216 offset:30720
    v_mfma_f32_16x16x32_bf16 v[100:103], v[148:151], v[200:203], v[100:103]
    ds_read_b64_tr_b16 v[172:173], v211 offset:16384
    v_mfma_f32_16x16x32_bf16 v[104:107], v[152:155], v[200:203], v[104:107]
    ds_read_b64_tr_b16 v[174:175], v211 offset:17408
    v_mfma_f32_16x16x32_bf16 v[108:111], v[156:159], v[200:203], v[108:111]
    s_waitcnt lgkmcnt(13)
    v_mfma_f32_16x16x32_bf16 v[112:115], v[144:147], v[204:207], v[112:115]
    ds_read_b128 v[196:199], v216 offset:31744
    v_mfma_f32_16x16x32_bf16 v[116:119], v[148:151], v[204:207], v[116:119]
    v_mfma_f32_16x16x32_bf16 v[120:123], v[152:155], v[204:207], v[120:123]
    v_mfma_f32_16x16x32_bf16 v[124:127], v[156:159], v[204:207], v[124:127]
    s_waitcnt lgkmcnt(13)
    v_mfma_f32_16x16x32_bf16 v[128:131], v[144:147], v[176:179], v[128:131]
    ds_read_b128 v[200:203], v216 offset:32768
    v_mfma_f32_16x16x32_bf16 v[132:135], v[148:151], v[176:179], v[132:135]
    v_mfma_f32_16x16x32_bf16 v[136:139], v[152:155], v[176:179], v[136:139]
    v_mfma_f32_16x16x32_bf16 v[140:143], v[156:159], v[176:179], v[140:143]
    s_waitcnt lgkmcnt(11)
    v_mfma_f32_16x16x32_bf16 v[0:3], v[160:163], v[180:183], v[0:3]
    ds_read_b32 v252, v251 offset:0
    s_waitcnt lgkmcnt(9)
    v_mfma_f32_16x16x32_bf16 v[4:7], v[164:167], v[180:183], v[4:7]
    s_waitcnt lgkmcnt(6)
    v_mfma_f32_16x16x32_bf16 v[8:11], v[168:171], v[180:183], v[8:11]
    ds_read_b128 v[204:207], v216 offset:33792
    s_waitcnt lgkmcnt(4)
    v_mfma_f32_16x16x32_bf16 v[12:15], v[172:175], v[180:183], v[12:15]
    v_mfma_f32_16x16x32_bf16 v[16:19], v[160:163], v[184:187], v[16:19]
    ds_read_b128 v[176:179], v216 offset:34816
    v_mfma_f32_16x16x32_bf16 v[20:23], v[164:167], v[184:187], v[20:23]
    v_mfma_f32_16x16x32_bf16 v[24:27], v[168:171], v[184:187], v[24:27]
    v_mov_b32 v237, 10
    v_mfma_f32_16x16x32_bf16 v[28:31], v[172:175], v[184:187], v[28:31]
    v_mfma_f32_16x16x32_bf16 v[32:35], v[160:163], v[188:191], v[32:35]
    ds_read_b128 v[180:183], v216 offset:35840
    v_mfma_f32_16x16x32_bf16 v[36:39], v[164:167], v[188:191], v[36:39]
    s_waitcnt lgkmcnt(3)
    v_cmp_lt_u32 s[56:57], v252, 11
    v_mfma_f32_16x16x32_bf16 v[40:43], v[168:171], v[188:191], v[40:43]
    ds_write_b32 v250, v237 offset:16
    v_mfma_f32_16x16x32_bf16 v[44:47], v[172:175], v[188:191], v[44:47]
    v_mfma_f32_16x16x32_bf16 v[48:51], v[160:163], v[192:195], v[48:51]
    s_cmp_eq_u64 s[56:57], 0
    s_cbranch_scc0 G0_qs10
G0_qs10_ret:
    ds_read_b128 v[184:187], v216 offset:36864
    v_mfma_f32_16x16x32_bf16 v[52:55], v[164:167], v[192:195], v[52:55]
    ds_read_b64_tr_b16 v[144:145], v208 offset:49152
    v_mfma_f32_16x16x32_bf16 v[56:59], v[168:171], v[192:195], v[56:59]
    ds_read_b64_tr_b16 v[146:147], v208 offset:50176
    v_mfma_f32_16x16x32_bf16 v[60:63], v[172:175], v[192:195], v[60:63]
    v_mfma_f32_16x16x32_bf16 v[64:67], v[160:163], v[196:199], v[64:67]
    ds_read_b128 v[188:191], v216 offset:37888
    v_mfma_f32_16x16x32_bf16 v[68:71], v[164:167], v[196:199], v[68:71]
    ds_read_b64_tr_b16 v[148:149], v209 offset:49152
    v_mfma_f32_16x16x32_bf16 v[72:75], v[168:171], v[196:199], v[72:75]
    ds_read_b64_tr_b16 v[150:151], v209 offset:50176
    v_mfma_f32_16x16x32_bf16 v[76:79], v[172:175], v[196:199], v[76:79]
    v_mfma_f32_16x16x32_bf16 v[80:83], v[160:163], v[200:203], v[80:83]
    ds_read_b128 v[192:195], v216 offset:38912
    v_mfma_f32_16x16x32_bf16 v[84:87], v[164:167], v[200:203], v[84:87]
    ds_read_b64_tr_b16 v[152:153], v210 offset:49152
    v_mfma_f32_16x16x32_bf16 v[88:91], v[168:171], v[200:203], v[88:91]
    ds_read_b64_tr_b16 v[154:155], v210 offset:50176
    v_mfma_f32_16x16x32_bf16 v[92:95], v[172:175], v[200:203], v[92:95]
    s_waitcnt lgkmcnt(12)
    v_mfma_f32_16x16x32_bf16 v[96:99], v[160:163], v[204:207], v[96:99]
    ds_read_b128 v[196:199], v216 offset:39936
    v_mfma_f32_16x16x32_bf16 v[100:103], v[164:167], v[204:207], v[100:103]
    ds_read_b64_tr_b16 v[156:157], v211 offset:49152
    v_mfma_f32_16x16x32_bf16 v[104:107], v[168:171], v[204:207], v[104:107]
    ds_read_b64_tr_b16 v[158:159], v211 offset:50176
    v_mfma_f32_16x16x32_bf16 v[108:111], v[172:175], v[204:207], v[108:111]
    s_waitcnt lgkmcnt(14)
    v_mfma_f32_16x16x32_bf16 v[112:115], v[160:163], v[176:179], v[112:115]
    ds_read_b128 v[200:203], v216 offset:40960
    v_mfma_f32_16x16x32_bf16 v[116:119], v[164:167], v[176:179], v[116:119]
    v_mfma_f32_16x16x32_bf16 v[120:123], v[168:171], v[176:179], v[120:123]
    v_mfma_f32_16x16x32_bf16 v[124:127], v[172:175], v[176:179], v[124:127]
    s_waitcnt lgkmcnt(14)
    v_mfma_f32_16x16x32_bf16 v[128:131], v[160:163], v[180:183], v[128:131]
    ds_read_b128 v[204:207], v216 offset:41984
    v_mfma_f32_16x16x32_bf16 v[132:135], v[164:167], v[180:183], v[132:135]
    v_mfma_f32_16x16x32_bf16 v[136:139], v[168:171], v[180:183], v[136:139]
    v_mfma_f32_16x16x32_bf16 v[140:143], v[172:175], v[180:183], v[140:143]
    s_waitcnt lgkmcnt(11)
    v_mfma_f32_16x16x32_bf16 v[0:3], v[144:147], v[184:187], v[0:3]
    ds_read_b32 v252, v251 offset:0
    s_waitcnt lgkmcnt(9)
    v_mfma_f32_16x16x32_bf16 v[4:7], v[148:151], v[184:187], v[4:7]
    s_waitcnt lgkmcnt(6)
    v_mfma_f32_16x16x32_bf16 v[8:11], v[152:155], v[184:187], v[8:11]
    ds_read_b128 v[176:179], v216 offset:43008
    s_waitcnt lgkmcnt(4)
    v_mfma_f32_16x16x32_bf16 v[12:15], v[156:159], v[184:187], v[12:15]
    v_mfma_f32_16x16x32_bf16 v[16:19], v[144:147], v[188:191], v[16:19]
    ds_read_b128 v[180:183], v216 offset:44032
    v_mfma_f32_16x16x32_bf16 v[20:23], v[148:151], v[188:191], v[20:23]
    v_mfma_f32_16x16x32_bf16 v[24:27], v[152:155], v[188:191], v[24:27]
    v_mfma_f32_16x16x32_bf16 v[28:31], v[156:159], v[188:191], v[28:31]
    v_mfma_f32_16x16x32_bf16 v[32:35], v[144:147], v[192:195], v[32:35]
    ds_read_b128 v[184:187], v216 offset:45056
    v_mfma_f32_16x16x32_bf16 v[36:39], v[148:151], v[192:195], v[36:39]
    v_mfma_f32_16x16x32_bf16 v[40:43], v[152:155], v[192:195], v[40:43]
    s_waitcnt lgkmcnt(3)
    v_cmp_lt_u32 s[56:57], v252, 12
    v_mfma_f32_16x16x32_bf16 v[44:47], v[156:159], v[192:195], v[44:47]
    v_mfma_f32_16x16x32_bf16 v[48:51], v[144:147], v[196:199], v[48:51]
    s_cmp_eq_u64 s[56:57], 0
    s_cbranch_scc0 G0_qs11
G0_qs11_ret:
    ds_read_b128 v[188:191], v216 offset:46080
    v_mfma_f32_16x16x32_bf16 v[52:55], v[148:151], v[196:199], v[52:55]
    ds_read_b64_tr_b16 v[160:161], v208 offset:32768
    v_mfma_f32_16x16x32_bf16 v[56:59], v[152:155], v[196:199], v[56:59]
    ds_read_b64_tr_b16 v[162:163], v208 offset:33792
    v_mfma_f32_16x16x32_bf16 v[60:63], v[156:159], v[196:199], v[60:63]
    v_mfma_f32_16x16x32_bf16 v[64:67], v[144:147], v[200:203], v[64:67]
    ds_read_b128 v[192:195], v216 offset:47104
    v_mfma_f32_16x16x32_bf16 v[68:71], v[148:151], v[200:203], v[68:71]
    ds_read_b64_tr_b16 v[164:165], v209 offset:32768
    v_mfma_f32_16x16x32_bf16 v[72:75], v[152:155], v[200:203], v[72:75]
    ds_read_b64_tr_b16 v[166:167], v209 offset:33792
    v_mfma_f32_16x16x32_bf16 v[76:79], v[156:159], v[200:203], v[76:79]
    v_mfma_f32_16x16x32_bf16 v[80:83], v[144:147], v[204:207], v[80:83]
    ds_read_b128 v[196:199], v216 offset:48128
    v_mfma_f32_16x16x32_bf16 v[84:87], v[148:151], v[204:207], v[84:87]
    ds_read_b64_tr_b16 v[168:169], v210 offset:32768
    v_mfma_f32_16x16x32_bf16 v[88:91], v[152:155], v[204:207], v[88:91]
    ds_read_b64_tr_b16 v[170:171], v210 offset:33792
    v_mfma_f32_16x16x32_bf16 v[92:95], v[156:159], v[204:207], v[92:95]
    s_waitcnt lgkmcnt(11)
    v_mfma_f32_16x16x32_bf16 v[96:99], v[144:147], v[176:179], v[96:99]
    ds_read_b128 v[200:203], v216 offset:49152
    v_mfma_f32_16x16x32_bf16 v[100:103], v[148:151], v[176:179], v[100:103]
    ds_read_b64_tr_b16 v[172:173], v211 offset:32768
    v_mfma_f32_16x16x32_bf16 v[104:107], v[152:155], v[176:179], v[104:107]
    ds_read_b64_tr_b16 v[174:175], v211 offset:33792
    v_mfma_f32_16x16x32_bf16 v[108:111], v[156:159], v[176:179], v[108:111]
    s_waitcnt lgkmcnt(13)
    v_mfma_f32_16x16x32_bf16 v[112:115], v[144:147], v[180:183], v[112:115]
    ds_read_b128 v[204:207], v216 offset:50176
    v_mfma_f32_16x16x32_bf16 v[116:119], v[148:151], v[180:183], v[116:119]
    v_mfma_f32_16x16x32_bf16 v[120:123], v[152:155], v[180:183], v[120:123]
    v_mfma_f32_16x16x32_bf16 v[124:127], v[156:159], v[180:183], v[124:127]
    s_waitcnt lgkmcnt(13)
    v_mfma_f32_16x16x32_bf16 v[128:131], v[144:147], v[184:187], v[128:131]
    ds_read_b128 v[176:179], v216 offset:51200
    v_mfma_f32_16x16x32_bf16 v[132:135], v[148:151], v[184:187], v[132:135]
    v_mfma_f32_16x16x32_bf16 v[136:139], v[152:155], v[184:187], v[136:139]
    v_mfma_f32_16x16x32_bf16 v[140:143], v[156:159], v[184:187], v[140:143]
    s_waitcnt lgkmcnt(11)
    v_mfma_f32_16x16x32_bf16 v[0:3], v[160:163], v[188:191], v[0:3]
    ds_read_b32 v252, v251 offset:0
    s_waitcnt lgkmcnt(9)
    v_mfma_f32_16x16x32_bf16 v[4:7], v[164:167], v[188:191], v[4:7]
    s_waitcnt lgkmcnt(6)
    v_mfma_f32_16x16x32_bf16 v[8:11], v[168:171], v[188:191], v[8:11]
    ds_read_b128 v[180:183], v216 offset:52224
    s_waitcnt lgkmcnt(4)
    v_mfma_f32_16x16x32_bf16 v[12:15], v[172:175], v[188:191], v[12:15]
    v_mfma_f32_16x16x32_bf16 v[16:19], v[160:163], v[192:195], v[16:19]
    ds_read_b128 v[184:187], v216 offset:53248
    v_mfma_f32_16x16x32_bf16 v[20:23], v[164:167], v[192:195], v[20:23]
    v_mfma_f32_16x16x32_bf16 v[24:27], v[168:171], v[192:195], v[24:27]
    v_mov_b32 v237, 12
    v_mfma_f32_16x16x32_bf16 v[28:31], v[172:175], v[192:195], v[28:31]
    v_mfma_f32_16x16x32_bf16 v[32:35], v[160:163], v[196:199], v[32:35]
    ds_read_b128 v[188:191], v216 offset:54272
    v_mfma_f32_16x16x32_bf16 v[36:39], v[164:167], v[196:199], v[36:39]
    s_waitcnt lgkmcnt(3)
    v_cmp_lt_u32 s[56:57], v252, 13
    v_mfma_f32_16x16x32_bf16 v[40:43], v[168:171], v[196:199], v[40:43]
    ds_write_b32 v250, v237 offset:16
    v_mfma_f32_16x16x32_bf16 v[44:47], v[172:175], v[196:199], v[44:47]
    v_mfma_f32_16x16x32_bf16 v[48:51], v[160:163], v[200:203], v[48:51]
    s_cmp_eq_u64 s[56:57], 0
    s_cbranch_scc0 G0_qs12
G0_qs12_ret:
    ds_read_b128 v[192:195], v216 offset:0
    v_mfma_f32_16x16x32_bf16 v[52:55], v[164:167], v[200:203], v[52:55]
    ds_read_b64_tr_b16 v[144:145], v212 offset:16384
    v_mfma_f32_16x16x32_bf16 v[56:59], v[168:171], v[200:203], v[56:59]
    ds_read_b64_tr_b16 v[146:147], v212 offset:17408
    v_mfma_f32_16x16x32_bf16 v[60:63], v[172:175], v[200:203], v[60:63]
    v_mfma_f32_16x16x32_bf16 v[64:67], v[160:163], v[204:207], v[64:67]
    ds_read_b128 v[196:199], v216 offset:1024
    v_mfma_f32_16x16x32_bf16 v[68:71], v[164:167], v[204:207], v[68:71]
    ds_read_b64_tr_b16 v[148:149], v213 offset:16384
    v_mfma_f32_16x16x32_bf16 v[72:75], v[168:171], v[204:207], v[72:75]
    ds_read_b64_tr_b16 v[150:151], v213 offset:17408
    v_mfma_f32_16x16x32_bf16 v[76:79], v[172:175], v[204:207], v[76:79]
    v_mfma_f32_16x16x32_bf16 v[80:83], v[160:163], v[176:179], v[80:83]
    ds_read_b128 v[200:203], v216 offset:2048
    v_mfma_f32_16x16x32_bf16 v[84:87], v[164:167], v[176:179], v[84:87]
    ds_read_b64_tr_b16 v[152:153], v214 offset:16384
    v_mfma_f32_16x16x32_bf16 v[88:91], v[168:171], v[176:179], v[88:91]
    ds_read_b64_tr_b16 v[154:155], v214 offset:17408
    v_mfma_f32_16x16x32_bf16 v[92:95], v[172:175], v[176:179], v[92:95]
    s_waitcnt lgkmcnt(12)
    v_mfma_f32_16x16x32_bf16 v[96:99], v[160:163], v[180:183], v[96:99]
    ds_read_b128 v[204:207], v216 offset:3072
    v_mfma_f32_16x16x32_bf16 v[100:103], v[164:167], v[180:183], v[100:103]
    ds_read_b64_tr_b16 v[156:157], v215 offset:16384
    v_mfma_f32_16x16x32_bf16 v[104:107], v[168:171], v[180:183], v[104:107]
    ds_read_b64_tr_b16 v[158:159], v215 offset:17408
    v_mfma_f32_16x16x32_bf16 v[108:111], v[172:175], v[180:183], v[108:111]
    s_waitcnt lgkmcnt(14)
    v_mfma_f32_16x16x32_bf16 v[112:115], v[160:163], v[184:187], v[112:115]
    ds_read_b128 v[176:179], v216 offset:4096
    v_mfma_f32_16x16x32_bf16 v[116:119], v[164:167], v[184:187], v[116:119]
    v_mfma_f32_16x16x32_bf16 v[120:123], v[168:171], v[184:187], v[120:123]
    v_mfma_f32_16x16x32_bf16 v[124:127], v[172:175], v[184:187], v[124:127]
    s_waitcnt lgkmcnt(14)
    v_mfma_f32_16x16x32_bf16 v[128:131], v[160:163], v[188:191], v[128:131]
    ds_read_b128 v[180:183], v216 offset:5120
    v_mfma_f32_16x16x32_bf16 v[132:135], v[164:167], v[188:191], v[132:135]
    v_mfma_f32_16x16x32_bf16 v[136:139], v[168:171], v[188:191], v[136:139]
    v_mfma_f32_16x16x32_bf16 v[140:143], v[172:175], v[188:191], v[140:143]
    s_waitcnt lgkmcnt(11)
    v_mfma_f32_16x16x32_bf16 v[0:3], v[144:147], v[192:195], v[0:3]
    ds_read_b32 v252, v251 offset:0
    s_waitcnt lgkmcnt(9)
    v_mfma_f32_16x16x32_bf16 v[4:7], v[148:151], v[192:195], v[4:7]
    s_waitcnt lgkmcnt(6)
    v_mfma_f32_16x16x32_bf16 v[8:11], v[152:155], v[192:195], v[8:11]
    ds_read_b128 v[184:187], v216 offset:6144
    s_waitcnt lgkmcnt(4)
    v_mfma_f32_16x16x32_bf16 v[12:15], v[156:159], v[192:195], v[12:15]
    v_mfma_f32_16x16x32_bf16 v[16:19], v[144:147], v[196:199], v[16:19]
    ds_read_b128 v[188:191], v216 offset:7168
    v_mfma_f32_16x16x32_bf16 v[20:23], v[148:151], v[196:199], v[20:23]
    v_mfma_f32_16x16x32_bf16 v[24:27], v[152:155], v[196:199], v[24:27]
    v_mfma_f32_16x16x32_bf16 v[28:31], v[156:159], v[196:199], v[28:31]
    v_mfma_f32_16x16x32_bf16 v[32:35], v[144:147], v[200:203], v[32:35]
    ds_read_b128 v[192:195], v216 offset:8192
    v_mfma_f32_16x16x32_bf16 v[36:39], v[148:151], v[200:203], v[36:39]
    v_mfma_f32_16x16x32_bf16 v[40:43], v[152:155], v[200:203], v[40:43]
    s_waitcnt lgkmcnt(3)
    v_cmp_lt_u32 s[56:57], v252, 14
    v_mfma_f32_16x16x32_bf16 v[44:47], v[156:159], v[200:203], v[44:47]
    v_mfma_f32_16x16x32_bf16 v[48:51], v[144:147], v[204:207], v[48:51]
    s_cmp_eq_u64 s[56:57], 0
    s_cbranch_scc0 G0_qs13
G0_qs13_ret:
    ds_read_b128 v[196:199], v216 offset:9216
    v_mfma_f32_16x16x32_bf16 v[52:55], v[148:151], v[204:207], v[52:55]
    ds_read_b64_tr_b16 v[160:161], v212 offset:32768
    v_mfma_f32_16x16x32_bf16 v[56:59], v[152:155], v[204:207], v[56:59]
    ds_read_b64_tr_b16 v[162:163], v212 offset:33792
    v_mfma_f32_16x16x32_bf16 v[60:63], v[156:159], v[204:207], v[60:63]
    v_mfma_f32_16x16x32_bf16 v[64:67], v[144:147], v[176:179], v[64:67]
    ds_read_b128 v[200:203], v216 offset:10240
    v_mfma_f32_16x16x32_bf16 v[68:71], v[148:151], v[176:179], v[68:71]
    ds_read_b64_tr_b16 v[164:165], v213 offset:32768
    v_mfma_f32_16x16x32_bf16 v[72:75], v[152:155], v[176:179], v[72:75]
    ds_read_b64_tr_b16 v[166:167], v213 offset:33792
    v_mfma_f32_16x16x32_bf16 v[76:79], v[156:159], v[176:179], v[76:79]
    v_mfma_f32_16x16x32_bf16 v[80:83], v[144:147], v[180:183], v[80:83]
    ds_read_b128 v[204:207], v216 offset:11264
    v_mfma_f32_16x16x32_bf16 v[84:87], v[148:151], v[180:183], v[84:87]
    ds_read_b64_tr_b16 v[168:169], v214 offset:32768
    v_mfma_f32_16x16x32_bf16 v[88:91], v[152:155], v[180:183], v[88:91]
    ds_read_b64_tr_b16 v[170:171], v214 offset:33792
    v_mfma_f32_16x16x32_bf16 v[92:95], v[156:159], v[180:183], v[92:95]
    s_waitcnt lgkmcnt(11)
    v_mfma_f32_16x16x32_bf16 v[96:99], v[144:147], v[184:187], v[96:99]
    ds_read_b128 v[176:179], v216 offset:12288
    v_mfma_f32_16x16x32_bf16 v[100:103], v[148:151], v[184:187], v[100:103]
    ds_read_b64_tr_b16 v[172:173], v215 offset:32768
    v_mfma_f32_16x16x32_bf16 v[104:107], v[152:155], v[184:187], v[104:107]
    ds_read_b64_tr_b16 v[174:175], v215 offset:33792
    v_mfma_f32_16x16x32_bf16 v[108:111], v[156:159], v[184:187], v[108:111]
    s_waitcnt lgkmcnt(13)
    v_mfma_f32_16x16x32_bf16 v[112:115], v[144:147], v[188:191], v[112:115]
    ds_read_b128 v[180:183], v216 offset:13312
    v_mfma_f32_16x16x32_bf16 v[116:119], v[148:151], v[188:191], v[116:119]
    v_mfma_f32_16x16x32_bf16 v[120:123], v[152:155], v[188:191], v[120:123]
    v_mfma_f32_16x16x32_bf16 v[124:127], v[156:159], v[188:191], v[124:127]
    s_waitcnt lgkmcnt(13)
    v_mfma_f32_16x16x32_bf16 v[128:131], v[144:147], v[192:195], v[128:131]
    ds_read_b128 v[184:187], v216 offset:14336
    v_mfma_f32_16x16x32_bf16 v[132:135], v[148:151], v[192:195], v[132:135]
    v_mfma_f32_16x16x32_bf16 v[136:139], v[152:155], v[192:195], v[136:139]
    v_mfma_f32_16x16x32_bf16 v[140:143], v[156:159], v[192:195], v[140:143]
    s_waitcnt lgkmcnt(11)
    v_mfma_f32_16x16x32_bf16 v[0:3], v[160:163], v[196:199], v[0:3]
    ds_read_b32 v252, v251 offset:0
    s_waitcnt lgkmcnt(9)
    v_mfma_f32_16x16x32_bf16 v[4:7], v[164:167], v[196:199], v[4:7]
    s_waitcnt lgkmcnt(6)
    v_mfma_f32_16x16x32_bf16 v[8:11], v[168:171], v[196:199], v[8:11]
    ds_read_b128 v[188:191], v216 offset:15360
    s_waitcnt lgkmcnt(4)
    v_mfma_f32_16x16x32_bf16 v[12:15], v[172:175], v[196:199], v[12:15]
    v_mfma_f32_16x16x32_bf16 v[16:19], v[160:163], v[200:203], v[16:19]
    ds_read_b128 v[192:195], v216 offset:16384
    v_mfma_f32_16x16x32_bf16 v[20:23], v[164:167], v[200:203], v[20:23]
    v_mfma_f32_16x16x32_bf16 v[24:27], v[168:171], v[200:203], v[24:27]
    v_mov_b32 v237, 14
    v_mfma_f32_16x16x32_bf16 v[28:31], v[172:175], v[200:203], v[28:31]
    v_mfma_f32_16x16x32_bf16 v[32:35], v[160:163], v[204:207], v[32:35]
    ds_read_b128 v[196:199], v216 offset:17408
    v_mfma_f32_16x16x32_bf16 v[36:39], v[164:167], v[204:207], v[36:39]
    s_waitcnt lgkmcnt(3)
    v_cmp_lt_u32 s[56:57], v252, 15
    v_mfma_f32_16x16x32_bf16 v[40:43], v[168:171], v[204:207], v[40:43]
    ds_write_b32 v250, v237 offset:16
    v_mfma_f32_16x16x32_bf16 v[44:47], v[172:175], v[204:207], v[44:47]
    v_mfma_f32_16x16x32_bf16 v[48:51], v[160:163], v[176:179], v[48:51]
    s_cmp_eq_u64 s[56:57], 0
    s_cbranch_scc0 G0_qs14
G0_qs14_ret:
    ds_read_b128 v[200:203], v216 offset:18432
    v_mfma_f32_16x16x32_bf16 v[52:55], v[164:167], v[176:179], v[52:55]
    ds_read_b64_tr_b16 v[144:145], v208 offset:0
    v_mfma_f32_16x16x32_bf16 v[56:59], v[168:171], v[176:179], v[56:59]
    ds_read_b64_tr_b16 v[146:147], v208 offset:1024
    v_mfma_f32_16x16x32_bf16 v[60:63], v[172:175], v[176:179], v[60:63]
    v_mfma_f32_16x16x32_bf16 v[64:67], v[160:163], v[180:183], v[64:67]
    ds_read_b128 v[204:207], v216 offset:19456
    v_mfma_f32_16x16x32_bf16 v[68:71], v[164:167], v[180:183], v[68:71]
    ds_read_b64_tr_b16 v[148:149], v209 offset:0
    v_mfma_f32_16x16x32_bf16 v[72:75], v[168:171], v[180:183], v[72:75]
    ds_read_b64_tr_b16 v[150:151], v209 offset:1024
    v_mfma_f32_16x16x32_bf16 v[76:79], v[172:175], v[180:183], v[76:79]
    v_mfma_f32_16x16x32_bf16 v[80:83], v[160:163], v[184:187], v[80:83]
    ds_read_b128 v[176:179], v216 offset:20480
    v_mfma_f32_16x16x32_bf16 v[84:87], v[164:167], v[184:187], v[84:87]
    ds_read_b64_tr_b16 v[152:153], v210 offset:0
    v_mfma_f32_16x16x32_bf16 v[88:91], v[168:171], v[184:187], v[88:91]
    ds_read_b64_tr_b16 v[154:155], v210 offset:1024
    v_mfma_f32_16x16x32_bf16 v[92:95], v[172:175], v[184:187], v[92:95]
    s_waitcnt lgkmcnt(12)
    v_mfma_f32_16x16x32_bf16 v[96:99], v[160:163], v[188:191], v[96:99]
    ds_read_b128 v[180:183], v216 offset:21504
    v_mfma_f32_16x16x32_bf16 v[100:103], v[164:167], v[188:191], v[100:103]
    ds_read_b64_tr_b16 v[156:157], v211 offset:0
    v_mfma_f32_16x16x32_bf16 v[104:107], v[168:171], v[188:191], v[104:107]
    ds_read_b64_tr_b16 v[158:159], v211 offset:1024
    v_mfma_f32_16x16x32_bf16 v[108:111], v[172:175], v[188:191], v[108:111]
    s_waitcnt lgkmcnt(14)
    v_mfma_f32_16x16x32_bf16 v[112:115], v[160:163], v[192:195], v[112:115]
    ds_read_b128 v[184:187], v216 offset:22528
    v_mfma_f32_16x16x32_bf16 v[116:119], v[164:167], v[192:195], v[116:119]
    v_mfma_f32_16x16x32_bf16 v[120:123], v[168:171], v[192:195], v[120:123]
    v_mfma_f32_16x16x32_bf16 v[124:127], v[172:175], v[192:195], v[124:127]
    s_waitcnt lgkmcnt(14)
    v_mfma_f32_16x16x32_bf16 v[128:131], v[160:163], v[196:199], v[128:131]
    ds_read_b128 v[188:191], v216 offset:23552
    v_mfma_f32_16x16x32_bf16 v[132:135], v[164:167], v[196:199], v[132:135]
    v_mfma_f32_16x16x32_bf16 v[136:139], v[168:171], v[196:199], v[136:139]
    v_mfma_f32_16x16x32_bf16 v[140:143], v[172:175], v[196:199], v[140:143]
    s_waitcnt lgkmcnt(11)
    v_mfma_f32_16x16x32_bf16 v[0:3], v[144:147], v[200:203], v[0:3]
    ds_read_b32 v252, v251 offset:0
    s_waitcnt lgkmcnt(9)
    v_mfma_f32_16x16x32_bf16 v[4:7], v[148:151], v[200:203], v[4:7]
    s_waitcnt lgkmcnt(6)
    v_mfma_f32_16x16x32_bf16 v[8:11], v[152:155], v[200:203], v[8:11]
    ds_read_b128 v[192:195], v216 offset:24576
    s_waitcnt lgkmcnt(4)
    v_mfma_f32_16x16x32_bf16 v[12:15], v[156:159], v[200:203], v[12:15]
    v_mfma_f32_16x16x32_bf16 v[16:19], v[144:147], v[204:207], v[16:19]
    ds_read_b128 v[196:199], v216 offset:25600
    v_mfma_f32_16x16x32_bf16 v[20:23], v[148:151], v[204:207], v[20:23]
    v_mfma_f32_16x16x32_bf16 v[24:27], v[152:155], v[204:207], v[24:27]
    v_mfma_f32_16x16x32_bf16 v[28:31], v[156:159], v[204:207], v[28:31]
    v_mfma_f32_16x16x32_bf16 v[32:35], v[144:147], v[176:179], v[32:35]
    ds_read_b128 v[200:203], v216 offset:26624
    v_mfma_f32_16x16x32_bf16 v[36:39], v[148:151], v[176:179], v[36:39]
    v_mfma_f32_16x16x32_bf16 v[40:43], v[152:155], v[176:179], v[40:43]
    s_waitcnt lgkmcnt(3)
    v_cmp_lt_u32 s[56:57], v252, 16
    v_mfma_f32_16x16x32_bf16 v[44:47], v[156:159], v[176:179], v[44:47]
    v_mfma_f32_16x16x32_bf16 v[48:51], v[144:147], v[180:183], v[48:51]
    s_cmp_eq_u64 s[56:57], 0
    s_cbranch_scc0 G0_qs15
G0_qs15_ret:
    ds_read_b128 v[204:207], v216 offset:27648
    v_mfma_f32_16x16x32_bf16 v[52:55], v[148:151], v[180:183], v[52:55]
    ds_read_b64_tr_b16 v[160:161], v208 offset:16384
    v_mfma_f32_16x16x32_bf16 v[56:59], v[152:155], v[180:183], v[56:59]
    ds_read_b64_tr_b16 v[162:163], v208 offset:17408
    v_mfma_f32_16x16x32_bf16 v[60:63], v[156:159], v[180:183], v[60:63]
    v_mfma_f32_16x16x32_bf16 v[64:67], v[144:147], v[184:187], v[64:67]
    ds_read_b128 v[176:179], v216 offset:28672
    v_mfma_f32_16x16x32_bf16 v[68:71], v[148:151], v[184:187], v[68:71]
    ds_read_b64_tr_b16 v[164:165], v209 offset:16384
    v_mfma_f32_16x16x32_bf16 v[72:75], v[152:155], v[184:187], v[72:75]
    ds_read_b64_tr_b16 v[166:167], v209 offset:17408
    v_mfma_f32_16x16x32_bf16 v[76:79], v[156:159], v[184:187], v[76:79]
    v_mfma_f32_16x16x32_bf16 v[80:83], v[144:147], v[188:191], v[80:83]
    ds_read_b128 v[180:183], v216 offset:29696
    v_mfma_f32_16x16x32_bf16 v[84:87], v[148:151], v[188:191], v[84:87]
    ds_read_b64_tr_b16 v[168:169], v210 offset:16384
    v_mfma_f32_16x16x32_bf16 v[88:91], v[152:155], v[188:191], v[88:91]
    ds_read_b64_tr_b16 v[170:171], v210 offset:17408
    v_mfma_f32_16x16x32_bf16 v[92:95], v[156:159], v[188:191], v[92:95]
    s_waitcnt lgkmcnt(11)
    v_mfma_f32_16x16x32_bf16 v[96:99], v[144:147], v[192:195], v[96:99]
    ds_read_b128 v[184:187], v216 offset:30720
    v_mfma_f32_16x16x32_bf16 v[100:103], v[148:151], v[192:195], v[100:103]
    ds_read_b64_tr_b16 v[172:173], v211 offset:16384
    v_mfma_f32_16x16x32_bf16 v[104:107], v[152:155], v[192:195], v[104:107]
    ds_read_b64_tr_b16 v[174:175], v211 offset:17408
    v_mfma_f32_16x16x32_bf16 v[108:111], v[156:159], v[192:195], v[108:111]
    s_waitcnt lgkmcnt(13)
    v_mfma_f32_16x16x32_bf16 v[112:115], v[144:147], v[196:199], v[112:115]
    ds_read_b128 v[188:191], v216 offset:31744
    v_mfma_f32_16x16x32_bf16 v[116:119], v[148:151], v[196:199], v[116:119]
    v_mfma_f32_16x16x32_bf16 v[120:123], v[152:155], v[196:199], v[120:123]
    v_mfma_f32_16x16x32_bf16 v[124:127], v[156:159], v[196:199], v[124:127]
    s_waitcnt lgkmcnt(13)
    v_mfma_f32_16x16x32_bf16 v[128:131], v[144:147], v[200:203], v[128:131]
    ds_read_b128 v[192:195], v216 offset:32768
    v_mfma_f32_16x16x32_bf16 v[132:135], v[148:151], v[200:203], v[132:135]
    v_mfma_f32_16x16x32_bf16 v[136:139], v[152:155], v[200:203], v[136:139]
    v_mfma_f32_16x16x32_bf16 v[140:143], v[156:159], v[200:203], v[140:143]
    s_waitcnt lgkmcnt(11)
    v_mfma_f32_16x16x32_bf16 v[0:3], v[160:163], v[204:207], v[0:3]
    ds_read_b32 v252, v251 offset:0
    s_waitcnt lgkmcnt(9)
    v_mfma_f32_16x16x32_bf16 v[4:7], v[164:167], v[204:207], v[4:7]
    s_waitcnt lgkmcnt(6)
    v_mfma_f32_16x16x32_bf16 v[8:11], v[168:171], v[204:207], v[8:11]
    ds_read_b128 v[196:199], v216 offset:33792
    s_waitcnt lgkmcnt(4)
    v_mfma_f32_16x16x32_bf16 v[12:15], v[172:175], v[204:207], v[12:15]
    v_mfma_f32_16x16x32_bf16 v[16:19], v[160:163], v[176:179], v[16:19]
    ds_read_b128 v[200:203], v216 offset:34816
    v_mfma_f32_16x16x32_bf16 v[20:23], v[164:167], v[176:179], v[20:23]
    v_mfma_f32_16x16x32_bf16 v[24:27], v[168:171], v[176:179], v[24:27]
    v_mov_b32 v237, 16
    v_mfma_f32_16x16x32_bf16 v[28:31], v[172:175], v[176:179], v[28:31]
    v_mfma_f32_16x16x32_bf16 v[32:35], v[160:163], v[180:183], v[32:35]
    ds_read_b128 v[204:207], v216 offset:35840
    v_mfma_f32_16x16x32_bf16 v[36:39], v[164:167], v[180:183], v[36:39]
    s_waitcnt lgkmcnt(3)
    v_cmp_lt_u32 s[56:57], v252, 17
    v_mfma_f32_16x16x32_bf16 v[40:43], v[168:171], v[180:183], v[40:43]
    ds_write_b32 v250, v237 offset:16
    v_mfma_f32_16x16x32_bf16 v[44:47], v[172:175], v[180:183], v[44:47]
    v_mfma_f32_16x16x32_bf16 v[48:51], v[160:163], v[184:187], v[48:51]
    s_cmp_eq_u64 s[56:57], 0
    s_cbranch_scc0 G0_qs16
G0_qs16_ret:
    ds_read_b128 v[176:179], v216 offset:36864
    v_mfma_f32_16x16x32_bf16 v[52:55], v[164:167], v[184:187], v[52:55]
    ds_read_b64_tr_b16 v[144:145], v208 offset:49152
    v_mfma_f32_16x16x32_bf16 v[56:59], v[168:171], v[184:187], v[56:59]
    ds_read_b64_tr_b16 v[146:147], v208 offset:50176
    v_mfma_f32_16x16x32_bf16 v[60:63], v[172:175], v[184:187], v[60:63]
    v_mfma_f32_16x16x32_bf16 v[64:67], v[160:163], v[188:191], v[64:67]
    ds_read_b128 v[180:183], v216 offset:37888
    v_mfma_f32_16x16x32_bf16 v[68:71], v[164:167], v[188:191], v[68:71]
    ds_read_b64_tr_b16 v[148:149], v209 offset:49152
    v_mfma_f32_16x16x32_bf16 v[72:75], v[168:171], v[188:191], v[72:75]
    ds_read_b64_tr_b16 v[150:151], v209 offset:50176
    v_mfma_f32_16x16x32_bf16 v[76:79], v[172:175], v[188:191], v[76:79]
    v_mfma_f32_16x16x32_bf16 v[80:83], v[160:163], v[192:195], v[80:83]
    ds_read_b128 v[184:187], v216 offset:38912
    v_mfma_f32_16x16x32_bf16 v[84:87], v[164:167], v[192:195], v[84:87]
    ds_read_b64_tr_b16 v[152:153], v210 offset:49152
    v_mfma_f32_16x16x32_bf16 v[88:91], v[168:171], v[192:195], v[88:91]
    ds_read_b64_tr_b16 v[154:155], v210 offset:50176
    v_mfma_f32_16x16x32_bf16 v[92:95], v[172:175], v[192:195], v[92:95]
    s_waitcnt lgkmcnt(12)
    v_mfma_f32_16x16x32_bf16 v[96:99], v[160:163], v[196:199], v[96:99]
    ds_read_b128 v[188:191], v216 offset:39936
    v_mfma_f32_16x16x32_bf16 v[100:103], v[164:167], v[196:199], v[100:103]
    ds_read_b64_tr_b16 v[156:157], v211 offset:49152
    v_mfma_f32_16x16x32_bf16 v[104:107], v[168:171], v[196:199], v[104:107]
    ds_read_b64_tr_b16 v[158:159], v211 offset:50176
    v_mfma_f32_16x16x32_bf16 v[108:111], v[172:175], v[196:199], v[108:111]
    s_waitcnt lgkmcnt(14)
    v_mfma_f32_16x16x32_bf16 v[112:115], v[160:163], v[200:203], v[112:115]
    ds_read_b128 v[192:195], v216 offset:40960
    v_mfma_f32_16x16x32_bf16 v[116:119], v[164:167], v[200:203], v[116:119]
    v_mfma_f32_16x16x32_bf16 v[120:123], v[168:171], v[200:203], v[120:123]
    v_mfma_f32_16x16x32_bf16 v[124:127], v[172:175], v[200:203], v[124:127]
    s_waitcnt lgkmcnt(14)
    v_mfma_f32_16x16x32_bf16 v[128:131], v[160:163], v[204:207], v[128:131]
    ds_read_b128 v[196:199], v216 offset:41984
    v_mfma_f32_16x16x32_bf16 v[132:135], v[164:167], v[204:207], v[132:135]
    v_mfma_f32_16x16x32_bf16 v[136:139], v[168:171], v[204:207], v[136:139]
    v_mfma_f32_16x16x32_bf16 v[140:143], v[172:175], v[204:207], v[140:143]
    s_waitcnt lgkmcnt(11)
    v_mfma_f32_16x16x32_bf16 v[0:3], v[144:147], v[176:179], v[0:3]
    ds_read_b32 v252, v251 offset:0
    s_waitcnt lgkmcnt(9)
    v_mfma_f32_16x16x32_bf16 v[4:7], v[148:151], v[176:179], v[4:7]
    s_waitcnt lgkmcnt(6)
    v_mfma_f32_16x16x32_bf16 v[8:11], v[152:155], v[176:179], v[8:11]
    ds_read_b128 v[200:203], v216 offset:43008
    s_waitcnt lgkmcnt(4)
    v_mfma_f32_16x16x32_bf16 v[12:15], v[156:159], v[176:179], v[12:15]
    v_mfma_f32_16x16x32_bf16 v[16:19], v[144:147], v[180:183], v[16:19]
    ds_read_b128 v[204:207], v216 offset:44032
    v_mfma_f32_16x16x32_bf16 v[20:23], v[148:151], v[180:183], v[20:23]
    v_mfma_f32_16x16x32_bf16 v[24:27], v[152:155], v[180:183], v[24:27]
    v_mfma_f32_16x16x32_bf16 v[28:31], v[156:159], v[180:183], v[28:31]
    v_mfma_f32_16x16x32_bf16 v[32:35], v[144:147], v[184:187], v[32:35]
    ds_read_b128 v[176:179], v216 offset:45056
    v_mfma_f32_16x16x32_bf16 v[36:39], v[148:151], v[184:187], v[36:39]
    v_mfma_f32_16x16x32_bf16 v[40:43], v[152:155], v[184:187], v[40:43]
    s_waitcnt lgkmcnt(3)
    v_cmp_lt_u32 s[56:57], v252, 18
    v_mfma_f32_16x16x32_bf16 v[44:47], v[156:159], v[184:187], v[44:47]
    v_mfma_f32_16x16x32_bf16 v[48:51], v[144:147], v[188:191], v[48:51]
    s_cmp_eq_u64 s[56:57], 0
    s_cbranch_scc0 G0_qs17
G0_qs17_ret:
    ds_read_b128 v[180:183], v216 offset:46080
    v_mfma_f32_16x16x32_bf16 v[52:55], v[148:151], v[188:191], v[52:55]
    ds_read_b64_tr_b16 v[160:161], v208 offset:32768
    v_mfma_f32_16x16x32_bf16 v[56:59], v[152:155], v[188:191], v[56:59]
    ds_read_b64_tr_b16 v[162:163], v208 offset:33792
    v_mfma_f32_16x16x32_bf16 v[60:63], v[156:159], v[188:191], v[60:63]
    v_mfma_f32_16x16x32_bf16 v[64:67], v[144:147], v[192:195], v[64:67]
    ds_read_b128 v[184:187], v216 offset:47104
    v_mfma_f32_16x16x32_bf16 v[68:71], v[148:151], v[192:195], v[68:71]
    ds_read_b64_tr_b16 v[164:165], v209 offset:32768
    v_mfma_f32_16x16x32_bf16 v[72:75], v[152:155], v[192:195], v[72:75]
    ds_read_b64_tr_b16 v[166:167], v209 offset:33792
    v_mfma_f32_16x16x32_bf16 v[76:79], v[156:159], v[192:195], v[76:79]
    v_mfma_f32_16x16x32_bf16 v[80:83], v[144:147], v[196:199], v[80:83]
    ds_read_b128 v[188:191], v216 offset:48128
    v_mfma_f32_16x16x32_bf16 v[84:87], v[148:151], v[196:199], v[84:87]
    ds_read_b64_tr_b16 v[168:169], v210 offset:32768
    v_mfma_f32_16x16x32_bf16 v[88:91], v[152:155], v[196:199], v[88:91]
    ds_read_b64_tr_b16 v[170:171], v210 offset:33792
    v_mfma_f32_16x16x32_bf16 v[92:95], v[156:159], v[196:199], v[92:95]
    s_waitcnt lgkmcnt(11)
    v_mfma_f32_16x16x32_bf16 v[96:99], v[144:147], v[200:203], v[96:99]
    ds_read_b128 v[192:195], v216 offset:49152
    v_mfma_f32_16x16x32_bf16 v[100:103], v[148:151], v[200:203], v[100:103]
    ds_read_b64_tr_b16 v[172:173], v211 offset:32768
    v_mfma_f32_16x16x32_bf16 v[104:107], v[152:155], v[200:203], v[104:107]
    ds_read_b64_tr_b16 v[174:175], v211 offset:33792
    v_mfma_f32_16x16x32_bf16 v[108:111], v[156:159], v[200:203], v[108:111]
    s_waitcnt lgkmcnt(13)
    v_mfma_f32_16x16x32_bf16 v[112:115], v[144:147], v[204:207], v[112:115]
    ds_read_b128 v[196:199], v216 offset:50176
    v_mfma_f32_16x16x32_bf16 v[116:119], v[148:151], v[204:207], v[116:119]
    v_mfma_f32_16x16x32_bf16 v[120:123], v[152:155], v[204:207], v[120:123]
    v_mfma_f32_16x16x32_bf16 v[124:127], v[156:159], v[204:207], v[124:127]
    s_waitcnt lgkmcnt(13)
    v_mfma_f32_16x16x32_bf16 v[128:131], v[144:147], v[176:179], v[128:131]
    ds_read_b128 v[200:203], v216 offset:51200
    v_mfma_f32_16x16x32_bf16 v[132:135], v[148:151], v[176:179], v[132:135]
    v_mfma_f32_16x16x32_bf16 v[136:139], v[152:155], v[176:179], v[136:139]
    v_mfma_f32_16x16x32_bf16 v[140:143], v[156:159], v[176:179], v[140:143]
    s_waitcnt lgkmcnt(11)
    v_mfma_f32_16x16x32_bf16 v[0:3], v[160:163], v[180:183], v[0:3]
    ds_read_b32 v252, v251 offset:0
    s_waitcnt lgkmcnt(9)
    v_mfma_f32_16x16x32_bf16 v[4:7], v[164:167], v[180:183], v[4:7]
    s_waitcnt lgkmcnt(6)
    v_mfma_f32_16x16x32_bf16 v[8:11], v[168:171], v[180:183], v[8:11]
    ds_read_b128 v[204:207], v216 offset:52224
    s_waitcnt lgkmcnt(4)
    v_mfma_f32_16x16x32_bf16 v[12:15], v[172:175], v[180:183], v[12:15]
    v_mfma_f32_16x16x32_bf16 v[16:19], v[160:163], v[184:187], v[16:19]
    ds_read_b128 v[176:179], v216 offset:53248
    v_mfma_f32_16x16x32_bf16 v[20:23], v[164:167], v[184:187], v[20:23]
    v_mfma_f32_16x16x32_bf16 v[24:27], v[168:171], v[184:187], v[24:27]
    v_mov_b32 v237, 18
    v_mfma_f32_16x16x32_bf16 v[28:31], v[172:175], v[184:187], v[28:31]
    v_mfma_f32_16x16x32_bf16 v[32:35], v[160:163], v[188:191], v[32:35]
    ds_read_b128 v[180:183], v216 offset:54272
    v_mfma_f32_16x16x32_bf16 v[36:39], v[164:167], v[188:191], v[36:39]
    s_waitcnt lgkmcnt(3)
    v_cmp_lt_u32 s[56:57], v252, 19
    v_mfma_f32_16x16x32_bf16 v[40:43], v[168:171], v[188:191], v[40:43]
    ds_write_b32 v250, v237 offset:16
    v_mfma_f32_16x16x32_bf16 v[44:47], v[172:175], v[188:191], v[44:47]
    v_mfma_f32_16x16x32_bf16 v[48:51], v[160:163], v[192:195], v[48:51]
    s_cmp_eq_u64 s[56:57], 0
    s_cbranch_scc0 G0_qs18
G0_qs18_ret:
    ds_read_b128 v[184:187], v216 offset:0
    v_mfma_f32_16x16x32_bf16 v[52:55], v[164:167], v[192:195], v[52:55]
    ds_read_b64_tr_b16 v[144:145], v212 offset:16384
    v_mfma_f32_16x16x32_bf16 v[56:59], v[168:171], v[192:195], v[56:59]
    ds_read_b64_tr_b16 v[146:147], v212 offset:17408
    v_mfma_f32_16x16x32_bf16 v[60:63], v[172:175], v[192:195], v[60:63]
    v_mfma_f32_16x16x32_bf16 v[64:67], v[160:163], v[196:199], v[64:67]
    ds_read_b128 v[188:191], v216 offset:1024
    v_mfma_f32_16x16x32_bf16 v[68:71], v[164:167], v[196:199], v[68:71]
    ds_read_b64_tr_b16 v[148:149], v213 offset:16384
    v_mfma_f32_16x16x32_bf16 v[72:75], v[168:171], v[196:199], v[72:75]
    ds_read_b64_tr_b16 v[150:151], v213 offset:17408
    v_mfma_f32_16x16x32_bf16 v[76:79], v[172:175], v[196:199], v[76:79]
    v_mfma_f32_16x16x32_bf16 v[80:83], v[160:163], v[200:203], v[80:83]
    ds_read_b128 v[192:195], v216 offset:2048
    v_mfma_f32_16x16x32_bf16 v[84:87], v[164:167], v[200:203], v[84:87]
    ds_read_b64_tr_b16 v[152:153], v214 offset:16384
    v_mfma_f32_16x16x32_bf16 v[88:91], v[168:171], v[200:203], v[88:91]
    ds_read_b64_tr_b16 v[154:155], v214 offset:17408
    v_mfma_f32_16x16x32_bf16 v[92:95], v[172:175], v[200:203], v[92:95]
    s_waitcnt lgkmcnt(12)
    v_mfma_f32_16x16x32_bf16 v[96:99], v[160:163], v[204:207], v[96:99]
    ds_read_b128 v[196:199], v216 offset:3072
    v_mfma_f32_16x16x32_bf16 v[100:103], v[164:167], v[204:207], v[100:103]
    ds_read_b64_tr_b16 v[156:157], v215 offset:16384
    v_mfma_f32_16x16x32_bf16 v[104:107], v[168:171], v[204:207], v[104:107]
    ds_read_b64_tr_b16 v[158:159], v215 offset:17408
    v_mfma_f32_16x16x32_bf16 v[108:111], v[172:175], v[204:207], v[108:111]
    s_waitcnt lgkmcnt(14)
    v_mfma_f32_16x16x32_bf16 v[112:115], v[160:163], v[176:179], v[112:115]
    ds_read_b128 v[200:203], v216 offset:4096
    v_mfma_f32_16x16x32_bf16 v[116:119], v[164:167], v[176:179], v[116:119]
    v_mfma_f32_16x16x32_bf16 v[120:123], v[168:171], v[176:179], v[120:123]
    v_mfma_f32_16x16x32_bf16 v[124:127], v[172:175], v[176:179], v[124:127]
    s_waitcnt lgkmcnt(14)
    v_mfma_f32_16x16x32_bf16 v[128:131], v[160:163], v[180:183], v[128:131]
    ds_read_b128 v[204:207], v216 offset:5120
    v_mfma_f32_16x16x32_bf16 v[132:135], v[164:167], v[180:183], v[132:135]
    v_mfma_f32_16x16x32_bf16 v[136:139], v[168:171], v[180:183], v[136:139]
    v_mfma_f32_16x16x32_bf16 v[140:143], v[172:175], v[180:183], v[140:143]
    s_waitcnt lgkmcnt(11)
    v_mfma_f32_16x16x32_bf16 v[0:3], v[144:147], v[184:187], v[0:3]
    ds_read_b32 v252, v251 offset:0
    s_waitcnt lgkmcnt(9)
    v_mfma_f32_16x16x32_bf16 v[4:7], v[148:151], v[184:187], v[4:7]
    s_waitcnt lgkmcnt(6)
    v_mfma_f32_16x16x32_bf16 v[8:11], v[152:155], v[184:187], v[8:11]
    ds_read_b128 v[176:179], v216 offset:6144
    s_waitcnt lgkmcnt(4)
    v_mfma_f32_16x16x32_bf16 v[12:15], v[156:159], v[184:187], v[12:15]
    v_mfma_f32_16x16x32_bf16 v[16:19], v[144:147], v[188:191], v[16:19]
    ds_read_b128 v[180:183], v216 offset:7168
    v_mfma_f32_16x16x32_bf16 v[20:23], v[148:151], v[188:191], v[20:23]
    v_mfma_f32_16x16x32_bf16 v[24:27], v[152:155], v[188:191], v[24:27]
    v_mfma_f32_16x16x32_bf16 v[28:31], v[156:159], v[188:191], v[28:31]
    v_mfma_f32_16x16x32_bf16 v[32:35], v[144:147], v[192:195], v[32:35]
    ds_read_b128 v[184:187], v216 offset:8192
    v_mfma_f32_16x16x32_bf16 v[36:39], v[148:151], v[192:195], v[36:39]
    v_mfma_f32_16x16x32_bf16 v[40:43], v[152:155], v[192:195], v[40:43]
    s_waitcnt lgkmcnt(3)
    v_cmp_lt_u32 s[56:57], v252, 20
    v_mfma_f32_16x16x32_bf16 v[44:47], v[156:159], v[192:195], v[44:47]
    v_mfma_f32_16x16x32_bf16 v[48:51], v[144:147], v[196:199], v[48:51]
    s_cmp_eq_u64 s[56:57], 0
    s_cbranch_scc0 G0_qs19
G0_qs19_ret:
    ds_read_b128 v[188:191], v216 offset:9216
    v_mfma_f32_16x16x32_bf16 v[52:55], v[148:151], v[196:199], v[52:55]
    ds_read_b64_tr_b16 v[160:161], v212 offset:32768
    v_mfma_f32_16x16x32_bf16 v[56:59], v[152:155], v[196:199], v[56:59]
    ds_read_b64_tr_b16 v[162:163], v212 offset:33792
    v_mfma_f32_16x16x32_bf16 v[60:63], v[156:159], v[196:199], v[60:63]
    v_mfma_f32_16x16x32_bf16 v[64:67], v[144:147], v[200:203], v[64:67]
    ds_read_b128 v[192:195], v216 offset:10240
    v_mfma_f32_16x16x32_bf16 v[68:71], v[148:151], v[200:203], v[68:71]
    ds_read_b64_tr_b16 v[164:165], v213 offset:32768
    v_mfma_f32_16x16x32_bf16 v[72:75], v[152:155], v[200:203], v[72:75]
    ds_read_b64_tr_b16 v[166:167], v213 offset:33792
    v_mfma_f32_16x16x32_bf16 v[76:79], v[156:159], v[200:203], v[76:79]
    v_mfma_f32_16x16x32_bf16 v[80:83], v[144:147], v[204:207], v[80:83]
    ds_read_b128 v[196:199], v216 offset:11264
    v_mfma_f32_16x16x32_bf16 v[84:87], v[148:151], v[204:207], v[84:87]
    ds_read_b64_tr_b16 v[168:169], v214 offset:32768
    v_mfma_f32_16x16x32_bf16 v[88:91], v[152:155], v[204:207], v[88:91]
    ds_read_b64_tr_b16 v[170:171], v214 offset:33792
    v_mfma_f32_16x16x32_bf16 v[92:95], v[156:159], v[204:207], v[92:95]
    s_waitcnt lgkmcnt(11)
    v_mfma_f32_16x16x32_bf16 v[96:99], v[144:147], v[176:179], v[96:99]
    ds_read_b128 v[200:203], v216 offset:12288
    v_mfma_f32_16x16x32_bf16 v[100:103], v[148:151], v[176:179], v[100:103]
    ds_read_b64_tr_b16 v[172:173], v215 offset:32768
    v_mfma_f32_16x16x32_bf16 v[104:107], v[152:155], v[176:179], v[104:107]
    ds_read_b64_tr_b16 v[174:175], v215 offset:33792
    v_mfma_f32_16x16x32_bf16 v[108:111], v[156:159], v[176:179], v[108:111]
    s_waitcnt lgkmcnt(13)
    v_mfma_f32_16x16x32_bf16 v[112:115], v[144:147], v[180:183], v[112:115]
    ds_read_b128 v[204:207], v216 offset:13312
    v_mfma_f32_16x16x32_bf16 v[116:119], v[148:151], v[180:183], v[116:119]
    v_mfma_f32_16x16x32_bf16 v[120:123], v[152:155], v[180:183], v[120:123]
    v_mfma_f32_16x16x32_bf16 v[124:127], v[156:159], v[180:183], v[124:127]
    s_waitcnt lgkmcnt(13)
    v_mfma_f32_16x16x32_bf16 v[128:131], v[144:147], v[184:187], v[128:131]
    ds_read_b128 v[176:179], v216 offset:14336
    v_mfma_f32_16x16x32_bf16 v[132:135], v[148:151], v[184:187], v[132:135]
    v_mfma_f32_16x16x32_bf16 v[136:139], v[152:155], v[184:187], v[136:139]
    v_mfma_f32_16x16x32_bf16 v[140:143], v[156:159], v[184:187], v[140:143]
    s_waitcnt lgkmcnt(11)
    v_mfma_f32_16x16x32_bf16 v[0:3], v[160:163], v[188:191], v[0:3]
    ds_read_b32 v252, v251 offset:0
    s_waitcnt lgkmcnt(9)
    v_mfma_f32_16x16x32_bf16 v[4:7], v[164:167], v[188:191], v[4:7]
    s_waitcnt lgkmcnt(6)
    v_mfma_f32_16x16x32_bf16 v[8:11], v[168:171], v[188:191], v[8:11]
    ds_read_b128 v[180:183], v216 offset:15360
    s_waitcnt lgkmcnt(4)
    v_mfma_f32_16x16x32_bf16 v[12:15], v[172:175], v[188:191], v[12:15]
    v_mfma_f32_16x16x32_bf16 v[16:19], v[160:163], v[192:195], v[16:19]
    ds_read_b128 v[184:187], v216 offset:16384
    v_mfma_f32_16x16x32_bf16 v[20:23], v[164:167], v[192:195], v[20:23]
    v_mfma_f32_16x16x32_bf16 v[24:27], v[168:171], v[192:195], v[24:27]
    v_mov_b32 v237, 20
    v_mfma_f32_16x16x32_bf16 v[28:31], v[172:175], v[192:195], v[28:31]
    v_mfma_f32_16x16x32_bf16 v[32:35], v[160:163], v[196:199], v[32:35]
    ds_read_b128 v[188:191], v216 offset:17408
    v_mfma_f32_16x16x32_bf16 v[36:39], v[164:167], v[196:199], v[36:39]
    s_waitcnt lgkmcnt(3)
    v_cmp_lt_u32 s[56:57], v252, 21
    v_mfma_f32_16x16x32_bf16 v[40:43], v[168:171], v[196:199], v[40:43]
    ds_write_b32 v250, v237 offset:16
    v_mfma_f32_16x16x32_bf16 v[44:47], v[172:175], v[196:199], v[44:47]
    v_mfma_f32_16x16x32_bf16 v[48:51], v[160:163], v[200:203], v[48:51]
    s_cmp_eq_u64 s[56:57], 0
    s_cbranch_scc0 G0_qs20
G0_qs20_ret:
    ds_read_b128 v[192:195], v216 offset:18432
    v_mfma_f32_16x16x32_bf16 v[52:55], v[164:167], v[200:203], v[52:55]
    ds_read_b64_tr_b16 v[144:145], v208 offset:0
    v_mfma_f32_16x16x32_bf16 v[56:59], v[168:171], v[200:203], v[56:59]
    ds_read_b64_tr_b16 v[146:147], v208 offset:1024
    v_mfma_f32_16x16x32_bf16 v[60:63], v[172:175], v[200:203], v[60:63]
    v_mfma_f32_16x16x32_bf16 v[64:67], v[160:163], v[204:207], v[64:67]
    ds_read_b128 v[196:199], v216 offset:19456
    v_mfma_f32_16x16x32_bf16 v[68:71], v[164:167], v[204:207], v[68:71]
    ds_read_b64_tr_b16 v[148:149], v209 offset:0
    v_mfma_f32_16x16x32_bf16 v[72:75], v[168:171], v[204:207], v[72:75]
    ds_read_b64_tr_b16 v[150:151], v209 offset:1024
    v_mfma_f32_16x16x32_bf16 v[76:79], v[172:175], v[204:207], v[76:79]
    v_mfma_f32_16x16x32_bf16 v[80:83], v[160:163], v[176:179], v[80:83]
    ds_read_b128 v[200:203], v216 offset:20480
    v_mfma_f32_16x16x32_bf16 v[84:87], v[164:167], v[176:179], v[84:87]
    ds_read_b64_tr_b16 v[152:153], v210 offset:0
    v_mfma_f32_16x16x32_bf16 v[88:91], v[168:171], v[176:179], v[88:91]
    ds_read_b64_tr_b16 v[154:155], v210 offset:1024
    v_mfma_f32_16x16x32_bf16 v[92:95], v[172:175], v[176:179], v[92:95]
    s_waitcnt lgkmcnt(12)
    v_mfma_f32_16x16x32_bf16 v[96:99], v[160:163], v[180:183], v[96:99]
    ds_read_b128 v[204:207], v216 offset:21504
    v_mfma_f32_16x16x32_bf16 v[100:103], v[164:167], v[180:183], v[100:103]
    ds_read_b64_tr_b16 v[156:157], v211 offset:0
    v_mfma_f32_16x16x32_bf16 v[104:107], v[168:171], v[180:183], v[104:107]
    ds_read_b64_tr_b16 v[158:159], v211 offset:1024
    v_mfma_f32_16x16x32_bf16 v[108:111], v[172:175], v[180:183], v[108:111]
    s_waitcnt lgkmcnt(14)
    v_mfma_f32_16x16x32_bf16 v[112:115], v[160:163], v[184:187], v[112:115]
    ds_read_b128 v[176:179], v216 offset:22528
    v_mfma_f32_16x16x32_bf16 v[116:119], v[164:167], v[184:187], v[116:119]
    v_mfma_f32_16x16x32_bf16 v[120:123], v[168:171], v[184:187], v[120:123]
    v_mfma_f32_16x16x32_bf16 v[124:127], v[172:175], v[184:187], v[124:127]
    s_waitcnt lgkmcnt(14)
    v_mfma_f32_16x16x32_bf16 v[128:131], v[160:163], v[188:191], v[128:131]
    ds_read_b128 v[180:183], v216 offset:23552
    v_mfma_f32_16x16x32_bf16 v[132:135], v[164:167], v[188:191], v[132:135]
    v_mfma_f32_16x16x32_bf16 v[136:139], v[168:171], v[188:191], v[136:139]
    v_mfma_f32_16x16x32_bf16 v[140:143], v[172:175], v[188:191], v[140:143]
    s_waitcnt lgkmcnt(11)
    v_mfma_f32_16x16x32_bf16 v[0:3], v[144:147], v[192:195], v[0:3]
    ds_read_b32 v252, v251 offset:0
    s_waitcnt lgkmcnt(9)
    v_mfma_f32_16x16x32_bf16 v[4:7], v[148:151], v[192:195], v[4:7]
    s_waitcnt lgkmcnt(6)
    v_mfma_f32_16x16x32_bf16 v[8:11], v[152:155], v[192:195], v[8:11]
    ds_read_b128 v[184:187], v216 offset:24576
    s_waitcnt lgkmcnt(4)
    v_mfma_f32_16x16x32_bf16 v[12:15], v[156:159], v[192:195], v[12:15]
    v_mfma_f32_16x16x32_bf16 v[16:19], v[144:147], v[196:199], v[16:19]
    ds_read_b128 v[188:191], v216 offset:25600
    v_mfma_f32_16x16x32_bf16 v[20:23], v[148:151], v[196:199], v[20:23]
    v_mfma_f32_16x16x32_bf16 v[24:27], v[152:155], v[196:199], v[24:27]
    v_mfma_f32_16x16x32_bf16 v[28:31], v[156:159], v[196:199], v[28:31]
    v_mfma_f32_16x16x32_bf16 v[32:35], v[144:147], v[200:203], v[32:35]
    ds_read_b128 v[192:195], v216 offset:26624
    v_mfma_f32_16x16x32_bf16 v[36:39], v[148:151], v[200:203], v[36:39]
    v_mfma_f32_16x16x32_bf16 v[40:43], v[152:155], v[200:203], v[40:43]
    s_waitcnt lgkmcnt(3)
    v_cmp_lt_u32 s[56:57], v252, 22
    v_mfma_f32_16x16x32_bf16 v[44:47], v[156:159], v[200:203], v[44:47]
    v_mfma_f32_16x16x32_bf16 v[48:51], v[144:147], v[204:207], v[48:51]
    s_cmp_eq_u64 s[56:57], 0
    s_cbranch_scc0 G0_qs21
G0_qs21_ret:
    ds_read_b128 v[196:199], v216 offset:27648
    v_mfma_f32_16x16x32_bf16 v[52:55], v[148:151], v[204:207], v[52:55]
    ds_read_b64_tr_b16 v[160:161], v208 offset:16384
    v_mfma_f32_16x16x32_bf16 v[56:59], v[152:155], v[204:207], v[56:59]
    ds_read_b64_tr_b16 v[162:163], v208 offset:17408
    v_mfma_f32_16x16x32_bf16 v[60:63], v[156:159], v[204:207], v[60:63]
    v_mfma_f32_16x16x32_bf16 v[64:67], v[144:147], v[176:179], v[64:67]
    ds_read_b128 v[200:203], v216 offset:28672
    v_mfma_f32_16x16x32_bf16 v[68:71], v[148:151], v[176:179], v[68:71]
    ds_read_b64_tr_b16 v[164:165], v209 offset:16384
    v_mfma_f32_16x16x32_bf16 v[72:75], v[152:155], v[176:179], v[72:75]
    ds_read_b64_tr_b16 v[166:167], v209 offset:17408
    v_mfma_f32_16x16x32_bf16 v[76:79], v[156:159], v[176:179], v[76:79]
    v_mfma_f32_16x16x32_bf16 v[80:83], v[144:147], v[180:183], v[80:83]
    ds_read_b128 v[204:207], v216 offset:29696
    v_mfma_f32_16x16x32_bf16 v[84:87], v[148:151], v[180:183], v[84:87]
    ds_read_b64_tr_b16 v[168:169], v210 offset:16384
    v_mfma_f32_16x16x32_bf16 v[88:91], v[152:155], v[180:183], v[88:91]
    ds_read_b64_tr_b16 v[170:171], v210 offset:17408
    v_mfma_f32_16x16x32_bf16 v[92:95], v[156:159], v[180:183], v[92:95]
    s_waitcnt lgkmcnt(11)
    v_mfma_f32_16x16x32_bf16 v[96:99], v[144:147], v[184:187], v[96:99]
    ds_read_b128 v[176:179], v216 offset:30720
    v_mfma_f32_16x16x32_bf16 v[100:103], v[148:151], v[184:187], v[100:103]
    ds_read_b64_tr_b16 v[172:173], v211 offset:16384
    v_mfma_f32_16x16x32_bf16 v[104:107], v[152:155], v[184:187], v[104:107]
    ds_read_b64_tr_b16 v[174:175], v211 offset:17408
    v_mfma_f32_16x16x32_bf16 v[108:111], v[156:159], v[184:187], v[108:111]
    s_waitcnt lgkmcnt(13)
    v_mfma_f32_16x16x32_bf16 v[112:115], v[144:147], v[188:191], v[112:115]
    ds_read_b128 v[180:183], v216 offset:31744
    v_mfma_f32_16x16x32_bf16 v[116:119], v[148:151], v[188:191], v[116:119]
    v_mfma_f32_16x16x32_bf16 v[120:123], v[152:155], v[188:191], v[120:123]
    v_mfma_f32_16x16x32_bf16 v[124:127], v[156:159], v[188:191], v[124:127]
    s_waitcnt lgkmcnt(13)
    v_mfma_f32_16x16x32_bf16 v[128:131], v[144:147], v[192:195], v[128:131]
    ds_read_b128 v[184:187], v216 offset:32768
    v_mfma_f32_16x16x32_bf16 v[132:135], v[148:151], v[192:195], v[132:135]
    v_mfma_f32_16x16x32_bf16 v[136:139], v[152:155], v[192:195], v[136:139]
    v_mfma_f32_16x16x32_bf16 v[140:143], v[156:159], v[192:195], v[140:143]
    s_waitcnt lgkmcnt(11)
    v_mfma_f32_16x16x32_bf16 v[0:3], v[160:163], v[196:199], v[0:3]
    ds_read_b32 v252, v251 offset:0
    s_waitcnt lgkmcnt(9)
    v_mfma_f32_16x16x32_bf16 v[4:7], v[164:167], v[196:199], v[4:7]
    s_waitcnt lgkmcnt(6)
    v_mfma_f32_16x16x32_bf16 v[8:11], v[168:171], v[196:199], v[8:11]
    ds_read_b128 v[188:191], v216 offset:33792
    s_waitcnt lgkmcnt(4)
    v_mfma_f32_16x16x32_bf16 v[12:15], v[172:175], v[196:199], v[12:15]
    v_mfma_f32_16x16x32_bf16 v[16:19], v[160:163], v[200:203], v[16:19]
    ds_read_b128 v[192:195], v216 offset:34816
    v_mfma_f32_16x16x32_bf16 v[20:23], v[164:167], v[200:203], v[20:23]
    v_mfma_f32_16x16x32_bf16 v[24:27], v[168:171], v[200:203], v[24:27]
    v_mov_b32 v237, 22
    v_mfma_f32_16x16x32_bf16 v[28:31], v[172:175], v[200:203], v[28:31]
    v_mfma_f32_16x16x32_bf16 v[32:35], v[160:163], v[204:207], v[32:35]
    ds_read_b128 v[196:199], v216 offset:35840
    v_mfma_f32_16x16x32_bf16 v[36:39], v[164:167], v[204:207], v[36:39]
    s_waitcnt lgkmcnt(3)
    v_cmp_lt_u32 s[56:57], v252, 23
    v_mfma_f32_16x16x32_bf16 v[40:43], v[168:171], v[204:207], v[40:43]
    ds_write_b32 v250, v237 offset:16
    v_mfma_f32_16x16x32_bf16 v[44:47], v[172:175], v[204:207], v[44:47]
    v_mfma_f32_16x16x32_bf16 v[48:51], v[160:163], v[176:179], v[48:51]
    s_cmp_eq_u64 s[56:57], 0
    s_cbranch_scc0 G0_qs22
G0_qs22_ret:
    ds_read_b128 v[200:203], v216 offset:36864
    v_mfma_f32_16x16x32_bf16 v[52:55], v[164:167], v[176:179], v[52:55]
    ds_read_b64_tr_b16 v[144:145], v208 offset:49152
    v_mfma_f32_16x16x32_bf16 v[56:59], v[168:171], v[176:179], v[56:59]
    ds_read_b64_tr_b16 v[146:147], v208 offset:50176
    v_mfma_f32_16x16x32_bf16 v[60:63], v[172:175], v[176:179], v[60:63]
    v_mfma_f32_16x16x32_bf16 v[64:67], v[160:163], v[180:183], v[64:67]
    ds_read_b128 v[204:207], v216 offset:37888
    v_mfma_f32_16x16x32_bf16 v[68:71], v[164:167], v[180:183], v[68:71]
    ds_read_b64_tr_b16 v[148:149], v209 offset:49152
    v_mfma_f32_16x16x32_bf16 v[72:75], v[168:171], v[180:183], v[72:75]
    ds_read_b64_tr_b16 v[150:151], v209 offset:50176
    v_mfma_f32_16x16x32_bf16 v[76:79], v[172:175], v[180:183], v[76:79]
    v_mfma_f32_16x16x32_bf16 v[80:83], v[160:163], v[184:187], v[80:83]
    ds_read_b128 v[176:179], v216 offset:38912
    v_mfma_f32_16x16x32_bf16 v[84:87], v[164:167], v[184:187], v[84:87]
    ds_read_b64_tr_b16 v[152:153], v210 offset:49152
    v_mfma_f32_16x16x32_bf16 v[88:91], v[168:171], v[184:187], v[88:91]
    ds_read_b64_tr_b16 v[154:155], v210 offset:50176
    v_mfma_f32_16x16x32_bf16 v[92:95], v[172:175], v[184:187], v[92:95]
    s_waitcnt lgkmcnt(12)
    v_mfma_f32_16x16x32_bf16 v[96:99], v[160:163], v[188:191], v[96:99]
    ds_read_b128 v[180:183], v216 offset:39936
    v_mfma_f32_16x16x32_bf16 v[100:103], v[164:167], v[188:191], v[100:103]
    ds_read_b64_tr_b16 v[156:157], v211 offset:49152
    v_mfma_f32_16x16x32_bf16 v[104:107], v[168:171], v[188:191], v[104:107]
    ds_read_b64_tr_b16 v[158:159], v211 offset:50176
    v_mfma_f32_16x16x32_bf16 v[108:111], v[172:175], v[188:191], v[108:111]
    s_waitcnt lgkmcnt(14)
    v_mfma_f32_16x16x32_bf16 v[112:115], v[160:163], v[192:195], v[112:115]
    ds_read_b128 v[184:187], v216 offset:40960
    v_mfma_f32_16x16x32_bf16 v[116:119], v[164:167], v[192:195], v[116:119]
    v_mfma_f32_16x16x32_bf16 v[120:123], v[168:171], v[192:195], v[120:123]
    v_mfma_f32_16x16x32_bf16 v[124:127], v[172:175], v[192:195], v[124:127]
    s_waitcnt lgkmcnt(14)
    v_mfma_f32_16x16x32_bf16 v[128:131], v[160:163], v[196:199], v[128:131]
    ds_read_b128 v[188:191], v216 offset:41984
    v_mfma_f32_16x16x32_bf16 v[132:135], v[164:167], v[196:199], v[132:135]
    v_mfma_f32_16x16x32_bf16 v[136:139], v[168:171], v[196:199], v[136:139]
    v_mfma_f32_16x16x32_bf16 v[140:143], v[172:175], v[196:199], v[140:143]
    s_waitcnt lgkmcnt(11)
    v_mfma_f32_16x16x32_bf16 v[0:3], v[144:147], v[200:203], v[0:3]
    ds_read_b32 v252, v251 offset:0
    s_waitcnt lgkmcnt(9)
    v_mfma_f32_16x16x32_bf16 v[4:7], v[148:151], v[200:203], v[4:7]
    s_waitcnt lgkmcnt(6)
    v_mfma_f32_16x16x32_bf16 v[8:11], v[152:155], v[200:203], v[8:11]
    ds_read_b128 v[192:195], v216 offset:43008
    s_waitcnt lgkmcnt(4)
    v_mfma_f32_16x16x32_bf16 v[12:15], v[156:159], v[200:203], v[12:15]
    v_mfma_f32_16x16x32_bf16 v[16:19], v[144:147], v[204:207], v[16:19]
    ds_read_b128 v[196:199], v216 offset:44032
    v_mfma_f32_16x16x32_bf16 v[20:23], v[148:151], v[204:207], v[20:23]
    v_mfma_f32_16x16x32_bf16 v[24:27], v[152:155], v[204:207], v[24:27]
    v_mfma_f32_16x16x32_bf16 v[28:31], v[156:159], v[204:207], v[28:31]
    v_mfma_f32_16x16x32_bf16 v[32:35], v[144:147], v[176:179], v[32:35]
    ds_read_b128 v[200:203], v216 offset:45056
    v_mfma_f32_16x16x32_bf16 v[36:39], v[148:151], v[176:179], v[36:39]
    v_mfma_f32_16x16x32_bf16 v[40:43], v[152:155], v[176:179], v[40:43]
    s_waitcnt lgkmcnt(3)
    v_cmp_lt_u32 s[56:57], v252, 24
    v_mfma_f32_16x16x32_bf16 v[44:47], v[156:159], v[176:179], v[44:47]
    v_mfma_f32_16x16x32_bf16 v[48:51], v[144:147], v[180:183], v[48:51]
    s_cmp_eq_u64 s[56:57], 0
    s_cbranch_scc0 G0_qs23
G0_qs23_ret:
    ds_read_b128 v[204:207], v216 offset:46080
    v_mfma_f32_16x16x32_bf16 v[52:55], v[148:151], v[180:183], v[52:55]
    ds_read_b64_tr_b16 v[160:161], v208 offset:32768
    v_mfma_f32_16x16x32_bf16 v[56:59], v[152:155], v[180:183], v[56:59]
    ds_read_b64_tr_b16 v[162:163], v208 offset:33792
    v_mfma_f32_16x16x32_bf16 v[60:63], v[156:159], v[180:183], v[60:63]
    v_mfma_f32_16x16x32_bf16 v[64:67], v[144:147], v[184:187], v[64:67]
    ds_read_b128 v[176:179], v216 offset:47104
    v_mfma_f32_16x16x32_bf16 v[68:71], v[148:151], v[184:187], v[68:71]
    ds_read_b64_tr_b16 v[164:165], v209 offset:32768
    v_mfma_f32_16x16x32_bf16 v[72:75], v[152:155], v[184:187], v[72:75]
    ds_read_b64_tr_b16 v[166:167], v209 offset:33792
    v_mfma_f32_16x16x32_bf16 v[76:79], v[156:159], v[184:187], v[76:79]
    v_mfma_f32_16x16x32_bf16 v[80:83], v[144:147], v[188:191], v[80:83]
    ds_read_b128 v[180:183], v216 offset:48128
    v_mfma_f32_16x16x32_bf16 v[84:87], v[148:151], v[188:191], v[84:87]
    ds_read_b64_tr_b16 v[168:169], v210 offset:32768
    v_mfma_f32_16x16x32_bf16 v[88:91], v[152:155], v[188:191], v[88:91]
    ds_read_b64_tr_b16 v[170:171], v210 offset:33792
    v_mfma_f32_16x16x32_bf16 v[92:95], v[156:159], v[188:191], v[92:95]
    s_waitcnt lgkmcnt(11)
    v_mfma_f32_16x16x32_bf16 v[96:99], v[144:147], v[192:195], v[96:99]
    ds_read_b128 v[184:187], v216 offset:49152
    v_mfma_f32_16x16x32_bf16 v[100:103], v[148:151], v[192:195], v[100:103]
    ds_read_b64_tr_b16 v[172:173], v211 offset:32768
    v_mfma_f32_16x16x32_bf16 v[104:107], v[152:155], v[192:195], v[104:107]
    ds_read_b64_tr_b16 v[174:175], v211 offset:33792
    v_mfma_f32_16x16x32_bf16 v[108:111], v[156:159], v[192:195], v[108:111]
    s_waitcnt lgkmcnt(13)
    v_mfma_f32_16x16x32_bf16 v[112:115], v[144:147], v[196:199], v[112:115]
    ds_read_b128 v[188:191], v216 offset:50176
    v_mfma_f32_16x16x32_bf16 v[116:119], v[148:151], v[196:199], v[116:119]
    v_mfma_f32_16x16x32_bf16 v[120:123], v[152:155], v[196:199], v[120:123]
    v_mfma_f32_16x16x32_bf16 v[124:127], v[156:159], v[196:199], v[124:127]
    s_waitcnt lgkmcnt(13)
    v_mfma_f32_16x16x32_bf16 v[128:131], v[144:147], v[200:203], v[128:131]
    ds_read_b128 v[192:195], v216 offset:51200
    v_mfma_f32_16x16x32_bf16 v[132:135], v[148:151], v[200:203], v[132:135]
    v_mfma_f32_16x16x32_bf16 v[136:139], v[152:155], v[200:203], v[136:139]
    v_mfma_f32_16x16x32_bf16 v[140:143], v[156:159], v[200:203], v[140:143]
    s_waitcnt lgkmcnt(11)
    v_mfma_f32_16x16x32_bf16 v[0:3], v[160:163], v[204:207], v[0:3]
    ds_read_b32 v252, v251 offset:0
    s_waitcnt lgkmcnt(9)
    v_mfma_f32_16x16x32_bf16 v[4:7], v[164:167], v[204:207], v[4:7]
    s_waitcnt lgkmcnt(6)
    v_mfma_f32_16x16x32_bf16 v[8:11], v[168:171], v[204:207], v[8:11]
    ds_read_b128 v[196:199], v216 offset:52224
    s_waitcnt lgkmcnt(4)
    v_mfma_f32_16x16x32_bf16 v[12:15], v[172:175], v[204:207], v[12:15]
    v_mfma_f32_16x16x32_bf16 v[16:19], v[160:163], v[176:179], v[16:19]
    ds_read_b128 v[200:203], v216 offset:53248
    v_mfma_f32_16x16x32_bf16 v[20:23], v[164:167], v[176:179], v[20:23]
    v_mfma_f32_16x16x32_bf16 v[24:27], v[168:171], v[176:179], v[24:27]
    v_mov_b32 v237, 24
    v_mfma_f32_16x16x32_bf16 v[28:31], v[172:175], v[176:179], v[28:31]
    v_mfma_f32_16x16x32_bf16 v[32:35], v[160:163], v[180:183], v[32:35]
    ds_read_b128 v[204:207], v216 offset:54272
    v_mfma_f32_16x16x32_bf16 v[36:39], v[164:167], v[180:183], v[36:39]
    s_waitcnt lgkmcnt(3)
    v_cmp_lt_u32 s[56:57], v252, 25
    v_mfma_f32_16x16x32_bf16 v[40:43], v[168:171], v[180:183], v[40:43]
    ds_write_b32 v250, v237 offset:16
    v_mfma_f32_16x16x32_bf16 v[44:47], v[172:175], v[180:183], v[44:47]
    v_mfma_f32_16x16x32_bf16 v[48:51], v[160:163], v[184:187], v[48:51]
    s_cmp_eq_u64 s[56:57], 0
    s_cbranch_scc0 G0_qs24
G0_qs24_ret:
    ds_read_b128 v[176:179], v216 offset:0
    v_mfma_f32_16x16x32_bf16 v[52:55], v[164:167], v[184:187], v[52:55]
    ds_read_b64_tr_b16 v[144:145], v212 offset:16384
    v_mfma_f32_16x16x32_bf16 v[56:59], v[168:171], v[184:187], v[56:59]
    ds_read_b64_tr_b16 v[146:147], v212 offset:17408
    v_mfma_f32_16x16x32_bf16 v[60:63], v[172:175], v[184:187], v[60:63]
    v_mfma_f32_16x16x32_bf16 v[64:67], v[160:163], v[188:191], v[64:67]
    ds_read_b128 v[180:183], v216 offset:1024
    v_mfma_f32_16x16x32_bf16 v[68:71], v[164:167], v[188:191], v[68:71]
    ds_read_b64_tr_b16 v[148:149], v213 offset:16384
    v_mfma_f32_16x16x32_bf16 v[72:75], v[168:171], v[188:191], v[72:75]
    ds_read_b64_tr_b16 v[150:151], v213 offset:17408
    v_mfma_f32_16x16x32_bf16 v[76:79], v[172:175], v[188:191], v[76:79]
    v_mfma_f32_16x16x32_bf16 v[80:83], v[160:163], v[192:195], v[80:83]
    ds_read_b128 v[184:187], v216 offset:2048
    v_mfma_f32_16x16x32_bf16 v[84:87], v[164:167], v[192:195], v[84:87]
    ds_read_b64_tr_b16 v[152:153], v214 offset:16384
    v_mfma_f32_16x16x32_bf16 v[88:91], v[168:171], v[192:195], v[88:91]
    ds_read_b64_tr_b16 v[154:155], v214 offset:17408
    v_mfma_f32_16x16x32_bf16 v[92:95], v[172:175], v[192:195], v[92:95]
    s_waitcnt lgkmcnt(12)
    v_mfma_f32_16x16x32_bf16 v[96:99], v[160:163], v[196:199], v[96:99]
    ds_read_b128 v[188:191], v216 offset:3072
    v_mfma_f32_16x16x32_bf16 v[100:103], v[164:167], v[196:199], v[100:103]
    ds_read_b64_tr_b16 v[156:157], v215 offset:16384
    v_mfma_f32_16x16x32_bf16 v[104:107], v[168:171], v[196:199], v[104:107]
    ds_read_b64_tr_b16 v[158:159], v215 offset:17408
    v_mfma_f32_16x16x32_bf16 v[108:111], v[172:175], v[196:199], v[108:111]
    s_waitcnt lgkmcnt(14)
    v_mfma_f32_16x16x32_bf16 v[112:115], v[160:163], v[200:203], v[112:115]
    ds_read_b128 v[192:195], v216 offset:4096
    v_mfma_f32_16x16x32_bf16 v[116:119], v[164:167], v[200:203], v[116:119]
    v_mfma_f32_16x16x32_bf16 v[120:123], v[168:171], v[200:203], v[120:123]
    v_mfma_f32_16x16x32_bf16 v[124:127], v[172:175], v[200:203], v[124:127]
    s_waitcnt lgkmcnt(14)
    v_mfma_f32_16x16x32_bf16 v[128:131], v[160:163], v[204:207], v[128:131]
    ds_read_b128 v[196:199], v216 offset:5120
    v_mfma_f32_16x16x32_bf16 v[132:135], v[164:167], v[204:207], v[132:135]
    v_mfma_f32_16x16x32_bf16 v[136:139], v[168:171], v[204:207], v[136:139]
    v_mfma_f32_16x16x32_bf16 v[140:143], v[172:175], v[204:207], v[140:143]
    s_waitcnt lgkmcnt(11)
    v_mfma_f32_16x16x32_bf16 v[0:3], v[144:147], v[176:179], v[0:3]
    ds_read_b32 v252, v251 offset:0
    s_waitcnt lgkmcnt(9)
    v_mfma_f32_16x16x32_bf16 v[4:7], v[148:151], v[176:179], v[4:7]
    s_waitcnt lgkmcnt(6)
    v_mfma_f32_16x16x32_bf16 v[8:11], v[152:155], v[176:179], v[8:11]
    ds_read_b128 v[200:203], v216 offset:6144
    s_waitcnt lgkmcnt(4)
    v_mfma_f32_16x16x32_bf16 v[12:15], v[156:159], v[176:179], v[12:15]
    v_mfma_f32_16x16x32_bf16 v[16:19], v[144:147], v[180:183], v[16:19]
    ds_read_b128 v[204:207], v216 offset:7168
    v_mfma_f32_16x16x32_bf16 v[20:23], v[148:151], v[180:183], v[20:23]
    v_mfma_f32_16x16x32_bf16 v[24:27], v[152:155], v[180:183], v[24:27]
    v_mfma_f32_16x16x32_bf16 v[28:31], v[156:159], v[180:183], v[28:31]
    v_mfma_f32_16x16x32_bf16 v[32:35], v[144:147], v[184:187], v[32:35]
    ds_read_b128 v[176:179], v216 offset:8192
    v_mfma_f32_16x16x32_bf16 v[36:39], v[148:151], v[184:187], v[36:39]
    v_mfma_f32_16x16x32_bf16 v[40:43], v[152:155], v[184:187], v[40:43]
    s_waitcnt lgkmcnt(3)
    v_cmp_lt_u32 s[56:57], v252, 26
    v_mfma_f32_16x16x32_bf16 v[44:47], v[156:159], v[184:187], v[44:47]
    v_mfma_f32_16x16x32_bf16 v[48:51], v[144:147], v[188:191], v[48:51]
    s_cmp_eq_u64 s[56:57], 0
    s_cbranch_scc0 G0_qs25
G0_qs25_ret:
    ds_read_b128 v[180:183], v216 offset:9216
    v_mfma_f32_16x16x32_bf16 v[52:55], v[148:151], v[188:191], v[52:55]
    ds_read_b64_tr_b16 v[160:161], v212 offset:32768
    v_mfma_f32_16x16x32_bf16 v[56:59], v[152:155], v[188:191], v[56:59]
    ds_read_b64_tr_b16 v[162:163], v212 offset:33792
    v_mfma_f32_16x16x32_bf16 v[60:63], v[156:159], v[188:191], v[60:63]
    v_mfma_f32_16x16x32_bf16 v[64:67], v[144:147], v[192:195], v[64:67]
    ds_read_b128 v[184:187], v216 offset:10240
    v_mfma_f32_16x16x32_bf16 v[68:71], v[148:151], v[192:195], v[68:71]
    ds_read_b64_tr_b16 v[164:165], v213 offset:32768
    v_mfma_f32_16x16x32_bf16 v[72:75], v[152:155], v[192:195], v[72:75]
    ds_read_b64_tr_b16 v[166:167], v213 offset:33792
    v_mfma_f32_16x16x32_bf16 v[76:79], v[156:159], v[192:195], v[76:79]
    v_mfma_f32_16x16x32_bf16 v[80:83], v[144:147], v[196:199], v[80:83]
    ds_read_b128 v[188:191], v216 offset:11264
    v_mfma_f32_16x16x32_bf16 v[84:87], v[148:151], v[196:199], v[84:87]
    ds_read_b64_tr_b16 v[168:169], v214 offset:32768
    v_mfma_f32_16x16x32_bf16 v[88:91], v[152:155], v[196:199], v[88:91]
    ds_read_b64_tr_b16 v[170:171], v214 offset:33792
    v_mfma_f32_16x16x32_bf16 v[92:95], v[156:159], v[196:199], v[92:95]
    s_waitcnt lgkmcnt(11)
    v_mfma_f32_16x16x32_bf16 v[96:99], v[144:147], v[200:203], v[96:99]
    ds_read_b128 v[192:195], v216 offset:12288
    v_mfma_f32_16x16x32_bf16 v[100:103], v[148:151], v[200:203], v[100:103]
    ds_read_b64_tr_b16 v[172:173], v215 offset:32768
    v_mfma_f32_16x16x32_bf16 v[104:107], v[152:155], v[200:203], v[104:107]
    ds_read_b64_tr_b16 v[174:175], v215 offset:33792
    v_mfma_f32_16x16x32_bf16 v[108:111], v[156:159], v[200:203], v[108:111]
    s_waitcnt lgkmcnt(13)
    v_mfma_f32_16x16x32_bf16 v[112:115], v[144:147], v[204:207], v[112:115]
    ds_read_b128 v[196:199], v216 offset:13312
    v_mfma_f32_16x16x32_bf16 v[116:119], v[148:151], v[204:207], v[116:119]
    v_mfma_f32_16x16x32_bf16 v[120:123], v[152:155], v[204:207], v[120:123]
    v_mfma_f32_16x16x32_bf16 v[124:127], v[156:159], v[204:207], v[124:127]
    s_waitcnt lgkmcnt(13)
    v_mfma_f32_16x16x32_bf16 v[128:131], v[144:147], v[176:179], v[128:131]
    ds_read_b128 v[200:203], v216 offset:14336
    v_mfma_f32_16x16x32_bf16 v[132:135], v[148:151], v[176:179], v[132:135]
    v_mfma_f32_16x16x32_bf16 v[136:139], v[152:155], v[176:179], v[136:139]
    v_mfma_f32_16x16x32_bf16 v[140:143], v[156:159], v[176:179], v[140:143]
    s_waitcnt lgkmcnt(11)
    v_mfma_f32_16x16x32_bf16 v[0:3], v[160:163], v[180:183], v[0:3]
    ds_read_b32 v252, v251 offset:0
    s_waitcnt lgkmcnt(9)
    v_mfma_f32_16x16x32_bf16 v[4:7], v[164:167], v[180:183], v[4:7]
    s_waitcnt lgkmcnt(6)
    v_mfma_f32_16x16x32_bf16 v[8:11], v[168:171], v[180:183], v[8:11]
    ds_read_b128 v[204:207], v216 offset:15360
    s_waitcnt lgkmcnt(4)
    v_mfma_f32_16x16x32_bf16 v[12:15], v[172:175], v[180:183], v[12:15]
    v_mfma_f32_16x16x32_bf16 v[16:19], v[160:163], v[184:187], v[16:19]
    ds_read_b128 v[176:179], v216 offset:16384
    v_mfma_f32_16x16x32_bf16 v[20:23], v[164:167], v[184:187], v[20:23]
    v_mfma_f32_16x16x32_bf16 v[24:27], v[168:171], v[184:187], v[24:27]
    v_mov_b32 v237, 26
    v_mfma_f32_16x16x32_bf16 v[28:31], v[172:175], v[184:187], v[28:31]
    v_mfma_f32_16x16x32_bf16 v[32:35], v[160:163], v[188:191], v[32:35]
    ds_read_b128 v[180:183], v216 offset:17408
    v_mfma_f32_16x16x32_bf16 v[36:39], v[164:167], v[188:191], v[36:39]
    s_waitcnt lgkmcnt(3)
    v_cmp_lt_u32 s[56:57], v252, 27
    v_mfma_f32_16x16x32_bf16 v[40:43], v[168:171], v[188:191], v[40:43]
    ds_write_b32 v250, v237 offset:16
    v_mfma_f32_16x16x32_bf16 v[44:47], v[172:175], v[188:191], v[44:47]
    v_mfma_f32_16x16x32_bf16 v[48:51], v[160:163], v[192:195], v[48:51]
    s_cmp_eq_u64 s[56:57], 0
    s_cbranch_scc0 G0_qs26
G0_qs26_ret:
    ds_read_b128 v[184:187], v216 offset:18432
    v_mfma_f32_16x16x32_bf16 v[52:55], v[164:167], v[192:195], v[52:55]
    ds_read_b64_tr_b16 v[144:145], v208 offset:0
    v_mfma_f32_16x16x32_bf16 v[56:59], v[168:171], v[192:195], v[56:59]
    ds_read_b64_tr_b16 v[146:147], v208 offset:1024
    v_mfma_f32_16x16x32_bf16 v[60:63], v[172:175], v[192:195], v[60:63]
    v_mfma_f32_16x16x32_bf16 v[64:67], v[160:163], v[196:199], v[64:67]
    ds_read_b128 v[188:191], v216 offset:19456
    v_mfma_f32_16x16x32_bf16 v[68:71], v[164:167], v[196:199], v[68:71]
    ds_read_b64_tr_b16 v[148:149], v209 offset:0
    v_mfma_f32_16x16x32_bf16 v[72:75], v[168:171], v[196:199], v[72:75]
    ds_read_b64_tr_b16 v[150:151], v209 offset:1024
    v_mfma_f32_16x16x32_bf16 v[76:79], v[172:175], v[196:199], v[76:79]
    v_mfma_f32_16x16x32_bf16 v[80:83], v[160:163], v[200:203], v[80:83]
    ds_read_b128 v[192:195], v216 offset:20480
    v_mfma_f32_16x16x32_bf16 v[84:87], v[164:167], v[200:203], v[84:87]
    ds_read_b64_tr_b16 v[152:153], v210 offset:0
    v_mfma_f32_16x16x32_bf16 v[88:91], v[168:171], v[200:203], v[88:91]
    ds_read_b64_tr_b16 v[154:155], v210 offset:1024
    v_mfma_f32_16x16x32_bf16 v[92:95], v[172:175], v[200:203], v[92:95]
    s_waitcnt lgkmcnt(12)
    v_mfma_f32_16x16x32_bf16 v[96:99], v[160:163], v[204:207], v[96:99]
    ds_read_b128 v[196:199], v216 offset:21504
    v_mfma_f32_16x16x32_bf16 v[100:103], v[164:167], v[204:207], v[100:103]
    ds_read_b64_tr_b16 v[156:157], v211 offset:0
    v_mfma_f32_16x16x32_bf16 v[104:107], v[168:171], v[204:207], v[104:107]
    ds_read_b64_tr_b16 v[158:159], v211 offset:1024
    v_mfma_f32_16x16x32_bf16 v[108:111], v[172:175], v[204:207], v[108:111]
    s_waitcnt lgkmcnt(14)
    v_mfma_f32_16x16x32_bf16 v[112:115], v[160:163], v[176:179], v[112:115]
    ds_read_b128 v[200:203], v216 offset:22528
    v_mfma_f32_16x16x32_bf16 v[116:119], v[164:167], v[176:179], v[116:119]
    v_mfma_f32_16x16x32_bf16 v[120:123], v[168:171], v[176:179], v[120:123]
    v_mfma_f32_16x16x32_bf16 v[124:127], v[172:175], v[176:179], v[124:127]
    s_waitcnt lgkmcnt(14)
    v_mfma_f32_16x16x32_bf16 v[128:131], v[160:163], v[180:183], v[128:131]
    ds_read_b128 v[204:207], v216 offset:23552
    v_mfma_f32_16x16x32_bf16 v[132:135], v[164:167], v[180:183], v[132:135]
    v_mfma_f32_16x16x32_bf16 v[136:139], v[168:171], v[180:183], v[136:139]
    v_mfma_f32_16x16x32_bf16 v[140:143], v[172:175], v[180:183], v[140:143]
    s_waitcnt lgkmcnt(11)
    v_mfma_f32_16x16x32_bf16 v[0:3], v[144:147], v[184:187], v[0:3]
    ds_read_b32 v252, v251 offset:0
    s_waitcnt lgkmcnt(9)
    v_mfma_f32_16x16x32_bf16 v[4:7], v[148:151], v[184:187], v[4:7]
    s_waitcnt lgkmcnt(6)
    v_mfma_f32_16x16x32_bf16 v[8:11], v[152:155], v[184:187], v[8:11]
    ds_read_b128 v[176:179], v216 offset:24576
    s_waitcnt lgkmcnt(4)
    v_mfma_f32_16x16x32_bf16 v[12:15], v[156:159], v[184:187], v[12:15]
    v_mfma_f32_16x16x32_bf16 v[16:19], v[144:147], v[188:191], v[16:19]
    ds_read_b128 v[180:183], v216 offset:25600
    v_mfma_f32_16x16x32_bf16 v[20:23], v[148:151], v[188:191], v[20:23]
    v_mfma_f32_16x16x32_bf16 v[24:27], v[152:155], v[188:191], v[24:27]
    v_mfma_f32_16x16x32_bf16 v[28:31], v[156:159], v[188:191], v[28:31]
    v_mfma_f32_16x16x32_bf16 v[32:35], v[144:147], v[192:195], v[32:35]
    ds_read_b128 v[184:187], v216 offset:26624
    v_mfma_f32_16x16x32_bf16 v[36:39], v[148:151], v[192:195], v[36:39]
    v_mfma_f32_16x16x32_bf16 v[40:43], v[152:155], v[192:195], v[40:43]
    s_waitcnt lgkmcnt(3)
    v_cmp_lt_u32 s[56:57], v252, 28
    v_mfma_f32_16x16x32_bf16 v[44:47], v[156:159], v[192:195], v[44:47]
    v_mfma_f32_16x16x32_bf16 v[48:51], v[144:147], v[196:199], v[48:51]
    s_cmp_eq_u64 s[56:57], 0
    s_cbranch_scc0 G0_qs27
G0_qs27_ret:
    ds_read_b128 v[188:191], v216 offset:27648
    v_mfma_f32_16x16x32_bf16 v[52:55], v[148:151], v[196:199], v[52:55]
    ds_read_b64_tr_b16 v[160:161], v208 offset:16384
    v_mfma_f32_16x16x32_bf16 v[56:59], v[152:155], v[196:199], v[56:59]
    ds_read_b64_tr_b16 v[162:163], v208 offset:17408
    v_mfma_f32_16x16x32_bf16 v[60:63], v[156:159], v[196:199], v[60:63]
    v_mfma_f32_16x16x32_bf16 v[64:67], v[144:147], v[200:203], v[64:67]
    ds_read_b128 v[192:195], v216 offset:28672
    v_mfma_f32_16x16x32_bf16 v[68:71], v[148:151], v[200:203], v[68:71]
    ds_read_b64_tr_b16 v[164:165], v209 offset:16384
    v_mfma_f32_16x16x32_bf16 v[72:75], v[152:155], v[200:203], v[72:75]
    ds_read_b64_tr_b16 v[166:167], v209 offset:17408
    v_mfma_f32_16x16x32_bf16 v[76:79], v[156:159], v[200:203], v[76:79]
    v_mfma_f32_16x16x32_bf16 v[80:83], v[144:147], v[204:207], v[80:83]
    ds_read_b128 v[196:199], v216 offset:29696
    v_mfma_f32_16x16x32_bf16 v[84:87], v[148:151], v[204:207], v[84:87]
    ds_read_b64_tr_b16 v[168:169], v210 offset:16384
    v_mfma_f32_16x16x32_bf16 v[88:91], v[152:155], v[204:207], v[88:91]
    ds_read_b64_tr_b16 v[170:171], v210 offset:17408
    v_mfma_f32_16x16x32_bf16 v[92:95], v[156:159], v[204:207], v[92:95]
    s_waitcnt lgkmcnt(11)
    v_mfma_f32_16x16x32_bf16 v[96:99], v[144:147], v[176:179], v[96:99]
    ds_read_b128 v[200:203], v216 offset:30720
    v_mfma_f32_16x16x32_bf16 v[100:103], v[148:151], v[176:179], v[100:103]
    ds_read_b64_tr_b16 v[172:173], v211 offset:16384
    v_mfma_f32_16x16x32_bf16 v[104:107], v[152:155], v[176:179], v[104:107]
    ds_read_b64_tr_b16 v[174:175], v211 offset:17408
    v_mfma_f32_16x16x32_bf16 v[108:111], v[156:159], v[176:179], v[108:111]
    s_waitcnt lgkmcnt(13)
    v_mfma_f32_16x16x32_bf16 v[112:115], v[144:147], v[180:183], v[112:115]
    ds_read_b128 v[204:207], v216 offset:31744
    v_mfma_f32_16x16x32_bf16 v[116:119], v[148:151], v[180:183], v[116:119]
    v_mfma_f32_16x16x32_bf16 v[120:123], v[152:155], v[180:183], v[120:123]
    v_mfma_f32_16x16x32_bf16 v[124:127], v[156:159], v[180:183], v[124:127]
    s_waitcnt lgkmcnt(13)
    v_mfma_f32_16x16x32_bf16 v[128:131], v[144:147], v[184:187], v[128:131]
    ds_read_b128 v[176:179], v216 offset:32768
    v_mfma_f32_16x16x32_bf16 v[132:135], v[148:151], v[184:187], v[132:135]
    v_mfma_f32_16x16x32_bf16 v[136:139], v[152:155], v[184:187], v[136:139]
    v_mfma_f32_16x16x32_bf16 v[140:143], v[156:159], v[184:187], v[140:143]
    s_waitcnt lgkmcnt(11)
    v_mfma_f32_16x16x32_bf16 v[0:3], v[160:163], v[188:191], v[0:3]
    ds_read_b32 v252, v251 offset:0
    s_waitcnt lgkmcnt(9)
    v_mfma_f32_16x16x32_bf16 v[4:7], v[164:167], v[188:191], v[4:7]
    s_waitcnt lgkmcnt(6)
    v_mfma_f32_16x16x32_bf16 v[8:11], v[168:171], v[188:191], v[8:11]
    ds_read_b128 v[180:183], v216 offset:33792
    s_waitcnt lgkmcnt(4)
    v_mfma_f32_16x16x32_bf16 v[12:15], v[172:175], v[188:191], v[12:15]
    v_mfma_f32_16x16x32_bf16 v[16:19], v[160:163], v[192:195], v[16:19]
    ds_read_b128 v[184:187], v216 offset:34816
    v_mfma_f32_16x16x32_bf16 v[20:23], v[164:167], v[192:195], v[20:23]
    v_mfma_f32_16x16x32_bf16 v[24:27], v[168:171], v[192:195], v[24:27]
    v_mov_b32 v237, 28
    v_mfma_f32_16x16x32_bf16 v[28:31], v[172:175], v[192:195], v[28:31]
    v_mfma_f32_16x16x32_bf16 v[32:35], v[160:163], v[196:199], v[32:35]
    ds_read_b128 v[188:191], v216 offset:35840
    v_mfma_f32_16x16x32_bf16 v[36:39], v[164:167], v[196:199], v[36:39]
    s_waitcnt lgkmcnt(3)
    v_cmp_lt_u32 s[56:57], v252, 29
    v_mfma_f32_16x16x32_bf16 v[40:43], v[168:171], v[196:199], v[40:43]
    ds_write_b32 v250, v237 offset:16
    v_mfma_f32_16x16x32_bf16 v[44:47], v[172:175], v[196:199], v[44:47]
    v_mfma_f32_16x16x32_bf16 v[48:51], v[160:163], v[200:203], v[48:51]
    s_cmp_eq_u64 s[56:57], 0
    s_cbranch_scc0 G0_qs28
G0_qs28_ret:
    ds_read_b128 v[192:195], v216 offset:36864
    v_mfma_f32_16x16x32_bf16 v[52:55], v[164:167], v[200:203], v[52:55]
    ds_read_b64_tr_b16 v[144:145], v208 offset:49152
    v_mfma_f32_16x16x32_bf16 v[56:59], v[168:171], v[200:203], v[56:59]
    ds_read_b64_tr_b16 v[146:147], v208 offset:50176
    v_mfma_f32_16x16x32_bf16 v[60:63], v[172:175], v[200:203], v[60:63]
    v_mfma_f32_16x16x32_bf16 v[64:67], v[160:163], v[204:207], v[64:67]
    ds_read_b128 v[196:199], v216 offset:37888
    v_mfma_f32_16x16x32_bf16 v[68:71], v[164:167], v[204:207], v[68:71]
    ds_read_b64_tr_b16 v[148:149], v209 offset:49152
    v_mfma_f32_16x16x32_bf16 v[72:75], v[168:171], v[204:207], v[72:75]
    ds_read_b64_tr_b16 v[150:151], v209 offset:50176
    v_mfma_f32_16x16x32_bf16 v[76:79], v[172:175], v[204:207], v[76:79]
    v_mfma_f32_16x16x32_bf16 v[80:83], v[160:163], v[176:179], v[80:83]
    ds_read_b128 v[200:203], v216 offset:38912
    v_mfma_f32_16x16x32_bf16 v[84:87], v[164:167], v[176:179], v[84:87]
    ds_read_b64_tr_b16 v[152:153], v210 offset:49152
    v_mfma_f32_16x16x32_bf16 v[88:91], v[168:171], v[176:179], v[88:91]
    ds_read_b64_tr_b16 v[154:155], v210 offset:50176
    v_mfma_f32_16x16x32_bf16 v[92:95], v[172:175], v[176:179], v[92:95]
    s_waitcnt lgkmcnt(12)
    v_mfma_f32_16x16x32_bf16 v[96:99], v[160:163], v[180:183], v[96:99]
    ds_read_b128 v[204:207], v216 offset:39936
    v_mfma_f32_16x16x32_bf16 v[100:103], v[164:167], v[180:183], v[100:103]
    ds_read_b64_tr_b16 v[156:157], v211 offset:49152
    v_mfma_f32_16x16x32_bf16 v[104:107], v[168:171], v[180:183], v[104:107]
    ds_read_b64_tr_b16 v[158:159], v211 offset:50176
    v_mfma_f32_16x16x32_bf16 v[108:111], v[172:175], v[180:183], v[108:111]
    s_waitcnt lgkmcnt(14)
    v_mfma_f32_16x16x32_bf16 v[112:115], v[160:163], v[184:187], v[112:115]
    ds_read_b128 v[176:179], v216 offset:40960
    v_mfma_f32_16x16x32_bf16 v[116:119], v[164:167], v[184:187], v[116:119]
    v_mfma_f32_16x16x32_bf16 v[120:123], v[168:171], v[184:187], v[120:123]
    v_mfma_f32_16x16x32_bf16 v[124:127], v[172:175], v[184:187], v[124:127]
    s_waitcnt lgkmcnt(14)
    v_mfma_f32_16x16x32_bf16 v[128:131], v[160:163], v[188:191], v[128:131]
    ds_read_b128 v[180:183], v216 offset:41984
    v_mfma_f32_16x16x32_bf16 v[132:135], v[164:167], v[188:191], v[132:135]
    v_mfma_f32_16x16x32_bf16 v[136:139], v[168:171], v[188:191], v[136:139]
    v_mfma_f32_16x16x32_bf16 v[140:143], v[172:175], v[188:191], v[140:143]
    s_waitcnt lgkmcnt(11)
    v_mfma_f32_16x16x32_bf16 v[0:3], v[144:147], v[192:195], v[0:3]
    ds_read_b32 v252, v251 offset:0
    s_waitcnt lgkmcnt(9)
    v_mfma_f32_16x16x32_bf16 v[4:7], v[148:151], v[192:195], v[4:7]
    s_waitcnt lgkmcnt(6)
    v_mfma_f32_16x16x32_bf16 v[8:11], v[152:155], v[192:195], v[8:11]
    ds_read_b128 v[184:187], v216 offset:43008
    s_waitcnt lgkmcnt(4)
    v_mfma_f32_16x16x32_bf16 v[12:15], v[156:159], v[192:195], v[12:15]
    v_mfma_f32_16x16x32_bf16 v[16:19], v[144:147], v[196:199], v[16:19]
    ds_read_b128 v[188:191], v216 offset:44032
    v_mfma_f32_16x16x32_bf16 v[20:23], v[148:151], v[196:199], v[20:23]
    v_mfma_f32_16x16x32_bf16 v[24:27], v[152:155], v[196:199], v[24:27]
    v_mfma_f32_16x16x32_bf16 v[28:31], v[156:159], v[196:199], v[28:31]
    v_mfma_f32_16x16x32_bf16 v[32:35], v[144:147], v[200:203], v[32:35]
    ds_read_b128 v[192:195], v216 offset:45056
    v_mfma_f32_16x16x32_bf16 v[36:39], v[148:151], v[200:203], v[36:39]
    v_mfma_f32_16x16x32_bf16 v[40:43], v[152:155], v[200:203], v[40:43]
    s_waitcnt lgkmcnt(3)
    v_cmp_lt_u32 s[56:57], v252, 30
    v_mfma_f32_16x16x32_bf16 v[44:47], v[156:159], v[200:203], v[44:47]
    v_mfma_f32_16x16x32_bf16 v[48:51], v[144:147], v[204:207], v[48:51]
    s_cmp_eq_u64 s[56:57], 0
    s_cbranch_scc0 G0_qs29
G0_qs29_ret:
    ds_read_b128 v[196:199], v216 offset:46080
    v_mfma_f32_16x16x32_bf16 v[52:55], v[148:151], v[204:207], v[52:55]
    ds_read_b64_tr_b16 v[160:161], v208 offset:32768
    v_mfma_f32_16x16x32_bf16 v[56:59], v[152:155], v[204:207], v[56:59]
    ds_read_b64_tr_b16 v[162:163], v208 offset:33792
    v_mfma_f32_16x16x32_bf16 v[60:63], v[156:159], v[204:207], v[60:63]
    v_mfma_f32_16x16x32_bf16 v[64:67], v[144:147], v[176:179], v[64:67]
    ds_read_b128 v[200:203], v216 offset:47104
    v_mfma_f32_16x16x32_bf16 v[68:71], v[148:151], v[176:179], v[68:71]
    ds_read_b64_tr_b16 v[164:165], v209 offset:32768
    v_mfma_f32_16x16x32_bf16 v[72:75], v[152:155], v[176:179], v[72:75]
    ds_read_b64_tr_b16 v[166:167], v209 offset:33792
    v_mfma_f32_16x16x32_bf16 v[76:79], v[156:159], v[176:179], v[76:79]
    v_mfma_f32_16x16x32_bf16 v[80:83], v[144:147], v[180:183], v[80:83]
    ds_read_b128 v[204:207], v216 offset:48128
    v_mfma_f32_16x16x32_bf16 v[84:87], v[148:151], v[180:183], v[84:87]
    ds_read_b64_tr_b16 v[168:169], v210 offset:32768
    v_mfma_f32_16x16x32_bf16 v[88:91], v[152:155], v[180:183], v[88:91]
    ds_read_b64_tr_b16 v[170:171], v210 offset:33792
    v_mfma_f32_16x16x32_bf16 v[92:95], v[156:159], v[180:183], v[92:95]
    s_waitcnt lgkmcnt(11)
    v_mfma_f32_16x16x32_bf16 v[96:99], v[144:147], v[184:187], v[96:99]
    ds_read_b128 v[176:179], v216 offset:49152
    v_mfma_f32_16x16x32_bf16 v[100:103], v[148:151], v[184:187], v[100:103]
    ds_read_b64_tr_b16 v[172:173], v211 offset:32768
    v_mfma_f32_16x16x32_bf16 v[104:107], v[152:155], v[184:187], v[104:107]
    ds_read_b64_tr_b16 v[174:175], v211 offset:33792
    v_mfma_f32_16x16x32_bf16 v[108:111], v[156:159], v[184:187], v[108:111]
    s_waitcnt lgkmcnt(13)
    v_mfma_f32_16x16x32_bf16 v[112:115], v[144:147], v[188:191], v[112:115]
    ds_read_b128 v[180:183], v216 offset:50176
    v_mfma_f32_16x16x32_bf16 v[116:119], v[148:151], v[188:191], v[116:119]
    v_mfma_f32_16x16x32_bf16 v[120:123], v[152:155], v[188:191], v[120:123]
    v_mfma_f32_16x16x32_bf16 v[124:127], v[156:159], v[188:191], v[124:127]
    s_waitcnt lgkmcnt(13)
    v_mfma_f32_16x16x32_bf16 v[128:131], v[144:147], v[192:195], v[128:131]
    ds_read_b128 v[184:187], v216 offset:51200
    v_mfma_f32_16x16x32_bf16 v[132:135], v[148:151], v[192:195], v[132:135]
    v_mfma_f32_16x16x32_bf16 v[136:139], v[152:155], v[192:195], v[136:139]
    v_mfma_f32_16x16x32_bf16 v[140:143], v[156:159], v[192:195], v[140:143]
    s_waitcnt lgkmcnt(11)
    v_mfma_f32_16x16x32_bf16 v[0:3], v[160:163], v[196:199], v[0:3]
    ds_read_b32 v252, v251 offset:0
    s_waitcnt lgkmcnt(9)
    v_mfma_f32_16x16x32_bf16 v[4:7], v[164:167], v[196:199], v[4:7]
    s_waitcnt lgkmcnt(6)
    v_mfma_f32_16x16x32_bf16 v[8:11], v[168:171], v[196:199], v[8:11]
    ds_read_b128 v[188:191], v216 offset:52224
    s_waitcnt lgkmcnt(4)
    v_mfma_f32_16x16x32_bf16 v[12:15], v[172:175], v[196:199], v[12:15]
    v_mfma_f32_16x16x32_bf16 v[16:19], v[160:163], v[200:203], v[16:19]
    ds_read_b128 v[192:195], v216 offset:53248
    v_mfma_f32_16x16x32_bf16 v[20:23], v[164:167], v[200:203], v[20:23]
    v_mfma_f32_16x16x32_bf16 v[24:27], v[168:171], v[200:203], v[24:27]
    v_mov_b32 v237, 30
    v_mfma_f32_16x16x32_bf16 v[28:31], v[172:175], v[200:203], v[28:31]
    v_mfma_f32_16x16x32_bf16 v[32:35], v[160:163], v[204:207], v[32:35]
    ds_read_b128 v[196:199], v216 offset:54272
    v_mfma_f32_16x16x32_bf16 v[36:39], v[164:167], v[204:207], v[36:39]
    s_waitcnt lgkmcnt(3)
    v_cmp_lt_u32 s[56:57], v252, 31
    v_mfma_f32_16x16x32_bf16 v[40:43], v[168:171], v[204:207], v[40:43]
    ds_write_b32 v250, v237 offset:16
    v_mfma_f32_16x16x32_bf16 v[44:47], v[172:175], v[204:207], v[44:47]
    v_mfma_f32_16x16x32_bf16 v[48:51], v[160:163], v[176:179], v[48:51]
    s_cmp_eq_u64 s[56:57], 0
    s_cbranch_scc0 G0_qs30
G0_qs30_ret:
    ds_read_b128 v[200:203], v216 offset:0
    v_mfma_f32_16x16x32_bf16 v[52:55], v[164:167], v[176:179], v[52:55]
    ds_read_b64_tr_b16 v[144:145], v212 offset:16384
    v_mfma_f32_16x16x32_bf16 v[56:59], v[168:171], v[176:179], v[56:59]
    ds_read_b64_tr_b16 v[146:147], v212 offset:17408
    v_mfma_f32_16x16x32_bf16 v[60:63], v[172:175], v[176:179], v[60:63]
    v_mfma_f32_16x16x32_bf16 v[64:67], v[160:163], v[180:183], v[64:67]
    ds_read_b128 v[204:207], v216 offset:1024
    v_mfma_f32_16x16x32_bf16 v[68:71], v[164:167], v[180:183], v[68:71]
    ds_read_b64_tr_b16 v[148:149], v213 offset:16384
    v_mfma_f32_16x16x32_bf16 v[72:75], v[168:171], v[180:183], v[72:75]
    ds_read_b64_tr_b16 v[150:151], v213 offset:17408
    v_mfma_f32_16x16x32_bf16 v[76:79], v[172:175], v[180:183], v[76:79]
    v_mfma_f32_16x16x32_bf16 v[80:83], v[160:163], v[184:187], v[80:83]
    ds_read_b128 v[176:179], v216 offset:2048
    v_mfma_f32_16x16x32_bf16 v[84:87], v[164:167], v[184:187], v[84:87]
    ds_read_b64_tr_b16 v[152:153], v214 offset:16384
    v_mfma_f32_16x16x32_bf16 v[88:91], v[168:171], v[184:187], v[88:91]
    ds_read_b64_tr_b16 v[154:155], v214 offset:17408
    v_mfma_f32_16x16x32_bf16 v[92:95], v[172:175], v[184:187], v[92:95]
    s_waitcnt lgkmcnt(12)
    v_mfma_f32_16x16x32_bf16 v[96:99], v[160:163], v[188:191], v[96:99]
    ds_read_b128 v[180:183], v216 offset:3072
    v_mfma_f32_16x16x32_bf16 v[100:103], v[164:167], v[188:191], v[100:103]
    ds_read_b64_tr_b16 v[156:157], v215 offset:16384
    v_mfma_f32_16x16x32_bf16 v[104:107], v[168:171], v[188:191], v[104:107]
    ds_read_b64_tr_b16 v[158:159], v215 offset:17408
    v_mfma_f32_16x16x32_bf16 v[108:111], v[172:175], v[188:191], v[108:111]
    s_waitcnt lgkmcnt(14)
    v_mfma_f32_16x16x32_bf16 v[112:115], v[160:163], v[192:195], v[112:115]
    ds_read_b128 v[184:187], v216 offset:4096
    v_mfma_f32_16x16x32_bf16 v[116:119], v[164:167], v[192:195], v[116:119]
    v_mfma_f32_16x16x32_bf16 v[120:123], v[168:171], v[192:195], v[120:123]
    v_mfma_f32_16x16x32_bf16 v[124:127], v[172:175], v[192:195], v[124:127]
    s_waitcnt lgkmcnt(14)
    v_mfma_f32_16x16x32_bf16 v[128:131], v[160:163], v[196:199], v[128:131]
    ds_read_b128 v[188:191], v216 offset:5120
    v_mfma_f32_16x16x32_bf16 v[132:135], v[164:167], v[196:199], v[132:135]
    v_mfma_f32_16x16x32_bf16 v[136:139], v[168:171], v[196:199], v[136:139]
    v_mfma_f32_16x16x32_bf16 v[140:143], v[172:175], v[196:199], v[140:143]
    s_waitcnt lgkmcnt(11)
    v_mfma_f32_16x16x32_bf16 v[0:3], v[144:147], v[200:203], v[0:3]
    ds_read_b32 v252, v251 offset:0
    s_waitcnt lgkmcnt(9)
    v_mfma_f32_16x16x32_bf16 v[4:7], v[148:151], v[200:203], v[4:7]
    s_waitcnt lgkmcnt(6)
    v_mfma_f32_16x16x32_bf16 v[8:11], v[152:155], v[200:203], v[8:11]
    ds_read_b128 v[192:195], v216 offset:6144
    s_waitcnt lgkmcnt(4)
    v_mfma_f32_16x16x32_bf16 v[12:15], v[156:159], v[200:203], v[12:15]
    v_mfma_f32_16x16x32_bf16 v[16:19], v[144:147], v[204:207], v[16:19]
    ds_read_b128 v[196:199], v216 offset:7168
    v_mfma_f32_16x16x32_bf16 v[20:23], v[148:151], v[204:207], v[20:23]
    v_mfma_f32_16x16x32_bf16 v[24:27], v[152:155], v[204:207], v[24:27]
    v_mfma_f32_16x16x32_bf16 v[28:31], v[156:159], v[204:207], v[28:31]
    v_mfma_f32_16x16x32_bf16 v[32:35], v[144:147], v[176:179], v[32:35]
    ds_read_b128 v[200:203], v216 offset:8192
    v_mfma_f32_16x16x32_bf16 v[36:39], v[148:151], v[176:179], v[36:39]
    v_mfma_f32_16x16x32_bf16 v[40:43], v[152:155], v[176:179], v[40:43]
    s_waitcnt lgkmcnt(3)
    v_cmp_lt_u32 s[56:57], v252, 32
    v_mfma_f32_16x16x32_bf16 v[44:47], v[156:159], v[176:179], v[44:47]
    v_mfma_f32_16x16x32_bf16 v[48:51], v[144:147], v[180:183], v[48:51]
    s_cmp_eq_u64 s[56:57], 0
    s_cbranch_scc0 G0_qs31
G0_qs31_ret:
    ds_read_b128 v[204:207], v216 offset:9216
    v_mfma_f32_16x16x32_bf16 v[52:55], v[148:151], v[180:183], v[52:55]
    ds_read_b64_tr_b16 v[160:161], v212 offset:32768
    v_mfma_f32_16x16x32_bf16 v[56:59], v[152:155], v[180:183], v[56:59]
    ds_read_b64_tr_b16 v[162:163], v212 offset:33792
    v_mfma_f32_16x16x32_bf16 v[60:63], v[156:159], v[180:183], v[60:63]
    v_mfma_f32_16x16x32_bf16 v[64:67], v[144:147], v[184:187], v[64:67]
    ds_read_b128 v[176:179], v216 offset:10240
    v_mfma_f32_16x16x32_bf16 v[68:71], v[148:151], v[184:187], v[68:71]
    ds_read_b64_tr_b16 v[164:165], v213 offset:32768
    v_mfma_f32_16x16x32_bf16 v[72:75], v[152:155], v[184:187], v[72:75]
    ds_read_b64_tr_b16 v[166:167], v213 offset:33792
    v_mfma_f32_16x16x32_bf16 v[76:79], v[156:159], v[184:187], v[76:79]
    v_mfma_f32_16x16x32_bf16 v[80:83], v[144:147], v[188:191], v[80:83]
    ds_read_b128 v[180:183], v216 offset:11264
    v_mfma_f32_16x16x32_bf16 v[84:87], v[148:151], v[188:191], v[84:87]
    ds_read_b64_tr_b16 v[168:169], v214 offset:32768
    v_mfma_f32_16x16x32_bf16 v[88:91], v[152:155], v[188:191], v[88:91]
    ds_read_b64_tr_b16 v[170:171], v214 offset:33792
    v_mfma_f32_16x16x32_bf16 v[92:95], v[156:159], v[188:191], v[92:95]
    s_waitcnt lgkmcnt(11)
    v_mfma_f32_16x16x32_bf16 v[96:99], v[144:147], v[192:195], v[96:99]
    ds_read_b128 v[184:187], v216 offset:12288
    v_mfma_f32_16x16x32_bf16 v[100:103], v[148:151], v[192:195], v[100:103]
    ds_read_b64_tr_b16 v[172:173], v215 offset:32768
    v_mfma_f32_16x16x32_bf16 v[104:107], v[152:155], v[192:195], v[104:107]
    ds_read_b64_tr_b16 v[174:175], v215 offset:33792
    v_mfma_f32_16x16x32_bf16 v[108:111], v[156:159], v[192:195], v[108:111]
    s_waitcnt lgkmcnt(13)
    v_mfma_f32_16x16x32_bf16 v[112:115], v[144:147], v[196:199], v[112:115]
    ds_read_b128 v[188:191], v216 offset:13312
    v_mfma_f32_16x16x32_bf16 v[116:119], v[148:151], v[196:199], v[116:119]
    v_mfma_f32_16x16x32_bf16 v[120:123], v[152:155], v[196:199], v[120:123]
    v_mfma_f32_16x16x32_bf16 v[124:127], v[156:159], v[196:199], v[124:127]
    s_waitcnt lgkmcnt(13)
    v_mfma_f32_16x16x32_bf16 v[128:131], v[144:147], v[200:203], v[128:131]
    ds_read_b128 v[192:195], v216 offset:14336
    v_mfma_f32_16x16x32_bf16 v[132:135], v[148:151], v[200:203], v[132:135]
    v_mfma_f32_16x16x32_bf16 v[136:139], v[152:155], v[200:203], v[136:139]
    v_mfma_f32_16x16x32_bf16 v[140:143], v[156:159], v[200:203], v[140:143]
    s_waitcnt lgkmcnt(11)
    v_mfma_f32_16x16x32_bf16 v[0:3], v[160:163], v[204:207], v[0:3]
    ds_read_b128 v[196:199], v216 offset:15360
    s_waitcnt lgkmcnt(9)
    v_mfma_f32_16x16x32_bf16 v[4:7], v[164:167], v[204:207], v[4:7]
    s_waitcnt lgkmcnt(6)
    v_mfma_f32_16x16x32_bf16 v[8:11], v[168:171], v[204:207], v[8:11]
    s_waitcnt lgkmcnt(3)
    v_mfma_f32_16x16x32_bf16 v[12:15], v[172:175], v[204:207], v[12:15]
    v_mfma_f32_16x16x32_bf16 v[16:19], v[160:163], v[176:179], v[16:19]
    ds_read_b128 v[200:203], v216 offset:16384
    v_mfma_f32_16x16x32_bf16 v[20:23], v[164:167], v[176:179], v[20:23]
    v_mfma_f32_16x16x32_bf16 v[24:27], v[168:171], v[176:179], v[24:27]
    v_mov_b32 v237, 32
    v_mfma_f32_16x16x32_bf16 v[28:31], v[172:175], v[176:179], v[28:31]
    v_mfma_f32_16x16x32_bf16 v[32:35], v[160:163], v[180:183], v[32:35]
    ds_read_b128 v[204:207], v216 offset:17408
    v_mul_f32 v0, s50, v0
    v_mul_f32 v1, s50, v1
    v_mfma_f32_16x16x32_bf16 v[36:39], v[164:167], v[180:183], v[36:39]
    v_mul_f32 v2, s50, v2
    v_mul_f32 v3, s50, v3
    v_cvt_pk_bf16_f32 v0, v0, v1
    v_mfma_f32_16x16x32_bf16 v[40:43], v[168:171], v[180:183], v[40:43]
    ds_write_b32 v250, v237 offset:16
    v_cvt_pk_bf16_f32 v1, v2, v3
    v_mul_f32 v4, s50, v4
    v_mfma_f32_16x16x32_bf16 v[44:47], v[172:175], v[180:183], v[44:47]
    v_mul_f32 v5, s50, v5
    v_mul_f32 v6, s50, v6
    v_mul_f32 v7, s50, v7
    v_mfma_f32_16x16x32_bf16 v[48:51], v[160:163], v[184:187], v[48:51]
    v_cvt_pk_bf16_f32 v4, v4, v5
    v_cvt_pk_bf16_f32 v5, v6, v7
    v_mul_f32 v8, s50, v8
    v_mfma_f32_16x16x32_bf16 v[52:55], v[164:167], v[184:187], v[52:55]
    v_mul_f32 v9, s50, v9
    v_mul_f32 v10, s50, v10
    v_mfma_f32_16x16x32_bf16 v[56:59], v[168:171], v[184:187], v[56:59]
    v_mul_f32 v11, s50, v11
    v_cvt_pk_bf16_f32 v8, v8, v9
    v_cvt_pk_bf16_f32 v9, v10, v11
    v_mfma_f32_16x16x32_bf16 v[60:63], v[172:175], v[184:187], v[60:63]
    v_mul_f32 v12, s50, v12
    v_mul_f32 v13, s50, v13
    s_waitcnt lgkmcnt(5)
    v_mfma_f32_16x16x32_bf16 v[64:67], v[160:163], v[188:191], v[64:67]
    v_mul_f32 v14, s50, v14
    v_mul_f32 v15, s50, v15
    v_cvt_pk_bf16_f32 v12, v12, v13
    v_mfma_f32_16x16x32_bf16 v[68:71], v[164:167], v[188:191], v[68:71]
    v_cvt_pk_bf16_f32 v13, v14, v15
    v_mul_f32 v16, s50, v16
    v_mfma_f32_16x16x32_bf16 v[72:75], v[168:171], v[188:191], v[72:75]
    v_mul_f32 v17, s50, v17
    v_mul_f32 v18, s50, v18
    v_mul_f32 v19, s50, v19
    v_mfma_f32_16x16x32_bf16 v[76:79], v[172:175], v[188:191], v[76:79]
    v_cvt_pk_bf16_f32 v16, v16, v17
    v_cvt_pk_bf16_f32 v17, v18, v19
    s_waitcnt lgkmcnt(4)
    v_mfma_f32_16x16x32_bf16 v[80:83], v[160:163], v[192:195], v[80:83]
    ds_read_b32 v252, v251 offset:16
    v_mul_f32 v20, s50, v20
    v_mul_f32 v21, s50, v21
    v_mfma_f32_16x16x32_bf16 v[84:87], v[164:167], v[192:195], v[84:87]
    v_mul_f32 v22, s50, v22
    v_mul_f32 v23, s50, v23
    v_cvt_pk_bf16_f32 v20, v20, v21
    v_mfma_f32_16x16x32_bf16 v[88:91], v[168:171], v[192:195], v[88:91]
    v_cvt_pk_bf16_f32 v21, v22, v23
    v_mul_f32 v24, s50, v24
    v_mfma_f32_16x16x32_bf16 v[92:95], v[172:175], v[192:195], v[92:95]
    v_mul_f32 v25, s50, v25
    v_mul_f32 v26, s50, v26
    v_mul_f32 v27, s50, v27
    s_waitcnt lgkmcnt(4)
    v_mfma_f32_16x16x32_bf16 v[96:99], v[160:163], v[196:199], v[96:99]
    v_cvt_pk_bf16_f32 v24, v24, v25
    v_cvt_pk_bf16_f32 v25, v26, v27
    v_mul_f32 v28, s50, v28
    v_mfma_f32_16x16x32_bf16 v[100:103], v[164:167], v[196:199], v[100:103]
    v_mul_f32 v29, s50, v29
    v_mul_f32 v30, s50, v30
    v_mfma_f32_16x16x32_bf16 v[104:107], v[168:171], v[196:199], v[104:107]
    v_mul_f32 v31, s50, v31
    v_cvt_pk_bf16_f32 v28, v28, v29
    v_cvt_pk_bf16_f32 v29, v30, v31
    v_mfma_f32_16x16x32_bf16 v[108:111], v[172:175], v[196:199], v[108:111]
    v_mul_f32 v32, s50, v32
    v_mul_f32 v33, s50, v33
    s_waitcnt lgkmcnt(3)
    v_mfma_f32_16x16x32_bf16 v[112:115], v[160:163], v[200:203], v[112:115]
    s_waitcnt lgkmcnt(0)
    v_cmp_lt_u32 s[56:57], v252, 32
    v_mul_f32 v34, s50, v34
    v_mul_f32 v35, s50, v35
    v_mfma_f32_16x16x32_bf16 v[116:119], v[164:167], v[200:203], v[116:119]
    v_cvt_pk_bf16_f32 v32, v32, v33
    v_cvt_pk_bf16_f32 v33, v34, v35
    v_mul_f32 v36, s50, v36
    v_mfma_f32_16x16x32_bf16 v[120:123], v[168:171], v[200:203], v[120:123]
    v_mul_f32 v37, s50, v37
    v_mul_f32 v38, s50, v38
    v_mfma_f32_16x16x32_bf16 v[124:127], v[172:175], v[200:203], v[124:127]
    v_mul_f32 v39, s50, v39
    v_cvt_pk_bf16_f32 v36, v36, v37
    v_cvt_pk_bf16_f32 v37, v38, v39
    v_mfma_f32_16x16x32_bf16 v[128:131], v[160:163], v[204:207], v[128:131]
    s_cmp_eq_u64 s[56:57], 0
    s_cbranch_scc0 G0_qfree
G0_qfree_ret:
    v_mul_f32 v40, s50, v40
    v_mul_f32 v41, s50, v41
    v_mul_f32 v42, s50, v42
    v_mfma_f32_16x16x32_bf16 v[132:135], v[164:167], v[204:207], v[132:135]
    v_mul_f32 v43, s50, v43
    v_cvt_pk_bf16_f32 v40, v40, v41
    v_mfma_f32_16x16x32_bf16 v[136:139], v[168:171], v[204:207], v[136:139]
    v_cvt_pk_bf16_f32 v41, v42, v43
    v_mul_f32 v44, s50, v44
    v_mul_f32 v45, s50, v45
    v_mfma_f32_16x16x32_bf16 v[140:143], v[172:175], v[204:207], v[140:143]
    v_mul_f32 v46, s50, v46
    v_mul_f32 v47, s50, v47
    ds_write_b64 v222, v[0:1] offset:0
    ds_write_b64 v222, v[4:5] offset:512
    ds_write_b64 v222, v[8:9] offset:1024
    ds_write_b64 v222, v[12:13] offset:1536
    ds_write_b64 v222, v[16:17] offset:4096
    ds_write_b64 v222, v[20:21] offset:4608
    ds_write_b64 v222, v[24:25] offset:5120
    ds_write_b64 v222, v[28:29] offset:5632
    v_cvt_pk_bf16_f32 v44, v44, v45
    v_cvt_pk_bf16_f32 v45, v46, v47
    ds_write_b64 v222, v[32:33] offset:8192
    ds_write_b64 v222, v[36:37] offset:8704
    ds_write_b64 v222, v[40:41] offset:9216
    ds_write_b64 v222, v[44:45] offset:9728
    v_mul_f32 v48, s50, v48
    v_mul_f32 v49, s50, v49
    v_mul_f32 v50, s50, v50
    v_mul_f32 v51, s50, v51
    v_cvt_pk_bf16_f32 v48, v48, v49
    v_cvt_pk_bf16_f32 v49, v50, v51
    v_mul_f32 v52, s50, v52
    v_mul_f32 v53, s50, v53
    v_mul_f32 v54, s50, v54
    v_mul_f32 v55, s50, v55
    v_cvt_pk_bf16_f32 v52, v52, v53
    v_cvt_pk_bf16_f32 v53, v54, v55
    v_mul_f32 v56, s50, v56
    v_mul_f32 v57, s50, v57
    v_mul_f32 v58, s50, v58
    v_mul_f32 v59, s50, v59
    v_cvt_pk_bf16_f32 v56, v56, v57
    v_cvt_pk_bf16_f32 v57, v58, v59
    v_mul_f32 v60, s50, v60
    v_mul_f32 v61, s50, v61
    v_mul_f32 v62, s50, v62
    v_mul_f32 v63, s50, v63
    v_cvt_pk_bf16_f32 v60, v60, v61
    v_cvt_pk_bf16_f32 v61, v62, v63
    ds_write_b64 v222, v[48:49] offset:12288
    ds_write_b64 v222, v[52:53] offset:12800
    ds_write_b64 v222, v[56:57] offset:13312
    ds_write_b64 v222, v[60:61] offset:13824
    v_mul_f32 v64, s50, v64
    v_mul_f32 v65, s50, v65
    v_mul_f32 v66, s50, v66
    v_mul_f32 v67, s50, v67
    v_cvt_pk_bf16_f32 v64, v64, v65
    v_cvt_pk_bf16_f32 v65, v66, v67
    v_mul_f32 v68, s50, v68
    v_mul_f32 v69, s50, v69
    v_mul_f32 v70, s50, v70
    v_mul_f32 v71, s50, v71
    v_cvt_pk_bf16_f32 v68, v68, v69
    v_cvt_pk_bf16_f32 v69, v70, v71
    v_mul_f32 v72, s50, v72
    v_mul_f32 v73, s50, v73
    v_mul_f32 v74, s50, v74
    v_mul_f32 v75, s50, v75
    v_cvt_pk_bf16_f32 v72, v72, v73
    v_cvt_pk_bf16_f32 v73, v74, v75
    v_mul_f32 v76, s50, v76
    v_mul_f32 v77, s50, v77
    v_mul_f32 v78, s50, v78
    v_mul_f32 v79, s50, v79
    v_cvt_pk_bf16_f32 v76, v76, v77
    v_cvt_pk_bf16_f32 v77, v78, v79
    ds_write_b64 v222, v[64:65] offset:16384
    ds_write_b64 v222, v[68:69] offset:16896
    ds_write_b64 v222, v[72:73] offset:17408
    ds_write_b64 v222, v[76:77] offset:17920
    v_mul_f32 v80, s50, v80
    v_mul_f32 v81, s50, v81
    v_mul_f32 v82, s50, v82
    v_mul_f32 v83, s50, v83
    v_cvt_pk_bf16_f32 v80, v80, v81
    v_cvt_pk_bf16_f32 v81, v82, v83
    v_mul_f32 v84, s50, v84
    v_mul_f32 v85, s50, v85
    v_mul_f32 v86, s50, v86
    v_mul_f32 v87, s50, v87
    v_cvt_pk_bf16_f32 v84, v84, v85
    v_cvt_pk_bf16_f32 v85, v86, v87
    v_mul_f32 v88, s50, v88
    v_mul_f32 v89, s50, v89
    v_mul_f32 v90, s50, v90
    v_mul_f32 v91, s50, v91
    v_cvt_pk_bf16_f32 v88, v88, v89
    v_cvt_pk_bf16_f32 v89, v90, v91
    v_mul_f32 v92, s50, v92
    v_mul_f32 v93, s50, v93
    v_mul_f32 v94, s50, v94
    v_mul_f32 v95, s50, v95
    v_cvt_pk_bf16_f32 v92, v92, v93
    v_cvt_pk_bf16_f32 v93, v94, v95
    ds_write_b64 v222, v[80:81] offset:20480
    ds_write_b64 v222, v[84:85] offset:20992
    ds_write_b64 v222, v[88:89] offset:21504
    ds_write_b64 v222, v[92:93] offset:22016
    v_mul_f32 v96, s50, v96
    v_mul_f32 v97, s50, v97
    v_mul_f32 v98, s50, v98
    v_mul_f32 v99, s50, v99
    v_cvt_pk_bf16_f32 v96, v96, v97
    v_cvt_pk_bf16_f32 v97, v98, v99
    v_mul_f32 v100, s50, v100
    v_mul_f32 v101, s50, v101
    v_mul_f32 v102, s50, v102
    v_mul_f32 v103, s50, v103
    v_cvt_pk_bf16_f32 v100, v100, v101
    v_cvt_pk_bf16_f32 v101, v102, v103
    v_mul_f32 v104, s50, v104
    v_mul_f32 v105, s50, v105
    v_mul_f32 v106, s50, v106
    v_mul_f32 v107, s50, v107
    v_cvt_pk_bf16_f32 v104, v104, v105
    v_cvt_pk_bf16_f32 v105, v106, v107
    v_mul_f32 v108, s50, v108
    v_mul_f32 v109, s50, v109
    v_mul_f32 v110, s50, v110
    v_mul_f32 v111, s50, v111
    v_cvt_pk_bf16_f32 v108, v108, v109
    v_cvt_pk_bf16_f32 v109, v110, v111
    ds_write_b64 v222, v[96:97] offset:24576
    ds_write_b64 v222, v[100:101] offset:25088
    ds_write_b64 v222, v[104:105] offset:25600
    ds_write_b64 v222, v[108:109] offset:26112
    v_mul_f32 v112, s50, v112
    v_mul_f32 v113, s50, v113
    v_mul_f32 v114, s50, v114
    v_mul_f32 v115, s50, v115
    v_cvt_pk_bf16_f32 v112, v112, v113
    v_cvt_pk_bf16_f32 v113, v114, v115
    v_mul_f32 v116, s50, v116
    v_mul_f32 v117, s50, v117
    v_mul_f32 v118, s50, v118
    v_mul_f32 v119, s50, v119
    v_cvt_pk_bf16_f32 v116, v116, v117
    v_cvt_pk_bf16_f32 v117, v118, v119
    v_mul_f32 v120, s50, v120
    v_mul_f32 v121, s50, v121
    v_mul_f32 v122, s50, v122
    v_mul_f32 v123, s50, v123
    v_cvt_pk_bf16_f32 v120, v120, v121
    v_cvt_pk_bf16_f32 v121, v122, v123
    v_mul_f32 v124, s50, v124
    v_mul_f32 v125, s50, v125
    v_mul_f32 v126, s50, v126
    v_mul_f32 v127, s50, v127
    v_cvt_pk_bf16_f32 v124, v124, v125
    v_cvt_pk_bf16_f32 v125, v126, v127
    ds_write_b64 v222, v[112:113] offset:28672
    ds_write_b64 v222, v[116:117] offset:29184
    ds_write_b64 v222, v[120:121] offset:29696
    ds_write_b64 v222, v[124:125] offset:30208
    v_mul_f32 v128, s50, v128
    v_mul_f32 v129, s50, v129
    v_mul_f32 v130, s50, v130
    v_mul_f32 v131, s50, v131
    v_cvt_pk_bf16_f32 v128, v128, v129
    v_cvt_pk_bf16_f32 v129, v130, v131
    v_mul_f32 v132, s50, v132
    v_mul_f32 v133, s50, v133
    v_mul_f32 v134, s50, v134
    v_mul_f32 v135, s50, v135
    v_cvt_pk_bf16_f32 v132, v132, v133
    v_cvt_pk_bf16_f32 v133, v134, v135
    v_mul_f32 v136, s50, v136
    v_mul_f32 v137, s50, v137
    v_mul_f32 v138, s50, v138
    v_mul_f32 v139, s50, v139
    v_cvt_pk_bf16_f32 v136, v136, v137
    v_cvt_pk_bf16_f32 v137, v138, v139
    v_mul_f32 v140, s50, v140
    v_mul_f32 v141, s50, v141
    v_mul_f32 v142, s50, v142
    v_mul_f32 v143, s50, v143
    v_cvt_pk_bf16_f32 v140, v140, v141
    v_cvt_pk_bf16_f32 v141, v142, v143
    ds_write_b64 v222, v[128:129] offset:32768
    ds_write_b64 v222, v[132:133] offset:33280
    ds_write_b64 v222, v[136:137] offset:33792
    ds_write_b64 v222, v[140:141] offset:34304
    v_mov_b32 v237, 1
    ds_write_b32 v250, v237 offset:32
    s_mov_b32 s59, 262144
G0_gb0:
    ds_read_b32 v252, v251 offset:32
    s_waitcnt lgkmcnt(0)
    v_cmp_lt_u32 s[56:57], v252, 1
    s_nop 0
    s_cmp_eq_u64 s[56:57], 0
    s_cbranch_scc1 G0_gb0_ok
    s_sleep 1
    s_sub_u32 s59, s59, 1
    s_cmp_lg_u32 s59, 0
    s_cbranch_scc1 G0_gb0
G0_gb0_ok:
    s_lshl_b32 s44, s24, 13
    s_add_u32 s44, s44, 89856
    v_lshl_add_u32 v253, v217, 4, s44
    s_lshl_b32 s44, s24, 11
    v_lshl_add_u32 v254, v217, 4, s44
    ds_read_b128 v[64:67], v253 offset:0
    ds_read_b128 v[80:83], v253 offset:4096
    ds_read_b128 v[68:71], v253 offset:1024
    ds_read_b128 v[84:87], v253 offset:5120
    ds_read_b128 v[72:75], v253 offset:2048
    ds_read_b128 v[88:91], v253 offset:6144
    ds_read_b128 v[76:79], v253 offset:3072
    ds_read_b128 v[92:95], v253 offset:7168
    s_mov_b32 s50, 0x41200000
    s_mov_b32 s42, 65
    v_mov_b32 v212, 0x3f803f80
    v_mov_b32 v213, 0x3f803f80
    v_mov_b32 v214, 0x3f803f80
    v_mov_b32 v215, 0x3f803f80
    s_mov_b32 s59, 262144
G0_k0:
    ds_read_b32 v252, v251 offset:0
    s_waitcnt lgkmcnt(0)
    v_cmp_lt_u32 s[56:57], v252, 34
    s_nop 0
    s_cmp_eq_u64 s[56:57], 0
    s_cbranch_scc1 G0_k0_ok
    s_sleep 1
    s_sub_u32 s59, s59, 1
    s_cmp_lg_u32 s59, 0
    s_cbranch_scc1 G0_k0
G0_k0_ok:
    ds_read_b128 v[160:163], v238 offset:0
    ds_read_b128 v[164:167], v239 offset:0
    ds_read_b128 v[168:171], v240 offset:0
    ds_read_b128 v[172:175], v241 offset:0
    ds_read_b128 v[176:179], v238 offset:4096
    ds_read_b128 v[180:183], v239 offset:4096
    ds_read_b128 v[184:187], v240 offset:4096
    ds_read_b128 v[188:191], v241 offset:4096
    s_waitcnt lgkmcnt(4)
    v_mfma_f32_16x16x32_bf16 v[96:99], v[160:163], v[64:67], 0
    ds_read_b128 v[192:195], v238 offset:8192
    v_mfma_f32_16x16x32_bf16 v[112:115], v[160:163], v[80:83], 0
    v_mfma_f32_16x16x32_bf16 v[96:99], v[164:167], v[68:71], v[96:99]
    ds_read_b128 v[196:199], v239 offset:8192
    v_mfma_f32_16x16x32_bf16 v[112:115], v[164:167], v[84:87], v[112:115]
    v_mfma_f32_16x16x32_bf16 v[96:99], v[168:171], v[72:75], v[96:99]
    ds_read_b128 v[200:203], v240 offset:8192
    v_mfma_f32_16x16x32_bf16 v[112:115], v[168:171], v[88:91], v[112:115]
    v_mfma_f32_16x16x32_bf16 v[96:99], v[172:175], v[76:79], v[96:99]
    ds_read_b128 v[204:207], v241 offset:8192
    v_mfma_f32_16x16x32_bf16 v[112:115], v[172:175], v[92:95], v[112:115]
    s_waitcnt lgkmcnt(4)
    v_mov_b32 v237, 33
    v_mfma_f32_16x16x32_bf16 v[100:103], v[176:179], v[64:67], 0
    ds_read_b128 v[208:211], v238 offset:12288
    v_mfma_f32_16x16x32_bf16 v[116:119], v[176:179], v[80:83], 0
    v_mfma_f32_16x16x32_bf16 v[100:103], v[180:183], v[68:71], v[100:103]
    ds_read_b128 v[160:163], v239 offset:12288
    v_mfma_f32_16x16x32_bf16 v[116:119], v[180:183], v[84:87], v[116:119]
    v_mfma_f32_16x16x32_bf16 v[100:103], v[184:187], v[72:75], v[100:103]
    ds_read_b128 v[164:167], v240 offset:12288
    v_mfma_f32_16x16x32_bf16 v[116:119], v[184:187], v[88:91], v[116:119]
    v_mfma_f32_16x16x32_bf16 v[100:103], v[188:191], v[76:79], v[100:103]
    ds_read_b128 v[168:171], v241 offset:12288
    v_mfma_f32_16x16x32_bf16 v[116:119], v[188:191], v[92:95], v[116:119]
    s_waitcnt lgkmcnt(4)
    v_mfma_f32_16x16x32_bf16 v[104:107], v[192:195], v[64:67], 0
    ds_write_b32 v250, v237 offset:16
    ds_read_b128 v[172:175], v238 offset:16384
    v_mfma_f32_16x16x32_bf16 v[120:123], v[192:195], v[80:83], 0
    v_mfma_f32_16x16x32_bf16 v[104:107], v[196:199], v[68:71], v[104:107]
    ds_read_b128 v[176:179], v239 offset:16384
    v_mfma_f32_16x16x32_bf16 v[120:123], v[196:199], v[84:87], v[120:123]
    v_mfma_f32_16x16x32_bf16 v[104:107], v[200:203], v[72:75], v[104:107]
    ds_read_b128 v[180:183], v240 offset:16384
    v_mfma_f32_16x16x32_bf16 v[120:123], v[200:203], v[88:91], v[120:123]
    v_mfma_f32_16x16x32_bf16 v[104:107], v[204:207], v[76:79], v[104:107]
    ds_read_b128 v[184:187], v241 offset:16384
    v_mfma_f32_16x16x32_bf16 v[120:123], v[204:207], v[92:95], v[120:123]
    s_waitcnt lgkmcnt(5)
    v_mfma_f32_16x16x32_bf16 v[108:111], v[208:211], v[64:67], 0
    ds_read_b128 v[188:191], v238 offset:20480
    v_mfma_f32_16x16x32_bf16 v[124:127], v[208:211], v[80:83], 0
    v_mfma_f32_16x16x32_bf16 v[108:111], v[160:163], v[68:71], v[108:111]
    ds_read_b128 v[192:195], v239 offset:20480
    v_mfma_f32_16x16x32_bf16 v[124:127], v[160:163], v[84:87], v[124:127]
    v_mfma_f32_16x16x32_bf16 v[108:111], v[164:167], v[72:75], v[108:111]
    ds_read_b128 v[196:199], v240 offset:20480
    v_mfma_f32_16x16x32_bf16 v[124:127], v[164:167], v[88:91], v[124:127]
    v_mfma_f32_16x16x32_bf16 v[108:111], v[168:171], v[76:79], v[108:111]
    ds_read_b128 v[200:203], v241 offset:20480
    v_mfma_f32_16x16x32_bf16 v[124:127], v[168:171], v[92:95], v[124:127]
    s_waitcnt lgkmcnt(4)
    v_max_f32 v234, v96, v97
    v_max_f32 v235, v112, v113
    v_max3_f32 v234, v98, v99, v234
    v_max3_f32 v235, v114, v115, v235
    v_max3_f32 v234, v100, v101, v234
    v_max3_f32 v235, v116, v117, v235
    v_max3_f32 v234, v102, v103, v234
    v_max3_f32 v235, v118, v119, v235
    v_max3_f32 v234, v104, v105, v234
    v_max3_f32 v235, v120, v121, v235
    v_max3_f32 v234, v106, v107, v234
    v_max3_f32 v235, v122, v123, v235
    v_max3_f32 v234, v108, v109, v234
    v_max3_f32 v235, v124, v125, v235
    v_max3_f32 v234, v110, v111, v234
    v_max3_f32 v235, v126, v127, v235
    v_mov_b32 v224, v234
    v_mov_b32 v228, v235
    s_nop 0
    v_permlane32_swap_b32 v224, v234
    v_permlane32_swap_b32 v228, v235
    v_max_f32 v234, v234, v224
    v_max_f32 v235, v235, v228
    v_mov_b32 v224, v234
    v_mov_b32 v228, v235
    s_nop 0
    v_permlane16_swap_b32 v224, v234
    v_permlane16_swap_b32 v228, v235
    v_max_f32 v234, v234, v224
    v_max_f32 v235, v235, v228
    v_sub_f32 v224, 0, v234
    v_sub_f32 v225, 0, v234
    v_sub_f32 v226, 0, v234
    v_sub_f32 v227, 0, v234
    v_sub_f32 v228, 0, v235
    v_sub_f32 v229, 0, v235
    v_sub_f32 v230, 0, v235
    v_sub_f32 v231, 0, v235
    v_sub_f32 v96, v96, v234
    v_sub_f32 v97, v97, v234
    v_sub_f32 v98, v98, v234
    v_sub_f32 v99, v99, v234
    v_sub_f32 v112, v112, v235
    v_sub_f32 v113, v113, v235
    v_sub_f32 v114, v114, v235
    v_sub_f32 v115, v115, v235
    v_sub_f32 v100, v100, v234
    v_sub_f32 v101, v101, v234
    v_sub_f32 v102, v102, v234
    v_sub_f32 v103, v103, v234
    v_sub_f32 v116, v116, v235
    v_sub_f32 v117, v117, v235
    v_sub_f32 v118, v118, v235
    v_sub_f32 v119, v119, v235
    v_sub_f32 v104, v104, v234
    v_sub_f32 v105, v105, v234
    v_sub_f32 v106, v106, v234
    v_sub_f32 v107, v107, v234
    v_sub_f32 v120, v120, v235
    v_sub_f32 v121, v121, v235
    v_sub_f32 v122, v122, v235
    v_sub_f32 v123, v123, v235
    v_sub_f32 v108, v108, v234
    v_sub_f32 v109, v109, v234
    v_sub_f32 v110, v110, v234
    v_sub_f32 v111, v111, v234
    v_sub_f32 v124, v124, v235
    v_sub_f32 v125, v125, v235
    v_sub_f32 v126, v126, v235
    v_sub_f32 v127, v127, v235
    v_mfma_f32_16x16x32_bf16 v[128:131], v[172:175], v[64:67], v[224:227]
    ds_read_b128 v[204:207], v238 offset:24576
    v_exp_f32 v96, v96
    v_mfma_f32_16x16x32_bf16 v[144:147], v[172:175], v[80:83], v[228:231]
    v_exp_f32 v97, v97
    v_exp_f32 v98, v98
    v_mfma_f32_16x16x32_bf16 v[128:131], v[176:179], v[68:71], v[128:131]
    ds_read_b128 v[208:211], v239 offset:24576
    v_mov_b32 v216, v96
    v_exp_f32 v99, v99
    v_mfma_f32_16x16x32_bf16 v[144:147], v[176:179], v[84:87], v[144:147]
    v_add_f32 v216, v216, v97
    v_cvt_pk_bf16_f32 v96, v96, v97
    v_exp_f32 v100, v100
    v_mfma_f32_16x16x32_bf16 v[128:131], v[180:183], v[72:75], v[128:131]
    ds_read_b128 v[160:163], v240 offset:24576
    v_add_f32 v216, v216, v98
    v_mfma_f32_16x16x32_bf16 v[144:147], v[180:183], v[88:91], v[144:147]
    v_exp_f32 v101, v101
    v_add_f32 v216, v216, v99
    v_cvt_pk_bf16_f32 v97, v98, v99
    v_mfma_f32_16x16x32_bf16 v[128:131], v[184:187], v[76:79], v[128:131]
    ds_read_b32 v252, v251 offset:0
    ds_read_b128 v[164:167], v241 offset:24576
    v_exp_f32 v102, v102
    v_mfma_f32_16x16x32_bf16 v[144:147], v[184:187], v[92:95], v[144:147]
    s_waitcnt lgkmcnt(5)
    v_add_f32 v216, v216, v100
    v_exp_f32 v103, v103
    v_mfma_f32_16x16x32_bf16 v[132:135], v[188:191], v[64:67], v[224:227]
    ds_read_b128 v[168:171], v238 offset:28672
    v_add_f32 v216, v216, v101
    v_cvt_pk_bf16_f32 v98, v100, v101
    v_add_f32 v216, v216, v102
    v_mfma_f32_16x16x32_bf16 v[148:151], v[188:191], v[80:83], v[228:231]
    v_add_f32 v216, v216, v103
    v_cvt_pk_bf16_f32 v99, v102, v103
    v_exp_f32 v112, v112
    v_mfma_f32_16x16x32_bf16 v[132:135], v[192:195], v[68:71], v[132:135]
    ds_read_b128 v[172:175], v239 offset:28672
    v_exp_f32 v113, v113
    v_mfma_f32_16x16x32_bf16 v[148:151], v[192:195], v[84:87], v[148:151]
    v_exp_f32 v114, v114
    v_mov_b32 v220, v112
    v_mfma_f32_16x16x32_bf16 v[132:135], v[196:199], v[72:75], v[132:135]
    ds_read_b128 v[176:179], v240 offset:28672
    v_exp_f32 v115, v115
    v_add_f32 v220, v220, v113
    v_mfma_f32_16x16x32_bf16 v[148:151], v[196:199], v[88:91], v[148:151]
    v_cvt_pk_bf16_f32 v112, v112, v113
    v_exp_f32 v116, v116
    v_mfma_f32_16x16x32_bf16 v[132:135], v[200:203], v[76:79], v[132:135]
    ds_read_b128 v[180:183], v241 offset:28672
    v_add_f32 v220, v220, v114
    v_exp_f32 v117, v117
    v_mfma_f32_16x16x32_bf16 v[148:151], v[200:203], v[92:95], v[148:151]
    s_waitcnt lgkmcnt(4)
    v_add_f32 v220, v220, v115
    v_mov_b32 v237, 34
    v_cmp_lt_u32 s[56:57], v252, 35
    v_mfma_f32_16x16x32_bf16 v[136:139], v[204:207], v[64:67], v[224:227]
    s_cmp_eq_u64 s[56:57], 0
    s_cbranch_scc0 G0_x2
G0_x2_ret:
    ds_write_b32 v250, v237 offset:16
    ds_read_b64_tr_b16 v[184:185], v242 offset:0
    v_cvt_pk_bf16_f32 v113, v114, v115
    v_mfma_f32_16x16x32_bf16 v[152:155], v[204:207], v[80:83], v[228:231]
    ds_read_b64_tr_b16 v[186:187], v242 offset:4096
    v_exp_f32 v118, v118
    v_mfma_f32_16x16x32_bf16 v[136:139], v[208:211], v[68:71], v[136:139]
    ds_read_b64_tr_b16 v[188:189], v243 offset:0
    v_add_f32 v220, v220, v116
    v_exp_f32 v119, v119
    v_mfma_f32_16x16x32_bf16 v[152:155], v[208:211], v[84:87], v[152:155]
    ds_read_b64_tr_b16 v[190:191], v243 offset:4096
    v_add_f32 v220, v220, v117
    v_cvt_pk_bf16_f32 v114, v116, v117
    v_mfma_f32_16x16x32_bf16 v[136:139], v[160:163], v[72:75], v[136:139]
    ds_read_b64_tr_b16 v[192:193], v244 offset:0
    v_add_f32 v220, v220, v118
    v_add_f32 v220, v220, v119
    v_mfma_f32_16x16x32_bf16 v[152:155], v[160:163], v[88:91], v[152:155]
    ds_read_b64_tr_b16 v[194:195], v244 offset:4096
    v_cvt_pk_bf16_f32 v115, v118, v119
    v_exp_f32 v104, v104
    v_mfma_f32_16x16x32_bf16 v[136:139], v[164:167], v[76:79], v[136:139]
    ds_read_b64_tr_b16 v[196:197], v245 offset:0
    v_exp_f32 v105, v105
    v_mfma_f32_16x16x32_bf16 v[152:155], v[164:167], v[92:95], v[152:155]
    s_waitcnt lgkmcnt(8)
    ds_read_b64_tr_b16 v[198:199], v245 offset:4096
    v_exp_f32 v106, v106
    v_mfma_f32_16x16x32_bf16 v[140:143], v[168:171], v[64:67], v[224:227]
    ds_read_b64_tr_b16 v[200:201], v246 offset:0
    v_add_f32 v216, v216, v104
    v_mfma_f32_16x16x32_bf16 v[156:159], v[168:171], v[80:83], v[228:231]
    ds_read_b64_tr_b16 v[202:203], v246 offset:4096
    v_exp_f32 v107, v107
    v_add_f32 v216, v216, v105
    v_mfma_f32_16x16x32_bf16 v[140:143], v[172:175], v[68:71], v[140:143]
    ds_read_b64_tr_b16 v[204:205], v247 offset:0
    v_cvt_pk_bf16_f32 v104, v104, v105
    v_exp_f32 v108, v108
    v_mfma_f32_16x16x32_bf16 v[156:159], v[172:175], v[84:87], v[156:159]
    ds_read_b64_tr_b16 v[206:207], v247 offset:4096
    v_add_f32 v216, v216, v106
    v_mfma_f32_16x16x32_bf16 v[140:143], v[176:179], v[72:75], v[140:143]
    ds_read_b64_tr_b16 v[208:209], v248 offset:0
    v_exp_f32 v109, v109
    v_mfma_f32_16x16x32_bf16 v[156:159], v[176:179], v[88:91], v[156:159]
    ds_read_b64_tr_b16 v[210:211], v248 offset:4096
    v_add_f32 v216, v216, v107
    v_cvt_pk_bf16_f32 v105, v106, v107
    v_mfma_f32_16x16x32_bf16 v[140:143], v[180:183], v[76:79], v[140:143]
    ds_read_b64_tr_b16 v[160:161], v249 offset:0
    v_exp_f32 v110, v110
    v_add_f32 v216, v216, v108
    v_mfma_f32_16x16x32_bf16 v[156:159], v[180:183], v[92:95], v[156:159]
    s_waitcnt lgkmcnt(7)
    ds_read_b64_tr_b16 v[162:163], v249 offset:4096
    v_exp_f32 v111, v111
    v_mfma_f32_16x16x32_bf16 v[0:3], v[184:187], v[96:99], 0
    ds_read_b64_tr_b16 v[164:165], v242 offset:8192
    v_add_f32 v216, v216, v109
    v_cvt_pk_bf16_f32 v106, v108, v109
    v_mfma_f32_16x16x32_bf16 v[32:35], v[184:187], v[112:115], 0
    ds_read_b64_tr_b16 v[166:167], v242 offset:12288
    v_add_f32 v216, v216, v110
    v_add_f32 v216, v216, v111
    v_cvt_pk_bf16_f32 v107, v110, v111
    v_mfma_f32_16x16x32_bf16 v[4:7], v[188:191], v[96:99], 0
    ds_read_b64_tr_b16 v[168:169], v243 offset:8192
    v_exp_f32 v120, v120
    v_mfma_f32_16x16x32_bf16 v[36:39], v[188:191], v[112:115], 0
    ds_read_b64_tr_b16 v[170:171], v243 offset:12288
    v_exp_f32 v121, v121
    v_mfma_f32_16x16x32_bf16 v[8:11], v[192:195], v[96:99], 0
    ds_read_b64_tr_b16 v[172:173], v244 offset:8192
    v_exp_f32 v122, v122
    v_mfma_f32_16x16x32_bf16 v[40:43], v[192:195], v[112:115], 0
    ds_read_b64_tr_b16 v[174:175], v244 offset:12288
    v_add_f32 v220, v220, v120
    v_exp_f32 v123, v123
    v_mfma_f32_16x16x32_bf16 v[12:15], v[196:199], v[96:99], 0
    ds_read_b32 v252, v251 offset:0
    ds_read_b64_tr_b16 v[176:177], v245 offset:8192
    v_add_f32 v220, v220, v121
    v_mfma_f32_16x16x32_bf16 v[44:47], v[196:199], v[112:115], 0
    s_waitcnt lgkmcnt(8)
    ds_read_b64_tr_b16 v[178:179], v245 offset:12288
    v_cvt_pk_bf16_f32 v120, v120, v121
    v_exp_f32 v124, v124
    v_mfma_f32_16x16x32_bf16 v[16:19], v[200:203], v[96:99], 0
    ds_read_b64_tr_b16 v[180:181], v246 offset:8192
    v_add_f32 v220, v220, v122
    v_mfma_f32_16x16x32_bf16 v[48:51], v[200:203], v[112:115], 0
    ds_read_b64_tr_b16 v[182:183], v246 offset:12288
    v_exp_f32 v125, v125
    v_add_f32 v220, v220, v123
    v_mfma_f32_16x16x32_bf16 v[20:23], v[204:207], v[96:99], 0
    ds_read_b64_tr_b16 v[184:185], v247 offset:8192
    v_cvt_pk_bf16_f32 v121, v122, v123
    v_mfma_f32_16x16x32_bf16 v[52:55], v[204:207], v[112:115], 0
    ds_read_b64_tr_b16 v[186:187], v247 offset:12288
    v_exp_f32 v126, v126
    v_add_f32 v220, v220, v124
    v_mfma_f32_16x16x32_bf16 v[24:27], v[208:211], v[96:99], 0
    ds_read_b64_tr_b16 v[188:189], v248 offset:8192
    v_exp_f32 v127, v127
    v_mfma_f32_16x16x32_bf16 v[56:59], v[208:211], v[112:115], 0
    ds_read_b64_tr_b16 v[190:191], v248 offset:12288
    v_add_f32 v220, v220, v125
    v_cvt_pk_bf16_f32 v122, v124, v125
    v_add_f32 v220, v220, v126
    v_mfma_f32_16x16x32_bf16 v[28:31], v[160:163], v[96:99], 0
    ds_read_b64_tr_b16 v[192:193], v249 offset:8192
    v_add_f32 v220, v220, v127
    v_cvt_pk_bf16_f32 v123, v126, v127
    v_mfma_f32_16x16x32_bf16 v[60:63], v[160:163], v[112:115], 0
    s_waitcnt lgkmcnt(7)
    ds_read_b64_tr_b16 v[194:195], v249 offset:12288
    v_mov_b32 v237, 35
    v_cmp_lt_u32 s[56:57], v252, 36
    v_mfma_f32_16x16x32_bf16 v[0:3], v[164:167], v[104:107], v[0:3]
    s_cmp_eq_u64 s[56:57], 0
    s_cbranch_scc0 G0_x4
G0_x4_ret:
    ds_write_b32 v250, v237 offset:16
    ds_read_b128 v[196:199], v238 offset:32768
    v_mfma_f32_16x16x32_bf16 v[32:35], v[164:167], v[120:123], v[32:35]
    ds_read_b128 v[200:203], v239 offset:32768
    v_max_f32 v234, v128, v129
    v_mfma_f32_16x16x32_bf16 v[4:7], v[168:171], v[104:107], v[4:7]
    v_max_f32 v235, v144, v145
    v_max3_f32 v234, v130, v131, v234
    v_mfma_f32_16x16x32_bf16 v[36:39], v[168:171], v[120:123], v[36:39]
    ds_read_b128 v[204:207], v240 offset:32768
    v_max3_f32 v235, v146, v147, v235
    v_mfma_f32_16x16x32_bf16 v[8:11], v[172:175], v[104:107], v[8:11]
    v_max3_f32 v234, v132, v133, v234
    v_max3_f32 v235, v148, v149, v235
    v_mfma_f32_16x16x32_bf16 v[40:43], v[172:175], v[120:123], v[40:43]
    ds_read_b128 v[208:211], v241 offset:32768
    v_max3_f32 v234, v134, v135, v234
    v_mfma_f32_16x16x32_bf16 v[12:15], v[176:179], v[104:107], v[12:15]
    v_max3_f32 v235, v150, v151, v235
    v_max3_f32 v234, v136, v137, v234
    v_mfma_f32_16x16x32_bf16 v[44:47], v[176:179], v[120:123], v[44:47]
    s_waitcnt lgkmcnt(5)
    ds_read_b128 v[160:163], v238 offset:36864
    v_mfma_f32_16x16x32_bf16 v[16:19], v[180:183], v[104:107], v[16:19]
    ds_read_b128 v[164:167], v239 offset:36864
    v_max3_f32 v235, v152, v153, v235
    v_mfma_f32_16x16x32_bf16 v[48:51], v[180:183], v[120:123], v[48:51]
    v_max3_f32 v234, v138, v139, v234
    v_max3_f32 v235, v154, v155, v235
    v_mfma_f32_16x16x32_bf16 v[20:23], v[184:187], v[104:107], v[20:23]
    ds_read_b128 v[168:171], v240 offset:36864
    v_max3_f32 v234, v140, v141, v234
    v_mfma_f32_16x16x32_bf16 v[52:55], v[184:187], v[120:123], v[52:55]
    v_max3_f32 v235, v156, v157, v235
    v_max3_f32 v234, v142, v143, v234
    v_mfma_f32_16x16x32_bf16 v[24:27], v[188:191], v[104:107], v[24:27]
    ds_read_b128 v[172:175], v241 offset:36864
    v_max3_f32 v235, v158, v159, v235
    v_mfma_f32_16x16x32_bf16 v[56:59], v[188:191], v[120:123], v[56:59]
    v_max_f32 v236, v234, v235
    v_cmp_lt_f32 vcc, s50, v236
    v_mfma_f32_16x16x32_bf16 v[28:31], v[192:195], v[104:107], v[28:31]
    v_mfma_f32_16x16x32_bf16 v[60:63], v[192:195], v[120:123], v[60:63]
    s_waitcnt lgkmcnt(4)
    s_cbranch_vccnz G0_g0
G0_g0_ret:
    v_mfma_f32_16x16x32_bf16 v[96:99], v[196:199], v[64:67], v[224:227]
    ds_read_b128 v[176:179], v238 offset:40960
    v_exp_f32 v128, v128
    v_mfma_f32_16x16x32_bf16 v[112:115], v[196:199], v[80:83], v[228:231]
    v_exp_f32 v129, v129
    v_exp_f32 v130, v130
    v_mfma_f32_16x16x32_bf16 v[96:99], v[200:203], v[68:71], v[96:99]
    ds_read_b128 v[180:183], v239 offset:40960
    v_add_f32 v216, v216, v128
    v_exp_f32 v131, v131
    v_mfma_f32_16x16x32_bf16 v[112:115], v[200:203], v[84:87], v[112:115]
    v_add_f32 v216, v216, v129
    v_cvt_pk_bf16_f32 v128, v128, v129
    v_exp_f32 v132, v132
    v_mfma_f32_16x16x32_bf16 v[96:99], v[204:207], v[72:75], v[96:99]
    ds_read_b128 v[184:187], v240 offset:40960
    v_add_f32 v216, v216, v130
    v_mfma_f32_16x16x32_bf16 v[112:115], v[204:207], v[88:91], v[112:115]
    v_exp_f32 v133, v133
    v_add_f32 v216, v216, v131
    v_cvt_pk_bf16_f32 v129, v130, v131
    v_mfma_f32_16x16x32_bf16 v[96:99], v[208:211], v[76:79], v[96:99]
    ds_read_b32 v252, v251 offset:0
    ds_read_b128 v[188:191], v241 offset:40960
    v_exp_f32 v134, v134
    v_mfma_f32_16x16x32_bf16 v[112:115], v[208:211], v[92:95], v[112:115]
    s_waitcnt lgkmcnt(5)
    v_add_f32 v216, v216, v132
    v_exp_f32 v135, v135
    v_mfma_f32_16x16x32_bf16 v[100:103], v[160:163], v[64:67], v[224:227]
    ds_read_b128 v[192:195], v238 offset:45056
    v_add_f32 v216, v216, v133
    v_cvt_pk_bf16_f32 v130, v132, v133
    v_add_f32 v216, v216, v134
    v_mfma_f32_16x16x32_bf16 v[116:119], v[160:163], v[80:83], v[228:231]
    v_add_f32 v216, v216, v135
    v_cvt_pk_bf16_f32 v131, v134, v135
    v_exp_f32 v144, v144
    v_mfma_f32_16x16x32_bf16 v[100:103], v[164:167], v[68:71], v[100:103]
    ds_read_b128 v[196:199], v239 offset:45056
    v_exp_f32 v145, v145
    v_mfma_f32_16x16x32_bf16 v[116:119], v[164:167], v[84:87], v[116:119]
    v_exp_f32 v146, v146
    v_add_f32 v220, v220, v144
    v_mfma_f32_16x16x32_bf16 v[100:103], v[168:171], v[72:75], v[100:103]
    ds_read_b128 v[200:203], v240 offset:45056
    v_exp_f32 v147, v147
    v_add_f32 v220, v220, v145
    v_mfma_f32_16x16x32_bf16 v[116:119], v[168:171], v[88:91], v[116:119]
    v_cvt_pk_bf16_f32 v144, v144, v145
    v_exp_f32 v148, v148
    v_mfma_f32_16x16x32_bf16 v[100:103], v[172:175], v[76:79], v[100:103]
    ds_read_b128 v[204:207], v241 offset:45056
    v_add_f32 v220, v220, v146
    v_exp_f32 v149, v149
    v_mfma_f32_16x16x32_bf16 v[116:119], v[172:175], v[92:95], v[116:119]
    s_waitcnt lgkmcnt(4)
    v_add_f32 v220, v220, v147
    v_mov_b32 v237, 36
    v_cmp_lt_u32 s[56:57], v252, 37
    v_mfma_f32_16x16x32_bf16 v[104:107], v[176:179], v[64:67], v[224:227]
    s_cmp_eq_u64 s[56:57], 0
    s_cbranch_scc0 G0_x6
G0_x6_ret:
    ds_write_b32 v250, v237 offset:16
    ds_read_b64_tr_b16 v[208:209], v242 offset:16384
    v_cvt_pk_bf16_f32 v145, v146, v147
    v_mfma_f32_16x16x32_bf16 v[120:123], v[176:179], v[80:83], v[228:231]
    ds_read_b64_tr_b16 v[210:211], v242 offset:20480
    v_exp_f32 v150, v150
    v_mfma_f32_16x16x32_bf16 v[104:107], v[180:183], v[68:71], v[104:107]
    ds_read_b64_tr_b16 v[160:161], v243 offset:16384
    v_add_f32 v220, v220, v148
    v_exp_f32 v151, v151
    v_mfma_f32_16x16x32_bf16 v[120:123], v[180:183], v[84:87], v[120:123]
    ds_read_b64_tr_b16 v[162:163], v243 offset:20480
    v_add_f32 v220, v220, v149
    v_cvt_pk_bf16_f32 v146, v148, v149
    v_mfma_f32_16x16x32_bf16 v[104:107], v[184:187], v[72:75], v[104:107]
    ds_read_b64_tr_b16 v[164:165], v244 offset:16384
    v_add_f32 v220, v220, v150
    v_add_f32 v220, v220, v151
    v_mfma_f32_16x16x32_bf16 v[120:123], v[184:187], v[88:91], v[120:123]
    ds_read_b64_tr_b16 v[166:167], v244 offset:20480
    v_cvt_pk_bf16_f32 v147, v150, v151
    v_exp_f32 v136, v136
    v_mfma_f32_16x16x32_bf16 v[104:107], v[188:191], v[76:79], v[104:107]
    ds_read_b64_tr_b16 v[168:169], v245 offset:16384
    v_exp_f32 v137, v137
    v_mfma_f32_16x16x32_bf16 v[120:123], v[188:191], v[92:95], v[120:123]
    s_waitcnt lgkmcnt(8)
    ds_read_b64_tr_b16 v[170:171], v245 offset:20480
    v_exp_f32 v138, v138
    v_mfma_f32_16x16x32_bf16 v[108:111], v[192:195], v[64:67], v[224:227]
    ds_read_b64_tr_b16 v[172:173], v246 offset:16384
    v_add_f32 v216, v216, v136
    v_mfma_f32_16x16x32_bf16 v[124:127], v[192:195], v[80:83], v[228:231]
    ds_read_b64_tr_b16 v[174:175], v246 offset:20480
    v_exp_f32 v139, v139
    v_add_f32 v216, v216, v137
    v_mfma_f32_16x16x32_bf16 v[108:111], v[196:199], v[68:71], v[108:111]
    ds_read_b64_tr_b16 v[176:177], v247 offset:16384
    v_cvt_pk_bf16_f32 v136, v136, v137
    v_exp_f32 v140, v140
    v_mfma_f32_16x16x32_bf16 v[124:127], v[196:199], v[84:87], v[124:127]
    ds_read_b64_tr_b16 v[178:179], v247 offset:20480
    v_add_f32 v216, v216, v138
    v_mfma_f32_16x16x32_bf16 v[108:111], v[200:203], v[72:75], v[108:111]
    ds_read_b64_tr_b16 v[180:181], v248 offset:16384
    v_exp_f32 v141, v141
    v_mfma_f32_16x16x32_bf16 v[124:127], v[200:203], v[88:91], v[124:127]
    ds_read_b64_tr_b16 v[182:183], v248 offset:20480
    v_add_f32 v216, v216, v139
    v_cvt_pk_bf16_f32 v137, v138, v139
    v_mfma_f32_16x16x32_bf16 v[108:111], v[204:207], v[76:79], v[108:111]
    ds_read_b64_tr_b16 v[184:185], v249 offset:16384
    v_exp_f32 v142, v142
    v_add_f32 v216, v216, v140
    v_mfma_f32_16x16x32_bf16 v[124:127], v[204:207], v[92:95], v[124:127]
    s_waitcnt lgkmcnt(7)
    ds_read_b64_tr_b16 v[186:187], v249 offset:20480
    v_exp_f32 v143, v143
    v_mfma_f32_16x16x32_bf16 v[0:3], v[208:211], v[128:131], v[0:3]
    ds_read_b64_tr_b16 v[188:189], v242 offset:24576
    v_add_f32 v216, v216, v141
    v_cvt_pk_bf16_f32 v138, v140, v141
    v_mfma_f32_16x16x32_bf16 v[32:35], v[208:211], v[144:147], v[32:35]
    ds_read_b64_tr_b16 v[190:191], v242 offset:28672
    v_add_f32 v216, v216, v142
    v_add_f32 v216, v216, v143
    v_cvt_pk_bf16_f32 v139, v142, v143
    v_mfma_f32_16x16x32_bf16 v[4:7], v[160:163], v[128:131], v[4:7]
    ds_read_b64_tr_b16 v[192:193], v243 offset:24576
    v_exp_f32 v152, v152
    v_mfma_f32_16x16x32_bf16 v[36:39], v[160:163], v[144:147], v[36:39]
    ds_read_b64_tr_b16 v[194:195], v243 offset:28672
    v_exp_f32 v153, v153
    v_mfma_f32_16x16x32_bf16 v[8:11], v[164:167], v[128:131], v[8:11]
    ds_read_b64_tr_b16 v[196:197], v244 offset:24576
    v_exp_f32 v154, v154
    v_mfma_f32_16x16x32_bf16 v[40:43], v[164:167], v[144:147], v[40:43]
    ds_read_b64_tr_b16 v[198:199], v244 offset:28672
    v_add_f32 v220, v220, v152
    v_exp_f32 v155, v155
    v_mfma_f32_16x16x32_bf16 v[12:15], v[168:171], v[128:131], v[12:15]
    ds_read_b32 v252, v251 offset:0
    ds_read_b64_tr_b16 v[200:201], v245 offset:24576
    v_add_f32 v220, v220, v153
    v_mfma_f32_16x16x32_bf16 v[44:47], v[168:171], v[144:147], v[44:47]
    s_waitcnt lgkmcnt(8)
    ds_read_b64_tr_b16 v[202:203], v245 offset:28672
    v_cvt_pk_bf16_f32 v152, v152, v153
    v_exp_f32 v156, v156
    v_mfma_f32_16x16x32_bf16 v[16:19], v[172:175], v[128:131], v[16:19]
    ds_read_b64_tr_b16 v[204:205], v246 offset:24576
    v_add_f32 v220, v220, v154
    v_mfma_f32_16x16x32_bf16 v[48:51], v[172:175], v[144:147], v[48:51]
    ds_read_b64_tr_b16 v[206:207], v246 offset:28672
    v_exp_f32 v157, v157
    v_add_f32 v220, v220, v155
    v_mfma_f32_16x16x32_bf16 v[20:23], v[176:179], v[128:131], v[20:23]
    ds_read_b64_tr_b16 v[208:209], v247 offset:24576
    v_cvt_pk_bf16_f32 v153, v154, v155
    v_mfma_f32_16x16x32_bf16 v[52:55], v[176:179], v[144:147], v[52:55]
    ds_read_b64_tr_b16 v[210:211], v247 offset:28672
    v_exp_f32 v158, v158
    v_add_f32 v220, v220, v156
    v_mfma_f32_16x16x32_bf16 v[24:27], v[180:183], v[128:131], v[24:27]
    ds_read_b64_tr_b16 v[160:161], v248 offset:24576
    v_exp_f32 v159, v159
    v_mfma_f32_16x16x32_bf16 v[56:59], v[180:183], v[144:147], v[56:59]
    ds_read_b64_tr_b16 v[162:163], v248 offset:28672
    v_add_f32 v220, v220, v157
    v_cvt_pk_bf16_f32 v154, v156, v157
    v_add_f32 v220, v220, v158
    v_mfma_f32_16x16x32_bf16 v[28:31], v[184:187], v[128:131], v[28:31]
    ds_read_b64_tr_b16 v[164:165], v249 offset:24576
    v_add_f32 v220, v220, v159
    v_cvt_pk_bf16_f32 v155, v158, v159
    v_mfma_f32_16x16x32_bf16 v[60:63], v[184:187], v[144:147], v[60:63]
    s_waitcnt lgkmcnt(7)
    ds_read_b64_tr_b16 v[166:167], v249 offset:28672
    v_mov_b32 v237, 37
    v_cmp_lt_u32 s[56:57], v252, 38
    v_mfma_f32_16x16x32_bf16 v[0:3], v[188:191], v[136:139], v[0:3]
    s_cmp_eq_u64 s[56:57], 0
    s_cbranch_scc0 G0_x8
G0_x8_ret:
    ds_write_b32 v250, v237 offset:16
    ds_read_b128 v[168:171], v238 offset:0
    v_mfma_f32_16x16x32_bf16 v[32:35], v[188:191], v[152:155], v[32:35]
    ds_read_b128 v[172:175], v239 offset:0
    v_max_f32 v234, v96, v97
    v_mfma_f32_16x16x32_bf16 v[4:7], v[192:195], v[136:139], v[4:7]
    v_max_f32 v235, v112, v113
    v_max3_f32 v234, v98, v99, v234
    v_mfma_f32_16x16x32_bf16 v[36:39], v[192:195], v[152:155], v[36:39]
    ds_read_b128 v[176:179], v240 offset:0
    v_max3_f32 v235, v114, v115, v235
    v_mfma_f32_16x16x32_bf16 v[8:11], v[196:199], v[136:139], v[8:11]
    v_max3_f32 v234, v100, v101, v234
    v_max3_f32 v235, v116, v117, v235
    v_mfma_f32_16x16x32_bf16 v[40:43], v[196:199], v[152:155], v[40:43]
    ds_read_b128 v[180:183], v241 offset:0
    v_max3_f32 v234, v102, v103, v234
    v_mfma_f32_16x16x32_bf16 v[12:15], v[200:203], v[136:139], v[12:15]
    v_max3_f32 v235, v118, v119, v235
    v_max3_f32 v234, v104, v105, v234
    v_mfma_f32_16x16x32_bf16 v[44:47], v[200:203], v[152:155], v[44:47]
    s_waitcnt lgkmcnt(5)
    ds_read_b128 v[184:187], v238 offset:4096
    v_mfma_f32_16x16x32_bf16 v[16:19], v[204:207], v[136:139], v[16:19]
    ds_read_b128 v[188:191], v239 offset:4096
    v_max3_f32 v235, v120, v121, v235
    v_mfma_f32_16x16x32_bf16 v[48:51], v[204:207], v[152:155], v[48:51]
    v_max3_f32 v234, v106, v107, v234
    v_max3_f32 v235, v122, v123, v235
    v_mfma_f32_16x16x32_bf16 v[20:23], v[208:211], v[136:139], v[20:23]
    ds_read_b128 v[192:195], v240 offset:4096
    v_max3_f32 v234, v108, v109, v234
    v_mfma_f32_16x16x32_bf16 v[52:55], v[208:211], v[152:155], v[52:55]
    v_max3_f32 v235, v124, v125, v235
    v_max3_f32 v234, v110, v111, v234
    v_mfma_f32_16x16x32_bf16 v[24:27], v[160:163], v[136:139], v[24:27]
    ds_read_b128 v[196:199], v241 offset:4096
    v_max3_f32 v235, v126, v127, v235
    v_mfma_f32_16x16x32_bf16 v[56:59], v[160:163], v[152:155], v[56:59]
    v_max_f32 v236, v234, v235
    v_cmp_lt_f32 vcc, s50, v236
    v_mfma_f32_16x16x32_bf16 v[28:31], v[164:167], v[136:139], v[28:31]
    v_mfma_f32_16x16x32_bf16 v[60:63], v[164:167], v[152:155], v[60:63]
    s_waitcnt lgkmcnt(4)
    s_cbranch_vccnz G0_g1
G0_g1_ret:
    v_mfma_f32_16x16x32_bf16 v[128:131], v[168:171], v[64:67], v[224:227]
    ds_read_b128 v[200:203], v238 offset:8192
    v_exp_f32 v96, v96
    v_mfma_f32_16x16x32_bf16 v[144:147], v[168:171], v[80:83], v[228:231]
    v_exp_f32 v97, v97
    v_exp_f32 v98, v98
    v_mfma_f32_16x16x32_bf16 v[128:131], v[172:175], v[68:71], v[128:131]
    ds_read_b128 v[204:207], v239 offset:8192
    v_add_f32 v216, v216, v96
    v_exp_f32 v99, v99
    v_mfma_f32_16x16x32_bf16 v[144:147], v[172:175], v[84:87], v[144:147]
    v_add_f32 v216, v216, v97
    v_cvt_pk_bf16_f32 v96, v96, v97
    v_exp_f32 v100, v100
    v_mfma_f32_16x16x32_bf16 v[128:131], v[176:179], v[72:75], v[128:131]
    ds_read_b128 v[208:211], v240 offset:8192
    v_add_f32 v216, v216, v98
    v_mfma_f32_16x16x32_bf16 v[144:147], v[176:179], v[88:91], v[144:147]
    v_exp_f32 v101, v101
    v_add_f32 v216, v216, v99
    v_cvt_pk_bf16_f32 v97, v98, v99
    v_mfma_f32_16x16x32_bf16 v[128:131], v[180:183], v[76:79], v[128:131]
    ds_read_b32 v252, v251 offset:0
    ds_read_b128 v[160:163], v241 offset:8192
    v_exp_f32 v102, v102
    v_mfma_f32_16x16x32_bf16 v[144:147], v[180:183], v[92:95], v[144:147]
    s_waitcnt lgkmcnt(5)
    v_add_f32 v216, v216, v100
    v_exp_f32 v103, v103
    v_mfma_f32_16x16x32_bf16 v[132:135], v[184:187], v[64:67], v[224:227]
    ds_read_b128 v[164:167], v238 offset:12288
    v_add_f32 v216, v216, v101
    v_cvt_pk_bf16_f32 v98, v100, v101
    v_add_f32 v216, v216, v102
    v_mfma_f32_16x16x32_bf16 v[148:151], v[184:187], v[80:83], v[228:231]
    v_add_f32 v216, v216, v103
    v_cvt_pk_bf16_f32 v99, v102, v103
    v_exp_f32 v112, v112
    v_mfma_f32_16x16x32_bf16 v[132:135], v[188:191], v[68:71], v[132:135]
    ds_read_b128 v[168:171], v239 offset:12288
    v_exp_f32 v113, v113
    v_mfma_f32_16x16x32_bf16 v[148:151], v[188:191], v[84:87], v[148:151]
    v_exp_f32 v114, v114
    v_add_f32 v220, v220, v112
    v_mfma_f32_16x16x32_bf16 v[132:135], v[192:195], v[72:75], v[132:135]
    ds_read_b128 v[172:175], v240 offset:12288
    v_exp_f32 v115, v115
    v_add_f32 v220, v220, v113
    v_mfma_f32_16x16x32_bf16 v[148:151], v[192:195], v[88:91], v[148:151]
    v_cvt_pk_bf16_f32 v112, v112, v113
    v_exp_f32 v116, v116
    v_mfma_f32_16x16x32_bf16 v[132:135], v[196:199], v[76:79], v[132:135]
    ds_read_b128 v[176:179], v241 offset:12288
    v_add_f32 v220, v220, v114
    v_exp_f32 v117, v117
    v_mfma_f32_16x16x32_bf16 v[148:151], v[196:199], v[92:95], v[148:151]
    s_waitcnt lgkmcnt(4)
    v_add_f32 v220, v220, v115
    v_mov_b32 v237, 38
    v_cmp_lt_u32 s[56:57], v252, 39
    v_mfma_f32_16x16x32_bf16 v[136:139], v[200:203], v[64:67], v[224:227]
    s_cmp_eq_u64 s[56:57], 0
    s_cbranch_scc0 G0_x10
G0_x10_ret:
    ds_write_b32 v250, v237 offset:16
    ds_read_b64_tr_b16 v[180:181], v242 offset:32768
    v_cvt_pk_bf16_f32 v113, v114, v115
    v_mfma_f32_16x16x32_bf16 v[152:155], v[200:203], v[80:83], v[228:231]
    ds_read_b64_tr_b16 v[182:183], v242 offset:36864
    v_exp_f32 v118, v118
    v_mfma_f32_16x16x32_bf16 v[136:139], v[204:207], v[68:71], v[136:139]
    ds_read_b64_tr_b16 v[184:185], v243 offset:32768
    v_add_f32 v220, v220, v116
    v_exp_f32 v119, v119
    v_mfma_f32_16x16x32_bf16 v[152:155], v[204:207], v[84:87], v[152:155]
    ds_read_b64_tr_b16 v[186:187], v243 offset:36864
    v_add_f32 v220, v220, v117
    v_cvt_pk_bf16_f32 v114, v116, v117
    v_mfma_f32_16x16x32_bf16 v[136:139], v[208:211], v[72:75], v[136:139]
    ds_read_b64_tr_b16 v[188:189], v244 offset:32768
    v_add_f32 v220, v220, v118
    v_add_f32 v220, v220, v119
    v_mfma_f32_16x16x32_bf16 v[152:155], v[208:211], v[88:91], v[152:155]
    ds_read_b64_tr_b16 v[190:191], v244 offset:36864
    v_cvt_pk_bf16_f32 v115, v118, v119
    v_exp_f32 v104, v104
    v_mfma_f32_16x16x32_bf16 v[136:139], v[160:163], v[76:79], v[136:139]
    ds_read_b64_tr_b16 v[192:193], v245 offset:32768
    v_exp_f32 v105, v105
    v_mfma_f32_16x16x32_bf16 v[152:155], v[160:163], v[92:95], v[152:155]
    s_waitcnt lgkmcnt(8)
    ds_read_b64_tr_b16 v[194:195], v245 offset:36864
    v_exp_f32 v106, v106
    v_mfma_f32_16x16x32_bf16 v[140:143], v[164:167], v[64:67], v[224:227]
    ds_read_b64_tr_b16 v[196:197], v246 offset:32768
    v_add_f32 v216, v216, v104
    v_mfma_f32_16x16x32_bf16 v[156:159], v[164:167], v[80:83], v[228:231]
    ds_read_b64_tr_b16 v[198:199], v246 offset:36864
    v_exp_f32 v107, v107
    v_add_f32 v216, v216, v105
    v_mfma_f32_16x16x32_bf16 v[140:143], v[168:171], v[68:71], v[140:143]
    ds_read_b64_tr_b16 v[200:201], v247 offset:32768
    v_cvt_pk_bf16_f32 v104, v104, v105
    v_exp_f32 v108, v108
    v_mfma_f32_16x16x32_bf16 v[156:159], v[168:171], v[84:87], v[156:159]
    ds_read_b64_tr_b16 v[202:203], v247 offset:36864
    v_add_f32 v216, v216, v106
    v_mfma_f32_16x16x32_bf16 v[140:143], v[172:175], v[72:75], v[140:143]
    ds_read_b64_tr_b16 v[204:205], v248 offset:32768
    v_exp_f32 v109, v109
    v_mfma_f32_16x16x32_bf16 v[156:159], v[172:175], v[88:91], v[156:159]
    ds_read_b64_tr_b16 v[206:207], v248 offset:36864
    v_add_f32 v216, v216, v107
    v_cvt_pk_bf16_f32 v105, v106, v107
    v_mfma_f32_16x16x32_bf16 v[140:143], v[176:179], v[76:79], v[140:143]
    ds_read_b64_tr_b16 v[208:209], v249 offset:32768
    v_exp_f32 v110, v110
    v_add_f32 v216, v216, v108
    v_mfma_f32_16x16x32_bf16 v[156:159], v[176:179], v[92:95], v[156:159]
    s_waitcnt lgkmcnt(7)
    ds_read_b64_tr_b16 v[210:211], v249 offset:36864
    v_exp_f32 v111, v111
    v_mfma_f32_16x16x32_bf16 v[0:3], v[180:183], v[96:99], v[0:3]
    ds_read_b64_tr_b16 v[160:161], v242 offset:40960
    v_add_f32 v216, v216, v109
    v_cvt_pk_bf16_f32 v106, v108, v109
    v_mfma_f32_16x16x32_bf16 v[32:35], v[180:183], v[112:115], v[32:35]
    ds_read_b64_tr_b16 v[162:163], v242 offset:45056
    v_add_f32 v216, v216, v110
    v_add_f32 v216, v216, v111
    v_cvt_pk_bf16_f32 v107, v110, v111
    v_mfma_f32_16x16x32_bf16 v[4:7], v[184:187], v[96:99], v[4:7]
    ds_read_b64_tr_b16 v[164:165], v243 offset:40960
    v_exp_f32 v120, v120
    v_mfma_f32_16x16x32_bf16 v[36:39], v[184:187], v[112:115], v[36:39]
    ds_read_b64_tr_b16 v[166:167], v243 offset:45056
    v_exp_f32 v121, v121
    v_mfma_f32_16x16x32_bf16 v[8:11], v[188:191], v[96:99], v[8:11]
    ds_read_b64_tr_b16 v[168:169], v244 offset:40960
    v_exp_f32 v122, v122
    v_mfma_f32_16x16x32_bf16 v[40:43], v[188:191], v[112:115], v[40:43]
    ds_read_b64_tr_b16 v[170:171], v244 offset:45056
    v_add_f32 v220, v220, v120
    v_exp_f32 v123, v123
    v_mfma_f32_16x16x32_bf16 v[12:15], v[192:195], v[96:99], v[12:15]
    ds_read_b32 v252, v251 offset:0
    ds_read_b64_tr_b16 v[172:173], v245 offset:40960
    v_add_f32 v220, v220, v121
    v_mfma_f32_16x16x32_bf16 v[44:47], v[192:195], v[112:115], v[44:47]
    s_waitcnt lgkmcnt(8)
    ds_read_b64_tr_b16 v[174:175], v245 offset:45056
    v_cvt_pk_bf16_f32 v120, v120, v121
    v_exp_f32 v124, v124
    v_mfma_f32_16x16x32_bf16 v[16:19], v[196:199], v[96:99], v[16:19]
    ds_read_b64_tr_b16 v[176:177], v246 offset:40960
    v_add_f32 v220, v220, v122
    v_mfma_f32_16x16x32_bf16 v[48:51], v[196:199], v[112:115], v[48:51]
    ds_read_b64_tr_b16 v[178:179], v246 offset:45056
    v_exp_f32 v125, v125
    v_add_f32 v220, v220, v123
    v_mfma_f32_16x16x32_bf16 v[20:23], v[200:203], v[96:99], v[20:23]
    ds_read_b64_tr_b16 v[180:181], v247 offset:40960
    v_cvt_pk_bf16_f32 v121, v122, v123
    v_mfma_f32_16x16x32_bf16 v[52:55], v[200:203], v[112:115], v[52:55]
    ds_read_b64_tr_b16 v[182:183], v247 offset:45056
    v_exp_f32 v126, v126
    v_add_f32 v220, v220, v124
    v_mfma_f32_16x16x32_bf16 v[24:27], v[204:207], v[96:99], v[24:27]
    ds_read_b64_tr_b16 v[184:185], v248 offset:40960
    v_exp_f32 v127, v127
    v_mfma_f32_16x16x32_bf16 v[56:59], v[204:207], v[112:115], v[56:59]
    ds_read_b64_tr_b16 v[186:187], v248 offset:45056
    v_add_f32 v220, v220, v125
    v_cvt_pk_bf16_f32 v122, v124, v125
    v_add_f32 v220, v220, v126
    v_mfma_f32_16x16x32_bf16 v[28:31], v[208:211], v[96:99], v[28:31]
    ds_read_b64_tr_b16 v[188:189], v249 offset:40960
    v_add_f32 v220, v220, v127
    v_cvt_pk_bf16_f32 v123, v126, v127
    v_mfma_f32_16x16x32_bf16 v[60:63], v[208:211], v[112:115], v[60:63]
    s_waitcnt lgkmcnt(7)
    ds_read_b64_tr_b16 v[190:191], v249 offset:45056
    v_mov_b32 v237, 39
    v_cmp_lt_u32 s[56:57], v252, 40
    v_mfma_f32_16x16x32_bf16 v[0:3], v[160:163], v[104:107], v[0:3]
    s_cmp_eq_u64 s[56:57], 0
    s_cbranch_scc0 G0_x12
G0_x12_ret:
    ds_write_b32 v250, v237 offset:16
    ds_read_b128 v[192:195], v238 offset:16384
    v_mfma_f32_16x16x32_bf16 v[32:35], v[160:163], v[120:123], v[32:35]
    ds_read_b128 v[196:199], v239 offset:16384
    v_max_f32 v234, v128, v129
    v_mfma_f32_16x16x32_bf16 v[4:7], v[164:167], v[104:107], v[4:7]
    v_max_f32 v235, v144, v145
    v_max3_f32 v234, v130, v131, v234
    v_mfma_f32_16x16x32_bf16 v[36:39], v[164:167], v[120:123], v[36:39]
    ds_read_b128 v[200:203], v240 offset:16384
    v_max3_f32 v235, v146, v147, v235
    v_mfma_f32_16x16x32_bf16 v[8:11], v[168:171], v[104:107], v[8:11]
    v_max3_f32 v234, v132, v133, v234
    v_max3_f32 v235, v148, v149, v235
    v_mfma_f32_16x16x32_bf16 v[40:43], v[168:171], v[120:123], v[40:43]
    ds_read_b128 v[204:207], v241 offset:16384
    v_max3_f32 v234, v134, v135, v234
    v_mfma_f32_16x16x32_bf16 v[12:15], v[172:175], v[104:107], v[12:15]
    v_max3_f32 v235, v150, v151, v235
    v_max3_f32 v234, v136, v137, v234
    v_mfma_f32_16x16x32_bf16 v[44:47], v[172:175], v[120:123], v[44:47]
    s_waitcnt lgkmcnt(5)
    ds_read_b128 v[208:211], v238 offset:20480
    v_mfma_f32_16x16x32_bf16 v[16:19], v[176:179], v[104:107], v[16:19]
    ds_read_b128 v[160:163], v239 offset:20480
    v_max3_f32 v235, v152, v153, v235
    v_mfma_f32_16x16x32_bf16 v[48:51], v[176:179], v[120:123], v[48:51]
    v_max3_f32 v234, v138, v139, v234
    v_max3_f32 v235, v154, v155, v235
    v_mfma_f32_16x16x32_bf16 v[20:23], v[180:183], v[104:107], v[20:23]
    ds_read_b128 v[164:167], v240 offset:20480
    v_max3_f32 v234, v140, v141, v234
    v_mfma_f32_16x16x32_bf16 v[52:55], v[180:183], v[120:123], v[52:55]
    v_max3_f32 v235, v156, v157, v235
    v_max3_f32 v234, v142, v143, v234
    v_mfma_f32_16x16x32_bf16 v[24:27], v[184:187], v[104:107], v[24:27]
    ds_read_b128 v[168:171], v241 offset:20480
    v_max3_f32 v235, v158, v159, v235
    v_mfma_f32_16x16x32_bf16 v[56:59], v[184:187], v[120:123], v[56:59]
    v_max_f32 v236, v234, v235
    v_cmp_lt_f32 vcc, s50, v236
    v_mfma_f32_16x16x32_bf16 v[28:31], v[188:191], v[104:107], v[28:31]
    v_mfma_f32_16x16x32_bf16 v[60:63], v[188:191], v[120:123], v[60:63]
    s_waitcnt lgkmcnt(4)
    s_cbranch_vccnz G0_g2
G0_g2_ret:
    v_mfma_f32_16x16x32_bf16 v[96:99], v[192:195], v[64:67], v[224:227]
    ds_read_b128 v[172:175], v238 offset:24576
    v_exp_f32 v128, v128
    v_mfma_f32_16x16x32_bf16 v[112:115], v[192:195], v[80:83], v[228:231]
    v_exp_f32 v129, v129
    v_exp_f32 v130, v130
    v_mfma_f32_16x16x32_bf16 v[96:99], v[196:199], v[68:71], v[96:99]
    ds_read_b128 v[176:179], v239 offset:24576
    v_add_f32 v216, v216, v128
    v_exp_f32 v131, v131
    v_mfma_f32_16x16x32_bf16 v[112:115], v[196:199], v[84:87], v[112:115]
    v_add_f32 v216, v216, v129
    v_cvt_pk_bf16_f32 v128, v128, v129
    v_exp_f32 v132, v132
    v_mfma_f32_16x16x32_bf16 v[96:99], v[200:203], v[72:75], v[96:99]
    ds_read_b128 v[180:183], v240 offset:24576
    v_add_f32 v216, v216, v130
    v_mfma_f32_16x16x32_bf16 v[112:115], v[200:203], v[88:91], v[112:115]
    v_exp_f32 v133, v133
    v_add_f32 v216, v216, v131
    v_cvt_pk_bf16_f32 v129, v130, v131
    v_mfma_f32_16x16x32_bf16 v[96:99], v[204:207], v[76:79], v[96:99]
    ds_read_b32 v252, v251 offset:0
    ds_read_b128 v[184:187], v241 offset:24576
    v_exp_f32 v134, v134
    v_mfma_f32_16x16x32_bf16 v[112:115], v[204:207], v[92:95], v[112:115]
    s_waitcnt lgkmcnt(5)
    v_add_f32 v216, v216, v132
    v_exp_f32 v135, v135
    v_mfma_f32_16x16x32_bf16 v[100:103], v[208:211], v[64:67], v[224:227]
    ds_read_b128 v[188:191], v238 offset:28672
    v_add_f32 v216, v216, v133
    v_cvt_pk_bf16_f32 v130, v132, v133
    v_add_f32 v216, v216, v134
    v_mfma_f32_16x16x32_bf16 v[116:119], v[208:211], v[80:83], v[228:231]
    v_add_f32 v216, v216, v135
    v_cvt_pk_bf16_f32 v131, v134, v135
    v_exp_f32 v144, v144
    v_mfma_f32_16x16x32_bf16 v[100:103], v[160:163], v[68:71], v[100:103]
    ds_read_b128 v[192:195], v239 offset:28672
    v_exp_f32 v145, v145
    v_mfma_f32_16x16x32_bf16 v[116:119], v[160:163], v[84:87], v[116:119]
    v_exp_f32 v146, v146
    v_add_f32 v220, v220, v144
    v_mfma_f32_16x16x32_bf16 v[100:103], v[164:167], v[72:75], v[100:103]
    ds_read_b128 v[196:199], v240 offset:28672
    v_exp_f32 v147, v147
    v_add_f32 v220, v220, v145
    v_mfma_f32_16x16x32_bf16 v[116:119], v[164:167], v[88:91], v[116:119]
    v_cvt_pk_bf16_f32 v144, v144, v145
    v_exp_f32 v148, v148
    v_mfma_f32_16x16x32_bf16 v[100:103], v[168:171], v[76:79], v[100:103]
    ds_read_b128 v[200:203], v241 offset:28672
    v_add_f32 v220, v220, v146
    v_exp_f32 v149, v149
    v_mfma_f32_16x16x32_bf16 v[116:119], v[168:171], v[92:95], v[116:119]
    s_waitcnt lgkmcnt(4)
    v_add_f32 v220, v220, v147
    v_mov_b32 v237, 40
    v_cmp_lt_u32 s[56:57], v252, 41
    v_mfma_f32_16x16x32_bf16 v[104:107], v[172:175], v[64:67], v[224:227]
    s_cmp_eq_u64 s[56:57], 0
    s_cbranch_scc0 G0_x14
G0_x14_ret:
    ds_write_b32 v250, v237 offset:16
    ds_read_b64_tr_b16 v[204:205], v242 offset:0
    v_cvt_pk_bf16_f32 v145, v146, v147
    v_mfma_f32_16x16x32_bf16 v[120:123], v[172:175], v[80:83], v[228:231]
    ds_read_b64_tr_b16 v[206:207], v242 offset:4096
    v_exp_f32 v150, v150
    v_mfma_f32_16x16x32_bf16 v[104:107], v[176:179], v[68:71], v[104:107]
    ds_read_b64_tr_b16 v[208:209], v243 offset:0
    v_add_f32 v220, v220, v148
    v_exp_f32 v151, v151
    v_mfma_f32_16x16x32_bf16 v[120:123], v[176:179], v[84:87], v[120:123]
    ds_read_b64_tr_b16 v[210:211], v243 offset:4096
    v_add_f32 v220, v220, v149
    v_cvt_pk_bf16_f32 v146, v148, v149
    v_mfma_f32_16x16x32_bf16 v[104:107], v[180:183], v[72:75], v[104:107]
    ds_read_b64_tr_b16 v[160:161], v244 offset:0
    v_add_f32 v220, v220, v150
    v_add_f32 v220, v220, v151
    v_mfma_f32_16x16x32_bf16 v[120:123], v[180:183], v[88:91], v[120:123]
    ds_read_b64_tr_b16 v[162:163], v244 offset:4096
    v_cvt_pk_bf16_f32 v147, v150, v151
    v_exp_f32 v136, v136
    v_mfma_f32_16x16x32_bf16 v[104:107], v[184:187], v[76:79], v[104:107]
    ds_read_b64_tr_b16 v[164:165], v245 offset:0
    v_exp_f32 v137, v137
    v_mfma_f32_16x16x32_bf16 v[120:123], v[184:187], v[92:95], v[120:123]
    s_waitcnt lgkmcnt(8)
    ds_read_b64_tr_b16 v[166:167], v245 offset:4096
    v_exp_f32 v138, v138
    v_mfma_f32_16x16x32_bf16 v[108:111], v[188:191], v[64:67], v[224:227]
    ds_read_b64_tr_b16 v[168:169], v246 offset:0
    v_add_f32 v216, v216, v136
    v_mfma_f32_16x16x32_bf16 v[124:127], v[188:191], v[80:83], v[228:231]
    ds_read_b64_tr_b16 v[170:171], v246 offset:4096
    v_exp_f32 v139, v139
    v_add_f32 v216, v216, v137
    v_mfma_f32_16x16x32_bf16 v[108:111], v[192:195], v[68:71], v[108:111]
    ds_read_b64_tr_b16 v[172:173], v247 offset:0
    v_cvt_pk_bf16_f32 v136, v136, v137
    v_exp_f32 v140, v140
    v_mfma_f32_16x16x32_bf16 v[124:127], v[192:195], v[84:87], v[124:127]
    ds_read_b64_tr_b16 v[174:175], v247 offset:4096
    v_add_f32 v216, v216, v138
    v_mfma_f32_16x16x32_bf16 v[108:111], v[196:199], v[72:75], v[108:111]
    ds_read_b64_tr_b16 v[176:177], v248 offset:0
    v_exp_f32 v141, v141
    v_mfma_f32_16x16x32_bf16 v[124:127], v[196:199], v[88:91], v[124:127]
    ds_read_b64_tr_b16 v[178:179], v248 offset:4096
    v_add_f32 v216, v216, v139
    v_cvt_pk_bf16_f32 v137, v138, v139
    v_mfma_f32_16x16x32_bf16 v[108:111], v[200:203], v[76:79], v[108:111]
    ds_read_b64_tr_b16 v[180:181], v249 offset:0
    v_exp_f32 v142, v142
    v_add_f32 v216, v216, v140
    v_mfma_f32_16x16x32_bf16 v[124:127], v[200:203], v[92:95], v[124:127]
    s_waitcnt lgkmcnt(7)
    ds_read_b64_tr_b16 v[182:183], v249 offset:4096
    v_exp_f32 v143, v143
    v_mfma_f32_16x16x32_bf16 v[0:3], v[204:207], v[128:131], v[0:3]
    ds_read_b64_tr_b16 v[184:185], v242 offset:8192
    v_add_f32 v216, v216, v141
    v_cvt_pk_bf16_f32 v138, v140, v141
    v_mfma_f32_16x16x32_bf16 v[32:35], v[204:207], v[144:147], v[32:35]
    ds_read_b64_tr_b16 v[186:187], v242 offset:12288
    v_add_f32 v216, v216, v142
    v_add_f32 v216, v216, v143
    v_cvt_pk_bf16_f32 v139, v142, v143
    v_mfma_f32_16x16x32_bf16 v[4:7], v[208:211], v[128:131], v[4:7]
    ds_read_b64_tr_b16 v[188:189], v243 offset:8192
    v_exp_f32 v152, v152
    v_mfma_f32_16x16x32_bf16 v[36:39], v[208:211], v[144:147], v[36:39]
    ds_read_b64_tr_b16 v[190:191], v243 offset:12288
    v_exp_f32 v153, v153
    v_mfma_f32_16x16x32_bf16 v[8:11], v[160:163], v[128:131], v[8:11]
    ds_read_b64_tr_b16 v[192:193], v244 offset:8192
    v_exp_f32 v154, v154
    v_mfma_f32_16x16x32_bf16 v[40:43], v[160:163], v[144:147], v[40:43]
    ds_read_b64_tr_b16 v[194:195], v244 offset:12288
    v_add_f32 v220, v220, v152
    v_exp_f32 v155, v155
    v_mfma_f32_16x16x32_bf16 v[12:15], v[164:167], v[128:131], v[12:15]
    ds_read_b32 v252, v251 offset:0
    ds_read_b64_tr_b16 v[196:197], v245 offset:8192
    v_add_f32 v220, v220, v153
    v_mfma_f32_16x16x32_bf16 v[44:47], v[164:167], v[144:147], v[44:47]
    s_waitcnt lgkmcnt(8)
    ds_read_b64_tr_b16 v[198:199], v245 offset:12288
    v_cvt_pk_bf16_f32 v152, v152, v153
    v_exp_f32 v156, v156
    v_mfma_f32_16x16x32_bf16 v[16:19], v[168:171], v[128:131], v[16:19]
    ds_read_b64_tr_b16 v[200:201], v246 offset:8192
    v_add_f32 v220, v220, v154
    v_mfma_f32_16x16x32_bf16 v[48:51], v[168:171], v[144:147], v[48:51]
    ds_read_b64_tr_b16 v[202:203], v246 offset:12288
    v_exp_f32 v157, v157
    v_add_f32 v220, v220, v155
    v_mfma_f32_16x16x32_bf16 v[20:23], v[172:175], v[128:131], v[20:23]
    ds_read_b64_tr_b16 v[204:205], v247 offset:8192
    v_cvt_pk_bf16_f32 v153, v154, v155
    v_mfma_f32_16x16x32_bf16 v[52:55], v[172:175], v[144:147], v[52:55]
    ds_read_b64_tr_b16 v[206:207], v247 offset:12288
    v_exp_f32 v158, v158
    v_add_f32 v220, v220, v156
    v_mfma_f32_16x16x32_bf16 v[24:27], v[176:179], v[128:131], v[24:27]
    ds_read_b64_tr_b16 v[208:209], v248 offset:8192
    v_exp_f32 v159, v159
    v_mfma_f32_16x16x32_bf16 v[56:59], v[176:179], v[144:147], v[56:59]
    ds_read_b64_tr_b16 v[210:211], v248 offset:12288
    v_add_f32 v220, v220, v157
    v_cvt_pk_bf16_f32 v154, v156, v157
    v_add_f32 v220, v220, v158
    v_mfma_f32_16x16x32_bf16 v[28:31], v[180:183], v[128:131], v[28:31]
    ds_read_b64_tr_b16 v[160:161], v249 offset:8192
    v_add_f32 v220, v220, v159
    v_cvt_pk_bf16_f32 v155, v158, v159
    v_mfma_f32_16x16x32_bf16 v[60:63], v[180:183], v[144:147], v[60:63]
    s_waitcnt lgkmcnt(7)
    ds_read_b64_tr_b16 v[162:163], v249 offset:12288
    v_mov_b32 v237, 41
    v_cmp_lt_u32 s[56:57], v252, 42
    v_mfma_f32_16x16x32_bf16 v[0:3], v[184:187], v[136:139], v[0:3]
    s_cmp_eq_u64 s[56:57], 0
    s_cbranch_scc0 G0_x16
G0_x16_ret:
    ds_write_b32 v250, v237 offset:16
    ds_read_b128 v[164:167], v238 offset:32768
    v_mfma_f32_16x16x32_bf16 v[32:35], v[184:187], v[152:155], v[32:35]
    ds_read_b128 v[168:171], v239 offset:32768
    v_max_f32 v234, v96, v97
    v_mfma_f32_16x16x32_bf16 v[4:7], v[188:191], v[136:139], v[4:7]
    v_max_f32 v235, v112, v113
    v_max3_f32 v234, v98, v99, v234
    v_mfma_f32_16x16x32_bf16 v[36:39], v[188:191], v[152:155], v[36:39]
    ds_read_b128 v[172:175], v240 offset:32768
    v_max3_f32 v235, v114, v115, v235
    v_mfma_f32_16x16x32_bf16 v[8:11], v[192:195], v[136:139], v[8:11]
    v_max3_f32 v234, v100, v101, v234
    v_max3_f32 v235, v116, v117, v235
    v_mfma_f32_16x16x32_bf16 v[40:43], v[192:195], v[152:155], v[40:43]
    ds_read_b128 v[176:179], v241 offset:32768
    v_max3_f32 v234, v102, v103, v234
    v_mfma_f32_16x16x32_bf16 v[12:15], v[196:199], v[136:139], v[12:15]
    v_max3_f32 v235, v118, v119, v235
    v_max3_f32 v234, v104, v105, v234
    v_mfma_f32_16x16x32_bf16 v[44:47], v[196:199], v[152:155], v[44:47]
    s_waitcnt lgkmcnt(5)
    ds_read_b128 v[180:183], v238 offset:36864
    v_mfma_f32_16x16x32_bf16 v[16:19], v[200:203], v[136:139], v[16:19]
    ds_read_b128 v[184:187], v239 offset:36864
    v_max3_f32 v235, v120, v121, v235
    v_mfma_f32_16x16x32_bf16 v[48:51], v[200:203], v[152:155], v[48:51]
    v_max3_f32 v234, v106, v107, v234
    v_max3_f32 v235, v122, v123, v235
    v_mfma_f32_16x16x32_bf16 v[20:23], v[204:207], v[136:139], v[20:23]
    ds_read_b128 v[188:191], v240 offset:36864
    v_max3_f32 v234, v108, v109, v234
    v_mfma_f32_16x16x32_bf16 v[52:55], v[204:207], v[152:155], v[52:55]
    v_max3_f32 v235, v124, v125, v235
    v_max3_f32 v234, v110, v111, v234
    v_mfma_f32_16x16x32_bf16 v[24:27], v[208:211], v[136:139], v[24:27]
    ds_read_b128 v[192:195], v241 offset:36864
    v_max3_f32 v235, v126, v127, v235
    v_mfma_f32_16x16x32_bf16 v[56:59], v[208:211], v[152:155], v[56:59]
    v_max_f32 v236, v234, v235
    v_cmp_lt_f32 vcc, s50, v236
    v_mfma_f32_16x16x32_bf16 v[28:31], v[160:163], v[136:139], v[28:31]
    v_mfma_f32_16x16x32_bf16 v[60:63], v[160:163], v[152:155], v[60:63]
    s_waitcnt lgkmcnt(4)
    s_cbranch_vccnz G0_g3
G0_g3_ret:
    v_mfma_f32_16x16x32_bf16 v[128:131], v[164:167], v[64:67], v[224:227]
    ds_read_b128 v[196:199], v238 offset:40960
    v_exp_f32 v96, v96
    v_mfma_f32_16x16x32_bf16 v[144:147], v[164:167], v[80:83], v[228:231]
    v_exp_f32 v97, v97
    v_exp_f32 v98, v98
    v_mfma_f32_16x16x32_bf16 v[128:131], v[168:171], v[68:71], v[128:131]
    ds_read_b128 v[200:203], v239 offset:40960
    v_add_f32 v216, v216, v96
    v_exp_f32 v99, v99
    v_mfma_f32_16x16x32_bf16 v[144:147], v[168:171], v[84:87], v[144:147]
    v_add_f32 v216, v216, v97
    v_cvt_pk_bf16_f32 v96, v96, v97
    v_exp_f32 v100, v100
    v_mfma_f32_16x16x32_bf16 v[128:131], v[172:175], v[72:75], v[128:131]
    ds_read_b128 v[204:207], v240 offset:40960
    v_add_f32 v216, v216, v98
    v_mfma_f32_16x16x32_bf16 v[144:147], v[172:175], v[88:91], v[144:147]
    v_exp_f32 v101, v101
    v_add_f32 v216, v216, v99
    v_cvt_pk_bf16_f32 v97, v98, v99
    v_mfma_f32_16x16x32_bf16 v[128:131], v[176:179], v[76:79], v[128:131]
    ds_read_b32 v252, v251 offset:0
    ds_read_b128 v[208:211], v241 offset:40960
    v_exp_f32 v102, v102
    v_mfma_f32_16x16x32_bf16 v[144:147], v[176:179], v[92:95], v[144:147]
    s_waitcnt lgkmcnt(5)
    v_add_f32 v216, v216, v100
    v_exp_f32 v103, v103
    v_mfma_f32_16x16x32_bf16 v[132:135], v[180:183], v[64:67], v[224:227]
    ds_read_b128 v[160:163], v238 offset:45056
    v_add_f32 v216, v216, v101
    v_cvt_pk_bf16_f32 v98, v100, v101
    v_add_f32 v216, v216, v102
    v_mfma_f32_16x16x32_bf16 v[148:151], v[180:183], v[80:83], v[228:231]
    v_add_f32 v216, v216, v103
    v_cvt_pk_bf16_f32 v99, v102, v103
    v_exp_f32 v112, v112
    v_mfma_f32_16x16x32_bf16 v[132:135], v[184:187], v[68:71], v[132:135]
    ds_read_b128 v[164:167], v239 offset:45056
    v_exp_f32 v113, v113
    v_mfma_f32_16x16x32_bf16 v[148:151], v[184:187], v[84:87], v[148:151]
    v_exp_f32 v114, v114
    v_add_f32 v220, v220, v112
    v_mfma_f32_16x16x32_bf16 v[132:135], v[188:191], v[72:75], v[132:135]
    ds_read_b128 v[168:171], v240 offset:45056
    v_exp_f32 v115, v115
    v_add_f32 v220, v220, v113
    v_mfma_f32_16x16x32_bf16 v[148:151], v[188:191], v[88:91], v[148:151]
    v_cvt_pk_bf16_f32 v112, v112, v113
    v_exp_f32 v116, v116
    v_mfma_f32_16x16x32_bf16 v[132:135], v[192:195], v[76:79], v[132:135]
    ds_read_b128 v[172:175], v241 offset:45056
    v_add_f32 v220, v220, v114
    v_exp_f32 v117, v117
    v_mfma_f32_16x16x32_bf16 v[148:151], v[192:195], v[92:95], v[148:151]
    s_waitcnt lgkmcnt(4)
    v_add_f32 v220, v220, v115
    v_mov_b32 v237, 42
    v_cmp_lt_u32 s[56:57], v252, 43
    v_mfma_f32_16x16x32_bf16 v[136:139], v[196:199], v[64:67], v[224:227]
    s_cmp_eq_u64 s[56:57], 0
    s_cbranch_scc0 G0_x18
G0_x18_ret:
    ds_write_b32 v250, v237 offset:16
    ds_read_b64_tr_b16 v[176:177], v242 offset:16384
    v_cvt_pk_bf16_f32 v113, v114, v115
    v_mfma_f32_16x16x32_bf16 v[152:155], v[196:199], v[80:83], v[228:231]
    ds_read_b64_tr_b16 v[178:179], v242 offset:20480
    v_exp_f32 v118, v118
    v_mfma_f32_16x16x32_bf16 v[136:139], v[200:203], v[68:71], v[136:139]
    ds_read_b64_tr_b16 v[180:181], v243 offset:16384
    v_add_f32 v220, v220, v116
    v_exp_f32 v119, v119
    v_mfma_f32_16x16x32_bf16 v[152:155], v[200:203], v[84:87], v[152:155]
    ds_read_b64_tr_b16 v[182:183], v243 offset:20480
    v_add_f32 v220, v220, v117
    v_cvt_pk_bf16_f32 v114, v116, v117
    v_mfma_f32_16x16x32_bf16 v[136:139], v[204:207], v[72:75], v[136:139]
    ds_read_b64_tr_b16 v[184:185], v244 offset:16384
    v_add_f32 v220, v220, v118
    v_add_f32 v220, v220, v119
    v_mfma_f32_16x16x32_bf16 v[152:155], v[204:207], v[88:91], v[152:155]
    ds_read_b64_tr_b16 v[186:187], v244 offset:20480
    v_cvt_pk_bf16_f32 v115, v118, v119
    v_exp_f32 v104, v104
    v_mfma_f32_16x16x32_bf16 v[136:139], v[208:211], v[76:79], v[136:139]
    ds_read_b64_tr_b16 v[188:189], v245 offset:16384
    v_exp_f32 v105, v105
    v_mfma_f32_16x16x32_bf16 v[152:155], v[208:211], v[92:95], v[152:155]
    s_waitcnt lgkmcnt(8)
    ds_read_b64_tr_b16 v[190:191], v245 offset:20480
    v_exp_f32 v106, v106
    v_mfma_f32_16x16x32_bf16 v[140:143], v[160:163], v[64:67], v[224:227]
    ds_read_b64_tr_b16 v[192:193], v246 offset:16384
    v_add_f32 v216, v216, v104
    v_mfma_f32_16x16x32_bf16 v[156:159], v[160:163], v[80:83], v[228:231]
    ds_read_b64_tr_b16 v[194:195], v246 offset:20480
    v_exp_f32 v107, v107
    v_add_f32 v216, v216, v105
    v_mfma_f32_16x16x32_bf16 v[140:143], v[164:167], v[68:71], v[140:143]
    ds_read_b64_tr_b16 v[196:197], v247 offset:16384
    v_cvt_pk_bf16_f32 v104, v104, v105
    v_exp_f32 v108, v108
    v_mfma_f32_16x16x32_bf16 v[156:159], v[164:167], v[84:87], v[156:159]
    ds_read_b64_tr_b16 v[198:199], v247 offset:20480
    v_add_f32 v216, v216, v106
    v_mfma_f32_16x16x32_bf16 v[140:143], v[168:171], v[72:75], v[140:143]
    ds_read_b64_tr_b16 v[200:201], v248 offset:16384
    v_exp_f32 v109, v109
    v_mfma_f32_16x16x32_bf16 v[156:159], v[168:171], v[88:91], v[156:159]
    ds_read_b64_tr_b16 v[202:203], v248 offset:20480
    v_add_f32 v216, v216, v107
    v_cvt_pk_bf16_f32 v105, v106, v107
    v_mfma_f32_16x16x32_bf16 v[140:143], v[172:175], v[76:79], v[140:143]
    ds_read_b64_tr_b16 v[204:205], v249 offset:16384
    v_exp_f32 v110, v110
    v_add_f32 v216, v216, v108
    v_mfma_f32_16x16x32_bf16 v[156:159], v[172:175], v[92:95], v[156:159]
    s_waitcnt lgkmcnt(7)
    ds_read_b64_tr_b16 v[206:207], v249 offset:20480
    v_exp_f32 v111, v111
    v_mfma_f32_16x16x32_bf16 v[0:3], v[176:179], v[96:99], v[0:3]
    ds_read_b64_tr_b16 v[208:209], v242 offset:24576
    v_add_f32 v216, v216, v109
    v_cvt_pk_bf16_f32 v106, v108, v109
    v_mfma_f32_16x16x32_bf16 v[32:35], v[176:179], v[112:115], v[32:35]
    ds_read_b64_tr_b16 v[210:211], v242 offset:28672
    v_add_f32 v216, v216, v110
    v_add_f32 v216, v216, v111
    v_cvt_pk_bf16_f32 v107, v110, v111
    v_mfma_f32_16x16x32_bf16 v[4:7], v[180:183], v[96:99], v[4:7]
    ds_read_b64_tr_b16 v[160:161], v243 offset:24576
    v_exp_f32 v120, v120
    v_mfma_f32_16x16x32_bf16 v[36:39], v[180:183], v[112:115], v[36:39]
    ds_read_b64_tr_b16 v[162:163], v243 offset:28672
    v_exp_f32 v121, v121
    v_mfma_f32_16x16x32_bf16 v[8:11], v[184:187], v[96:99], v[8:11]
    ds_read_b64_tr_b16 v[164:165], v244 offset:24576
    v_exp_f32 v122, v122
    v_mfma_f32_16x16x32_bf16 v[40:43], v[184:187], v[112:115], v[40:43]
    ds_read_b64_tr_b16 v[166:167], v244 offset:28672
    v_add_f32 v220, v220, v120
    v_exp_f32 v123, v123
    v_mfma_f32_16x16x32_bf16 v[12:15], v[188:191], v[96:99], v[12:15]
    ds_read_b32 v252, v251 offset:0
    ds_read_b64_tr_b16 v[168:169], v245 offset:24576
    v_add_f32 v220, v220, v121
    v_mfma_f32_16x16x32_bf16 v[44:47], v[188:191], v[112:115], v[44:47]
    s_waitcnt lgkmcnt(8)
    ds_read_b64_tr_b16 v[170:171], v245 offset:28672
    v_cvt_pk_bf16_f32 v120, v120, v121
    v_exp_f32 v124, v124
    v_mfma_f32_16x16x32_bf16 v[16:19], v[192:195], v[96:99], v[16:19]
    ds_read_b64_tr_b16 v[172:173], v246 offset:24576
    v_add_f32 v220, v220, v122
    v_mfma_f32_16x16x32_bf16 v[48:51], v[192:195], v[112:115], v[48:51]
    ds_read_b64_tr_b16 v[174:175], v246 offset:28672
    v_exp_f32 v125, v125
    v_add_f32 v220, v220, v123
    v_mfma_f32_16x16x32_bf16 v[20:23], v[196:199], v[96:99], v[20:23]
    ds_read_b64_tr_b16 v[176:177], v247 offset:24576
    v_cvt_pk_bf16_f32 v121, v122, v123
    v_mfma_f32_16x16x32_bf16 v[52:55], v[196:199], v[112:115], v[52:55]
    ds_read_b64_tr_b16 v[178:179], v247 offset:28672
    v_exp_f32 v126, v126
    v_add_f32 v220, v220, v124
    v_mfma_f32_16x16x32_bf16 v[24:27], v[200:203], v[96:99], v[24:27]
    ds_read_b64_tr_b16 v[180:181], v248 offset:24576
    v_exp_f32 v127, v127
    v_mfma_f32_16x16x32_bf16 v[56:59], v[200:203], v[112:115], v[56:59]
    ds_read_b64_tr_b16 v[182:183], v248 offset:28672
    v_add_f32 v220, v220, v125
    v_cvt_pk_bf16_f32 v122, v124, v125
    v_add_f32 v220, v220, v126
    v_mfma_f32_16x16x32_bf16 v[28:31], v[204:207], v[96:99], v[28:31]
    ds_read_b64_tr_b16 v[184:185], v249 offset:24576
    v_add_f32 v220, v220, v127
    v_cvt_pk_bf16_f32 v123, v126, v127
    v_mfma_f32_16x16x32_bf16 v[60:63], v[204:207], v[112:115], v[60:63]
    s_waitcnt lgkmcnt(7)
    ds_read_b64_tr_b16 v[186:187], v249 offset:28672
    v_mov_b32 v237, 43
    v_cmp_lt_u32 s[56:57], v252, 44
    v_mfma_f32_16x16x32_bf16 v[0:3], v[208:211], v[104:107], v[0:3]
    s_cmp_eq_u64 s[56:57], 0
    s_cbranch_scc0 G0_x20
G0_x20_ret:
    ds_write_b32 v250, v237 offset:16
    ds_read_b128 v[188:191], v238 offset:0
    v_mfma_f32_16x16x32_bf16 v[32:35], v[208:211], v[120:123], v[32:35]
    ds_read_b128 v[192:195], v239 offset:0
    v_max_f32 v234, v128, v129
    v_mfma_f32_16x16x32_bf16 v[4:7], v[160:163], v[104:107], v[4:7]
    v_max_f32 v235, v144, v145
    v_max3_f32 v234, v130, v131, v234
    v_mfma_f32_16x16x32_bf16 v[36:39], v[160:163], v[120:123], v[36:39]
    ds_read_b128 v[196:199], v240 offset:0
    v_max3_f32 v235, v146, v147, v235
    v_mfma_f32_16x16x32_bf16 v[8:11], v[164:167], v[104:107], v[8:11]
    v_max3_f32 v234, v132, v133, v234
    v_max3_f32 v235, v148, v149, v235
    v_mfma_f32_16x16x32_bf16 v[40:43], v[164:167], v[120:123], v[40:43]
    ds_read_b128 v[200:203], v241 offset:0
    v_max3_f32 v234, v134, v135, v234
    v_mfma_f32_16x16x32_bf16 v[12:15], v[168:171], v[104:107], v[12:15]
    v_max3_f32 v235, v150, v151, v235
    v_max3_f32 v234, v136, v137, v234
    v_mfma_f32_16x16x32_bf16 v[44:47], v[168:171], v[120:123], v[44:47]
    s_waitcnt lgkmcnt(5)
    ds_read_b128 v[204:207], v238 offset:4096
    v_mfma_f32_16x16x32_bf16 v[16:19], v[172:175], v[104:107], v[16:19]
    ds_read_b128 v[208:211], v239 offset:4096
    v_max3_f32 v235, v152, v153, v235
    v_mfma_f32_16x16x32_bf16 v[48:51], v[172:175], v[120:123], v[48:51]
    v_max3_f32 v234, v138, v139, v234
    v_max3_f32 v235, v154, v155, v235
    v_mfma_f32_16x16x32_bf16 v[20:23], v[176:179], v[104:107], v[20:23]
    ds_read_b128 v[160:163], v240 offset:4096
    v_max3_f32 v234, v140, v141, v234
    v_mfma_f32_16x16x32_bf16 v[52:55], v[176:179], v[120:123], v[52:55]
    v_max3_f32 v235, v156, v157, v235
    v_max3_f32 v234, v142, v143, v234
    v_mfma_f32_16x16x32_bf16 v[24:27], v[180:183], v[104:107], v[24:27]
    ds_read_b128 v[164:167], v241 offset:4096
    v_max3_f32 v235, v158, v159, v235
    v_mfma_f32_16x16x32_bf16 v[56:59], v[180:183], v[120:123], v[56:59]
    v_max_f32 v236, v234, v235
    v_cmp_lt_f32 vcc, s50, v236
    v_mfma_f32_16x16x32_bf16 v[28:31], v[184:187], v[104:107], v[28:31]
    v_mfma_f32_16x16x32_bf16 v[60:63], v[184:187], v[120:123], v[60:63]
    s_waitcnt lgkmcnt(4)
    s_cbranch_vccnz G0_g4
G0_g4_ret:
    v_mfma_f32_16x16x32_bf16 v[96:99], v[188:191], v[64:67], v[224:227]
    ds_read_b128 v[168:171], v238 offset:8192
    v_exp_f32 v128, v128
    v_mfma_f32_16x16x32_bf16 v[112:115], v[188:191], v[80:83], v[228:231]
    v_exp_f32 v129, v129
    v_exp_f32 v130, v130
    v_mfma_f32_16x16x32_bf16 v[96:99], v[192:195], v[68:71], v[96:99]
    ds_read_b128 v[172:175], v239 offset:8192
    v_add_f32 v216, v216, v128
    v_exp_f32 v131, v131
    v_mfma_f32_16x16x32_bf16 v[112:115], v[192:195], v[84:87], v[112:115]
    v_add_f32 v216, v216, v129
    v_cvt_pk_bf16_f32 v128, v128, v129
    v_exp_f32 v132, v132
    v_mfma_f32_16x16x32_bf16 v[96:99], v[196:199], v[72:75], v[96:99]
    ds_read_b128 v[176:179], v240 offset:8192
    v_add_f32 v216, v216, v130
    v_mfma_f32_16x16x32_bf16 v[112:115], v[196:199], v[88:91], v[112:115]
    v_exp_f32 v133, v133
    v_add_f32 v216, v216, v131
    v_cvt_pk_bf16_f32 v129, v130, v131
    v_mfma_f32_16x16x32_bf16 v[96:99], v[200:203], v[76:79], v[96:99]
    ds_read_b32 v252, v251 offset:0
    ds_read_b128 v[180:183], v241 offset:8192
    v_exp_f32 v134, v134
    v_mfma_f32_16x16x32_bf16 v[112:115], v[200:203], v[92:95], v[112:115]
    s_waitcnt lgkmcnt(5)
    v_add_f32 v216, v216, v132
    v_exp_f32 v135, v135
    v_mfma_f32_16x16x32_bf16 v[100:103], v[204:207], v[64:67], v[224:227]
    ds_read_b128 v[184:187], v238 offset:12288
    v_add_f32 v216, v216, v133
    v_cvt_pk_bf16_f32 v130, v132, v133
    v_add_f32 v216, v216, v134
    v_mfma_f32_16x16x32_bf16 v[116:119], v[204:207], v[80:83], v[228:231]
    v_add_f32 v216, v216, v135
    v_cvt_pk_bf16_f32 v131, v134, v135
    v_exp_f32 v144, v144
    v_mfma_f32_16x16x32_bf16 v[100:103], v[208:211], v[68:71], v[100:103]
    ds_read_b128 v[188:191], v239 offset:12288
    v_exp_f32 v145, v145
    v_mfma_f32_16x16x32_bf16 v[116:119], v[208:211], v[84:87], v[116:119]
    v_exp_f32 v146, v146
    v_add_f32 v220, v220, v144
    v_mfma_f32_16x16x32_bf16 v[100:103], v[160:163], v[72:75], v[100:103]
    ds_read_b128 v[192:195], v240 offset:12288
    v_exp_f32 v147, v147
    v_add_f32 v220, v220, v145
    v_mfma_f32_16x16x32_bf16 v[116:119], v[160:163], v[88:91], v[116:119]
    v_cvt_pk_bf16_f32 v144, v144, v145
    v_exp_f32 v148, v148
    v_mfma_f32_16x16x32_bf16 v[100:103], v[164:167], v[76:79], v[100:103]
    ds_read_b128 v[196:199], v241 offset:12288
    v_add_f32 v220, v220, v146
    v_exp_f32 v149, v149
    v_mfma_f32_16x16x32_bf16 v[116:119], v[164:167], v[92:95], v[116:119]
    s_waitcnt lgkmcnt(4)
    v_add_f32 v220, v220, v147
    v_mov_b32 v237, 44
    v_cmp_lt_u32 s[56:57], v252, 45
    v_mfma_f32_16x16x32_bf16 v[104:107], v[168:171], v[64:67], v[224:227]
    s_cmp_eq_u64 s[56:57], 0
    s_cbranch_scc0 G0_x22
G0_x22_ret:
    ds_write_b32 v250, v237 offset:16
    ds_read_b64_tr_b16 v[200:201], v242 offset:32768
    v_cvt_pk_bf16_f32 v145, v146, v147
    v_mfma_f32_16x16x32_bf16 v[120:123], v[168:171], v[80:83], v[228:231]
    ds_read_b64_tr_b16 v[202:203], v242 offset:36864
    v_exp_f32 v150, v150
    v_mfma_f32_16x16x32_bf16 v[104:107], v[172:175], v[68:71], v[104:107]
    ds_read_b64_tr_b16 v[204:205], v243 offset:32768
    v_add_f32 v220, v220, v148
    v_exp_f32 v151, v151
    v_mfma_f32_16x16x32_bf16 v[120:123], v[172:175], v[84:87], v[120:123]
    ds_read_b64_tr_b16 v[206:207], v243 offset:36864
    v_add_f32 v220, v220, v149
    v_cvt_pk_bf16_f32 v146, v148, v149
    v_mfma_f32_16x16x32_bf16 v[104:107], v[176:179], v[72:75], v[104:107]
    ds_read_b64_tr_b16 v[208:209], v244 offset:32768
    v_add_f32 v220, v220, v150
    v_add_f32 v220, v220, v151
    v_mfma_f32_16x16x32_bf16 v[120:123], v[176:179], v[88:91], v[120:123]
    ds_read_b64_tr_b16 v[210:211], v244 offset:36864
    v_cvt_pk_bf16_f32 v147, v150, v151
    v_exp_f32 v136, v136
    v_mfma_f32_16x16x32_bf16 v[104:107], v[180:183], v[76:79], v[104:107]
    ds_read_b64_tr_b16 v[160:161], v245 offset:32768
    v_exp_f32 v137, v137
    v_mfma_f32_16x16x32_bf16 v[120:123], v[180:183], v[92:95], v[120:123]
    s_waitcnt lgkmcnt(8)
    ds_read_b64_tr_b16 v[162:163], v245 offset:36864
    v_exp_f32 v138, v138
    v_mfma_f32_16x16x32_bf16 v[108:111], v[184:187], v[64:67], v[224:227]
    ds_read_b64_tr_b16 v[164:165], v246 offset:32768
    v_add_f32 v216, v216, v136
    v_mfma_f32_16x16x32_bf16 v[124:127], v[184:187], v[80:83], v[228:231]
    ds_read_b64_tr_b16 v[166:167], v246 offset:36864
    v_exp_f32 v139, v139
    v_add_f32 v216, v216, v137
    v_mfma_f32_16x16x32_bf16 v[108:111], v[188:191], v[68:71], v[108:111]
    ds_read_b64_tr_b16 v[168:169], v247 offset:32768
    v_cvt_pk_bf16_f32 v136, v136, v137
    v_exp_f32 v140, v140
    v_mfma_f32_16x16x32_bf16 v[124:127], v[188:191], v[84:87], v[124:127]
    ds_read_b64_tr_b16 v[170:171], v247 offset:36864
    v_add_f32 v216, v216, v138
    v_mfma_f32_16x16x32_bf16 v[108:111], v[192:195], v[72:75], v[108:111]
    ds_read_b64_tr_b16 v[172:173], v248 offset:32768
    v_exp_f32 v141, v141
    v_mfma_f32_16x16x32_bf16 v[124:127], v[192:195], v[88:91], v[124:127]
    ds_read_b64_tr_b16 v[174:175], v248 offset:36864
    v_add_f32 v216, v216, v139
    v_cvt_pk_bf16_f32 v137, v138, v139
    v_mfma_f32_16x16x32_bf16 v[108:111], v[196:199], v[76:79], v[108:111]
    ds_read_b64_tr_b16 v[176:177], v249 offset:32768
    v_exp_f32 v142, v142
    v_add_f32 v216, v216, v140
    v_mfma_f32_16x16x32_bf16 v[124:127], v[196:199], v[92:95], v[124:127]
    s_waitcnt lgkmcnt(7)
    ds_read_b64_tr_b16 v[178:179], v249 offset:36864
    v_exp_f32 v143, v143
    v_mfma_f32_16x16x32_bf16 v[0:3], v[200:203], v[128:131], v[0:3]
    ds_read_b64_tr_b16 v[180:181], v242 offset:40960
    v_add_f32 v216, v216, v141
    v_cvt_pk_bf16_f32 v138, v140, v141
    v_mfma_f32_16x16x32_bf16 v[32:35], v[200:203], v[144:147], v[32:35]
    ds_read_b64_tr_b16 v[182:183], v242 offset:45056
    v_add_f32 v216, v216, v142
    v_add_f32 v216, v216, v143
    v_cvt_pk_bf16_f32 v139, v142, v143
    v_mfma_f32_16x16x32_bf16 v[4:7], v[204:207], v[128:131], v[4:7]
    ds_read_b64_tr_b16 v[184:185], v243 offset:40960
    v_exp_f32 v152, v152
    v_mfma_f32_16x16x32_bf16 v[36:39], v[204:207], v[144:147], v[36:39]
    ds_read_b64_tr_b16 v[186:187], v243 offset:45056
    v_exp_f32 v153, v153
    v_mfma_f32_16x16x32_bf16 v[8:11], v[208:211], v[128:131], v[8:11]
    ds_read_b64_tr_b16 v[188:189], v244 offset:40960
    v_exp_f32 v154, v154
    v_mfma_f32_16x16x32_bf16 v[40:43], v[208:211], v[144:147], v[40:43]
    ds_read_b64_tr_b16 v[190:191], v244 offset:45056
    v_add_f32 v220, v220, v152
    v_exp_f32 v155, v155
    v_mfma_f32_16x16x32_bf16 v[12:15], v[160:163], v[128:131], v[12:15]
    ds_read_b32 v252, v251 offset:0
    ds_read_b64_tr_b16 v[192:193], v245 offset:40960
    v_add_f32 v220, v220, v153
    v_mfma_f32_16x16x32_bf16 v[44:47], v[160:163], v[144:147], v[44:47]
    s_waitcnt lgkmcnt(8)
    ds_read_b64_tr_b16 v[194:195], v245 offset:45056
    v_cvt_pk_bf16_f32 v152, v152, v153
    v_exp_f32 v156, v156
    v_mfma_f32_16x16x32_bf16 v[16:19], v[164:167], v[128:131], v[16:19]
    ds_read_b64_tr_b16 v[196:197], v246 offset:40960
    v_add_f32 v220, v220, v154
    v_mfma_f32_16x16x32_bf16 v[48:51], v[164:167], v[144:147], v[48:51]
    ds_read_b64_tr_b16 v[198:199], v246 offset:45056
    v_exp_f32 v157, v157
    v_add_f32 v220, v220, v155
    v_mfma_f32_16x16x32_bf16 v[20:23], v[168:171], v[128:131], v[20:23]
    ds_read_b64_tr_b16 v[200:201], v247 offset:40960
    v_cvt_pk_bf16_f32 v153, v154, v155
    v_mfma_f32_16x16x32_bf16 v[52:55], v[168:171], v[144:147], v[52:55]
    ds_read_b64_tr_b16 v[202:203], v247 offset:45056
    v_exp_f32 v158, v158
    v_add_f32 v220, v220, v156
    v_mfma_f32_16x16x32_bf16 v[24:27], v[172:175], v[128:131], v[24:27]
    ds_read_b64_tr_b16 v[204:205], v248 offset:40960
    v_exp_f32 v159, v159
    v_mfma_f32_16x16x32_bf16 v[56:59], v[172:175], v[144:147], v[56:59]
    ds_read_b64_tr_b16 v[206:207], v248 offset:45056
    v_add_f32 v220, v220, v157
    v_cvt_pk_bf16_f32 v154, v156, v157
    v_add_f32 v220, v220, v158
    v_mfma_f32_16x16x32_bf16 v[28:31], v[176:179], v[128:131], v[28:31]
    ds_read_b64_tr_b16 v[208:209], v249 offset:40960
    v_add_f32 v220, v220, v159
    v_cvt_pk_bf16_f32 v155, v158, v159
    v_mfma_f32_16x16x32_bf16 v[60:63], v[176:179], v[144:147], v[60:63]
    s_waitcnt lgkmcnt(7)
    ds_read_b64_tr_b16 v[210:211], v249 offset:45056
    v_mov_b32 v237, 45
    v_cmp_lt_u32 s[56:57], v252, 46
    v_mfma_f32_16x16x32_bf16 v[0:3], v[180:183], v[136:139], v[0:3]
    s_cmp_eq_u64 s[56:57], 0
    s_cbranch_scc0 G0_x24
G0_x24_ret:
    ds_write_b32 v250, v237 offset:16
    ds_read_b128 v[160:163], v238 offset:16384
    v_mfma_f32_16x16x32_bf16 v[32:35], v[180:183], v[152:155], v[32:35]
    ds_read_b128 v[164:167], v239 offset:16384
    v_max_f32 v234, v96, v97
    v_mfma_f32_16x16x32_bf16 v[4:7], v[184:187], v[136:139], v[4:7]
    v_max_f32 v235, v112, v113
    v_max3_f32 v234, v98, v99, v234
    v_mfma_f32_16x16x32_bf16 v[36:39], v[184:187], v[152:155], v[36:39]
    ds_read_b128 v[168:171], v240 offset:16384
    v_max3_f32 v235, v114, v115, v235
    v_mfma_f32_16x16x32_bf16 v[8:11], v[188:191], v[136:139], v[8:11]
    v_max3_f32 v234, v100, v101, v234
    v_max3_f32 v235, v116, v117, v235
    v_mfma_f32_16x16x32_bf16 v[40:43], v[188:191], v[152:155], v[40:43]
    ds_read_b128 v[172:175], v241 offset:16384
    v_max3_f32 v234, v102, v103, v234
    v_mfma_f32_16x16x32_bf16 v[12:15], v[192:195], v[136:139], v[12:15]
    v_max3_f32 v235, v118, v119, v235
    v_max3_f32 v234, v104, v105, v234
    v_mfma_f32_16x16x32_bf16 v[44:47], v[192:195], v[152:155], v[44:47]
    s_waitcnt lgkmcnt(5)
    ds_read_b128 v[176:179], v238 offset:20480
    v_mfma_f32_16x16x32_bf16 v[16:19], v[196:199], v[136:139], v[16:19]
    ds_read_b128 v[180:183], v239 offset:20480
    v_max3_f32 v235, v120, v121, v235
    v_mfma_f32_16x16x32_bf16 v[48:51], v[196:199], v[152:155], v[48:51]
    v_max3_f32 v234, v106, v107, v234
    v_max3_f32 v235, v122, v123, v235
    v_mfma_f32_16x16x32_bf16 v[20:23], v[200:203], v[136:139], v[20:23]
    ds_read_b128 v[184:187], v240 offset:20480
    v_max3_f32 v234, v108, v109, v234
    v_mfma_f32_16x16x32_bf16 v[52:55], v[200:203], v[152:155], v[52:55]
    v_max3_f32 v235, v124, v125, v235
    v_max3_f32 v234, v110, v111, v234
    v_mfma_f32_16x16x32_bf16 v[24:27], v[204:207], v[136:139], v[24:27]
    ds_read_b128 v[188:191], v241 offset:20480
    v_max3_f32 v235, v126, v127, v235
    v_mfma_f32_16x16x32_bf16 v[56:59], v[204:207], v[152:155], v[56:59]
    v_max_f32 v236, v234, v235
    v_cmp_lt_f32 vcc, s50, v236
    v_mfma_f32_16x16x32_bf16 v[28:31], v[208:211], v[136:139], v[28:31]
    v_mfma_f32_16x16x32_bf16 v[60:63], v[208:211], v[152:155], v[60:63]
    s_waitcnt lgkmcnt(4)
    s_cbranch_vccnz G0_g5
G0_g5_ret:
    v_mfma_f32_16x16x32_bf16 v[128:131], v[160:163], v[64:67], v[224:227]
    ds_read_b128 v[192:195], v238 offset:24576
    v_exp_f32 v96, v96
    v_mfma_f32_16x16x32_bf16 v[144:147], v[160:163], v[80:83], v[228:231]
    v_exp_f32 v97, v97
    v_exp_f32 v98, v98
    v_mfma_f32_16x16x32_bf16 v[128:131], v[164:167], v[68:71], v[128:131]
    ds_read_b128 v[196:199], v239 offset:24576
    v_add_f32 v216, v216, v96
    v_exp_f32 v99, v99
    v_mfma_f32_16x16x32_bf16 v[144:147], v[164:167], v[84:87], v[144:147]
    v_add_f32 v216, v216, v97
    v_cvt_pk_bf16_f32 v96, v96, v97
    v_exp_f32 v100, v100
    v_mfma_f32_16x16x32_bf16 v[128:131], v[168:171], v[72:75], v[128:131]
    ds_read_b128 v[200:203], v240 offset:24576
    v_add_f32 v216, v216, v98
    v_mfma_f32_16x16x32_bf16 v[144:147], v[168:171], v[88:91], v[144:147]
    v_exp_f32 v101, v101
    v_add_f32 v216, v216, v99
    v_cvt_pk_bf16_f32 v97, v98, v99
    v_mfma_f32_16x16x32_bf16 v[128:131], v[172:175], v[76:79], v[128:131]
    ds_read_b32 v252, v251 offset:0
    ds_read_b128 v[204:207], v241 offset:24576
    v_exp_f32 v102, v102
    v_mfma_f32_16x16x32_bf16 v[144:147], v[172:175], v[92:95], v[144:147]
    s_waitcnt lgkmcnt(5)
    v_add_f32 v216, v216, v100
    v_exp_f32 v103, v103
    v_mfma_f32_16x16x32_bf16 v[132:135], v[176:179], v[64:67], v[224:227]
    ds_read_b128 v[208:211], v238 offset:28672
    v_add_f32 v216, v216, v101
    v_cvt_pk_bf16_f32 v98, v100, v101
    v_add_f32 v216, v216, v102
    v_mfma_f32_16x16x32_bf16 v[148:151], v[176:179], v[80:83], v[228:231]
    v_add_f32 v216, v216, v103
    v_cvt_pk_bf16_f32 v99, v102, v103
    v_exp_f32 v112, v112
    v_mfma_f32_16x16x32_bf16 v[132:135], v[180:183], v[68:71], v[132:135]
    ds_read_b128 v[160:163], v239 offset:28672
    v_exp_f32 v113, v113
    v_mfma_f32_16x16x32_bf16 v[148:151], v[180:183], v[84:87], v[148:151]
    v_exp_f32 v114, v114
    v_add_f32 v220, v220, v112
    v_mfma_f32_16x16x32_bf16 v[132:135], v[184:187], v[72:75], v[132:135]
    ds_read_b128 v[164:167], v240 offset:28672
    v_exp_f32 v115, v115
    v_add_f32 v220, v220, v113
    v_mfma_f32_16x16x32_bf16 v[148:151], v[184:187], v[88:91], v[148:151]
    v_cvt_pk_bf16_f32 v112, v112, v113
    v_exp_f32 v116, v116
    v_mfma_f32_16x16x32_bf16 v[132:135], v[188:191], v[76:79], v[132:135]
    ds_read_b128 v[168:171], v241 offset:28672
    v_add_f32 v220, v220, v114
    v_exp_f32 v117, v117
    v_mfma_f32_16x16x32_bf16 v[148:151], v[188:191], v[92:95], v[148:151]
    s_waitcnt lgkmcnt(4)
    v_add_f32 v220, v220, v115
    v_mov_b32 v237, 46
    v_cmp_lt_u32 s[56:57], v252, 47
    v_mfma_f32_16x16x32_bf16 v[136:139], v[192:195], v[64:67], v[224:227]
    s_cmp_eq_u64 s[56:57], 0
    s_cbranch_scc0 G0_x26
G0_x26_ret:
    ds_write_b32 v250, v237 offset:16
    ds_read_b64_tr_b16 v[172:173], v242 offset:0
    v_cvt_pk_bf16_f32 v113, v114, v115
    v_mfma_f32_16x16x32_bf16 v[152:155], v[192:195], v[80:83], v[228:231]
    ds_read_b64_tr_b16 v[174:175], v242 offset:4096
    v_exp_f32 v118, v118
    v_mfma_f32_16x16x32_bf16 v[136:139], v[196:199], v[68:71], v[136:139]
    ds_read_b64_tr_b16 v[176:177], v243 offset:0
    v_add_f32 v220, v220, v116
    v_exp_f32 v119, v119
    v_mfma_f32_16x16x32_bf16 v[152:155], v[196:199], v[84:87], v[152:155]
    ds_read_b64_tr_b16 v[178:179], v243 offset:4096
    v_add_f32 v220, v220, v117
    v_cvt_pk_bf16_f32 v114, v116, v117
    v_mfma_f32_16x16x32_bf16 v[136:139], v[200:203], v[72:75], v[136:139]
    ds_read_b64_tr_b16 v[180:181], v244 offset:0
    v_add_f32 v220, v220, v118
    v_add_f32 v220, v220, v119
    v_mfma_f32_16x16x32_bf16 v[152:155], v[200:203], v[88:91], v[152:155]
    ds_read_b64_tr_b16 v[182:183], v244 offset:4096
    v_cvt_pk_bf16_f32 v115, v118, v119
    v_exp_f32 v104, v104
    v_mfma_f32_16x16x32_bf16 v[136:139], v[204:207], v[76:79], v[136:139]
    ds_read_b64_tr_b16 v[184:185], v245 offset:0
    v_exp_f32 v105, v105
    v_mfma_f32_16x16x32_bf16 v[152:155], v[204:207], v[92:95], v[152:155]
    s_waitcnt lgkmcnt(8)
    ds_read_b64_tr_b16 v[186:187], v245 offset:4096
    v_exp_f32 v106, v106
    v_mfma_f32_16x16x32_bf16 v[140:143], v[208:211], v[64:67], v[224:227]
    ds_read_b64_tr_b16 v[188:189], v246 offset:0
    v_add_f32 v216, v216, v104
    v_mfma_f32_16x16x32_bf16 v[156:159], v[208:211], v[80:83], v[228:231]
    ds_read_b64_tr_b16 v[190:191], v246 offset:4096
    v_exp_f32 v107, v107
    v_add_f32 v216, v216, v105
    v_mfma_f32_16x16x32_bf16 v[140:143], v[160:163], v[68:71], v[140:143]
    ds_read_b64_tr_b16 v[192:193], v247 offset:0
    v_cvt_pk_bf16_f32 v104, v104, v105
    v_exp_f32 v108, v108
    v_mfma_f32_16x16x32_bf16 v[156:159], v[160:163], v[84:87], v[156:159]
    ds_read_b64_tr_b16 v[194:195], v247 offset:4096
    v_add_f32 v216, v216, v106
    v_mfma_f32_16x16x32_bf16 v[140:143], v[164:167], v[72:75], v[140:143]
    ds_read_b64_tr_b16 v[196:197], v248 offset:0
    v_exp_f32 v109, v109
    v_mfma_f32_16x16x32_bf16 v[156:159], v[164:167], v[88:91], v[156:159]
    ds_read_b64_tr_b16 v[198:199], v248 offset:4096
    v_add_f32 v216, v216, v107
    v_cvt_pk_bf16_f32 v105, v106, v107
    v_mfma_f32_16x16x32_bf16 v[140:143], v[168:171], v[76:79], v[140:143]
    ds_read_b64_tr_b16 v[200:201], v249 offset:0
    v_exp_f32 v110, v110
    v_add_f32 v216, v216, v108
    v_mfma_f32_16x16x32_bf16 v[156:159], v[168:171], v[92:95], v[156:159]
    s_waitcnt lgkmcnt(7)
    ds_read_b64_tr_b16 v[202:203], v249 offset:4096
    v_exp_f32 v111, v111
    v_mfma_f32_16x16x32_bf16 v[0:3], v[172:175], v[96:99], v[0:3]
    ds_read_b64_tr_b16 v[204:205], v242 offset:8192
    v_add_f32 v216, v216, v109
    v_cvt_pk_bf16_f32 v106, v108, v109
    v_mfma_f32_16x16x32_bf16 v[32:35], v[172:175], v[112:115], v[32:35]
    ds_read_b64_tr_b16 v[206:207], v242 offset:12288
    v_add_f32 v216, v216, v110
    v_add_f32 v216, v216, v111
    v_cvt_pk_bf16_f32 v107, v110, v111
    v_mfma_f32_16x16x32_bf16 v[4:7], v[176:179], v[96:99], v[4:7]
    ds_read_b64_tr_b16 v[208:209], v243 offset:8192
    v_exp_f32 v120, v120
    v_mfma_f32_16x16x32_bf16 v[36:39], v[176:179], v[112:115], v[36:39]
    ds_read_b64_tr_b16 v[210:211], v243 offset:12288
    v_exp_f32 v121, v121
    v_mfma_f32_16x16x32_bf16 v[8:11], v[180:183], v[96:99], v[8:11]
    ds_read_b64_tr_b16 v[160:161], v244 offset:8192
    v_exp_f32 v122, v122
    v_mfma_f32_16x16x32_bf16 v[40:43], v[180:183], v[112:115], v[40:43]
    ds_read_b64_tr_b16 v[162:163], v244 offset:12288
    v_add_f32 v220, v220, v120
    v_exp_f32 v123, v123
    v_mfma_f32_16x16x32_bf16 v[12:15], v[184:187], v[96:99], v[12:15]
    ds_read_b32 v252, v251 offset:0
    ds_read_b64_tr_b16 v[164:165], v245 offset:8192
    v_add_f32 v220, v220, v121
    v_mfma_f32_16x16x32_bf16 v[44:47], v[184:187], v[112:115], v[44:47]
    s_waitcnt lgkmcnt(8)
    ds_read_b64_tr_b16 v[166:167], v245 offset:12288
    v_cvt_pk_bf16_f32 v120, v120, v121
    v_exp_f32 v124, v124
    v_mfma_f32_16x16x32_bf16 v[16:19], v[188:191], v[96:99], v[16:19]
    ds_read_b64_tr_b16 v[168:169], v246 offset:8192
    v_add_f32 v220, v220, v122
    v_mfma_f32_16x16x32_bf16 v[48:51], v[188:191], v[112:115], v[48:51]
    ds_read_b64_tr_b16 v[170:171], v246 offset:12288
    v_exp_f32 v125, v125
    v_add_f32 v220, v220, v123
    v_mfma_f32_16x16x32_bf16 v[20:23], v[192:195], v[96:99], v[20:23]
    ds_read_b64_tr_b16 v[172:173], v247 offset:8192
    v_cvt_pk_bf16_f32 v121, v122, v123
    v_mfma_f32_16x16x32_bf16 v[52:55], v[192:195], v[112:115], v[52:55]
    ds_read_b64_tr_b16 v[174:175], v247 offset:12288
    v_exp_f32 v126, v126
    v_add_f32 v220, v220, v124
    v_mfma_f32_16x16x32_bf16 v[24:27], v[196:199], v[96:99], v[24:27]
    ds_read_b64_tr_b16 v[176:177], v248 offset:8192
    v_exp_f32 v127, v127
    v_mfma_f32_16x16x32_bf16 v[56:59], v[196:199], v[112:115], v[56:59]
    ds_read_b64_tr_b16 v[178:179], v248 offset:12288
    v_add_f32 v220, v220, v125
    v_cvt_pk_bf16_f32 v122, v124, v125
    v_add_f32 v220, v220, v126
    v_mfma_f32_16x16x32_bf16 v[28:31], v[200:203], v[96:99], v[28:31]
    ds_read_b64_tr_b16 v[180:181], v249 offset:8192
    v_add_f32 v220, v220, v127
    v_cvt_pk_bf16_f32 v123, v126, v127
    v_mfma_f32_16x16x32_bf16 v[60:63], v[200:203], v[112:115], v[60:63]
    s_waitcnt lgkmcnt(7)
    ds_read_b64_tr_b16 v[182:183], v249 offset:12288
    v_mov_b32 v237, 47
    v_cmp_lt_u32 s[56:57], v252, 48
    v_mfma_f32_16x16x32_bf16 v[0:3], v[204:207], v[104:107], v[0:3]
    s_cmp_eq_u64 s[56:57], 0
    s_cbranch_scc0 G0_x28
G0_x28_ret:
    ds_write_b32 v250, v237 offset:16
    ds_read_b128 v[184:187], v238 offset:32768
    ds_read_b128 v[64:67], v253 offset:36864
    v_mfma_f32_16x16x32_bf16 v[32:35], v[204:207], v[120:123], v[32:35]
    ds_read_b128 v[188:191], v239 offset:32768
    v_max_f32 v234, v128, v129
    v_mfma_f32_16x16x32_bf16 v[4:7], v[208:211], v[104:107], v[4:7]
    ds_read_b128 v[80:83], v253 offset:40960
    v_max_f32 v235, v144, v145
    v_max3_f32 v234, v130, v131, v234
    v_mfma_f32_16x16x32_bf16 v[36:39], v[208:211], v[120:123], v[36:39]
    ds_read_b128 v[192:195], v240 offset:32768
    v_max3_f32 v235, v146, v147, v235
    v_mfma_f32_16x16x32_bf16 v[8:11], v[160:163], v[104:107], v[8:11]
    ds_read_b128 v[68:71], v253 offset:37888
    v_max3_f32 v234, v132, v133, v234
    v_max3_f32 v235, v148, v149, v235
    v_mfma_f32_16x16x32_bf16 v[40:43], v[160:163], v[120:123], v[40:43]
    ds_read_b128 v[196:199], v241 offset:32768
    v_max3_f32 v234, v134, v135, v234
    v_mfma_f32_16x16x32_bf16 v[12:15], v[164:167], v[104:107], v[12:15]
    ds_read_b128 v[84:87], v253 offset:41984
    v_max3_f32 v235, v150, v151, v235
    v_max3_f32 v234, v136, v137, v234
    v_mfma_f32_16x16x32_bf16 v[44:47], v[164:167], v[120:123], v[44:47]
    s_waitcnt lgkmcnt(9)
    ds_read_b128 v[200:203], v238 offset:36864
    ds_read_b128 v[72:75], v253 offset:38912
    v_mfma_f32_16x16x32_bf16 v[16:19], v[168:171], v[104:107], v[16:19]
    ds_read_b128 v[204:207], v239 offset:36864
    v_max3_f32 v235, v152, v153, v235
    v_max3_f32 v234, v138, v139, v234
    v_mfma_f32_16x16x32_bf16 v[48:51], v[168:171], v[120:123], v[48:51]
    ds_read_b128 v[88:91], v253 offset:43008
    v_max3_f32 v235, v154, v155, v235
    v_mfma_f32_16x16x32_bf16 v[20:23], v[172:175], v[104:107], v[20:23]
    ds_read_b128 v[208:211], v240 offset:36864
    v_max3_f32 v234, v140, v141, v234
    v_max3_f32 v235, v156, v157, v235
    v_mfma_f32_16x16x32_bf16 v[52:55], v[172:175], v[120:123], v[52:55]
    ds_read_b128 v[76:79], v253 offset:39936
    v_max3_f32 v234, v142, v143, v234
    v_mfma_f32_16x16x32_bf16 v[24:27], v[176:179], v[104:107], v[24:27]
    ds_read_b128 v[160:163], v241 offset:36864
    v_max3_f32 v235, v158, v159, v235
    v_max_f32 v236, v234, v235
    v_mfma_f32_16x16x32_bf16 v[56:59], v[176:179], v[120:123], v[56:59]
    ds_read_b128 v[92:95], v253 offset:44032
    v_cmp_lt_f32 vcc, s50, v236
    v_mfma_f32_16x16x32_bf16 v[28:31], v[180:183], v[104:107], v[28:31]
    v_mfma_f32_16x16x32_bf16 v[60:63], v[180:183], v[120:123], v[60:63]
    s_waitcnt lgkmcnt(9)
    s_cbranch_vccnz G0_g6
G0_g6_ret:
    v_mfma_f32_16x16x32_bf16 v[96:99], v[184:187], v[64:67], 0
    ds_read_b128 v[164:167], v238 offset:40960
    v_exp_f32 v128, v128
    v_mfma_f32_16x16x32_bf16 v[112:115], v[184:187], v[80:83], 0
    v_exp_f32 v129, v129
    v_exp_f32 v130, v130
    v_mfma_f32_16x16x32_bf16 v[96:99], v[188:191], v[68:71], v[96:99]
    ds_read_b128 v[168:171], v239 offset:40960
    v_add_f32 v216, v216, v128
    v_exp_f32 v131, v131
    s_waitcnt lgkmcnt(10)
    v_mfma_f32_16x16x32_bf16 v[112:115], v[188:191], v[84:87], v[112:115]
    v_add_f32 v216, v216, v129
    v_cvt_pk_bf16_f32 v128, v128, v129
    v_exp_f32 v132, v132
    s_waitcnt lgkmcnt(8)
    v_mfma_f32_16x16x32_bf16 v[96:99], v[192:195], v[72:75], v[96:99]
    ds_read_b128 v[172:175], v240 offset:40960
    v_add_f32 v216, v216, v130
    s_waitcnt lgkmcnt(7)
    v_mfma_f32_16x16x32_bf16 v[112:115], v[192:195], v[88:91], v[112:115]
    v_exp_f32 v133, v133
    v_add_f32 v216, v216, v131
    v_cvt_pk_bf16_f32 v129, v130, v131
    s_waitcnt lgkmcnt(5)
    v_mfma_f32_16x16x32_bf16 v[96:99], v[196:199], v[76:79], v[96:99]
    ds_read_b32 v252, v251 offset:0
    ds_read_b128 v[176:179], v241 offset:40960
    v_exp_f32 v134, v134
    s_waitcnt lgkmcnt(5)
    v_mfma_f32_16x16x32_bf16 v[112:115], v[196:199], v[92:95], v[112:115]
    v_add_f32 v216, v216, v132
    v_exp_f32 v135, v135
    v_mfma_f32_16x16x32_bf16 v[100:103], v[200:203], v[64:67], 0
    ds_read_b128 v[180:183], v238 offset:45056
    v_add_f32 v216, v216, v133
    v_cvt_pk_bf16_f32 v130, v132, v133
    v_add_f32 v216, v216, v134
    v_mfma_f32_16x16x32_bf16 v[116:119], v[200:203], v[80:83], 0
    v_add_f32 v216, v216, v135
    v_cvt_pk_bf16_f32 v131, v134, v135
    v_exp_f32 v144, v144
    v_mfma_f32_16x16x32_bf16 v[100:103], v[204:207], v[68:71], v[100:103]
    ds_read_b128 v[184:187], v239 offset:45056
    v_exp_f32 v145, v145
    v_mfma_f32_16x16x32_bf16 v[116:119], v[204:207], v[84:87], v[116:119]
    v_exp_f32 v146, v146
    v_add_f32 v220, v220, v144
    v_mfma_f32_16x16x32_bf16 v[100:103], v[208:211], v[72:75], v[100:103]
    ds_read_b128 v[188:191], v240 offset:45056
    v_exp_f32 v147, v147
    v_add_f32 v220, v220, v145
    v_mfma_f32_16x16x32_bf16 v[116:119], v[208:211], v[88:91], v[116:119]
    v_cvt_pk_bf16_f32 v144, v144, v145
    v_exp_f32 v148, v148
    v_mfma_f32_16x16x32_bf16 v[100:103], v[160:163], v[76:79], v[100:103]
    ds_read_b128 v[192:195], v241 offset:45056
    v_add_f32 v220, v220, v146
    v_exp_f32 v149, v149
    v_mfma_f32_16x16x32_bf16 v[116:119], v[160:163], v[92:95], v[116:119]
    s_waitcnt lgkmcnt(4)
    v_add_f32 v220, v220, v147
    v_mov_b32 v237, 48
    v_cmp_lt_u32 s[56:57], v252, 49
    v_mfma_f32_16x16x32_bf16 v[104:107], v[164:167], v[64:67], 0
    s_cmp_eq_u64 s[56:57], 0
    s_cbranch_scc0 G0_x30
G0_x30_ret:
    ds_write_b32 v250, v237 offset:16
    ds_read_b64_tr_b16 v[196:197], v242 offset:16384
    v_cvt_pk_bf16_f32 v145, v146, v147
    v_mfma_f32_16x16x32_bf16 v[120:123], v[164:167], v[80:83], 0
    ds_read_b64_tr_b16 v[198:199], v242 offset:20480
    v_exp_f32 v150, v150
    v_mfma_f32_16x16x32_bf16 v[104:107], v[168:171], v[68:71], v[104:107]
    ds_read_b64_tr_b16 v[200:201], v243 offset:16384
    v_add_f32 v220, v220, v148
    v_exp_f32 v151, v151
    v_mfma_f32_16x16x32_bf16 v[120:123], v[168:171], v[84:87], v[120:123]
    ds_read_b64_tr_b16 v[202:203], v243 offset:20480
    v_add_f32 v220, v220, v149
    v_cvt_pk_bf16_f32 v146, v148, v149
    v_mfma_f32_16x16x32_bf16 v[104:107], v[172:175], v[72:75], v[104:107]
    ds_read_b64_tr_b16 v[204:205], v244 offset:16384
    v_add_f32 v220, v220, v150
    v_add_f32 v220, v220, v151
    v_mfma_f32_16x16x32_bf16 v[120:123], v[172:175], v[88:91], v[120:123]
    ds_read_b64_tr_b16 v[206:207], v244 offset:20480
    v_cvt_pk_bf16_f32 v147, v150, v151
    v_exp_f32 v136, v136
    v_mfma_f32_16x16x32_bf16 v[104:107], v[176:179], v[76:79], v[104:107]
    ds_read_b64_tr_b16 v[208:209], v245 offset:16384
    v_exp_f32 v137, v137
    v_mfma_f32_16x16x32_bf16 v[120:123], v[176:179], v[92:95], v[120:123]
    s_waitcnt lgkmcnt(8)
    ds_read_b64_tr_b16 v[210:211], v245 offset:20480
    v_exp_f32 v138, v138
    v_mfma_f32_16x16x32_bf16 v[108:111], v[180:183], v[64:67], 0
    ds_read_b64_tr_b16 v[160:161], v246 offset:16384
    v_add_f32 v216, v216, v136
    v_mfma_f32_16x16x32_bf16 v[124:127], v[180:183], v[80:83], 0
    ds_read_b64_tr_b16 v[162:163], v246 offset:20480
    v_exp_f32 v139, v139
    v_add_f32 v216, v216, v137
    v_mfma_f32_16x16x32_bf16 v[108:111], v[184:187], v[68:71], v[108:111]
    ds_read_b64_tr_b16 v[164:165], v247 offset:16384
    v_cvt_pk_bf16_f32 v136, v136, v137
    v_exp_f32 v140, v140
    v_mfma_f32_16x16x32_bf16 v[124:127], v[184:187], v[84:87], v[124:127]
    ds_read_b64_tr_b16 v[166:167], v247 offset:20480
    v_add_f32 v216, v216, v138
    v_mfma_f32_16x16x32_bf16 v[108:111], v[188:191], v[72:75], v[108:111]
    ds_read_b64_tr_b16 v[168:169], v248 offset:16384
    v_exp_f32 v141, v141
    v_mfma_f32_16x16x32_bf16 v[124:127], v[188:191], v[88:91], v[124:127]
    ds_read_b64_tr_b16 v[170:171], v248 offset:20480
    v_add_f32 v216, v216, v139
    v_cvt_pk_bf16_f32 v137, v138, v139
    v_mfma_f32_16x16x32_bf16 v[108:111], v[192:195], v[76:79], v[108:111]
    ds_read_b64_tr_b16 v[172:173], v249 offset:16384
    v_exp_f32 v142, v142
    v_add_f32 v216, v216, v140
    v_mfma_f32_16x16x32_bf16 v[124:127], v[192:195], v[92:95], v[124:127]
    s_waitcnt lgkmcnt(7)
    ds_read_b64_tr_b16 v[174:175], v249 offset:20480
    v_exp_f32 v143, v143
    v_mfma_f32_16x16x32_bf16 v[0:3], v[196:199], v[128:131], v[0:3]
    ds_read_b64_tr_b16 v[176:177], v242 offset:24576
    v_add_f32 v216, v216, v141
    v_cvt_pk_bf16_f32 v138, v140, v141
    v_add_f32 v216, v216, v142
    v_mfma_f32_16x16x32_bf16 v[32:35], v[196:199], v[144:147], v[32:35]
    ds_read_b64_tr_b16 v[178:179], v242 offset:28672
    v_add_f32 v216, v216, v143
    v_cvt_pk_bf16_f32 v139, v142, v143
    v_exp_f32 v152, v152
    v_mfma_f32_16x16x32_bf16 v[4:7], v[200:203], v[128:131], v[4:7]
    ds_read_b64_tr_b16 v[180:181], v243 offset:24576
    v_exp_f32 v153, v153
    v_mfma_f32_16x16x32_bf16 v[36:39], v[200:203], v[144:147], v[36:39]
    ds_read_b64_tr_b16 v[182:183], v243 offset:28672
    v_exp_f32 v154, v154
    v_add_f32 v220, v220, v152
    v_exp_f32 v155, v155
    v_mfma_f32_16x16x32_bf16 v[8:11], v[204:207], v[128:131], v[8:11]
    ds_read_b64_tr_b16 v[184:185], v244 offset:24576
    v_add_f32 v220, v220, v153
    v_cvt_pk_bf16_f32 v152, v152, v153
    v_mfma_f32_16x16x32_bf16 v[40:43], v[204:207], v[144:147], v[40:43]
    ds_read_b64_tr_b16 v[186:187], v244 offset:28672
    v_exp_f32 v156, v156
    v_add_f32 v220, v220, v154
    v_mfma_f32_16x16x32_bf16 v[12:15], v[208:211], v[128:131], v[12:15]
    ds_read_b32 v252, v251 offset:0
    ds_read_b64_tr_b16 v[188:189], v245 offset:24576
    v_exp_f32 v157, v157
    v_add_f32 v220, v220, v155
    v_mfma_f32_16x16x32_bf16 v[44:47], v[208:211], v[144:147], v[44:47]
    s_waitcnt lgkmcnt(8)
    ds_read_b64_tr_b16 v[190:191], v245 offset:28672
    v_cvt_pk_bf16_f32 v153, v154, v155
    v_exp_f32 v158, v158
    v_mfma_f32_16x16x32_bf16 v[16:19], v[160:163], v[128:131], v[16:19]
    ds_read_b64_tr_b16 v[192:193], v246 offset:24576
    v_add_f32 v220, v220, v156
    v_exp_f32 v159, v159
    v_mfma_f32_16x16x32_bf16 v[48:51], v[160:163], v[144:147], v[48:51]
    ds_read_b64_tr_b16 v[194:195], v246 offset:28672
    v_add_f32 v220, v220, v157
    v_cvt_pk_bf16_f32 v154, v156, v157
    v_add_f32 v220, v220, v158
    v_add_f32 v220, v220, v159
    v_mfma_f32_16x16x32_bf16 v[20:23], v[164:167], v[128:131], v[20:23]
    ds_read_b64_tr_b16 v[196:197], v247 offset:24576
    v_cvt_pk_bf16_f32 v155, v158, v159
    v_max_f32 v234, v96, v97
    v_max_f32 v235, v112, v113
    v_mfma_f32_16x16x32_bf16 v[52:55], v[164:167], v[144:147], v[52:55]
    ds_read_b64_tr_b16 v[198:199], v247 offset:28672
    v_max3_f32 v234, v98, v99, v234
    v_max3_f32 v235, v114, v115, v235
    v_max3_f32 v234, v100, v101, v234
    v_mfma_f32_16x16x32_bf16 v[24:27], v[168:171], v[128:131], v[24:27]
    ds_read_b64_tr_b16 v[200:201], v248 offset:24576
    v_max3_f32 v235, v116, v117, v235
    v_max3_f32 v234, v102, v103, v234
    v_max3_f32 v235, v118, v119, v235
    v_mfma_f32_16x16x32_bf16 v[56:59], v[168:171], v[144:147], v[56:59]
    ds_read_b64_tr_b16 v[202:203], v248 offset:28672
    v_max3_f32 v234, v104, v105, v234
    v_max3_f32 v235, v120, v121, v235
    v_max3_f32 v234, v106, v107, v234
    v_max3_f32 v235, v122, v123, v235
    v_mfma_f32_16x16x32_bf16 v[28:31], v[172:175], v[128:131], v[28:31]
    ds_read_b64_tr_b16 v[204:205], v249 offset:24576
    v_max3_f32 v234, v108, v109, v234
    v_max3_f32 v235, v124, v125, v235
    v_max3_f32 v234, v110, v111, v234
    v_mfma_f32_16x16x32_bf16 v[60:63], v[172:175], v[144:147], v[60:63]
    s_waitcnt lgkmcnt(7)
    ds_read_b64_tr_b16 v[206:207], v249 offset:28672
    v_max3_f32 v235, v126, v127, v235
    v_mov_b32 v237, 49
    v_cmp_lt_u32 s[56:57], v252, 50
    v_mfma_f32_16x16x32_bf16 v[0:3], v[176:179], v[136:139], v[0:3]
    s_cmp_eq_u64 s[56:57], 0
    s_cbranch_scc0 G0_x32
G0_x32_ret:
    ds_write_b32 v250, v237 offset:16
    ds_read_b128 v[208:211], v238 offset:0
    v_mov_b32 v224, v234
    v_mov_b32 v228, v235
    v_mfma_f32_16x16x32_bf16 v[32:35], v[176:179], v[152:155], v[32:35]
    v_permlane32_swap_b32 v224, v234
    v_permlane32_swap_b32 v228, v235
    v_max_f32 v234, v234, v224
    v_max_f32 v235, v235, v228
    v_mfma_f32_16x16x32_bf16 v[4:7], v[180:183], v[136:139], v[4:7]
    ds_read_b128 v[160:163], v239 offset:0
    v_mov_b32 v224, v234
    v_mov_b32 v228, v235
    v_mfma_f32_16x16x32_bf16 v[36:39], v[180:183], v[152:155], v[36:39]
    v_permlane16_swap_b32 v224, v234
    v_permlane16_swap_b32 v228, v235
    v_max_f32 v234, v234, v224
    v_max_f32 v235, v235, v228
    v_mfma_f32_16x16x32_bf16 v[8:11], v[184:187], v[136:139], v[8:11]
    ds_read_b128 v[164:167], v240 offset:0
    v_sub_f32 v224, 0, v234
    v_sub_f32 v225, 0, v234
    v_sub_f32 v226, 0, v234
    v_mfma_f32_16x16x32_bf16 v[40:43], v[184:187], v[152:155], v[40:43]
    v_sub_f32 v227, 0, v234
    v_sub_f32 v228, 0, v235
    v_sub_f32 v229, 0, v235
    v_sub_f32 v230, 0, v235
    v_mfma_f32_16x16x32_bf16 v[12:15], v[188:191], v[136:139], v[12:15]
    ds_read_b128 v[168:171], v241 offset:0
    v_sub_f32 v231, 0, v235
    v_sub_f32 v96, v96, v234
    v_sub_f32 v97, v97, v234
    v_mfma_f32_16x16x32_bf16 v[44:47], v[188:191], v[152:155], v[44:47]
    s_waitcnt lgkmcnt(5)
    v_sub_f32 v98, v98, v234
    v_sub_f32 v99, v99, v234
    v_sub_f32 v112, v112, v235
    v_sub_f32 v113, v113, v235
    v_mfma_f32_16x16x32_bf16 v[16:19], v[192:195], v[136:139], v[16:19]
    ds_read_b128 v[172:175], v238 offset:4096
    v_sub_f32 v114, v114, v235
    v_sub_f32 v115, v115, v235
    v_mfma_f32_16x16x32_bf16 v[48:51], v[192:195], v[152:155], v[48:51]
    v_sub_f32 v100, v100, v234
    v_sub_f32 v101, v101, v234
    v_sub_f32 v102, v102, v234
    v_sub_f32 v103, v103, v234
    v_mfma_f32_16x16x32_bf16 v[20:23], v[196:199], v[136:139], v[20:23]
    ds_read_b128 v[176:179], v239 offset:4096
    v_sub_f32 v116, v116, v235
    v_sub_f32 v117, v117, v235
    v_sub_f32 v118, v118, v235
    v_mfma_f32_16x16x32_bf16 v[52:55], v[196:199], v[152:155], v[52:55]
    v_sub_f32 v119, v119, v235
    v_sub_f32 v104, v104, v234
    v_sub_f32 v105, v105, v234
    v_sub_f32 v106, v106, v234
    v_mfma_f32_16x16x32_bf16 v[24:27], v[200:203], v[136:139], v[24:27]
    ds_read_b128 v[180:183], v240 offset:4096
    v_sub_f32 v107, v107, v234
    v_sub_f32 v120, v120, v235
    v_sub_f32 v121, v121, v235
    v_mfma_f32_16x16x32_bf16 v[56:59], v[200:203], v[152:155], v[56:59]
    v_sub_f32 v122, v122, v235
    v_sub_f32 v123, v123, v235
    v_sub_f32 v108, v108, v234
    v_mfma_f32_16x16x32_bf16 v[28:31], v[204:207], v[136:139], v[28:31]
    ds_read_b128 v[184:187], v241 offset:4096
    v_sub_f32 v109, v109, v234
    v_sub_f32 v110, v110, v234
    v_sub_f32 v111, v111, v234
    v_mfma_f32_16x16x32_bf16 v[60:63], v[204:207], v[152:155], v[60:63]
    s_waitcnt lgkmcnt(4)
    v_sub_f32 v124, v124, v235
    v_sub_f32 v125, v125, v235
    v_sub_f32 v126, v126, v235
    v_sub_f32 v127, v127, v235
    v_mfma_f32_16x16x32_bf16 v[128:131], v[208:211], v[64:67], v[224:227]
    ds_read_b128 v[188:191], v238 offset:8192
    v_mov_b32 v232, v216
    v_mov_b32 v233, v220
    s_nop 0
    v_permlane32_swap_b32 v232, v216
    v_permlane32_swap_b32 v233, v220
    v_add_f32 v216, v216, v232
    v_add_f32 v220, v220, v233
    v_mfma_f32_16x16x32_bf16 v[144:147], v[208:211], v[80:83], v[228:231]
    v_mov_b32 v232, v216
    v_mov_b32 v233, v220
    s_nop 0
    v_permlane16_swap_b32 v232, v216
    v_permlane16_swap_b32 v233, v220
    v_add_f32 v216, v216, v232
    v_add_f32 v220, v220, v233
    v_mfma_f32_16x16x32_bf16 v[128:131], v[160:163], v[68:71], v[128:131]
    ds_read_b128 v[192:195], v239 offset:8192
    v_rcp_f32 v232, v216
    v_rcp_f32 v233, v220
    v_mul_f32 v0, v0, v232
    v_mul_f32 v1, v1, v232
    v_mul_f32 v2, v2, v232
    v_mfma_f32_16x16x32_bf16 v[144:147], v[160:163], v[84:87], v[144:147]
    v_mul_f32 v3, v3, v232
    v_mul_f32 v4, v4, v232
    v_mul_f32 v5, v5, v232
    v_mul_f32 v6, v6, v232
    v_mul_f32 v7, v7, v232
    v_cvt_pk_bf16_f32 v0, v0, v1
    v_cvt_pk_bf16_f32 v1, v2, v3
    v_mfma_f32_16x16x32_bf16 v[128:131], v[164:167], v[72:75], v[128:131]
    ds_read_b128 v[196:199], v240 offset:8192
    v_cvt_pk_bf16_f32 v2, v4, v5
    v_cvt_pk_bf16_f32 v3, v6, v7
    s_mov_b32 s45, 0
    buffer_store_dwordx4 v[0:3], v254, s[20:23], s45 offen offset:0 sc1
    v_mul_f32 v32, v32, v233
    v_mul_f32 v33, v33, v233
    v_mfma_f32_16x16x32_bf16 v[144:147], v[164:167], v[88:91], v[144:147]
    v_mul_f32 v34, v34, v233
    v_mul_f32 v35, v35, v233
    v_mul_f32 v36, v36, v233
    v_mul_f32 v37, v37, v233
    v_mul_f32 v38, v38, v233
    v_mul_f32 v39, v39, v233
    v_cvt_pk_bf16_f32 v32, v32, v33
    v_mfma_f32_16x16x32_bf16 v[128:131], v[168:171], v[76:79], v[128:131]
    ds_read_b32 v252, v251 offset:0
    ds_read_b128 v[200:203], v241 offset:8192
    v_cvt_pk_bf16_f32 v33, v34, v35
    v_cvt_pk_bf16_f32 v34, v36, v37
    v_cvt_pk_bf16_f32 v35, v38, v39
    s_mov_b32 s45, 0
    buffer_store_dwordx4 v[32:35], v254, s[20:23], s45 offen offset:1024 sc1
    v_mul_f32 v8, v8, v232
    v_mfma_f32_16x16x32_bf16 v[144:147], v[168:171], v[92:95], v[144:147]
    s_waitcnt lgkmcnt(5)
    v_mul_f32 v9, v9, v232
    v_mul_f32 v10, v10, v232
    v_mul_f32 v11, v11, v232
    v_mul_f32 v12, v12, v232
    v_mul_f32 v13, v13, v232
    v_mul_f32 v14, v14, v232
    v_mul_f32 v15, v15, v232
    v_mfma_f32_16x16x32_bf16 v[132:135], v[172:175], v[64:67], v[224:227]
    ds_read_b128 v[204:207], v238 offset:12288
    v_cvt_pk_bf16_f32 v8, v8, v9
    v_cvt_pk_bf16_f32 v9, v10, v11
    v_cvt_pk_bf16_f32 v10, v12, v13
    v_cvt_pk_bf16_f32 v11, v14, v15
    s_mov_b32 s45, 9216
    buffer_store_dwordx4 v[8:11], v254, s[20:23], s45 offen offset:0 sc1
    v_mul_f32 v40, v40, v233
    v_mfma_f32_16x16x32_bf16 v[148:151], v[172:175], v[80:83], v[228:231]
    v_mul_f32 v41, v41, v233
    v_mul_f32 v42, v42, v233
    v_mul_f32 v43, v43, v233
    v_mul_f32 v44, v44, v233
    v_mul_f32 v45, v45, v233
    v_mul_f32 v46, v46, v233
    v_mul_f32 v47, v47, v233
    v_mfma_f32_16x16x32_bf16 v[132:135], v[176:179], v[68:71], v[132:135]
    ds_read_b128 v[208:211], v239 offset:12288
    v_cvt_pk_bf16_f32 v40, v40, v41
    v_cvt_pk_bf16_f32 v41, v42, v43
    v_cvt_pk_bf16_f32 v42, v44, v45
    v_cvt_pk_bf16_f32 v43, v46, v47
    s_mov_b32 s45, 9216
    buffer_store_dwordx4 v[40:43], v254, s[20:23], s45 offen offset:1024 sc1
    v_mul_f32 v16, v16, v232
    v_mfma_f32_16x16x32_bf16 v[148:151], v[176:179], v[84:87], v[148:151]
    v_mul_f32 v17, v17, v232
    v_mul_f32 v18, v18, v232
    v_mul_f32 v19, v19, v232
    v_mul_f32 v20, v20, v232
    v_mul_f32 v21, v21, v232
    v_mul_f32 v22, v22, v232
    v_mul_f32 v23, v23, v232
    v_mfma_f32_16x16x32_bf16 v[132:135], v[180:183], v[72:75], v[132:135]
    ds_read_b128 v[160:163], v240 offset:12288
    v_cvt_pk_bf16_f32 v16, v16, v17
    v_cvt_pk_bf16_f32 v17, v18, v19
    v_cvt_pk_bf16_f32 v18, v20, v21
    v_cvt_pk_bf16_f32 v19, v22, v23
    s_mov_b32 s45, 18432
    buffer_store_dwordx4 v[16:19], v254, s[20:23], s45 offen offset:0 sc1
    v_mfma_f32_16x16x32_bf16 v[148:151], v[180:183], v[88:91], v[148:151]
    v_mul_f32 v48, v48, v233
    v_mul_f32 v49, v49, v233
    v_mul_f32 v50, v50, v233
    v_mul_f32 v51, v51, v233
    v_mul_f32 v52, v52, v233
    v_mul_f32 v53, v53, v233
    v_mul_f32 v54, v54, v233
    v_mfma_f32_16x16x32_bf16 v[132:135], v[184:187], v[76:79], v[132:135]
    ds_read_b128 v[164:167], v241 offset:12288
    v_mul_f32 v55, v55, v233
    v_cvt_pk_bf16_f32 v48, v48, v49
    v_cvt_pk_bf16_f32 v49, v50, v51
    v_cvt_pk_bf16_f32 v50, v52, v53
    v_cvt_pk_bf16_f32 v51, v54, v55
    s_mov_b32 s45, 18432
    buffer_store_dwordx4 v[48:51], v254, s[20:23], s45 offen offset:1024 sc1
    v_mfma_f32_16x16x32_bf16 v[148:151], v[184:187], v[92:95], v[148:151]
    s_waitcnt lgkmcnt(4)
    v_mul_f32 v24, v24, v232
    v_mul_f32 v25, v25, v232
    v_mul_f32 v26, v26, v232
    v_mul_f32 v27, v27, v232
    v_mul_f32 v28, v28, v232
    v_mov_b32 v237, 50
    v_cmp_lt_u32 s[56:57], v252, 51
    v_mfma_f32_16x16x32_bf16 v[136:139], v[188:191], v[64:67], v[224:227]
    s_cmp_eq_u64 s[56:57], 0
    s_cbranch_scc0 G0_x34
G0_x34_ret:
    ds_write_b32 v250, v237 offset:16
    ds_read_b64_tr_b16 v[168:169], v242 offset:32768
    v_mul_f32 v29, v29, v232
    v_mul_f32 v30, v30, v232
    v_mul_f32 v31, v31, v232
    v_cvt_pk_bf16_f32 v24, v24, v25
    v_mfma_f32_16x16x32_bf16 v[152:155], v[188:191], v[80:83], v[228:231]
    ds_read_b64_tr_b16 v[170:171], v242 offset:36864
    v_cvt_pk_bf16_f32 v25, v26, v27
    v_cvt_pk_bf16_f32 v26, v28, v29
    v_cvt_pk_bf16_f32 v27, v30, v31
    s_mov_b32 s45, 27648
    buffer_store_dwordx4 v[24:27], v254, s[20:23], s45 offen offset:0 sc1
    v_mul_f32 v56, v56, v233
    v_mfma_f32_16x16x32_bf16 v[136:139], v[192:195], v[68:71], v[136:139]
    ds_read_b64_tr_b16 v[172:173], v243 offset:32768
    v_mul_f32 v57, v57, v233
    v_mul_f32 v58, v58, v233
    v_mul_f32 v59, v59, v233
    v_mul_f32 v60, v60, v233
    v_mul_f32 v61, v61, v233
    v_mfma_f32_16x16x32_bf16 v[152:155], v[192:195], v[84:87], v[152:155]
    ds_read_b64_tr_b16 v[174:175], v243 offset:36864
    v_mul_f32 v62, v62, v233
    v_mul_f32 v63, v63, v233
    v_cvt_pk_bf16_f32 v56, v56, v57
    v_cvt_pk_bf16_f32 v57, v58, v59
    v_cvt_pk_bf16_f32 v58, v60, v61
    v_mfma_f32_16x16x32_bf16 v[136:139], v[196:199], v[72:75], v[136:139]
    ds_read_b64_tr_b16 v[176:177], v244 offset:32768
    v_cvt_pk_bf16_f32 v59, v62, v63
    s_mov_b32 s45, 27648
    buffer_store_dwordx4 v[56:59], v254, s[20:23], s45 offen offset:1024 sc1
    v_exp_f32 v96, v96
    v_mfma_f32_16x16x32_bf16 v[152:155], v[196:199], v[88:91], v[152:155]
    ds_read_b64_tr_b16 v[178:179], v244 offset:36864
    v_exp_f32 v97, v97
    v_exp_f32 v98, v98
    v_mov_b32 v217, v96
    v_mfma_f32_16x16x32_bf16 v[136:139], v[200:203], v[76:79], v[136:139]
    ds_read_b64_tr_b16 v[180:181], v245 offset:32768
    v_exp_f32 v99, v99
    v_add_f32 v217, v217, v97
    v_cvt_pk_bf16_f32 v96, v96, v97
    v_exp_f32 v100, v100
    v_mfma_f32_16x16x32_bf16 v[152:155], v[200:203], v[92:95], v[152:155]
    s_waitcnt lgkmcnt(8)
    ds_read_b64_tr_b16 v[182:183], v245 offset:36864
    v_add_f32 v217, v217, v98
    v_exp_f32 v101, v101
    v_add_f32 v217, v217, v99
    v_mfma_f32_16x16x32_bf16 v[140:143], v[204:207], v[64:67], v[224:227]
    ds_read_b64_tr_b16 v[184:185], v246 offset:32768
    v_cvt_pk_bf16_f32 v97, v98, v99
    v_exp_f32 v102, v102
    v_add_f32 v217, v217, v100
    v_mfma_f32_16x16x32_bf16 v[156:159], v[204:207], v[80:83], v[228:231]
    ds_read_b64_tr_b16 v[186:187], v246 offset:36864
    v_exp_f32 v103, v103
    v_add_f32 v217, v217, v101
    v_cvt_pk_bf16_f32 v98, v100, v101
    v_add_f32 v217, v217, v102
    v_add_f32 v217, v217, v103
    v_mfma_f32_16x16x32_bf16 v[140:143], v[208:211], v[68:71], v[140:143]
    ds_read_b64_tr_b16 v[188:189], v247 offset:32768
    v_cvt_pk_bf16_f32 v99, v102, v103
    v_exp_f32 v112, v112
    v_exp_f32 v113, v113
    v_mfma_f32_16x16x32_bf16 v[156:159], v[208:211], v[84:87], v[156:159]
    ds_read_b64_tr_b16 v[190:191], v247 offset:36864
    v_exp_f32 v114, v114
    v_mov_b32 v221, v112
    v_exp_f32 v115, v115
    v_mfma_f32_16x16x32_bf16 v[140:143], v[160:163], v[72:75], v[140:143]
    ds_read_b64_tr_b16 v[192:193], v248 offset:32768
    v_add_f32 v221, v221, v113
    v_cvt_pk_bf16_f32 v112, v112, v113
    v_exp_f32 v116, v116
    v_mfma_f32_16x16x32_bf16 v[156:159], v[160:163], v[88:91], v[156:159]
    ds_read_b64_tr_b16 v[194:195], v248 offset:36864
    v_add_f32 v221, v221, v114
    v_exp_f32 v117, v117
    v_add_f32 v221, v221, v115
    v_cvt_pk_bf16_f32 v113, v114, v115
    v_mfma_f32_16x16x32_bf16 v[140:143], v[164:167], v[76:79], v[140:143]
    ds_read_b64_tr_b16 v[196:197], v249 offset:32768
    v_exp_f32 v118, v118
    v_add_f32 v221, v221, v116
    v_exp_f32 v119, v119
    v_mfma_f32_16x16x32_bf16 v[156:159], v[164:167], v[92:95], v[156:159]
    s_waitcnt lgkmcnt(7)
    ds_read_b64_tr_b16 v[198:199], v249 offset:36864
    v_add_f32 v221, v221, v117
    v_cvt_pk_bf16_f32 v114, v116, v117
    v_add_f32 v221, v221, v118
    v_add_f32 v221, v221, v119
    v_cvt_pk_bf16_f32 v115, v118, v119
    v_mfma_f32_16x16x32_bf16 v[0:3], v[168:171], v[96:99], 0
    ds_read_b64_tr_b16 v[200:201], v242 offset:40960
    v_exp_f32 v104, v104
    v_exp_f32 v105, v105
    v_mfma_f32_16x16x32_bf16 v[32:35], v[168:171], v[112:115], 0
    ds_read_b64_tr_b16 v[202:203], v242 offset:45056
    v_exp_f32 v106, v106
    v_add_f32 v217, v217, v104
    v_mfma_f32_16x16x32_bf16 v[4:7], v[172:175], v[96:99], 0
    ds_read_b64_tr_b16 v[204:205], v243 offset:40960
    v_exp_f32 v107, v107
    v_add_f32 v217, v217, v105
    v_cvt_pk_bf16_f32 v104, v104, v105
    v_mfma_f32_16x16x32_bf16 v[36:39], v[172:175], v[112:115], 0
    ds_read_b64_tr_b16 v[206:207], v243 offset:45056
    v_exp_f32 v108, v108
    v_add_f32 v217, v217, v106
    v_mfma_f32_16x16x32_bf16 v[8:11], v[176:179], v[96:99], 0
    ds_read_b64_tr_b16 v[208:209], v244 offset:40960
    v_exp_f32 v109, v109
    v_add_f32 v217, v217, v107
    v_cvt_pk_bf16_f32 v105, v106, v107
    v_mfma_f32_16x16x32_bf16 v[40:43], v[176:179], v[112:115], 0
    ds_read_b64_tr_b16 v[210:211], v244 offset:45056
    v_exp_f32 v110, v110
    v_add_f32 v217, v217, v108
    v_exp_f32 v111, v111
    v_mfma_f32_16x16x32_bf16 v[12:15], v[180:183], v[96:99], 0
    ds_read_b32 v252, v251 offset:0
    ds_read_b64_tr_b16 v[160:161], v245 offset:40960
    v_add_f32 v217, v217, v109
    v_cvt_pk_bf16_f32 v106, v108, v109
    v_mfma_f32_16x16x32_bf16 v[44:47], v[180:183], v[112:115], 0
    s_waitcnt lgkmcnt(8)
    ds_read_b64_tr_b16 v[162:163], v245 offset:45056
    v_add_f32 v217, v217, v110
    v_add_f32 v217, v217, v111
    v_cvt_pk_bf16_f32 v107, v110, v111
    v_mfma_f32_16x16x32_bf16 v[16:19], v[184:187], v[96:99], 0
    ds_read_b64_tr_b16 v[164:165], v246 offset:40960
    v_exp_f32 v120, v120
    v_exp_f32 v121, v121
    v_mfma_f32_16x16x32_bf16 v[48:51], v[184:187], v[112:115], 0
    ds_read_b64_tr_b16 v[166:167], v246 offset:45056
    v_exp_f32 v122, v122
    v_add_f32 v221, v221, v120
    v_mfma_f32_16x16x32_bf16 v[20:23], v[188:191], v[96:99], 0
    ds_read_b64_tr_b16 v[168:169], v247 offset:40960
    v_exp_f32 v123, v123
    v_add_f32 v221, v221, v121
    v_cvt_pk_bf16_f32 v120, v120, v121
    v_mfma_f32_16x16x32_bf16 v[52:55], v[188:191], v[112:115], 0
    ds_read_b64_tr_b16 v[170:171], v247 offset:45056
    v_exp_f32 v124, v124
    v_add_f32 v221, v221, v122
    v_exp_f32 v125, v125
    v_mfma_f32_16x16x32_bf16 v[24:27], v[192:195], v[96:99], 0
    ds_read_b64_tr_b16 v[172:173], v248 offset:40960
    v_add_f32 v221, v221, v123
    v_cvt_pk_bf16_f32 v121, v122, v123
    v_mfma_f32_16x16x32_bf16 v[56:59], v[192:195], v[112:115], 0
    ds_read_b64_tr_b16 v[174:175], v248 offset:45056
    v_exp_f32 v126, v126
    v_add_f32 v221, v221, v124
    v_exp_f32 v127, v127
    v_mfma_f32_16x16x32_bf16 v[28:31], v[196:199], v[96:99], 0
    ds_read_b64_tr_b16 v[176:177], v249 offset:40960
    v_add_f32 v221, v221, v125
    v_cvt_pk_bf16_f32 v122, v124, v125
    v_add_f32 v221, v221, v126
    v_mfma_f32_16x16x32_bf16 v[60:63], v[196:199], v[112:115], 0
    s_waitcnt lgkmcnt(7)
    ds_read_b64_tr_b16 v[178:179], v249 offset:45056
    v_add_f32 v221, v221, v127
    v_cvt_pk_bf16_f32 v123, v126, v127
    v_mov_b32 v237, 51
    v_cmp_lt_u32 s[56:57], v252, 52
    v_mfma_f32_16x16x32_bf16 v[0:3], v[200:203], v[104:107], v[0:3]
    s_cmp_eq_u64 s[56:57], 0
    s_cbranch_scc0 G0_x36
G0_x36_ret:
    ds_write_b32 v250, v237 offset:16
    ds_read_b128 v[180:183], v238 offset:16384
    v_mfma_f32_16x16x32_bf16 v[32:35], v[200:203], v[120:123], v[32:35]
    ds_read_b128 v[184:187], v239 offset:16384
    v_max_f32 v234, v128, v129
    v_mfma_f32_16x16x32_bf16 v[4:7], v[204:207], v[104:107], v[4:7]
    v_max_f32 v235, v144, v145
    v_max3_f32 v234, v130, v131, v234
    v_mfma_f32_16x16x32_bf16 v[36:39], v[204:207], v[120:123], v[36:39]
    ds_read_b128 v[188:191], v240 offset:16384
    v_max3_f32 v235, v146, v147, v235
    v_mfma_f32_16x16x32_bf16 v[8:11], v[208:211], v[104:107], v[8:11]
    v_max3_f32 v234, v132, v133, v234
    v_max3_f32 v235, v148, v149, v235
    v_mfma_f32_16x16x32_bf16 v[40:43], v[208:211], v[120:123], v[40:43]
    ds_read_b128 v[192:195], v241 offset:16384
    v_max3_f32 v234, v134, v135, v234
    v_mfma_f32_16x16x32_bf16 v[12:15], v[160:163], v[104:107], v[12:15]
    v_max3_f32 v235, v150, v151, v235
    v_max3_f32 v234, v136, v137, v234
    v_mfma_f32_16x16x32_bf16 v[44:47], v[160:163], v[120:123], v[44:47]
    s_waitcnt lgkmcnt(5)
    ds_read_b128 v[196:199], v238 offset:20480
    v_mfma_f32_16x16x32_bf16 v[16:19], v[164:167], v[104:107], v[16:19]
    ds_read_b128 v[200:203], v239 offset:20480
    v_max3_f32 v235, v152, v153, v235
    v_mfma_f32_16x16x32_bf16 v[48:51], v[164:167], v[120:123], v[48:51]
    v_max3_f32 v234, v138, v139, v234
    v_max3_f32 v235, v154, v155, v235
    v_mfma_f32_16x16x32_bf16 v[20:23], v[168:171], v[104:107], v[20:23]
    ds_read_b128 v[204:207], v240 offset:20480
    v_max3_f32 v234, v140, v141, v234
    v_mfma_f32_16x16x32_bf16 v[52:55], v[168:171], v[120:123], v[52:55]
    v_max3_f32 v235, v156, v157, v235
    v_max3_f32 v234, v142, v143, v234
    v_mfma_f32_16x16x32_bf16 v[24:27], v[172:175], v[104:107], v[24:27]
    ds_read_b128 v[208:211], v241 offset:20480
    v_max3_f32 v235, v158, v159, v235
    v_mfma_f32_16x16x32_bf16 v[56:59], v[172:175], v[120:123], v[56:59]
    v_max_f32 v236, v234, v235
    v_cmp_lt_f32 vcc, s50, v236
    v_mfma_f32_16x16x32_bf16 v[28:31], v[176:179], v[104:107], v[28:31]
    v_mfma_f32_16x16x32_bf16 v[60:63], v[176:179], v[120:123], v[60:63]
    s_waitcnt lgkmcnt(4)
    s_cbranch_vccnz G0_g8
G0_g8_ret:
    v_mfma_f32_16x16x32_bf16 v[96:99], v[180:183], v[64:67], v[224:227]
    ds_read_b128 v[160:163], v238 offset:24576
    v_exp_f32 v128, v128
    v_mfma_f32_16x16x32_bf16 v[112:115], v[180:183], v[80:83], v[228:231]
    v_exp_f32 v129, v129
    v_exp_f32 v130, v130
    v_mfma_f32_16x16x32_bf16 v[96:99], v[184:187], v[68:71], v[96:99]
    ds_read_b128 v[164:167], v239 offset:24576
    v_add_f32 v217, v217, v128
    v_exp_f32 v131, v131
    v_mfma_f32_16x16x32_bf16 v[112:115], v[184:187], v[84:87], v[112:115]
    v_add_f32 v217, v217, v129
    v_cvt_pk_bf16_f32 v128, v128, v129
    v_exp_f32 v132, v132
    v_mfma_f32_16x16x32_bf16 v[96:99], v[188:191], v[72:75], v[96:99]
    ds_read_b128 v[168:171], v240 offset:24576
    v_add_f32 v217, v217, v130
    v_mfma_f32_16x16x32_bf16 v[112:115], v[188:191], v[88:91], v[112:115]
    v_exp_f32 v133, v133
    v_add_f32 v217, v217, v131
    v_cvt_pk_bf16_f32 v129, v130, v131
    v_mfma_f32_16x16x32_bf16 v[96:99], v[192:195], v[76:79], v[96:99]
    ds_read_b32 v252, v251 offset:0
    ds_read_b128 v[172:175], v241 offset:24576
    v_exp_f32 v134, v134
    v_mfma_f32_16x16x32_bf16 v[112:115], v[192:195], v[92:95], v[112:115]
    s_waitcnt lgkmcnt(5)
    v_add_f32 v217, v217, v132
    v_exp_f32 v135, v135
    v_mfma_f32_16x16x32_bf16 v[100:103], v[196:199], v[64:67], v[224:227]
    ds_read_b128 v[176:179], v238 offset:28672
    v_add_f32 v217, v217, v133
    v_cvt_pk_bf16_f32 v130, v132, v133
    v_add_f32 v217, v217, v134
    v_mfma_f32_16x16x32_bf16 v[116:119], v[196:199], v[80:83], v[228:231]
    v_add_f32 v217, v217, v135
    v_cvt_pk_bf16_f32 v131, v134, v135
    v_exp_f32 v144, v144
    v_mfma_f32_16x16x32_bf16 v[100:103], v[200:203], v[68:71], v[100:103]
    ds_read_b128 v[180:183], v239 offset:28672
    v_exp_f32 v145, v145
    v_mfma_f32_16x16x32_bf16 v[116:119], v[200:203], v[84:87], v[116:119]
    v_exp_f32 v146, v146
    v_add_f32 v221, v221, v144
    v_mfma_f32_16x16x32_bf16 v[100:103], v[204:207], v[72:75], v[100:103]
    ds_read_b128 v[184:187], v240 offset:28672
    v_exp_f32 v147, v147
    v_add_f32 v221, v221, v145
    v_mfma_f32_16x16x32_bf16 v[116:119], v[204:207], v[88:91], v[116:119]
    v_cvt_pk_bf16_f32 v144, v144, v145
    v_exp_f32 v148, v148
    v_mfma_f32_16x16x32_bf16 v[100:103], v[208:211], v[76:79], v[100:103]
    ds_read_b128 v[188:191], v241 offset:28672
    v_add_f32 v221, v221, v146
    v_exp_f32 v149, v149
    v_mfma_f32_16x16x32_bf16 v[116:119], v[208:211], v[92:95], v[116:119]
    s_waitcnt lgkmcnt(4)
    v_add_f32 v221, v221, v147
    v_mov_b32 v237, 52
    v_cmp_lt_u32 s[56:57], v252, 53
    v_mfma_f32_16x16x32_bf16 v[104:107], v[160:163], v[64:67], v[224:227]
    s_cmp_eq_u64 s[56:57], 0
    s_cbranch_scc0 G0_x38
G0_x38_ret:
    ds_write_b32 v250, v237 offset:16
    ds_read_b64_tr_b16 v[192:193], v242 offset:0
    v_cvt_pk_bf16_f32 v145, v146, v147
    v_mfma_f32_16x16x32_bf16 v[120:123], v[160:163], v[80:83], v[228:231]
    ds_read_b64_tr_b16 v[194:195], v242 offset:4096
    v_exp_f32 v150, v150
    v_mfma_f32_16x16x32_bf16 v[104:107], v[164:167], v[68:71], v[104:107]
    ds_read_b64_tr_b16 v[196:197], v243 offset:0
    v_add_f32 v221, v221, v148
    v_exp_f32 v151, v151
    v_mfma_f32_16x16x32_bf16 v[120:123], v[164:167], v[84:87], v[120:123]
    ds_read_b64_tr_b16 v[198:199], v243 offset:4096
    v_add_f32 v221, v221, v149
    v_cvt_pk_bf16_f32 v146, v148, v149
    v_mfma_f32_16x16x32_bf16 v[104:107], v[168:171], v[72:75], v[104:107]
    ds_read_b64_tr_b16 v[200:201], v244 offset:0
    v_add_f32 v221, v221, v150
    v_add_f32 v221, v221, v151
    v_mfma_f32_16x16x32_bf16 v[120:123], v[168:171], v[88:91], v[120:123]
    ds_read_b64_tr_b16 v[202:203], v244 offset:4096
    v_cvt_pk_bf16_f32 v147, v150, v151
    v_exp_f32 v136, v136
    v_mfma_f32_16x16x32_bf16 v[104:107], v[172:175], v[76:79], v[104:107]
    ds_read_b64_tr_b16 v[204:205], v245 offset:0
    v_exp_f32 v137, v137
    v_mfma_f32_16x16x32_bf16 v[120:123], v[172:175], v[92:95], v[120:123]
    s_waitcnt lgkmcnt(8)
    ds_read_b64_tr_b16 v[206:207], v245 offset:4096
    v_exp_f32 v138, v138
    v_mfma_f32_16x16x32_bf16 v[108:111], v[176:179], v[64:67], v[224:227]
    ds_read_b64_tr_b16 v[208:209], v246 offset:0
    v_add_f32 v217, v217, v136
    v_mfma_f32_16x16x32_bf16 v[124:127], v[176:179], v[80:83], v[228:231]
    ds_read_b64_tr_b16 v[210:211], v246 offset:4096
    v_exp_f32 v139, v139
    v_add_f32 v217, v217, v137
    v_mfma_f32_16x16x32_bf16 v[108:111], v[180:183], v[68:71], v[108:111]
    ds_read_b64_tr_b16 v[160:161], v247 offset:0
    v_cvt_pk_bf16_f32 v136, v136, v137
    v_exp_f32 v140, v140
    v_mfma_f32_16x16x32_bf16 v[124:127], v[180:183], v[84:87], v[124:127]
    ds_read_b64_tr_b16 v[162:163], v247 offset:4096
    v_add_f32 v217, v217, v138
    v_mfma_f32_16x16x32_bf16 v[108:111], v[184:187], v[72:75], v[108:111]
    ds_read_b64_tr_b16 v[164:165], v248 offset:0
    v_exp_f32 v141, v141
    v_mfma_f32_16x16x32_bf16 v[124:127], v[184:187], v[88:91], v[124:127]
    ds_read_b64_tr_b16 v[166:167], v248 offset:4096
    v_add_f32 v217, v217, v139
    v_cvt_pk_bf16_f32 v137, v138, v139
    v_mfma_f32_16x16x32_bf16 v[108:111], v[188:191], v[76:79], v[108:111]
    ds_read_b64_tr_b16 v[168:169], v249 offset:0
    v_exp_f32 v142, v142
    v_add_f32 v217, v217, v140
    v_mfma_f32_16x16x32_bf16 v[124:127], v[188:191], v[92:95], v[124:127]
    s_waitcnt lgkmcnt(7)
    ds_read_b64_tr_b16 v[170:171], v249 offset:4096
    v_exp_f32 v143, v143
    v_mfma_f32_16x16x32_bf16 v[0:3], v[192:195], v[128:131], v[0:3]
    ds_read_b64_tr_b16 v[172:173], v242 offset:8192
    v_add_f32 v217, v217, v141
    v_cvt_pk_bf16_f32 v138, v140, v141
    v_mfma_f32_16x16x32_bf16 v[32:35], v[192:195], v[144:147], v[32:35]
    ds_read_b64_tr_b16 v[174:175], v242 offset:12288
    v_add_f32 v217, v217, v142
    v_add_f32 v217, v217, v143
    v_cvt_pk_bf16_f32 v139, v142, v143
    v_mfma_f32_16x16x32_bf16 v[4:7], v[196:199], v[128:131], v[4:7]
    ds_read_b64_tr_b16 v[176:177], v243 offset:8192
    v_exp_f32 v152, v152
    v_mfma_f32_16x16x32_bf16 v[36:39], v[196:199], v[144:147], v[36:39]
    ds_read_b64_tr_b16 v[178:179], v243 offset:12288
    v_exp_f32 v153, v153
    v_mfma_f32_16x16x32_bf16 v[8:11], v[200:203], v[128:131], v[8:11]
    ds_read_b64_tr_b16 v[180:181], v244 offset:8192
    v_exp_f32 v154, v154
    v_mfma_f32_16x16x32_bf16 v[40:43], v[200:203], v[144:147], v[40:43]
    ds_read_b64_tr_b16 v[182:183], v244 offset:12288
    v_add_f32 v221, v221, v152
    v_exp_f32 v155, v155
    v_mfma_f32_16x16x32_bf16 v[12:15], v[204:207], v[128:131], v[12:15]
    ds_read_b32 v252, v251 offset:0
    ds_read_b64_tr_b16 v[184:185], v245 offset:8192
    v_add_f32 v221, v221, v153
    v_mfma_f32_16x16x32_bf16 v[44:47], v[204:207], v[144:147], v[44:47]
    s_waitcnt lgkmcnt(8)
    ds_read_b64_tr_b16 v[186:187], v245 offset:12288
    v_cvt_pk_bf16_f32 v152, v152, v153
    v_exp_f32 v156, v156
    v_mfma_f32_16x16x32_bf16 v[16:19], v[208:211], v[128:131], v[16:19]
    ds_read_b64_tr_b16 v[188:189], v246 offset:8192
    v_add_f32 v221, v221, v154
    v_mfma_f32_16x16x32_bf16 v[48:51], v[208:211], v[144:147], v[48:51]
    ds_read_b64_tr_b16 v[190:191], v246 offset:12288
    v_exp_f32 v157, v157
    v_add_f32 v221, v221, v155
    v_mfma_f32_16x16x32_bf16 v[20:23], v[160:163], v[128:131], v[20:23]
    ds_read_b64_tr_b16 v[192:193], v247 offset:8192
    v_cvt_pk_bf16_f32 v153, v154, v155
    v_mfma_f32_16x16x32_bf16 v[52:55], v[160:163], v[144:147], v[52:55]
    ds_read_b64_tr_b16 v[194:195], v247 offset:12288
    v_exp_f32 v158, v158
    v_add_f32 v221, v221, v156
    v_mfma_f32_16x16x32_bf16 v[24:27], v[164:167], v[128:131], v[24:27]
    ds_read_b64_tr_b16 v[196:197], v248 offset:8192
    v_exp_f32 v159, v159
    v_mfma_f32_16x16x32_bf16 v[56:59], v[164:167], v[144:147], v[56:59]
    ds_read_b64_tr_b16 v[198:199], v248 offset:12288
    v_add_f32 v221, v221, v157
    v_cvt_pk_bf16_f32 v154, v156, v157
    v_add_f32 v221, v221, v158
    v_mfma_f32_16x16x32_bf16 v[28:31], v[168:171], v[128:131], v[28:31]
    ds_read_b64_tr_b16 v[200:201], v249 offset:8192
    v_add_f32 v221, v221, v159
    v_cvt_pk_bf16_f32 v155, v158, v159
    v_mfma_f32_16x16x32_bf16 v[60:63], v[168:171], v[144:147], v[60:63]
    s_waitcnt lgkmcnt(7)
    ds_read_b64_tr_b16 v[202:203], v249 offset:12288
    v_mov_b32 v237, 53
    v_cmp_lt_u32 s[56:57], v252, 54
    v_mfma_f32_16x16x32_bf16 v[0:3], v[172:175], v[136:139], v[0:3]
    s_cmp_eq_u64 s[56:57], 0
    s_cbranch_scc0 G0_x40
G0_x40_ret:
    ds_write_b32 v250, v237 offset:16
    ds_read_b128 v[204:207], v238 offset:32768
    v_mfma_f32_16x16x32_bf16 v[32:35], v[172:175], v[152:155], v[32:35]
    ds_read_b128 v[208:211], v239 offset:32768
    v_max_f32 v234, v96, v97
    v_mfma_f32_16x16x32_bf16 v[4:7], v[176:179], v[136:139], v[4:7]
    v_max_f32 v235, v112, v113
    v_max3_f32 v234, v98, v99, v234
    v_mfma_f32_16x16x32_bf16 v[36:39], v[176:179], v[152:155], v[36:39]
    ds_read_b128 v[160:163], v240 offset:32768
    v_max3_f32 v235, v114, v115, v235
    v_mfma_f32_16x16x32_bf16 v[8:11], v[180:183], v[136:139], v[8:11]
    v_max3_f32 v234, v100, v101, v234
    v_max3_f32 v235, v116, v117, v235
    v_mfma_f32_16x16x32_bf16 v[40:43], v[180:183], v[152:155], v[40:43]
    ds_read_b128 v[164:167], v241 offset:32768
    v_max3_f32 v234, v102, v103, v234
    v_mfma_f32_16x16x32_bf16 v[12:15], v[184:187], v[136:139], v[12:15]
    v_max3_f32 v235, v118, v119, v235
    v_max3_f32 v234, v104, v105, v234
    v_mfma_f32_16x16x32_bf16 v[44:47], v[184:187], v[152:155], v[44:47]
    s_waitcnt lgkmcnt(5)
    ds_read_b128 v[168:171], v238 offset:36864
    v_mfma_f32_16x16x32_bf16 v[16:19], v[188:191], v[136:139], v[16:19]
    ds_read_b128 v[172:175], v239 offset:36864
    v_max3_f32 v235, v120, v121, v235
    v_mfma_f32_16x16x32_bf16 v[48:51], v[188:191], v[152:155], v[48:51]
    v_max3_f32 v234, v106, v107, v234
    v_max3_f32 v235, v122, v123, v235
    v_mfma_f32_16x16x32_bf16 v[20:23], v[192:195], v[136:139], v[20:23]
    ds_read_b128 v[176:179], v240 offset:36864
    v_max3_f32 v234, v108, v109, v234
    v_mfma_f32_16x16x32_bf16 v[52:55], v[192:195], v[152:155], v[52:55]
    v_max3_f32 v235, v124, v125, v235
    v_max3_f32 v234, v110, v111, v234
    v_mfma_f32_16x16x32_bf16 v[24:27], v[196:199], v[136:139], v[24:27]
    ds_read_b128 v[180:183], v241 offset:36864
    v_max3_f32 v235, v126, v127, v235
    v_mfma_f32_16x16x32_bf16 v[56:59], v[196:199], v[152:155], v[56:59]
    v_max_f32 v236, v234, v235
    v_cmp_lt_f32 vcc, s50, v236
    v_mfma_f32_16x16x32_bf16 v[28:31], v[200:203], v[136:139], v[28:31]
    v_mfma_f32_16x16x32_bf16 v[60:63], v[200:203], v[152:155], v[60:63]
    s_waitcnt lgkmcnt(4)
    s_cbranch_vccnz G0_g9
G0_g9_ret:
    v_mfma_f32_16x16x32_bf16 v[128:131], v[204:207], v[64:67], v[224:227]
    ds_read_b128 v[184:187], v238 offset:40960
    v_exp_f32 v96, v96
    v_mfma_f32_16x16x32_bf16 v[144:147], v[204:207], v[80:83], v[228:231]
    v_exp_f32 v97, v97
    v_exp_f32 v98, v98
    v_mfma_f32_16x16x32_bf16 v[128:131], v[208:211], v[68:71], v[128:131]
    ds_read_b128 v[188:191], v239 offset:40960
    v_add_f32 v217, v217, v96
    v_exp_f32 v99, v99
    v_mfma_f32_16x16x32_bf16 v[144:147], v[208:211], v[84:87], v[144:147]
    v_add_f32 v217, v217, v97
    v_cvt_pk_bf16_f32 v96, v96, v97
    v_exp_f32 v100, v100
    v_mfma_f32_16x16x32_bf16 v[128:131], v[160:163], v[72:75], v[128:131]
    ds_read_b128 v[192:195], v240 offset:40960
    v_add_f32 v217, v217, v98
    v_mfma_f32_16x16x32_bf16 v[144:147], v[160:163], v[88:91], v[144:147]
    v_exp_f32 v101, v101
    v_add_f32 v217, v217, v99
    v_cvt_pk_bf16_f32 v97, v98, v99
    v_mfma_f32_16x16x32_bf16 v[128:131], v[164:167], v[76:79], v[128:131]
    ds_read_b32 v252, v251 offset:0
    ds_read_b128 v[196:199], v241 offset:40960
    v_exp_f32 v102, v102
    v_mfma_f32_16x16x32_bf16 v[144:147], v[164:167], v[92:95], v[144:147]
    s_waitcnt lgkmcnt(5)
    v_add_f32 v217, v217, v100
    v_exp_f32 v103, v103
    v_mfma_f32_16x16x32_bf16 v[132:135], v[168:171], v[64:67], v[224:227]
    ds_read_b128 v[200:203], v238 offset:45056
    v_add_f32 v217, v217, v101
    v_cvt_pk_bf16_f32 v98, v100, v101
    v_add_f32 v217, v217, v102
    v_mfma_f32_16x16x32_bf16 v[148:151], v[168:171], v[80:83], v[228:231]
    v_add_f32 v217, v217, v103
    v_cvt_pk_bf16_f32 v99, v102, v103
    v_exp_f32 v112, v112
    v_mfma_f32_16x16x32_bf16 v[132:135], v[172:175], v[68:71], v[132:135]
    ds_read_b128 v[204:207], v239 offset:45056
    v_exp_f32 v113, v113
    v_mfma_f32_16x16x32_bf16 v[148:151], v[172:175], v[84:87], v[148:151]
    v_exp_f32 v114, v114
    v_add_f32 v221, v221, v112
    v_mfma_f32_16x16x32_bf16 v[132:135], v[176:179], v[72:75], v[132:135]
    ds_read_b128 v[208:211], v240 offset:45056
    v_exp_f32 v115, v115
    v_add_f32 v221, v221, v113
    v_mfma_f32_16x16x32_bf16 v[148:151], v[176:179], v[88:91], v[148:151]
    v_cvt_pk_bf16_f32 v112, v112, v113
    v_exp_f32 v116, v116
    v_mfma_f32_16x16x32_bf16 v[132:135], v[180:183], v[76:79], v[132:135]
    ds_read_b128 v[160:163], v241 offset:45056
    v_add_f32 v221, v221, v114
    v_exp_f32 v117, v117
    v_mfma_f32_16x16x32_bf16 v[148:151], v[180:183], v[92:95], v[148:151]
    s_waitcnt lgkmcnt(4)
    v_add_f32 v221, v221, v115
    v_mov_b32 v237, 54
    v_cmp_lt_u32 s[56:57], v252, 55
    v_mfma_f32_16x16x32_bf16 v[136:139], v[184:187], v[64:67], v[224:227]
    s_cmp_eq_u64 s[56:57], 0
    s_cbranch_scc0 G0_x42
G0_x42_ret:
    ds_write_b32 v250, v237 offset:16
    ds_read_b64_tr_b16 v[164:165], v242 offset:16384
    v_cvt_pk_bf16_f32 v113, v114, v115
    v_mfma_f32_16x16x32_bf16 v[152:155], v[184:187], v[80:83], v[228:231]
    ds_read_b64_tr_b16 v[166:167], v242 offset:20480
    v_exp_f32 v118, v118
    v_add_f32 v221, v221, v116
    v_mfma_f32_16x16x32_bf16 v[136:139], v[188:191], v[68:71], v[136:139]
    v_mov_b32 v236, 1
    ds_read_b64_tr_b16 v[168:169], v243 offset:16384
    v_mfma_f32_16x16x32_bf16 v[152:155], v[188:191], v[84:87], v[152:155]
    ds_read_b64_tr_b16 v[170:171], v243 offset:20480
    v_exp_f32 v119, v119
    v_add_f32 v221, v221, v117
    v_mfma_f32_16x16x32_bf16 v[136:139], v[192:195], v[72:75], v[136:139]
    s_waitcnt vmcnt(0)
    ds_write_b32 v250, v236 offset:64
    ds_read_b64_tr_b16 v[172:173], v244 offset:16384
    v_cvt_pk_bf16_f32 v114, v116, v117
    v_add_f32 v221, v221, v118
    v_mfma_f32_16x16x32_bf16 v[152:155], v[192:195], v[88:91], v[152:155]
    ds_read_b64_tr_b16 v[174:175], v244 offset:20480
    v_add_f32 v221, v221, v119
    v_cvt_pk_bf16_f32 v115, v118, v119
    v_mfma_f32_16x16x32_bf16 v[136:139], v[196:199], v[76:79], v[136:139]
    ds_read_b64_tr_b16 v[176:177], v245 offset:16384
    v_exp_f32 v104, v104
    v_mfma_f32_16x16x32_bf16 v[152:155], v[196:199], v[92:95], v[152:155]
    s_waitcnt lgkmcnt(9)
    ds_read_b64_tr_b16 v[178:179], v245 offset:20480
    v_exp_f32 v105, v105
    v_mfma_f32_16x16x32_bf16 v[140:143], v[200:203], v[64:67], v[224:227]
    ds_read_b64_tr_b16 v[180:181], v246 offset:16384
    v_exp_f32 v106, v106
    v_add_f32 v217, v217, v104
    v_mfma_f32_16x16x32_bf16 v[156:159], v[200:203], v[80:83], v[228:231]
    ds_read_b64_tr_b16 v[182:183], v246 offset:20480
    v_exp_f32 v107, v107
    v_mfma_f32_16x16x32_bf16 v[140:143], v[204:207], v[68:71], v[140:143]
    ds_read_b64_tr_b16 v[184:185], v247 offset:16384
    v_add_f32 v217, v217, v105
    v_cvt_pk_bf16_f32 v104, v104, v105
    v_mfma_f32_16x16x32_bf16 v[156:159], v[204:207], v[84:87], v[156:159]
    ds_read_b64_tr_b16 v[186:187], v247 offset:20480
    v_exp_f32 v108, v108
    v_add_f32 v217, v217, v106
    v_mfma_f32_16x16x32_bf16 v[140:143], v[208:211], v[72:75], v[140:143]
    ds_read_b64_tr_b16 v[188:189], v248 offset:16384
    v_exp_f32 v109, v109
    v_mfma_f32_16x16x32_bf16 v[156:159], v[208:211], v[88:91], v[156:159]
    ds_read_b64_tr_b16 v[190:191], v248 offset:20480
    v_add_f32 v217, v217, v107
    v_cvt_pk_bf16_f32 v105, v106, v107
    v_mfma_f32_16x16x32_bf16 v[140:143], v[160:163], v[76:79], v[140:143]
    ds_read_b64_tr_b16 v[192:193], v249 offset:16384
    v_exp_f32 v110, v110
    v_add_f32 v217, v217, v108
    v_mfma_f32_16x16x32_bf16 v[156:159], v[160:163], v[92:95], v[156:159]
    s_waitcnt lgkmcnt(7)
    ds_read_b64_tr_b16 v[194:195], v249 offset:20480
    v_exp_f32 v111, v111
    v_mfma_f32_16x16x32_bf16 v[0:3], v[164:167], v[96:99], v[0:3]
    ds_read_b64_tr_b16 v[196:197], v242 offset:24576
    v_add_f32 v217, v217, v109
    v_cvt_pk_bf16_f32 v106, v108, v109
    v_mfma_f32_16x16x32_bf16 v[32:35], v[164:167], v[112:115], v[32:35]
    ds_read_b64_tr_b16 v[198:199], v242 offset:28672
    v_add_f32 v217, v217, v110
    v_add_f32 v217, v217, v111
    v_cvt_pk_bf16_f32 v107, v110, v111
    v_mfma_f32_16x16x32_bf16 v[4:7], v[168:171], v[96:99], v[4:7]
    ds_read_b64_tr_b16 v[200:201], v243 offset:24576
    v_exp_f32 v120, v120
    v_mfma_f32_16x16x32_bf16 v[36:39], v[168:171], v[112:115], v[36:39]
    ds_read_b64_tr_b16 v[202:203], v243 offset:28672
    v_exp_f32 v121, v121
    v_mfma_f32_16x16x32_bf16 v[8:11], v[172:175], v[96:99], v[8:11]
    ds_read_b64_tr_b16 v[204:205], v244 offset:24576
    v_exp_f32 v122, v122
    v_mfma_f32_16x16x32_bf16 v[40:43], v[172:175], v[112:115], v[40:43]
    ds_read_b64_tr_b16 v[206:207], v244 offset:28672
    v_add_f32 v221, v221, v120
    v_exp_f32 v123, v123
    v_mfma_f32_16x16x32_bf16 v[12:15], v[176:179], v[96:99], v[12:15]
    ds_read_b32 v252, v251 offset:0
    ds_read_b64_tr_b16 v[208:209], v245 offset:24576
    v_add_f32 v221, v221, v121
    v_mfma_f32_16x16x32_bf16 v[44:47], v[176:179], v[112:115], v[44:47]
    s_waitcnt lgkmcnt(8)
    ds_read_b64_tr_b16 v[210:211], v245 offset:28672
    v_cvt_pk_bf16_f32 v120, v120, v121
    v_exp_f32 v124, v124
    v_mfma_f32_16x16x32_bf16 v[16:19], v[180:183], v[96:99], v[16:19]
    ds_read_b64_tr_b16 v[160:161], v246 offset:24576
    v_add_f32 v221, v221, v122
    v_mfma_f32_16x16x32_bf16 v[48:51], v[180:183], v[112:115], v[48:51]
    ds_read_b64_tr_b16 v[162:163], v246 offset:28672
    v_exp_f32 v125, v125
    v_add_f32 v221, v221, v123
    v_mfma_f32_16x16x32_bf16 v[20:23], v[184:187], v[96:99], v[20:23]
    ds_read_b64_tr_b16 v[164:165], v247 offset:24576
    v_cvt_pk_bf16_f32 v121, v122, v123
    v_mfma_f32_16x16x32_bf16 v[52:55], v[184:187], v[112:115], v[52:55]
    ds_read_b64_tr_b16 v[166:167], v247 offset:28672
    v_exp_f32 v126, v126
    v_add_f32 v221, v221, v124
    v_mfma_f32_16x16x32_bf16 v[24:27], v[188:191], v[96:99], v[24:27]
    ds_read_b64_tr_b16 v[168:169], v248 offset:24576
    v_exp_f32 v127, v127
    v_mfma_f32_16x16x32_bf16 v[56:59], v[188:191], v[112:115], v[56:59]
    ds_read_b64_tr_b16 v[170:171], v248 offset:28672
    v_add_f32 v221, v221, v125
    v_cvt_pk_bf16_f32 v122, v124, v125
    v_add_f32 v221, v221, v126
    v_mfma_f32_16x16x32_bf16 v[28:31], v[192:195], v[96:99], v[28:31]
    ds_read_b64_tr_b16 v[172:173], v249 offset:24576
    v_add_f32 v221, v221, v127
    v_cvt_pk_bf16_f32 v123, v126, v127
    v_mfma_f32_16x16x32_bf16 v[60:63], v[192:195], v[112:115], v[60:63]
    s_waitcnt lgkmcnt(7)
    ds_read_b64_tr_b16 v[174:175], v249 offset:28672
    v_mov_b32 v237, 55
    v_cmp_lt_u32 s[56:57], v252, 56
    v_mfma_f32_16x16x32_bf16 v[0:3], v[196:199], v[104:107], v[0:3]
    s_cmp_eq_u64 s[56:57], 0
    s_cbranch_scc0 G0_x44
G0_x44_ret:
    ds_write_b32 v250, v237 offset:16
    ds_read_b128 v[176:179], v238 offset:0
    v_mfma_f32_16x16x32_bf16 v[32:35], v[196:199], v[120:123], v[32:35]
    ds_read_b128 v[180:183], v239 offset:0
    v_max_f32 v234, v128, v129
    v_mfma_f32_16x16x32_bf16 v[4:7], v[200:203], v[104:107], v[4:7]
    v_max_f32 v235, v144, v145
    v_max3_f32 v234, v130, v131, v234
    v_mfma_f32_16x16x32_bf16 v[36:39], v[200:203], v[120:123], v[36:39]
    ds_read_b128 v[184:187], v240 offset:0
    v_max3_f32 v235, v146, v147, v235
    v_mfma_f32_16x16x32_bf16 v[8:11], v[204:207], v[104:107], v[8:11]
    v_max3_f32 v234, v132, v133, v234
    v_max3_f32 v235, v148, v149, v235
    v_mfma_f32_16x16x32_bf16 v[40:43], v[204:207], v[120:123], v[40:43]
    ds_read_b128 v[188:191], v241 offset:0
    v_max3_f32 v234, v134, v135, v234
    v_mfma_f32_16x16x32_bf16 v[12:15], v[208:211], v[104:107], v[12:15]
    v_max3_f32 v235, v150, v151, v235
    v_max3_f32 v234, v136, v137, v234
    v_mfma_f32_16x16x32_bf16 v[44:47], v[208:211], v[120:123], v[44:47]
    s_waitcnt lgkmcnt(5)
    ds_read_b128 v[192:195], v238 offset:4096
    v_mfma_f32_16x16x32_bf16 v[16:19], v[160:163], v[104:107], v[16:19]
    ds_read_b128 v[196:199], v239 offset:4096
    v_max3_f32 v235, v152, v153, v235
    v_mfma_f32_16x16x32_bf16 v[48:51], v[160:163], v[120:123], v[48:51]
    v_max3_f32 v234, v138, v139, v234
    v_max3_f32 v235, v154, v155, v235
    v_mfma_f32_16x16x32_bf16 v[20:23], v[164:167], v[104:107], v[20:23]
    ds_read_b128 v[200:203], v240 offset:4096
    v_max3_f32 v234, v140, v141, v234
    v_mfma_f32_16x16x32_bf16 v[52:55], v[164:167], v[120:123], v[52:55]
    v_max3_f32 v235, v156, v157, v235
    v_max3_f32 v234, v142, v143, v234
    v_mfma_f32_16x16x32_bf16 v[24:27], v[168:171], v[104:107], v[24:27]
    ds_read_b128 v[204:207], v241 offset:4096
    v_max3_f32 v235, v158, v159, v235
    v_mfma_f32_16x16x32_bf16 v[56:59], v[168:171], v[120:123], v[56:59]
    v_max_f32 v236, v234, v235
    v_cmp_lt_f32 vcc, s50, v236
    v_mfma_f32_16x16x32_bf16 v[28:31], v[172:175], v[104:107], v[28:31]
    v_mfma_f32_16x16x32_bf16 v[60:63], v[172:175], v[120:123], v[60:63]
    s_waitcnt lgkmcnt(4)
    s_cbranch_vccnz G0_g10
G0_g10_ret:
    v_mfma_f32_16x16x32_bf16 v[96:99], v[176:179], v[64:67], v[224:227]
    ds_read_b128 v[208:211], v238 offset:8192
    v_exp_f32 v128, v128
    v_mfma_f32_16x16x32_bf16 v[112:115], v[176:179], v[80:83], v[228:231]
    v_exp_f32 v129, v129
    v_exp_f32 v130, v130
    v_mfma_f32_16x16x32_bf16 v[96:99], v[180:183], v[68:71], v[96:99]
    ds_read_b128 v[160:163], v239 offset:8192
    v_add_f32 v217, v217, v128
    v_exp_f32 v131, v131
    v_mfma_f32_16x16x32_bf16 v[112:115], v[180:183], v[84:87], v[112:115]
    v_add_f32 v217, v217, v129
    v_cvt_pk_bf16_f32 v128, v128, v129
    v_exp_f32 v132, v132
    v_mfma_f32_16x16x32_bf16 v[96:99], v[184:187], v[72:75], v[96:99]
    ds_read_b128 v[164:167], v240 offset:8192
    v_add_f32 v217, v217, v130
    v_mfma_f32_16x16x32_bf16 v[112:115], v[184:187], v[88:91], v[112:115]
    v_exp_f32 v133, v133
    v_add_f32 v217, v217, v131
    v_cvt_pk_bf16_f32 v129, v130, v131
    v_mfma_f32_16x16x32_bf16 v[96:99], v[188:191], v[76:79], v[96:99]
    ds_read_b32 v252, v251 offset:0
    ds_read_b128 v[168:171], v241 offset:8192
    v_exp_f32 v134, v134
    v_mfma_f32_16x16x32_bf16 v[112:115], v[188:191], v[92:95], v[112:115]
    s_waitcnt lgkmcnt(5)
    v_add_f32 v217, v217, v132
    v_exp_f32 v135, v135
    v_mfma_f32_16x16x32_bf16 v[100:103], v[192:195], v[64:67], v[224:227]
    ds_read_b128 v[172:175], v238 offset:12288
    v_add_f32 v217, v217, v133
    v_cvt_pk_bf16_f32 v130, v132, v133
    v_add_f32 v217, v217, v134
    v_mfma_f32_16x16x32_bf16 v[116:119], v[192:195], v[80:83], v[228:231]
    v_add_f32 v217, v217, v135
    v_cvt_pk_bf16_f32 v131, v134, v135
    v_exp_f32 v144, v144
    v_mfma_f32_16x16x32_bf16 v[100:103], v[196:199], v[68:71], v[100:103]
    ds_read_b128 v[176:179], v239 offset:12288
    v_exp_f32 v145, v145
    v_mfma_f32_16x16x32_bf16 v[116:119], v[196:199], v[84:87], v[116:119]
    v_exp_f32 v146, v146
    v_add_f32 v221, v221, v144
    v_mfma_f32_16x16x32_bf16 v[100:103], v[200:203], v[72:75], v[100:103]
    ds_read_b128 v[180:183], v240 offset:12288
    v_exp_f32 v147, v147
    v_add_f32 v221, v221, v145
    v_mfma_f32_16x16x32_bf16 v[116:119], v[200:203], v[88:91], v[116:119]
    v_cvt_pk_bf16_f32 v144, v144, v145
    v_exp_f32 v148, v148
    v_mfma_f32_16x16x32_bf16 v[100:103], v[204:207], v[76:79], v[100:103]
    ds_read_b128 v[184:187], v241 offset:12288
    v_add_f32 v221, v221, v146
    v_exp_f32 v149, v149
    v_mfma_f32_16x16x32_bf16 v[116:119], v[204:207], v[92:95], v[116:119]
    s_waitcnt lgkmcnt(4)
    v_add_f32 v221, v221, v147
    v_mov_b32 v237, 56
    v_cmp_lt_u32 s[56:57], v252, 57
    v_mfma_f32_16x16x32_bf16 v[104:107], v[208:211], v[64:67], v[224:227]
    s_cmp_eq_u64 s[56:57], 0
    s_cbranch_scc0 G0_x46
G0_x46_ret:
    ds_write_b32 v250, v237 offset:16
    ds_read_b64_tr_b16 v[188:189], v242 offset:32768
    v_cvt_pk_bf16_f32 v145, v146, v147
    v_mfma_f32_16x16x32_bf16 v[120:123], v[208:211], v[80:83], v[228:231]
    ds_read_b64_tr_b16 v[190:191], v242 offset:36864
    v_exp_f32 v150, v150
    v_mfma_f32_16x16x32_bf16 v[104:107], v[160:163], v[68:71], v[104:107]
    ds_read_b64_tr_b16 v[192:193], v243 offset:32768
    v_add_f32 v221, v221, v148
    v_exp_f32 v151, v151
    v_mfma_f32_16x16x32_bf16 v[120:123], v[160:163], v[84:87], v[120:123]
    ds_read_b64_tr_b16 v[194:195], v243 offset:36864
    v_add_f32 v221, v221, v149
    v_cvt_pk_bf16_f32 v146, v148, v149
    v_mfma_f32_16x16x32_bf16 v[104:107], v[164:167], v[72:75], v[104:107]
    ds_read_b64_tr_b16 v[196:197], v244 offset:32768
    v_add_f32 v221, v221, v150
    v_add_f32 v221, v221, v151
    v_mfma_f32_16x16x32_bf16 v[120:123], v[164:167], v[88:91], v[120:123]
    ds_read_b64_tr_b16 v[198:199], v244 offset:36864
    v_cvt_pk_bf16_f32 v147, v150, v151
    v_exp_f32 v136, v136
    v_mfma_f32_16x16x32_bf16 v[104:107], v[168:171], v[76:79], v[104:107]
    ds_read_b64_tr_b16 v[200:201], v245 offset:32768
    v_exp_f32 v137, v137
    v_mfma_f32_16x16x32_bf16 v[120:123], v[168:171], v[92:95], v[120:123]
    s_waitcnt lgkmcnt(8)
    ds_read_b64_tr_b16 v[202:203], v245 offset:36864
    v_exp_f32 v138, v138
    v_mfma_f32_16x16x32_bf16 v[108:111], v[172:175], v[64:67], v[224:227]
    ds_read_b64_tr_b16 v[204:205], v246 offset:32768
    v_add_f32 v217, v217, v136
    v_mfma_f32_16x16x32_bf16 v[124:127], v[172:175], v[80:83], v[228:231]
    ds_read_b64_tr_b16 v[206:207], v246 offset:36864
    v_exp_f32 v139, v139
    v_add_f32 v217, v217, v137
    v_mfma_f32_16x16x32_bf16 v[108:111], v[176:179], v[68:71], v[108:111]
    ds_read_b64_tr_b16 v[208:209], v247 offset:32768
    v_cvt_pk_bf16_f32 v136, v136, v137
    v_exp_f32 v140, v140
    v_mfma_f32_16x16x32_bf16 v[124:127], v[176:179], v[84:87], v[124:127]
    ds_read_b64_tr_b16 v[210:211], v247 offset:36864
    v_add_f32 v217, v217, v138
    v_mfma_f32_16x16x32_bf16 v[108:111], v[180:183], v[72:75], v[108:111]
    ds_read_b64_tr_b16 v[160:161], v248 offset:32768
    v_exp_f32 v141, v141
    v_mfma_f32_16x16x32_bf16 v[124:127], v[180:183], v[88:91], v[124:127]
    ds_read_b64_tr_b16 v[162:163], v248 offset:36864
    v_add_f32 v217, v217, v139
    v_cvt_pk_bf16_f32 v137, v138, v139
    v_mfma_f32_16x16x32_bf16 v[108:111], v[184:187], v[76:79], v[108:111]
    ds_read_b64_tr_b16 v[164:165], v249 offset:32768
    v_exp_f32 v142, v142
    v_add_f32 v217, v217, v140
    v_mfma_f32_16x16x32_bf16 v[124:127], v[184:187], v[92:95], v[124:127]
    s_waitcnt lgkmcnt(7)
    ds_read_b64_tr_b16 v[166:167], v249 offset:36864
    v_exp_f32 v143, v143
    v_mfma_f32_16x16x32_bf16 v[0:3], v[188:191], v[128:131], v[0:3]
    ds_read_b64_tr_b16 v[168:169], v242 offset:40960
    v_add_f32 v217, v217, v141
    v_cvt_pk_bf16_f32 v138, v140, v141
    v_mfma_f32_16x16x32_bf16 v[32:35], v[188:191], v[144:147], v[32:35]
    ds_read_b64_tr_b16 v[170:171], v242 offset:45056
    v_add_f32 v217, v217, v142
    v_add_f32 v217, v217, v143
    v_cvt_pk_bf16_f32 v139, v142, v143
    v_mfma_f32_16x16x32_bf16 v[4:7], v[192:195], v[128:131], v[4:7]
    ds_read_b64_tr_b16 v[172:173], v243 offset:40960
    v_exp_f32 v152, v152
    v_mfma_f32_16x16x32_bf16 v[36:39], v[192:195], v[144:147], v[36:39]
    ds_read_b64_tr_b16 v[174:175], v243 offset:45056
    v_exp_f32 v153, v153
    v_mfma_f32_16x16x32_bf16 v[8:11], v[196:199], v[128:131], v[8:11]
    ds_read_b64_tr_b16 v[176:177], v244 offset:40960
    v_exp_f32 v154, v154
    v_mfma_f32_16x16x32_bf16 v[40:43], v[196:199], v[144:147], v[40:43]
    ds_read_b64_tr_b16 v[178:179], v244 offset:45056
    v_add_f32 v221, v221, v152
    v_exp_f32 v155, v155
    v_mfma_f32_16x16x32_bf16 v[12:15], v[200:203], v[128:131], v[12:15]
    ds_read_b32 v252, v251 offset:0
    ds_read_b64_tr_b16 v[180:181], v245 offset:40960
    v_add_f32 v221, v221, v153
    v_mfma_f32_16x16x32_bf16 v[44:47], v[200:203], v[144:147], v[44:47]
    s_waitcnt lgkmcnt(8)
    ds_read_b64_tr_b16 v[182:183], v245 offset:45056
    v_cvt_pk_bf16_f32 v152, v152, v153
    v_exp_f32 v156, v156
    v_mfma_f32_16x16x32_bf16 v[16:19], v[204:207], v[128:131], v[16:19]
    ds_read_b64_tr_b16 v[184:185], v246 offset:40960
    v_add_f32 v221, v221, v154
    v_mfma_f32_16x16x32_bf16 v[48:51], v[204:207], v[144:147], v[48:51]
    ds_read_b64_tr_b16 v[186:187], v246 offset:45056
    v_exp_f32 v157, v157
    v_add_f32 v221, v221, v155
    v_mfma_f32_16x16x32_bf16 v[20:23], v[208:211], v[128:131], v[20:23]
    ds_read_b64_tr_b16 v[188:189], v247 offset:40960
    v_cvt_pk_bf16_f32 v153, v154, v155
    v_mfma_f32_16x16x32_bf16 v[52:55], v[208:211], v[144:147], v[52:55]
    ds_read_b64_tr_b16 v[190:191], v247 offset:45056
    v_exp_f32 v158, v158
    v_add_f32 v221, v221, v156
    v_mfma_f32_16x16x32_bf16 v[24:27], v[160:163], v[128:131], v[24:27]
    ds_read_b64_tr_b16 v[192:193], v248 offset:40960
    v_exp_f32 v159, v159
    v_mfma_f32_16x16x32_bf16 v[56:59], v[160:163], v[144:147], v[56:59]
    ds_read_b64_tr_b16 v[194:195], v248 offset:45056
    v_add_f32 v221, v221, v157
    v_cvt_pk_bf16_f32 v154, v156, v157
    v_add_f32 v221, v221, v158
    v_mfma_f32_16x16x32_bf16 v[28:31], v[164:167], v[128:131], v[28:31]
    ds_read_b64_tr_b16 v[196:197], v249 offset:40960
    v_add_f32 v221, v221, v159
    v_cvt_pk_bf16_f32 v155, v158, v159
    v_mfma_f32_16x16x32_bf16 v[60:63], v[164:167], v[144:147], v[60:63]
    s_waitcnt lgkmcnt(7)
    ds_read_b64_tr_b16 v[198:199], v249 offset:45056
    v_mov_b32 v237, 57
    v_cmp_lt_u32 s[56:57], v252, 58
    v_mfma_f32_16x16x32_bf16 v[0:3], v[168:171], v[136:139], v[0:3]
    s_cmp_eq_u64 s[56:57], 0
    s_cbranch_scc0 G0_x48
G0_x48_ret:
    ds_write_b32 v250, v237 offset:16
    ds_read_b128 v[200:203], v238 offset:16384
    v_mfma_f32_16x16x32_bf16 v[32:35], v[168:171], v[152:155], v[32:35]
    ds_read_b128 v[204:207], v239 offset:16384
    v_max_f32 v234, v96, v97
    v_mfma_f32_16x16x32_bf16 v[4:7], v[172:175], v[136:139], v[4:7]
    v_max_f32 v235, v112, v113
    v_max3_f32 v234, v98, v99, v234
    v_mfma_f32_16x16x32_bf16 v[36:39], v[172:175], v[152:155], v[36:39]
    ds_read_b128 v[208:211], v240 offset:16384
    v_max3_f32 v235, v114, v115, v235
    v_mfma_f32_16x16x32_bf16 v[8:11], v[176:179], v[136:139], v[8:11]
    v_max3_f32 v234, v100, v101, v234
    v_max3_f32 v235, v116, v117, v235
    v_mfma_f32_16x16x32_bf16 v[40:43], v[176:179], v[152:155], v[40:43]
    ds_read_b128 v[160:163], v241 offset:16384
    v_max3_f32 v234, v102, v103, v234
    v_mfma_f32_16x16x32_bf16 v[12:15], v[180:183], v[136:139], v[12:15]
    v_max3_f32 v235, v118, v119, v235
    v_max3_f32 v234, v104, v105, v234
    v_mfma_f32_16x16x32_bf16 v[44:47], v[180:183], v[152:155], v[44:47]
    s_waitcnt lgkmcnt(5)
    ds_read_b128 v[164:167], v238 offset:20480
    v_mfma_f32_16x16x32_bf16 v[16:19], v[184:187], v[136:139], v[16:19]
    ds_read_b128 v[168:171], v239 offset:20480
    v_max3_f32 v235, v120, v121, v235
    v_mfma_f32_16x16x32_bf16 v[48:51], v[184:187], v[152:155], v[48:51]
    v_max3_f32 v234, v106, v107, v234
    v_max3_f32 v235, v122, v123, v235
    v_mfma_f32_16x16x32_bf16 v[20:23], v[188:191], v[136:139], v[20:23]
    ds_read_b128 v[172:175], v240 offset:20480
    v_max3_f32 v234, v108, v109, v234
    v_mfma_f32_16x16x32_bf16 v[52:55], v[188:191], v[152:155], v[52:55]
    v_max3_f32 v235, v124, v125, v235
    v_max3_f32 v234, v110, v111, v234
    v_mfma_f32_16x16x32_bf16 v[24:27], v[192:195], v[136:139], v[24:27]
    ds_read_b128 v[176:179], v241 offset:20480
    v_max3_f32 v235, v126, v127, v235
    v_mfma_f32_16x16x32_bf16 v[56:59], v[192:195], v[152:155], v[56:59]
    v_max_f32 v236, v234, v235
    v_cmp_lt_f32 vcc, s50, v236
    v_mfma_f32_16x16x32_bf16 v[28:31], v[196:199], v[136:139], v[28:31]
    v_mfma_f32_16x16x32_bf16 v[60:63], v[196:199], v[152:155], v[60:63]
    s_waitcnt lgkmcnt(4)
    s_cbranch_vccnz G0_g11
G0_g11_ret:
    v_mfma_f32_16x16x32_bf16 v[128:131], v[200:203], v[64:67], v[224:227]
    ds_read_b128 v[180:183], v238 offset:24576
    v_exp_f32 v96, v96
    v_mfma_f32_16x16x32_bf16 v[144:147], v[200:203], v[80:83], v[228:231]
    v_exp_f32 v97, v97
    v_exp_f32 v98, v98
    v_mfma_f32_16x16x32_bf16 v[128:131], v[204:207], v[68:71], v[128:131]
    ds_read_b128 v[184:187], v239 offset:24576
    v_add_f32 v217, v217, v96
    v_exp_f32 v99, v99
    v_mfma_f32_16x16x32_bf16 v[144:147], v[204:207], v[84:87], v[144:147]
    v_add_f32 v217, v217, v97
    v_cvt_pk_bf16_f32 v96, v96, v97
    v_exp_f32 v100, v100
    v_mfma_f32_16x16x32_bf16 v[128:131], v[208:211], v[72:75], v[128:131]
    ds_read_b128 v[188:191], v240 offset:24576
    v_add_f32 v217, v217, v98
    v_mfma_f32_16x16x32_bf16 v[144:147], v[208:211], v[88:91], v[144:147]
    v_exp_f32 v101, v101
    v_add_f32 v217, v217, v99
    v_cvt_pk_bf16_f32 v97, v98, v99
    v_mfma_f32_16x16x32_bf16 v[128:131], v[160:163], v[76:79], v[128:131]
    ds_read_b32 v252, v251 offset:0
    ds_read_b128 v[192:195], v241 offset:24576
    v_exp_f32 v102, v102
    v_mfma_f32_16x16x32_bf16 v[144:147], v[160:163], v[92:95], v[144:147]
    s_waitcnt lgkmcnt(5)
    v_add_f32 v217, v217, v100
    v_exp_f32 v103, v103
    v_mfma_f32_16x16x32_bf16 v[132:135], v[164:167], v[64:67], v[224:227]
    ds_read_b128 v[196:199], v238 offset:28672
    v_add_f32 v217, v217, v101
    v_cvt_pk_bf16_f32 v98, v100, v101
    v_add_f32 v217, v217, v102
    v_mfma_f32_16x16x32_bf16 v[148:151], v[164:167], v[80:83], v[228:231]
    v_add_f32 v217, v217, v103
    v_cvt_pk_bf16_f32 v99, v102, v103
    v_exp_f32 v112, v112
    v_mfma_f32_16x16x32_bf16 v[132:135], v[168:171], v[68:71], v[132:135]
    ds_read_b128 v[200:203], v239 offset:28672
    v_exp_f32 v113, v113
    v_mfma_f32_16x16x32_bf16 v[148:151], v[168:171], v[84:87], v[148:151]
    v_exp_f32 v114, v114
    v_add_f32 v221, v221, v112
    v_mfma_f32_16x16x32_bf16 v[132:135], v[172:175], v[72:75], v[132:135]
    ds_read_b128 v[204:207], v240 offset:28672
    v_exp_f32 v115, v115
    v_add_f32 v221, v221, v113
    v_mfma_f32_16x16x32_bf16 v[148:151], v[172:175], v[88:91], v[148:151]
    v_cvt_pk_bf16_f32 v112, v112, v113
    v_exp_f32 v116, v116
    v_mfma_f32_16x16x32_bf16 v[132:135], v[176:179], v[76:79], v[132:135]
    ds_read_b128 v[208:211], v241 offset:28672
    v_add_f32 v221, v221, v114
    v_exp_f32 v117, v117
    v_mfma_f32_16x16x32_bf16 v[148:151], v[176:179], v[92:95], v[148:151]
    s_waitcnt lgkmcnt(4)
    v_add_f32 v221, v221, v115
    v_mov_b32 v237, 58
    v_cmp_lt_u32 s[56:57], v252, 59
    v_mfma_f32_16x16x32_bf16 v[136:139], v[180:183], v[64:67], v[224:227]
    s_cmp_eq_u64 s[56:57], 0
    s_cbranch_scc0 G0_x50
G0_x50_ret:
    ds_write_b32 v250, v237 offset:16
    ds_read_b64_tr_b16 v[160:161], v242 offset:0
    v_cvt_pk_bf16_f32 v113, v114, v115
    v_mfma_f32_16x16x32_bf16 v[152:155], v[180:183], v[80:83], v[228:231]
    ds_read_b64_tr_b16 v[162:163], v242 offset:4096
    v_exp_f32 v118, v118
    v_mfma_f32_16x16x32_bf16 v[136:139], v[184:187], v[68:71], v[136:139]
    ds_read_b64_tr_b16 v[164:165], v243 offset:0
    v_add_f32 v221, v221, v116
    v_exp_f32 v119, v119
    v_mfma_f32_16x16x32_bf16 v[152:155], v[184:187], v[84:87], v[152:155]
    ds_read_b64_tr_b16 v[166:167], v243 offset:4096
    v_add_f32 v221, v221, v117
    v_cvt_pk_bf16_f32 v114, v116, v117
    v_mfma_f32_16x16x32_bf16 v[136:139], v[188:191], v[72:75], v[136:139]
    ds_read_b64_tr_b16 v[168:169], v244 offset:0
    v_add_f32 v221, v221, v118
    v_add_f32 v221, v221, v119
    v_mfma_f32_16x16x32_bf16 v[152:155], v[188:191], v[88:91], v[152:155]
    ds_read_b64_tr_b16 v[170:171], v244 offset:4096
    v_cvt_pk_bf16_f32 v115, v118, v119
    v_exp_f32 v104, v104
    v_mfma_f32_16x16x32_bf16 v[136:139], v[192:195], v[76:79], v[136:139]
    ds_read_b64_tr_b16 v[172:173], v245 offset:0
    v_exp_f32 v105, v105
    v_mfma_f32_16x16x32_bf16 v[152:155], v[192:195], v[92:95], v[152:155]
    s_waitcnt lgkmcnt(8)
    ds_read_b64_tr_b16 v[174:175], v245 offset:4096
    v_exp_f32 v106, v106
    v_mfma_f32_16x16x32_bf16 v[140:143], v[196:199], v[64:67], v[224:227]
    ds_read_b64_tr_b16 v[176:177], v246 offset:0
    v_add_f32 v217, v217, v104
    v_mfma_f32_16x16x32_bf16 v[156:159], v[196:199], v[80:83], v[228:231]
    ds_read_b64_tr_b16 v[178:179], v246 offset:4096
    v_exp_f32 v107, v107
    v_add_f32 v217, v217, v105
    v_mfma_f32_16x16x32_bf16 v[140:143], v[200:203], v[68:71], v[140:143]
    ds_read_b64_tr_b16 v[180:181], v247 offset:0
    v_cvt_pk_bf16_f32 v104, v104, v105
    v_exp_f32 v108, v108
    v_mfma_f32_16x16x32_bf16 v[156:159], v[200:203], v[84:87], v[156:159]
    ds_read_b64_tr_b16 v[182:183], v247 offset:4096
    v_add_f32 v217, v217, v106
    v_mfma_f32_16x16x32_bf16 v[140:143], v[204:207], v[72:75], v[140:143]
    ds_read_b64_tr_b16 v[184:185], v248 offset:0
    v_exp_f32 v109, v109
    v_mfma_f32_16x16x32_bf16 v[156:159], v[204:207], v[88:91], v[156:159]
    ds_read_b64_tr_b16 v[186:187], v248 offset:4096
    v_add_f32 v217, v217, v107
    v_cvt_pk_bf16_f32 v105, v106, v107
    v_mfma_f32_16x16x32_bf16 v[140:143], v[208:211], v[76:79], v[140:143]
    ds_read_b64_tr_b16 v[188:189], v249 offset:0
    v_exp_f32 v110, v110
    v_add_f32 v217, v217, v108
    v_mfma_f32_16x16x32_bf16 v[156:159], v[208:211], v[92:95], v[156:159]
    s_waitcnt lgkmcnt(7)
    ds_read_b64_tr_b16 v[190:191], v249 offset:4096
    v_exp_f32 v111, v111
    v_mfma_f32_16x16x32_bf16 v[0:3], v[160:163], v[96:99], v[0:3]
    ds_read_b64_tr_b16 v[192:193], v242 offset:8192
    v_add_f32 v217, v217, v109
    v_cvt_pk_bf16_f32 v106, v108, v109
    v_mfma_f32_16x16x32_bf16 v[32:35], v[160:163], v[112:115], v[32:35]
    ds_read_b64_tr_b16 v[194:195], v242 offset:12288
    v_add_f32 v217, v217, v110
    v_add_f32 v217, v217, v111
    v_cvt_pk_bf16_f32 v107, v110, v111
    v_mfma_f32_16x16x32_bf16 v[4:7], v[164:167], v[96:99], v[4:7]
    ds_read_b64_tr_b16 v[196:197], v243 offset:8192
    v_exp_f32 v120, v120
    v_mfma_f32_16x16x32_bf16 v[36:39], v[164:167], v[112:115], v[36:39]
    ds_read_b64_tr_b16 v[198:199], v243 offset:12288
    v_exp_f32 v121, v121
    v_mfma_f32_16x16x32_bf16 v[8:11], v[168:171], v[96:99], v[8:11]
    ds_read_b64_tr_b16 v[200:201], v244 offset:8192
    v_exp_f32 v122, v122
    v_mfma_f32_16x16x32_bf16 v[40:43], v[168:171], v[112:115], v[40:43]
    ds_read_b64_tr_b16 v[202:203], v244 offset:12288
    v_add_f32 v221, v221, v120
    v_exp_f32 v123, v123
    v_mfma_f32_16x16x32_bf16 v[12:15], v[172:175], v[96:99], v[12:15]
    ds_read_b32 v252, v251 offset:0
    ds_read_b64_tr_b16 v[204:205], v245 offset:8192
    v_add_f32 v221, v221, v121
    v_mfma_f32_16x16x32_bf16 v[44:47], v[172:175], v[112:115], v[44:47]
    s_waitcnt lgkmcnt(8)
    ds_read_b64_tr_b16 v[206:207], v245 offset:12288
    v_cvt_pk_bf16_f32 v120, v120, v121
    v_exp_f32 v124, v124
    v_mfma_f32_16x16x32_bf16 v[16:19], v[176:179], v[96:99], v[16:19]
    ds_read_b64_tr_b16 v[208:209], v246 offset:8192
    v_add_f32 v221, v221, v122
    v_mfma_f32_16x16x32_bf16 v[48:51], v[176:179], v[112:115], v[48:51]
    ds_read_b64_tr_b16 v[210:211], v246 offset:12288
    v_exp_f32 v125, v125
    v_add_f32 v221, v221, v123
    v_mfma_f32_16x16x32_bf16 v[20:23], v[180:183], v[96:99], v[20:23]
    ds_read_b64_tr_b16 v[160:161], v247 offset:8192
    v_cvt_pk_bf16_f32 v121, v122, v123
    v_mfma_f32_16x16x32_bf16 v[52:55], v[180:183], v[112:115], v[52:55]
    ds_read_b64_tr_b16 v[162:163], v247 offset:12288
    v_exp_f32 v126, v126
    v_add_f32 v221, v221, v124
    v_mfma_f32_16x16x32_bf16 v[24:27], v[184:187], v[96:99], v[24:27]
    ds_read_b64_tr_b16 v[164:165], v248 offset:8192
    v_exp_f32 v127, v127
    v_mfma_f32_16x16x32_bf16 v[56:59], v[184:187], v[112:115], v[56:59]
    ds_read_b64_tr_b16 v[166:167], v248 offset:12288
    v_add_f32 v221, v221, v125
    v_cvt_pk_bf16_f32 v122, v124, v125
    v_add_f32 v221, v221, v126
    v_mfma_f32_16x16x32_bf16 v[28:31], v[188:191], v[96:99], v[28:31]
    ds_read_b64_tr_b16 v[168:169], v249 offset:8192
    v_add_f32 v221, v221, v127
    v_cvt_pk_bf16_f32 v123, v126, v127
    v_mfma_f32_16x16x32_bf16 v[60:63], v[188:191], v[112:115], v[60:63]
    s_waitcnt lgkmcnt(7)
    ds_read_b64_tr_b16 v[170:171], v249 offset:12288
    v_mov_b32 v237, 59
    v_cmp_lt_u32 s[56:57], v252, 60
    v_mfma_f32_16x16x32_bf16 v[0:3], v[192:195], v[104:107], v[0:3]
    s_cmp_eq_u64 s[56:57], 0
    s_cbranch_scc0 G0_x52
G0_x52_ret:
    ds_write_b32 v250, v237 offset:16
    ds_read_b128 v[172:175], v238 offset:32768
    v_mfma_f32_16x16x32_bf16 v[32:35], v[192:195], v[120:123], v[32:35]
    ds_read_b128 v[176:179], v239 offset:32768
    v_max_f32 v234, v128, v129
    v_mfma_f32_16x16x32_bf16 v[4:7], v[196:199], v[104:107], v[4:7]
    v_max_f32 v235, v144, v145
    v_max3_f32 v234, v130, v131, v234
    v_mfma_f32_16x16x32_bf16 v[36:39], v[196:199], v[120:123], v[36:39]
    ds_read_b128 v[180:183], v240 offset:32768
    v_max3_f32 v235, v146, v147, v235
    v_mfma_f32_16x16x32_bf16 v[8:11], v[200:203], v[104:107], v[8:11]
    v_max3_f32 v234, v132, v133, v234
    v_max3_f32 v235, v148, v149, v235
    v_mfma_f32_16x16x32_bf16 v[40:43], v[200:203], v[120:123], v[40:43]
    ds_read_b128 v[184:187], v241 offset:32768
    v_max3_f32 v234, v134, v135, v234
    v_mfma_f32_16x16x32_bf16 v[12:15], v[204:207], v[104:107], v[12:15]
    v_max3_f32 v235, v150, v151, v235
    v_max3_f32 v234, v136, v137, v234
    v_mfma_f32_16x16x32_bf16 v[44:47], v[204:207], v[120:123], v[44:47]
    s_waitcnt lgkmcnt(5)
    ds_read_b128 v[188:191], v238 offset:36864
    v_mfma_f32_16x16x32_bf16 v[16:19], v[208:211], v[104:107], v[16:19]
    ds_read_b128 v[192:195], v239 offset:36864
    v_max3_f32 v235, v152, v153, v235
    v_mfma_f32_16x16x32_bf16 v[48:51], v[208:211], v[120:123], v[48:51]
    v_max3_f32 v234, v138, v139, v234
    v_max3_f32 v235, v154, v155, v235
    v_mfma_f32_16x16x32_bf16 v[20:23], v[160:163], v[104:107], v[20:23]
    ds_read_b128 v[196:199], v240 offset:36864
    v_max3_f32 v234, v140, v141, v234
    v_mfma_f32_16x16x32_bf16 v[52:55], v[160:163], v[120:123], v[52:55]
    v_max3_f32 v235, v156, v157, v235
    v_max3_f32 v234, v142, v143, v234
    v_mfma_f32_16x16x32_bf16 v[24:27], v[164:167], v[104:107], v[24:27]
    ds_read_b128 v[200:203], v241 offset:36864
    v_max3_f32 v235, v158, v159, v235
    v_mfma_f32_16x16x32_bf16 v[56:59], v[164:167], v[120:123], v[56:59]
    v_max_f32 v236, v234, v235
    v_cmp_lt_f32 vcc, s50, v236
    v_mfma_f32_16x16x32_bf16 v[28:31], v[168:171], v[104:107], v[28:31]
    v_mfma_f32_16x16x32_bf16 v[60:63], v[168:171], v[120:123], v[60:63]
    s_waitcnt lgkmcnt(4)
    s_cbranch_vccnz G0_g12
G0_g12_ret:
    v_mfma_f32_16x16x32_bf16 v[96:99], v[172:175], v[64:67], v[224:227]
    ds_read_b128 v[204:207], v238 offset:40960
    v_exp_f32 v128, v128
    v_mfma_f32_16x16x32_bf16 v[112:115], v[172:175], v[80:83], v[228:231]
    v_exp_f32 v129, v129
    v_exp_f32 v130, v130
    v_mfma_f32_16x16x32_bf16 v[96:99], v[176:179], v[68:71], v[96:99]
    ds_read_b128 v[208:211], v239 offset:40960
    v_add_f32 v217, v217, v128
    v_exp_f32 v131, v131
    v_mfma_f32_16x16x32_bf16 v[112:115], v[176:179], v[84:87], v[112:115]
    v_add_f32 v217, v217, v129
    v_cvt_pk_bf16_f32 v128, v128, v129
    v_exp_f32 v132, v132
    v_mfma_f32_16x16x32_bf16 v[96:99], v[180:183], v[72:75], v[96:99]
    ds_read_b128 v[160:163], v240 offset:40960
    v_add_f32 v217, v217, v130
    v_mfma_f32_16x16x32_bf16 v[112:115], v[180:183], v[88:91], v[112:115]
    v_exp_f32 v133, v133
    v_add_f32 v217, v217, v131
    v_cvt_pk_bf16_f32 v129, v130, v131
    v_mfma_f32_16x16x32_bf16 v[96:99], v[184:187], v[76:79], v[96:99]
    ds_read_b32 v252, v251 offset:0
    ds_read_b128 v[164:167], v241 offset:40960
    v_exp_f32 v134, v134
    v_mfma_f32_16x16x32_bf16 v[112:115], v[184:187], v[92:95], v[112:115]
    s_waitcnt lgkmcnt(5)
    v_add_f32 v217, v217, v132
    v_exp_f32 v135, v135
    v_mfma_f32_16x16x32_bf16 v[100:103], v[188:191], v[64:67], v[224:227]
    ds_read_b128 v[168:171], v238 offset:45056
    v_add_f32 v217, v217, v133
    v_cvt_pk_bf16_f32 v130, v132, v133
    v_add_f32 v217, v217, v134
    v_mfma_f32_16x16x32_bf16 v[116:119], v[188:191], v[80:83], v[228:231]
    v_add_f32 v217, v217, v135
    v_cvt_pk_bf16_f32 v131, v134, v135
    v_exp_f32 v144, v144
    v_mfma_f32_16x16x32_bf16 v[100:103], v[192:195], v[68:71], v[100:103]
    ds_read_b128 v[172:175], v239 offset:45056
    v_exp_f32 v145, v145
    v_mfma_f32_16x16x32_bf16 v[116:119], v[192:195], v[84:87], v[116:119]
    v_exp_f32 v146, v146
    v_add_f32 v221, v221, v144
    v_mfma_f32_16x16x32_bf16 v[100:103], v[196:199], v[72:75], v[100:103]
    ds_read_b128 v[176:179], v240 offset:45056
    v_exp_f32 v147, v147
    v_add_f32 v221, v221, v145
    v_mfma_f32_16x16x32_bf16 v[116:119], v[196:199], v[88:91], v[116:119]
    v_cvt_pk_bf16_f32 v144, v144, v145
    v_exp_f32 v148, v148
    v_mfma_f32_16x16x32_bf16 v[100:103], v[200:203], v[76:79], v[100:103]
    ds_read_b128 v[180:183], v241 offset:45056
    v_add_f32 v221, v221, v146
    v_exp_f32 v149, v149
    v_mfma_f32_16x16x32_bf16 v[116:119], v[200:203], v[92:95], v[116:119]
    s_waitcnt lgkmcnt(4)
    v_add_f32 v221, v221, v147
    v_mov_b32 v237, 60
    v_cmp_lt_u32 s[56:57], v252, 61
    v_mfma_f32_16x16x32_bf16 v[104:107], v[204:207], v[64:67], v[224:227]
    s_cmp_eq_u64 s[56:57], 0
    s_cbranch_scc0 G0_x54
G0_x54_ret:
    ds_write_b32 v250, v237 offset:16
    ds_read_b64_tr_b16 v[184:185], v242 offset:16384
    v_cvt_pk_bf16_f32 v145, v146, v147
    v_mfma_f32_16x16x32_bf16 v[120:123], v[204:207], v[80:83], v[228:231]
    ds_read_b64_tr_b16 v[186:187], v242 offset:20480
    v_exp_f32 v150, v150
    v_mfma_f32_16x16x32_bf16 v[104:107], v[208:211], v[68:71], v[104:107]
    ds_read_b64_tr_b16 v[188:189], v243 offset:16384
    v_add_f32 v221, v221, v148
    v_exp_f32 v151, v151
    v_mfma_f32_16x16x32_bf16 v[120:123], v[208:211], v[84:87], v[120:123]
    ds_read_b64_tr_b16 v[190:191], v243 offset:20480
    v_add_f32 v221, v221, v149
    v_cvt_pk_bf16_f32 v146, v148, v149
    v_mfma_f32_16x16x32_bf16 v[104:107], v[160:163], v[72:75], v[104:107]
    ds_read_b64_tr_b16 v[192:193], v244 offset:16384
    v_add_f32 v221, v221, v150
    v_add_f32 v221, v221, v151
    v_mfma_f32_16x16x32_bf16 v[120:123], v[160:163], v[88:91], v[120:123]
    ds_read_b64_tr_b16 v[194:195], v244 offset:20480
    v_cvt_pk_bf16_f32 v147, v150, v151
    v_exp_f32 v136, v136
    v_mfma_f32_16x16x32_bf16 v[104:107], v[164:167], v[76:79], v[104:107]
    ds_read_b64_tr_b16 v[196:197], v245 offset:16384
    v_exp_f32 v137, v137
    v_mfma_f32_16x16x32_bf16 v[120:123], v[164:167], v[92:95], v[120:123]
    s_waitcnt lgkmcnt(8)
    ds_read_b64_tr_b16 v[198:199], v245 offset:20480
    v_exp_f32 v138, v138
    v_mfma_f32_16x16x32_bf16 v[108:111], v[168:171], v[64:67], v[224:227]
    ds_read_b64_tr_b16 v[200:201], v246 offset:16384
    v_add_f32 v217, v217, v136
    v_mfma_f32_16x16x32_bf16 v[124:127], v[168:171], v[80:83], v[228:231]
    ds_read_b64_tr_b16 v[202:203], v246 offset:20480
    v_exp_f32 v139, v139
    v_add_f32 v217, v217, v137
    v_mfma_f32_16x16x32_bf16 v[108:111], v[172:175], v[68:71], v[108:111]
    ds_read_b64_tr_b16 v[204:205], v247 offset:16384
    v_cvt_pk_bf16_f32 v136, v136, v137
    v_exp_f32 v140, v140
    v_mfma_f32_16x16x32_bf16 v[124:127], v[172:175], v[84:87], v[124:127]
    ds_read_b64_tr_b16 v[206:207], v247 offset:20480
    v_add_f32 v217, v217, v138
    v_mfma_f32_16x16x32_bf16 v[108:111], v[176:179], v[72:75], v[108:111]
    ds_read_b64_tr_b16 v[208:209], v248 offset:16384
    v_exp_f32 v141, v141
    v_mfma_f32_16x16x32_bf16 v[124:127], v[176:179], v[88:91], v[124:127]
    ds_read_b64_tr_b16 v[210:211], v248 offset:20480
    v_add_f32 v217, v217, v139
    v_cvt_pk_bf16_f32 v137, v138, v139
    v_mfma_f32_16x16x32_bf16 v[108:111], v[180:183], v[76:79], v[108:111]
    ds_read_b64_tr_b16 v[160:161], v249 offset:16384
    v_exp_f32 v142, v142
    v_add_f32 v217, v217, v140
    v_mfma_f32_16x16x32_bf16 v[124:127], v[180:183], v[92:95], v[124:127]
    s_waitcnt lgkmcnt(7)
    ds_read_b64_tr_b16 v[162:163], v249 offset:20480
    v_exp_f32 v143, v143
    v_mfma_f32_16x16x32_bf16 v[0:3], v[184:187], v[128:131], v[0:3]
    ds_read_b64_tr_b16 v[164:165], v242 offset:24576
    v_add_f32 v217, v217, v141
    v_cvt_pk_bf16_f32 v138, v140, v141
    v_mfma_f32_16x16x32_bf16 v[32:35], v[184:187], v[144:147], v[32:35]
    ds_read_b64_tr_b16 v[166:167], v242 offset:28672
    v_add_f32 v217, v217, v142
    v_add_f32 v217, v217, v143
    v_cvt_pk_bf16_f32 v139, v142, v143
    v_mfma_f32_16x16x32_bf16 v[4:7], v[188:191], v[128:131], v[4:7]
    ds_read_b64_tr_b16 v[168:169], v243 offset:24576
    v_exp_f32 v152, v152
    v_mfma_f32_16x16x32_bf16 v[36:39], v[188:191], v[144:147], v[36:39]
    ds_read_b64_tr_b16 v[170:171], v243 offset:28672
    v_exp_f32 v153, v153
    v_mfma_f32_16x16x32_bf16 v[8:11], v[192:195], v[128:131], v[8:11]
    ds_read_b64_tr_b16 v[172:173], v244 offset:24576
    v_exp_f32 v154, v154
    v_mfma_f32_16x16x32_bf16 v[40:43], v[192:195], v[144:147], v[40:43]
    ds_read_b64_tr_b16 v[174:175], v244 offset:28672
    v_add_f32 v221, v221, v152
    v_exp_f32 v155, v155
    v_mfma_f32_16x16x32_bf16 v[12:15], v[196:199], v[128:131], v[12:15]
    ds_read_b32 v252, v251 offset:0
    ds_read_b64_tr_b16 v[176:177], v245 offset:24576
    v_add_f32 v221, v221, v153
    v_mfma_f32_16x16x32_bf16 v[44:47], v[196:199], v[144:147], v[44:47]
    s_waitcnt lgkmcnt(8)
    ds_read_b64_tr_b16 v[178:179], v245 offset:28672
    v_cvt_pk_bf16_f32 v152, v152, v153
    v_exp_f32 v156, v156
    v_mfma_f32_16x16x32_bf16 v[16:19], v[200:203], v[128:131], v[16:19]
    ds_read_b64_tr_b16 v[180:181], v246 offset:24576
    v_add_f32 v221, v221, v154
    v_mfma_f32_16x16x32_bf16 v[48:51], v[200:203], v[144:147], v[48:51]
    ds_read_b64_tr_b16 v[182:183], v246 offset:28672
    v_exp_f32 v157, v157
    v_add_f32 v221, v221, v155
    v_mfma_f32_16x16x32_bf16 v[20:23], v[204:207], v[128:131], v[20:23]
    ds_read_b64_tr_b16 v[184:185], v247 offset:24576
    v_cvt_pk_bf16_f32 v153, v154, v155
    v_mfma_f32_16x16x32_bf16 v[52:55], v[204:207], v[144:147], v[52:55]
    ds_read_b64_tr_b16 v[186:187], v247 offset:28672
    v_exp_f32 v158, v158
    v_add_f32 v221, v221, v156
    v_mfma_f32_16x16x32_bf16 v[24:27], v[208:211], v[128:131], v[24:27]
    ds_read_b64_tr_b16 v[188:189], v248 offset:24576
    v_exp_f32 v159, v159
    v_mfma_f32_16x16x32_bf16 v[56:59], v[208:211], v[144:147], v[56:59]
    ds_read_b64_tr_b16 v[190:191], v248 offset:28672
    v_add_f32 v221, v221, v157
    v_cvt_pk_bf16_f32 v154, v156, v157
    v_add_f32 v221, v221, v158
    v_mfma_f32_16x16x32_bf16 v[28:31], v[160:163], v[128:131], v[28:31]
    ds_read_b64_tr_b16 v[192:193], v249 offset:24576
    v_add_f32 v221, v221, v159
    v_cvt_pk_bf16_f32 v155, v158, v159
    v_mfma_f32_16x16x32_bf16 v[60:63], v[160:163], v[144:147], v[60:63]
    s_waitcnt lgkmcnt(7)
    ds_read_b64_tr_b16 v[194:195], v249 offset:28672
    v_mov_b32 v237, 61
    v_cmp_lt_u32 s[56:57], v252, 62
    v_mfma_f32_16x16x32_bf16 v[0:3], v[164:167], v[136:139], v[0:3]
    s_cmp_eq_u64 s[56:57], 0
    s_cbranch_scc0 G0_x56
G0_x56_ret:
    ds_write_b32 v250, v237 offset:16
    ds_read_b128 v[196:199], v238 offset:0
    v_mfma_f32_16x16x32_bf16 v[32:35], v[164:167], v[152:155], v[32:35]
    ds_read_b128 v[200:203], v239 offset:0
    v_max_f32 v234, v96, v97
    v_mfma_f32_16x16x32_bf16 v[4:7], v[168:171], v[136:139], v[4:7]
    v_max_f32 v235, v112, v113
    v_max3_f32 v234, v98, v99, v234
    v_mfma_f32_16x16x32_bf16 v[36:39], v[168:171], v[152:155], v[36:39]
    ds_read_b128 v[204:207], v240 offset:0
    v_max3_f32 v235, v114, v115, v235
    v_mfma_f32_16x16x32_bf16 v[8:11], v[172:175], v[136:139], v[8:11]
    v_max3_f32 v234, v100, v101, v234
    v_max3_f32 v235, v116, v117, v235
    v_mfma_f32_16x16x32_bf16 v[40:43], v[172:175], v[152:155], v[40:43]
    ds_read_b128 v[208:211], v241 offset:0
    v_max3_f32 v234, v102, v103, v234
    v_mfma_f32_16x16x32_bf16 v[12:15], v[176:179], v[136:139], v[12:15]
    v_max3_f32 v235, v118, v119, v235
    v_max3_f32 v234, v104, v105, v234
    v_mfma_f32_16x16x32_bf16 v[44:47], v[176:179], v[152:155], v[44:47]
    s_waitcnt lgkmcnt(5)
    ds_read_b128 v[160:163], v238 offset:4096
    v_mfma_f32_16x16x32_bf16 v[16:19], v[180:183], v[136:139], v[16:19]
    ds_read_b128 v[164:167], v239 offset:4096
    v_max3_f32 v235, v120, v121, v235
    v_mfma_f32_16x16x32_bf16 v[48:51], v[180:183], v[152:155], v[48:51]
    v_max3_f32 v234, v106, v107, v234
    v_max3_f32 v235, v122, v123, v235
    v_mfma_f32_16x16x32_bf16 v[20:23], v[184:187], v[136:139], v[20:23]
    ds_read_b128 v[168:171], v240 offset:4096
    v_max3_f32 v234, v108, v109, v234
    v_mfma_f32_16x16x32_bf16 v[52:55], v[184:187], v[152:155], v[52:55]
    v_max3_f32 v235, v124, v125, v235
    v_max3_f32 v234, v110, v111, v234
    v_mfma_f32_16x16x32_bf16 v[24:27], v[188:191], v[136:139], v[24:27]
    ds_read_b128 v[172:175], v241 offset:4096
    v_max3_f32 v235, v126, v127, v235
    v_mfma_f32_16x16x32_bf16 v[56:59], v[188:191], v[152:155], v[56:59]
    v_max_f32 v236, v234, v235
    v_cmp_lt_f32 vcc, s50, v236
    v_mfma_f32_16x16x32_bf16 v[28:31], v[192:195], v[136:139], v[28:31]
    v_mfma_f32_16x16x32_bf16 v[60:63], v[192:195], v[152:155], v[60:63]
    s_waitcnt lgkmcnt(4)
    s_cbranch_vccnz G0_g13
G0_g13_ret:
    v_mfma_f32_16x16x32_bf16 v[128:131], v[196:199], v[64:67], v[224:227]
    ds_read_b128 v[176:179], v238 offset:8192
    v_exp_f32 v96, v96
    v_mfma_f32_16x16x32_bf16 v[144:147], v[196:199], v[80:83], v[228:231]
    v_exp_f32 v97, v97
    v_exp_f32 v98, v98
    v_mfma_f32_16x16x32_bf16 v[128:131], v[200:203], v[68:71], v[128:131]
    ds_read_b128 v[180:183], v239 offset:8192
    v_add_f32 v217, v217, v96
    v_exp_f32 v99, v99
    v_mfma_f32_16x16x32_bf16 v[144:147], v[200:203], v[84:87], v[144:147]
    v_add_f32 v217, v217, v97
    v_cvt_pk_bf16_f32 v96, v96, v97
    v_exp_f32 v100, v100
    v_mfma_f32_16x16x32_bf16 v[128:131], v[204:207], v[72:75], v[128:131]
    ds_read_b128 v[184:187], v240 offset:8192
    v_add_f32 v217, v217, v98
    v_mfma_f32_16x16x32_bf16 v[144:147], v[204:207], v[88:91], v[144:147]
    v_exp_f32 v101, v101
    v_add_f32 v217, v217, v99
    v_cvt_pk_bf16_f32 v97, v98, v99
    v_mfma_f32_16x16x32_bf16 v[128:131], v[208:211], v[76:79], v[128:131]
    ds_read_b32 v252, v251 offset:0
    ds_read_b128 v[188:191], v241 offset:8192
    v_exp_f32 v102, v102
    v_mfma_f32_16x16x32_bf16 v[144:147], v[208:211], v[92:95], v[144:147]
    s_waitcnt lgkmcnt(5)
    v_add_f32 v217, v217, v100
    v_exp_f32 v103, v103
    v_mfma_f32_16x16x32_bf16 v[132:135], v[160:163], v[64:67], v[224:227]
    ds_read_b128 v[192:195], v238 offset:12288
    v_add_f32 v217, v217, v101
    v_cvt_pk_bf16_f32 v98, v100, v101
    v_add_f32 v217, v217, v102
    v_mfma_f32_16x16x32_bf16 v[148:151], v[160:163], v[80:83], v[228:231]
    v_add_f32 v217, v217, v103
    v_cvt_pk_bf16_f32 v99, v102, v103
    v_exp_f32 v112, v112
    v_mfma_f32_16x16x32_bf16 v[132:135], v[164:167], v[68:71], v[132:135]
    ds_read_b128 v[196:199], v239 offset:12288
    v_exp_f32 v113, v113
    v_mfma_f32_16x16x32_bf16 v[148:151], v[164:167], v[84:87], v[148:151]
    v_exp_f32 v114, v114
    v_add_f32 v221, v221, v112
    v_mfma_f32_16x16x32_bf16 v[132:135], v[168:171], v[72:75], v[132:135]
    ds_read_b128 v[200:203], v240 offset:12288
    v_exp_f32 v115, v115
    v_add_f32 v221, v221, v113
    v_mfma_f32_16x16x32_bf16 v[148:151], v[168:171], v[88:91], v[148:151]
    v_cvt_pk_bf16_f32 v112, v112, v113
    v_exp_f32 v116, v116
    v_mfma_f32_16x16x32_bf16 v[132:135], v[172:175], v[76:79], v[132:135]
    ds_read_b128 v[204:207], v241 offset:12288
    v_add_f32 v221, v221, v114
    v_exp_f32 v117, v117
    v_mfma_f32_16x16x32_bf16 v[148:151], v[172:175], v[92:95], v[148:151]
    s_waitcnt lgkmcnt(4)
    v_add_f32 v221, v221, v115
    v_mov_b32 v237, 62
    v_cmp_lt_u32 s[56:57], v252, 63
    v_mfma_f32_16x16x32_bf16 v[136:139], v[176:179], v[64:67], v[224:227]
    s_cmp_eq_u64 s[56:57], 0
    s_cbranch_scc0 G0_x58
G0_x58_ret:
    ds_write_b32 v250, v237 offset:16
    ds_read_b64_tr_b16 v[208:209], v242 offset:32768
    v_cvt_pk_bf16_f32 v113, v114, v115
    v_mfma_f32_16x16x32_bf16 v[152:155], v[176:179], v[80:83], v[228:231]
    ds_read_b64_tr_b16 v[210:211], v242 offset:36864
    v_exp_f32 v118, v118
    v_mfma_f32_16x16x32_bf16 v[136:139], v[180:183], v[68:71], v[136:139]
    ds_read_b64_tr_b16 v[160:161], v243 offset:32768
    v_add_f32 v221, v221, v116
    v_exp_f32 v119, v119
    v_mfma_f32_16x16x32_bf16 v[152:155], v[180:183], v[84:87], v[152:155]
    ds_read_b64_tr_b16 v[162:163], v243 offset:36864
    v_add_f32 v221, v221, v117
    v_cvt_pk_bf16_f32 v114, v116, v117
    v_mfma_f32_16x16x32_bf16 v[136:139], v[184:187], v[72:75], v[136:139]
    ds_read_b64_tr_b16 v[164:165], v244 offset:32768
    v_add_f32 v221, v221, v118
    v_add_f32 v221, v221, v119
    v_mfma_f32_16x16x32_bf16 v[152:155], v[184:187], v[88:91], v[152:155]
    ds_read_b64_tr_b16 v[166:167], v244 offset:36864
    v_cvt_pk_bf16_f32 v115, v118, v119
    v_exp_f32 v104, v104
    v_mfma_f32_16x16x32_bf16 v[136:139], v[188:191], v[76:79], v[136:139]
    ds_read_b64_tr_b16 v[168:169], v245 offset:32768
    v_exp_f32 v105, v105
    v_mfma_f32_16x16x32_bf16 v[152:155], v[188:191], v[92:95], v[152:155]
    s_waitcnt lgkmcnt(8)
    ds_read_b64_tr_b16 v[170:171], v245 offset:36864
    v_exp_f32 v106, v106
    v_mfma_f32_16x16x32_bf16 v[140:143], v[192:195], v[64:67], v[224:227]
    ds_read_b64_tr_b16 v[172:173], v246 offset:32768
    v_add_f32 v217, v217, v104
    v_mfma_f32_16x16x32_bf16 v[156:159], v[192:195], v[80:83], v[228:231]
    ds_read_b64_tr_b16 v[174:175], v246 offset:36864
    v_exp_f32 v107, v107
    v_add_f32 v217, v217, v105
    v_mfma_f32_16x16x32_bf16 v[140:143], v[196:199], v[68:71], v[140:143]
    ds_read_b64_tr_b16 v[176:177], v247 offset:32768
    v_cvt_pk_bf16_f32 v104, v104, v105
    v_exp_f32 v108, v108
    v_mfma_f32_16x16x32_bf16 v[156:159], v[196:199], v[84:87], v[156:159]
    ds_read_b64_tr_b16 v[178:179], v247 offset:36864
    v_add_f32 v217, v217, v106
    v_mfma_f32_16x16x32_bf16 v[140:143], v[200:203], v[72:75], v[140:143]
    ds_read_b64_tr_b16 v[180:181], v248 offset:32768
    v_exp_f32 v109, v109
    v_mfma_f32_16x16x32_bf16 v[156:159], v[200:203], v[88:91], v[156:159]
    ds_read_b64_tr_b16 v[182:183], v248 offset:36864
    v_add_f32 v217, v217, v107
    v_cvt_pk_bf16_f32 v105, v106, v107
    v_mfma_f32_16x16x32_bf16 v[140:143], v[204:207], v[76:79], v[140:143]
    ds_read_b64_tr_b16 v[184:185], v249 offset:32768
    v_exp_f32 v110, v110
    v_add_f32 v217, v217, v108
    v_mfma_f32_16x16x32_bf16 v[156:159], v[204:207], v[92:95], v[156:159]
    s_waitcnt lgkmcnt(7)
    ds_read_b64_tr_b16 v[186:187], v249 offset:36864
    v_exp_f32 v111, v111
    v_mfma_f32_16x16x32_bf16 v[0:3], v[208:211], v[96:99], v[0:3]
    ds_read_b64_tr_b16 v[188:189], v242 offset:40960
    v_add_f32 v217, v217, v109
    v_cvt_pk_bf16_f32 v106, v108, v109
    v_mfma_f32_16x16x32_bf16 v[32:35], v[208:211], v[112:115], v[32:35]
    ds_read_b64_tr_b16 v[190:191], v242 offset:45056
    v_add_f32 v217, v217, v110
    v_add_f32 v217, v217, v111
    v_cvt_pk_bf16_f32 v107, v110, v111
    v_mfma_f32_16x16x32_bf16 v[4:7], v[160:163], v[96:99], v[4:7]
    ds_read_b64_tr_b16 v[192:193], v243 offset:40960
    v_exp_f32 v120, v120
    v_mfma_f32_16x16x32_bf16 v[36:39], v[160:163], v[112:115], v[36:39]
    ds_read_b64_tr_b16 v[194:195], v243 offset:45056
    v_exp_f32 v121, v121
    v_mfma_f32_16x16x32_bf16 v[8:11], v[164:167], v[96:99], v[8:11]
    ds_read_b64_tr_b16 v[196:197], v244 offset:40960
    v_exp_f32 v122, v122
    v_mfma_f32_16x16x32_bf16 v[40:43], v[164:167], v[112:115], v[40:43]
    ds_read_b64_tr_b16 v[198:199], v244 offset:45056
    v_add_f32 v221, v221, v120
    v_exp_f32 v123, v123
    v_mfma_f32_16x16x32_bf16 v[12:15], v[168:171], v[96:99], v[12:15]
    ds_read_b32 v252, v251 offset:0
    ds_read_b64_tr_b16 v[200:201], v245 offset:40960
    v_add_f32 v221, v221, v121
    v_mfma_f32_16x16x32_bf16 v[44:47], v[168:171], v[112:115], v[44:47]
    s_waitcnt lgkmcnt(8)
    ds_read_b64_tr_b16 v[202:203], v245 offset:45056
    v_cvt_pk_bf16_f32 v120, v120, v121
    v_exp_f32 v124, v124
    v_mfma_f32_16x16x32_bf16 v[16:19], v[172:175], v[96:99], v[16:19]
    ds_read_b64_tr_b16 v[204:205], v246 offset:40960
    v_add_f32 v221, v221, v122
    v_mfma_f32_16x16x32_bf16 v[48:51], v[172:175], v[112:115], v[48:51]
    ds_read_b64_tr_b16 v[206:207], v246 offset:45056
    v_exp_f32 v125, v125
    v_add_f32 v221, v221, v123
    v_mfma_f32_16x16x32_bf16 v[20:23], v[176:179], v[96:99], v[20:23]
    ds_read_b64_tr_b16 v[208:209], v247 offset:40960
    v_cvt_pk_bf16_f32 v121, v122, v123
    v_mfma_f32_16x16x32_bf16 v[52:55], v[176:179], v[112:115], v[52:55]
    ds_read_b64_tr_b16 v[210:211], v247 offset:45056
    v_exp_f32 v126, v126
    v_add_f32 v221, v221, v124
    v_mfma_f32_16x16x32_bf16 v[24:27], v[180:183], v[96:99], v[24:27]
    ds_read_b64_tr_b16 v[160:161], v248 offset:40960
    v_exp_f32 v127, v127
    v_mfma_f32_16x16x32_bf16 v[56:59], v[180:183], v[112:115], v[56:59]
    ds_read_b64_tr_b16 v[162:163], v248 offset:45056
    v_add_f32 v221, v221, v125
    v_cvt_pk_bf16_f32 v122, v124, v125
    v_add_f32 v221, v221, v126
    v_mfma_f32_16x16x32_bf16 v[28:31], v[184:187], v[96:99], v[28:31]
    ds_read_b64_tr_b16 v[164:165], v249 offset:40960
    v_add_f32 v221, v221, v127
    v_cvt_pk_bf16_f32 v123, v126, v127
    v_mfma_f32_16x16x32_bf16 v[60:63], v[184:187], v[112:115], v[60:63]
    s_waitcnt lgkmcnt(7)
    ds_read_b64_tr_b16 v[166:167], v249 offset:45056
    v_mov_b32 v237, 63
    v_cmp_lt_u32 s[56:57], v252, s42
    v_mfma_f32_16x16x32_bf16 v[0:3], v[188:191], v[104:107], v[0:3]
    s_cmp_eq_u64 s[56:57], 0
    s_cbranch_scc0 G0_x60
G0_x60_ret:
    ds_write_b32 v250, v237 offset:16
    ds_read_b64_tr_b16 v[168:169], v242 offset:0
    ds_read_b64_tr_b16 v[170:171], v242 offset:4096
    v_mfma_f32_16x16x32_bf16 v[32:35], v[188:191], v[120:123], v[32:35]
    ds_read_b64_tr_b16 v[172:173], v243 offset:0
    v_max_f32 v234, v128, v129
    v_mfma_f32_16x16x32_bf16 v[4:7], v[192:195], v[104:107], v[4:7]
    ds_read_b64_tr_b16 v[174:175], v243 offset:4096
    v_max_f32 v235, v144, v145
    v_max3_f32 v234, v130, v131, v234
    v_mfma_f32_16x16x32_bf16 v[36:39], v[192:195], v[120:123], v[36:39]
    ds_read_b64_tr_b16 v[176:177], v244 offset:0
    v_max3_f32 v235, v146, v147, v235
    v_mfma_f32_16x16x32_bf16 v[8:11], v[196:199], v[104:107], v[8:11]
    ds_read_b64_tr_b16 v[178:179], v244 offset:4096
    v_max3_f32 v234, v132, v133, v234
    v_max3_f32 v235, v148, v149, v235
    v_mfma_f32_16x16x32_bf16 v[40:43], v[196:199], v[120:123], v[40:43]
    ds_read_b64_tr_b16 v[180:181], v245 offset:0
    v_max3_f32 v234, v134, v135, v234
    v_mfma_f32_16x16x32_bf16 v[12:15], v[200:203], v[104:107], v[12:15]
    ds_read_b64_tr_b16 v[182:183], v245 offset:4096
    v_max3_f32 v235, v150, v151, v235
    v_max3_f32 v234, v136, v137, v234
    v_mfma_f32_16x16x32_bf16 v[44:47], v[200:203], v[120:123], v[44:47]
    s_waitcnt lgkmcnt(9)
    ds_read_b64_tr_b16 v[184:185], v246 offset:0
    ds_read_b64_tr_b16 v[186:187], v246 offset:4096
    v_mfma_f32_16x16x32_bf16 v[16:19], v[204:207], v[104:107], v[16:19]
    ds_read_b64_tr_b16 v[188:189], v247 offset:0
    v_max3_f32 v235, v152, v153, v235
    v_max3_f32 v234, v138, v139, v234
    v_mfma_f32_16x16x32_bf16 v[48:51], v[204:207], v[120:123], v[48:51]
    ds_read_b64_tr_b16 v[190:191], v247 offset:4096
    v_max3_f32 v235, v154, v155, v235
    v_mfma_f32_16x16x32_bf16 v[20:23], v[208:211], v[104:107], v[20:23]
    ds_read_b64_tr_b16 v[192:193], v248 offset:0
    v_max3_f32 v234, v140, v141, v234
    v_max3_f32 v235, v156, v157, v235
    v_mfma_f32_16x16x32_bf16 v[52:55], v[208:211], v[120:123], v[52:55]
    ds_read_b64_tr_b16 v[194:195], v248 offset:4096
    v_max3_f32 v234, v142, v143, v234
    v_mfma_f32_16x16x32_bf16 v[24:27], v[160:163], v[104:107], v[24:27]
    ds_read_b64_tr_b16 v[196:197], v249 offset:0
    v_max3_f32 v235, v158, v159, v235
    v_max_f32 v236, v234, v235
    v_mfma_f32_16x16x32_bf16 v[56:59], v[160:163], v[120:123], v[56:59]
    ds_read_b64_tr_b16 v[198:199], v249 offset:4096
    v_cmp_lt_f32 vcc, s50, v236
    v_mfma_f32_16x16x32_bf16 v[28:31], v[164:167], v[104:107], v[28:31]
    v_mfma_f32_16x16x32_bf16 v[60:63], v[164:167], v[120:123], v[60:63]
    s_waitcnt lgkmcnt(8)
    s_cbranch_vccnz G0_g14
G0_g14_ret:
    v_exp_f32 v128, v128
    v_exp_f32 v129, v129
    v_exp_f32 v130, v130
    v_add_f32 v217, v217, v128
    v_exp_f32 v131, v131
    v_add_f32 v217, v217, v129
    v_cvt_pk_bf16_f32 v128, v128, v129
    v_exp_f32 v132, v132
    v_add_f32 v217, v217, v130
    v_exp_f32 v133, v133
    v_add_f32 v217, v217, v131
    v_cvt_pk_bf16_f32 v129, v130, v131
    v_exp_f32 v134, v134
    v_add_f32 v217, v217, v132
    v_exp_f32 v135, v135
    v_add_f32 v217, v217, v133
    v_cvt_pk_bf16_f32 v130, v132, v133
    v_add_f32 v217, v217, v134
    v_add_f32 v217, v217, v135
    v_cvt_pk_bf16_f32 v131, v134, v135
    v_exp_f32 v144, v144
    v_exp_f32 v145, v145
    v_exp_f32 v146, v146
    v_add_f32 v221, v221, v144
    v_exp_f32 v147, v147
    v_add_f32 v221, v221, v145
    v_cvt_pk_bf16_f32 v144, v144, v145
    v_exp_f32 v148, v148
    v_add_f32 v221, v221, v146
    v_exp_f32 v149, v149
    v_add_f32 v221, v221, v147
    v_cvt_pk_bf16_f32 v145, v146, v147
    v_exp_f32 v150, v150
    v_add_f32 v221, v221, v148
    v_exp_f32 v151, v151
    v_add_f32 v221, v221, v149
    v_cvt_pk_bf16_f32 v146, v148, v149
    v_add_f32 v221, v221, v150
    v_add_f32 v221, v221, v151
    v_cvt_pk_bf16_f32 v147, v150, v151
    v_mfma_f32_16x16x32_bf16 v[0:3], v[168:171], v[128:131], v[0:3]
    ds_read_b64_tr_b16 v[200:201], v242 offset:8192
    v_exp_f32 v136, v136
    v_exp_f32 v137, v137
    v_mfma_f32_16x16x32_bf16 v[32:35], v[168:171], v[144:147], v[32:35]
    ds_read_b64_tr_b16 v[202:203], v242 offset:12288
    v_exp_f32 v138, v138
    v_add_f32 v217, v217, v136
    v_mfma_f32_16x16x32_bf16 v[4:7], v[172:175], v[128:131], v[4:7]
    ds_read_b64_tr_b16 v[204:205], v243 offset:8192
    v_exp_f32 v139, v139
    v_add_f32 v217, v217, v137
    v_cvt_pk_bf16_f32 v136, v136, v137
    v_mfma_f32_16x16x32_bf16 v[36:39], v[172:175], v[144:147], v[36:39]
    ds_read_b64_tr_b16 v[206:207], v243 offset:12288
    v_exp_f32 v140, v140
    v_add_f32 v217, v217, v138
    v_mfma_f32_16x16x32_bf16 v[8:11], v[176:179], v[128:131], v[8:11]
    ds_read_b64_tr_b16 v[208:209], v244 offset:8192
    v_exp_f32 v141, v141
    v_add_f32 v217, v217, v139
    v_cvt_pk_bf16_f32 v137, v138, v139
    v_mfma_f32_16x16x32_bf16 v[40:43], v[176:179], v[144:147], v[40:43]
    ds_read_b64_tr_b16 v[210:211], v244 offset:12288
    v_exp_f32 v142, v142
    v_add_f32 v217, v217, v140
    v_mfma_f32_16x16x32_bf16 v[12:15], v[180:183], v[128:131], v[12:15]
    ds_read_b64_tr_b16 v[160:161], v245 offset:8192
    v_exp_f32 v143, v143
    v_add_f32 v217, v217, v141
    v_cvt_pk_bf16_f32 v138, v140, v141
    v_mfma_f32_16x16x32_bf16 v[44:47], v[180:183], v[144:147], v[44:47]
    s_waitcnt lgkmcnt(7)
    ds_read_b64_tr_b16 v[162:163], v245 offset:12288
    v_add_f32 v217, v217, v142
    v_add_f32 v217, v217, v143
    v_cvt_pk_bf16_f32 v139, v142, v143
    v_mfma_f32_16x16x32_bf16 v[16:19], v[184:187], v[128:131], v[16:19]
    ds_read_b64_tr_b16 v[164:165], v246 offset:8192
    v_exp_f32 v152, v152
    v_exp_f32 v153, v153
    v_mfma_f32_16x16x32_bf16 v[48:51], v[184:187], v[144:147], v[48:51]
    ds_read_b64_tr_b16 v[166:167], v246 offset:12288
    v_exp_f32 v154, v154
    v_add_f32 v221, v221, v152
    v_mfma_f32_16x16x32_bf16 v[20:23], v[188:191], v[128:131], v[20:23]
    ds_read_b64_tr_b16 v[168:169], v247 offset:8192
    v_exp_f32 v155, v155
    v_add_f32 v221, v221, v153
    v_cvt_pk_bf16_f32 v152, v152, v153
    v_mfma_f32_16x16x32_bf16 v[52:55], v[188:191], v[144:147], v[52:55]
    ds_read_b64_tr_b16 v[170:171], v247 offset:12288
    v_exp_f32 v156, v156
    v_add_f32 v221, v221, v154
    v_mfma_f32_16x16x32_bf16 v[24:27], v[192:195], v[128:131], v[24:27]
    ds_read_b64_tr_b16 v[172:173], v248 offset:8192
    v_exp_f32 v157, v157
    v_add_f32 v221, v221, v155
    v_cvt_pk_bf16_f32 v153, v154, v155
    v_mfma_f32_16x16x32_bf16 v[56:59], v[192:195], v[144:147], v[56:59]
    ds_read_b64_tr_b16 v[174:175], v248 offset:12288
    v_exp_f32 v158, v158
    v_add_f32 v221, v221, v156
    v_mfma_f32_16x16x32_bf16 v[28:31], v[196:199], v[128:131], v[28:31]
    ds_read_b64_tr_b16 v[176:177], v249 offset:8192
    v_exp_f32 v159, v159
    v_add_f32 v221, v221, v157
    v_cvt_pk_bf16_f32 v154, v156, v157
    v_mfma_f32_16x16x32_bf16 v[60:63], v[196:199], v[144:147], v[60:63]
    s_waitcnt lgkmcnt(7)
    ds_read_b64_tr_b16 v[178:179], v249 offset:12288
    v_add_f32 v221, v221, v158
    v_add_f32 v221, v221, v159
    v_cvt_pk_bf16_f32 v155, v158, v159
    v_mfma_f32_16x16x32_bf16 v[0:3], v[200:203], v[136:139], v[0:3]
    s_nop 0
    v_mfma_f32_16x16x32_bf16 v[32:35], v[200:203], v[152:155], v[32:35]
    v_mfma_f32_16x16x32_bf16 v[4:7], v[204:207], v[136:139], v[4:7]
    v_mfma_f32_16x16x32_bf16 v[36:39], v[204:207], v[152:155], v[36:39]
    v_mfma_f32_16x16x32_bf16 v[8:11], v[208:211], v[136:139], v[8:11]
    v_mfma_f32_16x16x32_bf16 v[40:43], v[208:211], v[152:155], v[40:43]
    v_mfma_f32_16x16x32_bf16 v[12:15], v[160:163], v[136:139], v[12:15]
    v_mfma_f32_16x16x32_bf16 v[44:47], v[160:163], v[152:155], v[44:47]
    s_waitcnt lgkmcnt(0)
    v_mfma_f32_16x16x32_bf16 v[16:19], v[164:167], v[136:139], v[16:19]
    v_mfma_f32_16x16x32_bf16 v[48:51], v[164:167], v[152:155], v[48:51]
    v_mfma_f32_16x16x32_bf16 v[20:23], v[168:171], v[136:139], v[20:23]
    v_mfma_f32_16x16x32_bf16 v[52:55], v[168:171], v[152:155], v[52:55]
    v_mfma_f32_16x16x32_bf16 v[24:27], v[172:175], v[136:139], v[24:27]
    v_mfma_f32_16x16x32_bf16 v[56:59], v[172:175], v[152:155], v[56:59]
    v_mfma_f32_16x16x32_bf16 v[28:31], v[176:179], v[136:139], v[28:31]
    v_mfma_f32_16x16x32_bf16 v[60:63], v[176:179], v[152:155], v[60:63]
    v_mov_b32 v253, 2
    ds_write_b32 v250, v253 offset:32
    v_mov_b32 v232, v217
    v_mov_b32 v233, v221
    s_nop 0
    v_permlane32_swap_b32 v232, v217
    v_permlane32_swap_b32 v233, v221
    v_add_f32 v217, v217, v232
    v_add_f32 v221, v221, v233
    v_mov_b32 v232, v217
    v_mov_b32 v233, v221
    s_nop 0
    v_permlane16_swap_b32 v232, v217
    v_permlane16_swap_b32 v233, v221
    v_add_f32 v217, v217, v232
    v_add_f32 v221, v221, v233
    v_rcp_f32 v232, v217
    v_rcp_f32 v233, v221
    v_mul_f32 v0, v0, v232
    v_mul_f32 v1, v1, v232
    v_mul_f32 v2, v2, v232
    v_mul_f32 v3, v3, v232
    v_mul_f32 v4, v4, v232
    v_mul_f32 v5, v5, v232
    v_mul_f32 v6, v6, v232
    v_mul_f32 v7, v7, v232
    v_cvt_pk_bf16_f32 v0, v0, v1
    v_cvt_pk_bf16_f32 v1, v2, v3
    v_cvt_pk_bf16_f32 v2, v4, v5
    v_cvt_pk_bf16_f32 v3, v6, v7
    s_mov_b32 s45, 36864
    buffer_store_dwordx4 v[0:3], v254, s[20:23], s45 offen offset:0 sc1
    v_mul_f32 v32, v32, v233
    v_mul_f32 v33, v33, v233
    v_mul_f32 v34, v34, v233
    v_mul_f32 v35, v35, v233
    v_mul_f32 v36, v36, v233
    v_mul_f32 v37, v37, v233
    v_mul_f32 v38, v38, v233
    v_mul_f32 v39, v39, v233
    v_cvt_pk_bf16_f32 v32, v32, v33
    v_cvt_pk_bf16_f32 v33, v34, v35
    v_cvt_pk_bf16_f32 v34, v36, v37
    v_cvt_pk_bf16_f32 v35, v38, v39
    s_mov_b32 s45, 36864
    buffer_store_dwordx4 v[32:35], v254, s[20:23], s45 offen offset:1024 sc1
    v_mul_f32 v8, v8, v232
    v_mul_f32 v9, v9, v232
    v_mul_f32 v10, v10, v232
    v_mul_f32 v11, v11, v232
    v_mul_f32 v12, v12, v232
    v_mul_f32 v13, v13, v232
    v_mul_f32 v14, v14, v232
    v_mul_f32 v15, v15, v232
    v_cvt_pk_bf16_f32 v8, v8, v9
    v_cvt_pk_bf16_f32 v9, v10, v11
    v_cvt_pk_bf16_f32 v10, v12, v13
    v_cvt_pk_bf16_f32 v11, v14, v15
    s_mov_b32 s45, 46080
    buffer_store_dwordx4 v[8:11], v254, s[20:23], s45 offen offset:0 sc1
    v_mul_f32 v40, v40, v233
    v_mul_f32 v41, v41, v233
    v_mul_f32 v42, v42, v233
    v_mul_f32 v43, v43, v233
    v_mul_f32 v44, v44, v233
    v_mul_f32 v45, v45, v233
    v_mul_f32 v46, v46, v233
    v_mul_f32 v47, v47, v233
    v_cvt_pk_bf16_f32 v40, v40, v41
    v_cvt_pk_bf16_f32 v41, v42, v43
    v_cvt_pk_bf16_f32 v42, v44, v45
    v_cvt_pk_bf16_f32 v43, v46, v47
    s_mov_b32 s45, 46080
    buffer_store_dwordx4 v[40:43], v254, s[20:23], s45 offen offset:1024 sc1
    v_mul_f32 v16, v16, v232
    v_mul_f32 v17, v17, v232
    v_mul_f32 v18, v18, v232
    v_mul_f32 v19, v19, v232
    v_mul_f32 v20, v20, v232
    v_mul_f32 v21, v21, v232
    v_mul_f32 v22, v22, v232
    v_mul_f32 v23, v23, v232
    v_cvt_pk_bf16_f32 v16, v16, v17
    v_cvt_pk_bf16_f32 v17, v18, v19
    v_cvt_pk_bf16_f32 v18, v20, v21
    v_cvt_pk_bf16_f32 v19, v22, v23
    s_mov_b32 s45, 55296
    buffer_store_dwordx4 v[16:19], v254, s[20:23], s45 offen offset:0 sc1
    v_mul_f32 v48, v48, v233
    v_mul_f32 v49, v49, v233
    v_mul_f32 v50, v50, v233
    v_mul_f32 v51, v51, v233
    v_mul_f32 v52, v52, v233
    v_mul_f32 v53, v53, v233
    v_mul_f32 v54, v54, v233
    v_mul_f32 v55, v55, v233
    v_cvt_pk_bf16_f32 v48, v48, v49
    v_cvt_pk_bf16_f32 v49, v50, v51
    v_cvt_pk_bf16_f32 v50, v52, v53
    v_cvt_pk_bf16_f32 v51, v54, v55
    s_mov_b32 s45, 55296
    buffer_store_dwordx4 v[48:51], v254, s[20:23], s45 offen offset:1024 sc1
    v_mul_f32 v24, v24, v232
    v_mul_f32 v25, v25, v232
    v_mul_f32 v26, v26, v232
    v_mul_f32 v27, v27, v232
    v_mul_f32 v28, v28, v232
    v_mul_f32 v29, v29, v232
    v_mul_f32 v30, v30, v232
    v_mul_f32 v31, v31, v232
    v_cvt_pk_bf16_f32 v24, v24, v25
    v_cvt_pk_bf16_f32 v25, v26, v27
    v_cvt_pk_bf16_f32 v26, v28, v29
    v_cvt_pk_bf16_f32 v27, v30, v31
    s_mov_b32 s45, 64512
    buffer_store_dwordx4 v[24:27], v254, s[20:23], s45 offen offset:0 sc1
    v_mul_f32 v56, v56, v233
    v_mul_f32 v57, v57, v233
    v_mul_f32 v58, v58, v233
    v_mul_f32 v59, v59, v233
    v_mul_f32 v60, v60, v233
    v_mul_f32 v61, v61, v233
    v_mul_f32 v62, v62, v233
    v_mul_f32 v63, v63, v233
    v_cvt_pk_bf16_f32 v56, v56, v57
    v_cvt_pk_bf16_f32 v57, v58, v59
    v_cvt_pk_bf16_f32 v58, v60, v61
    v_cvt_pk_bf16_f32 v59, v62, v63
    s_mov_b32 s45, 64512
    buffer_store_dwordx4 v[56:59], v254, s[20:23], s45 offen offset:1024 sc1
    s_load_dwordx4 s[28:31], s[0:1], 32
    s_load_dwordx2 s[32:33], s[0:1], 48
    s_bfe_u32 s34, s2, 0x20001
    s_lshl_b32 s34, s34, 2
    s_bfe_u32 s35, s2, 0x20003
    s_add_u32 s34, s34, s35
    s_bfe_u32 s35, s2, 0x30005
    s_add_u32 s53, s34, s35
    s_and_b32 s53, s53, 3
    s_and_b32 s52, s2, 1
    s_lshl_b32 s35, s35, 1
    s_add_u32 s35, s35, s52
    s_xor_b32 s35, s35, 1
    s_lshl_b32 s52, s52, 1
    s_and_b32 s40, s34, 1
    s_lshl_b32 s40, s40, 6
    s_add_u32 s40, s40, s34
    s_and_b32 s40, s40, 0xfe
    s_lshl_b32 s40, s40, 1
    v_mbcnt_lo_u32_b32 v64, -1, 0
    v_mbcnt_hi_u32_b32 v64, -1, v64
    v_mov_b32 v65, v251
    v_mov_b32 v253, v250
    v_lshrrev_b32 v66, 4, v64
    v_lshlrev_b32 v66, 1, v66
    v_and_b32 v252, 7, v64
    v_xor_b32 v252, v252, v66
    v_lshlrev_b32 v252, 4, v252
    v_lshrrev_b32 v66, 3, v64
    v_lshl_add_u32 v252, v66, 11, v252
    s_lshl_b32 s44, s24, 16
    v_add_u32 v252, s44, v252
    s_lshl_b32 s41, s24, 12
    s_add_u32 s41, s41, 98048
    v_lshrrev_b32 v66, 2, v64
    v_and_b32 v249, 3, v64
    v_lshlrev_b32 v249, 3, v249
    v_lshl_add_u32 v248, v66, 7, v249
    v_bfe_u32 v66, v64, 3, 2
    v_xor_b32 v66, s24, v66
    v_lshl_add_u32 v248, v66, 5, v248
    v_add_u32 v248, s41, v248
    v_xor_b32 v249, 32, v248
    v_xor_b32 v250, 64, v248
    v_xor_b32 v251, 96, v248
    s_mul_i32 s44, s24, 9216
    v_lshl_add_u32 v254, v64, 4, s44
    s_waitcnt lgkmcnt(0)
    s_lshl_b32 s44, s35, 7
    s_add_u32 s8, s28, s44
    s_addc_u32 s9, s29, 0
    s_sub_u32 s10, 8388608, s44
    s_mov_b32 s11, 0x20000
    s_mov_b32 s16, s32
    s_mov_b32 s17, s33
    s_mov_b32 s18, 256
    s_mov_b32 s19, 0x20000
    s_mul_i32 s44, s2, 36864
    s_add_u32 s44, s44, 33554432
    s_add_u32 s12, s36, s44
    s_addc_u32 s13, s37, 0
    s_mov_b32 s14, 36864
    s_mov_b32 s15, 0x20000
    s_mov_b32 s59, 262144
G0_l0:
    ds_read_b32 v255, v65 offset:32
    s_waitcnt lgkmcnt(0)
    v_cmp_lt_u32 s[56:57], v255, 2
    s_nop 0
    s_cmp_eq_u64 s[56:57], 0
    s_cbranch_scc1 G0_l0_ok
    s_sleep 1
    s_sub_u32 s59, s59, 1
    s_cmp_lg_u32 s59, 0
    s_cbranch_scc1 G0_l0
G0_l0_ok:
    s_mov_b32 s59, 262144
G0_l1:
    ds_read_b32 v255, v65 offset:48
    s_waitcnt lgkmcnt(0)
    v_cmp_lt_u32 s[56:57], v255, 3
    s_nop 0
    s_cmp_eq_u64 s[56:57], 0
    s_cbranch_scc1 G0_l1_ok
    s_sleep 1
    s_sub_u32 s59, s59, 1
    s_cmp_lg_u32 s59, 0
    s_cbranch_scc1 G0_l1
G0_l1_ok:
    s_add_u32 m0, s41, 0
    s_mul_i32 s46, s53, 4
    s_add_u32 s46, s46, 0
    s_add_u32 s46, s46, s52
    s_lshl_b32 s46, s46, 18
    buffer_load_dwordx4 v252, s[8:11], s46 offen offset:0  lds
    s_add_u32 s46, s46, 15360
    buffer_load_dwordx4 v252, s[8:11], s46 offen offset:1024  lds
    s_add_u32 s46, s46, 15360
    buffer_load_dwordx4 v252, s[8:11], s46 offen offset:2048  lds
    s_add_u32 s46, s46, 15360
    buffer_load_dwordx4 v252, s[8:11], s46 offen offset:3072  lds
    s_add_u32 m0, s41, 16384
    s_cmp_eq_u32 s53, 0
    s_cselect_b32 s46, 16, 0
    s_add_u32 s46, s46, s52
    s_lshl_b32 s46, s46, 18
    buffer_load_dwordx4 v252, s[8:11], s46 offen offset:0  lds
    s_add_u32 s46, s46, 15360
    buffer_load_dwordx4 v252, s[8:11], s46 offen offset:1024  lds
    s_add_u32 s46, s46, 15360
    buffer_load_dwordx4 v252, s[8:11], s46 offen offset:2048  lds
    s_add_u32 s46, s46, 15360
    buffer_load_dwordx4 v252, s[8:11], s46 offen offset:3072  lds
    v_mov_b32 v255, 2
    s_waitcnt vmcnt(8)
    ds_write_b32 v253, v255 offset:64
    s_setprio 0
    s_mov_b32 s59, 262144
G0_b0:
    ds_read_b32 v255, v253 offset:96
    s_waitcnt lgkmcnt(0)
    v_cmp_lt_u32 s[56:57], v255, 1
    s_nop 0
    s_cmp_eq_u64 s[56:57], 0
    s_cbranch_scc1 G0_b0_ok
    s_sleep 1
    s_sub_u32 s59, s59, 1
    s_cmp_lg_u32 s59, 0
    s_cbranch_scc1 G0_b0
G0_b0_ok:
    s_waitcnt vmcnt(4)
    ds_read_b64_tr_b16 v[216:217], v248 offset:0
    ds_read_b64_tr_b16 v[218:219], v248 offset:2048
    ds_read_b64_tr_b16 v[220:221], v249 offset:0
    ds_read_b64_tr_b16 v[222:223], v249 offset:2048
    ds_read_b64_tr_b16 v[224:225], v250 offset:0
    ds_read_b64_tr_b16 v[226:227], v250 offset:2048
    ds_read_b64_tr_b16 v[228:229], v251 offset:0
    ds_read_b64_tr_b16 v[230:231], v251 offset:2048
    ds_read_b128 v[144:147], v254 offset:0
    ds_read_b128 v[148:151], v254 offset:1024
    ds_read_b128 v[152:155], v254 offset:2048
    ds_read_b128 v[156:159], v254 offset:3072
    ds_read_b128 v[160:163], v254 offset:4096
    ds_read_b128 v[164:167], v254 offset:5120
    ds_read_b128 v[168:171], v254 offset:6144
    ds_read_b128 v[172:175], v254 offset:7168
    ds_read_b128 v[176:179], v254 offset:8192
    v_mov_b32 v255, 1
    ds_write_b32 v253, v255 offset:112
    s_waitcnt lgkmcnt(0)
    s_add_u32 m0, s41, 0
    s_cmp_eq_u32 s53, 1
    s_cselect_b32 s46, 20, 4
    s_add_u32 s46, s46, s52
    s_lshl_b32 s46, s46, 18
    buffer_load_dwordx4 v252, s[8:11], s46 offen offset:0  lds
    s_add_u32 s46, s46, 15360
    buffer_load_dwordx4 v252, s[8:11], s46 offen offset:1024  lds
    s_add_u32 s46, s46, 15360
    buffer_load_dwordx4 v252, s[8:11], s46 offen offset:2048  lds
    s_add_u32 s46, s46, 15360
    buffer_load_dwordx4 v252, s[8:11], s46 offen offset:3072  lds
    v_mfma_f32_16x16x32_bf16 v[0:3], v[216:219], v[144:147], 0
    v_mfma_f32_16x16x32_bf16 v[4:7], v[220:223], v[144:147], 0
    v_mfma_f32_16x16x32_bf16 v[8:11], v[224:227], v[144:147], 0
    v_mfma_f32_16x16x32_bf16 v[12:15], v[228:231], v[144:147], 0
    s_waitcnt vmcnt(4)
    v_mfma_f32_16x16x32_bf16 v[16:19], v[216:219], v[148:151], 0
    ds_read_b64_tr_b16 v[232:233], v248 offset:16384
    v_mfma_f32_16x16x32_bf16 v[20:23], v[220:223], v[148:151], 0
    ds_read_b64_tr_b16 v[234:235], v248 offset:18432
    v_mfma_f32_16x16x32_bf16 v[24:27], v[224:227], v[148:151], 0
    ds_read_b64_tr_b16 v[236:237], v249 offset:16384
    v_mfma_f32_16x16x32_bf16 v[28:31], v[228:231], v[148:151], 0
    ds_read_b64_tr_b16 v[238:239], v249 offset:18432
    v_mfma_f32_16x16x32_bf16 v[32:35], v[216:219], v[152:155], 0
    ds_read_b64_tr_b16 v[240:241], v250 offset:16384
    v_mfma_f32_16x16x32_bf16 v[36:39], v[220:223], v[152:155], 0
    ds_read_b64_tr_b16 v[242:243], v250 offset:18432
    v_mfma_f32_16x16x32_bf16 v[40:43], v[224:227], v[152:155], 0
    ds_read_b64_tr_b16 v[244:245], v251 offset:16384
    v_mfma_f32_16x16x32_bf16 v[44:47], v[228:231], v[152:155], 0
    ds_read_b64_tr_b16 v[246:247], v251 offset:18432
    v_mfma_f32_16x16x32_bf16 v[48:51], v[216:219], v[156:159], 0
    ds_read_b32 v255, v253 offset:96
    v_mfma_f32_16x16x32_bf16 v[52:55], v[220:223], v[156:159], 0
    v_mfma_f32_16x16x32_bf16 v[56:59], v[224:227], v[156:159], 0
    v_mfma_f32_16x16x32_bf16 v[60:63], v[228:231], v[156:159], 0
    v_mfma_f32_16x16x32_bf16 v[64:67], v[216:219], v[160:163], 0
    s_nop 0
    v_mfma_f32_16x16x32_bf16 v[68:71], v[220:223], v[160:163], 0
    s_waitcnt lgkmcnt(0)
    v_cmp_gt_u32 vcc, 2, v255
    v_mfma_f32_16x16x32_bf16 v[72:75], v[224:227], v[160:163], 0
    s_nop 0
    v_mfma_f32_16x16x32_bf16 v[76:79], v[228:231], v[160:163], 0
    s_cbranch_vccnz G0_b1
G0_b1_ret:
    v_mfma_f32_16x16x32_bf16 v[80:83], v[216:219], v[164:167], 0
    ds_read_b128 v[180:183], v254 offset:36864
    v_mfma_f32_16x16x32_bf16 v[84:87], v[220:223], v[164:167], 0
    ds_read_b128 v[184:187], v254 offset:37888
    v_mfma_f32_16x16x32_bf16 v[88:91], v[224:227], v[164:167], 0
    ds_read_b128 v[188:191], v254 offset:38912
    v_mfma_f32_16x16x32_bf16 v[92:95], v[228:231], v[164:167], 0
    v_mfma_f32_16x16x32_bf16 v[96:99], v[216:219], v[168:171], 0
    ds_read_b128 v[192:195], v254 offset:39936
    v_mfma_f32_16x16x32_bf16 v[100:103], v[220:223], v[168:171], 0
    ds_read_b128 v[196:199], v254 offset:40960
    v_mfma_f32_16x16x32_bf16 v[104:107], v[224:227], v[168:171], 0
    ds_read_b128 v[200:203], v254 offset:41984
    v_mfma_f32_16x16x32_bf16 v[108:111], v[228:231], v[168:171], 0
    v_mfma_f32_16x16x32_bf16 v[112:115], v[216:219], v[172:175], 0
    ds_read_b128 v[204:207], v254 offset:43008
    v_mfma_f32_16x16x32_bf16 v[116:119], v[220:223], v[172:175], 0
    ds_read_b128 v[208:211], v254 offset:44032
    v_mfma_f32_16x16x32_bf16 v[120:123], v[224:227], v[172:175], 0
    ds_read_b128 v[212:215], v254 offset:45056
    v_mfma_f32_16x16x32_bf16 v[124:127], v[228:231], v[172:175], 0
    v_mfma_f32_16x16x32_bf16 v[128:131], v[216:219], v[176:179], 0
    v_mov_b32 v255, 2
    v_mfma_f32_16x16x32_bf16 v[132:135], v[220:223], v[176:179], 0
    v_mfma_f32_16x16x32_bf16 v[136:139], v[224:227], v[176:179], 0
    ds_write_b32 v253, v255 offset:112
    v_mfma_f32_16x16x32_bf16 v[140:143], v[228:231], v[176:179], 0
    s_waitcnt lgkmcnt(0)
    s_add_u32 m0, s41, 16384
    s_cmp_eq_u32 s53, 2
    s_cselect_b32 s46, 24, 8
    s_add_u32 s46, s46, s52
    s_lshl_b32 s46, s46, 18
    buffer_load_dwordx4 v252, s[8:11], s46 offen offset:0  lds
    s_add_u32 s46, s46, 15360
    buffer_load_dwordx4 v252, s[8:11], s46 offen offset:1024  lds
    s_add_u32 s46, s46, 15360
    buffer_load_dwordx4 v252, s[8:11], s46 offen offset:2048  lds
    s_add_u32 s46, s46, 15360
    buffer_load_dwordx4 v252, s[8:11], s46 offen offset:3072  lds
    v_mfma_f32_16x16x32_bf16 v[0:3], v[232:235], v[180:183], v[0:3]
    v_mfma_f32_16x16x32_bf16 v[4:7], v[236:239], v[180:183], v[4:7]
    v_mfma_f32_16x16x32_bf16 v[8:11], v[240:243], v[180:183], v[8:11]
    v_mfma_f32_16x16x32_bf16 v[12:15], v[244:247], v[180:183], v[12:15]
    s_waitcnt vmcnt(4)
    v_mfma_f32_16x16x32_bf16 v[16:19], v[232:235], v[184:187], v[16:19]
    ds_read_b64_tr_b16 v[216:217], v248 offset:0
    v_mfma_f32_16x16x32_bf16 v[20:23], v[236:239], v[184:187], v[20:23]
    ds_read_b64_tr_b16 v[218:219], v248 offset:2048
    v_mfma_f32_16x16x32_bf16 v[24:27], v[240:243], v[184:187], v[24:27]
    ds_read_b64_tr_b16 v[220:221], v249 offset:0
    v_mfma_f32_16x16x32_bf16 v[28:31], v[244:247], v[184:187], v[28:31]
    ds_read_b64_tr_b16 v[222:223], v249 offset:2048
    v_mfma_f32_16x16x32_bf16 v[32:35], v[232:235], v[188:191], v[32:35]
    ds_read_b64_tr_b16 v[224:225], v250 offset:0
    v_mfma_f32_16x16x32_bf16 v[36:39], v[236:239], v[188:191], v[36:39]
    ds_read_b64_tr_b16 v[226:227], v250 offset:2048
    v_mfma_f32_16x16x32_bf16 v[40:43], v[240:243], v[188:191], v[40:43]
    ds_read_b64_tr_b16 v[228:229], v251 offset:0
    v_mfma_f32_16x16x32_bf16 v[44:47], v[244:247], v[188:191], v[44:47]
    ds_read_b64_tr_b16 v[230:231], v251 offset:2048
    v_mfma_f32_16x16x32_bf16 v[48:51], v[232:235], v[192:195], v[48:51]
    ds_read_b32 v255, v253 offset:96
    v_mfma_f32_16x16x32_bf16 v[52:55], v[236:239], v[192:195], v[52:55]
    v_mfma_f32_16x16x32_bf16 v[56:59], v[240:243], v[192:195], v[56:59]
    v_mfma_f32_16x16x32_bf16 v[60:63], v[244:247], v[192:195], v[60:63]
    v_mfma_f32_16x16x32_bf16 v[64:67], v[232:235], v[196:199], v[64:67]
    s_nop 0
    v_mfma_f32_16x16x32_bf16 v[68:71], v[236:239], v[196:199], v[68:71]
    s_waitcnt lgkmcnt(0)
    v_cmp_gt_u32 vcc, 3, v255
    v_mfma_f32_16x16x32_bf16 v[72:75], v[240:243], v[196:199], v[72:75]
    s_nop 0
    v_mfma_f32_16x16x32_bf16 v[76:79], v[244:247], v[196:199], v[76:79]
    s_cbranch_vccnz G0_b2
G0_b2_ret:
    v_mfma_f32_16x16x32_bf16 v[80:83], v[232:235], v[200:203], v[80:83]
    ds_read_b128 v[144:147], v254 offset:0
    v_mfma_f32_16x16x32_bf16 v[84:87], v[236:239], v[200:203], v[84:87]
    ds_read_b128 v[148:151], v254 offset:1024
    v_mfma_f32_16x16x32_bf16 v[88:91], v[240:243], v[200:203], v[88:91]
    ds_read_b128 v[152:155], v254 offset:2048
    v_mfma_f32_16x16x32_bf16 v[92:95], v[244:247], v[200:203], v[92:95]
    v_mfma_f32_16x16x32_bf16 v[96:99], v[232:235], v[204:207], v[96:99]
    ds_read_b128 v[156:159], v254 offset:3072
    v_mfma_f32_16x16x32_bf16 v[100:103], v[236:239], v[204:207], v[100:103]
    ds_read_b128 v[160:163], v254 offset:4096
    v_mfma_f32_16x16x32_bf16 v[104:107], v[240:243], v[204:207], v[104:107]
    ds_read_b128 v[164:167], v254 offset:5120
    v_mfma_f32_16x16x32_bf16 v[108:111], v[244:247], v[204:207], v[108:111]
    v_mfma_f32_16x16x32_bf16 v[112:115], v[232:235], v[208:211], v[112:115]
    ds_read_b128 v[168:171], v254 offset:6144
    v_mfma_f32_16x16x32_bf16 v[116:119], v[236:239], v[208:211], v[116:119]
    ds_read_b128 v[172:175], v254 offset:7168
    v_mfma_f32_16x16x32_bf16 v[120:123], v[240:243], v[208:211], v[120:123]
    ds_read_b128 v[176:179], v254 offset:8192
    v_mfma_f32_16x16x32_bf16 v[124:127], v[244:247], v[208:211], v[124:127]
    v_mfma_f32_16x16x32_bf16 v[128:131], v[232:235], v[212:215], v[128:131]
    v_mov_b32 v255, 3
    v_mfma_f32_16x16x32_bf16 v[132:135], v[236:239], v[212:215], v[132:135]
    v_mfma_f32_16x16x32_bf16 v[136:139], v[240:243], v[212:215], v[136:139]
    ds_write_b32 v253, v255 offset:112
    v_mfma_f32_16x16x32_bf16 v[140:143], v[244:247], v[212:215], v[140:143]
    s_waitcnt lgkmcnt(0)
    s_add_u32 m0, s41, 0
    s_cmp_eq_u32 s53, 3
    s_cselect_b32 s46, 28, 12
    s_add_u32 s46, s46, s52
    s_lshl_b32 s46, s46, 18
    buffer_load_dwordx4 v252, s[8:11], s46 offen offset:0  lds
    s_add_u32 s46, s46, 15360
    buffer_load_dwordx4 v252, s[8:11], s46 offen offset:1024  lds
    s_add_u32 s46, s46, 15360
    buffer_load_dwordx4 v252, s[8:11], s46 offen offset:2048  lds
    s_add_u32 s46, s46, 15360
    buffer_load_dwordx4 v252, s[8:11], s46 offen offset:3072  lds
    v_mfma_f32_16x16x32_bf16 v[0:3], v[216:219], v[144:147], v[0:3]
    v_mfma_f32_16x16x32_bf16 v[4:7], v[220:223], v[144:147], v[4:7]
    v_mfma_f32_16x16x32_bf16 v[8:11], v[224:227], v[144:147], v[8:11]
    v_mfma_f32_16x16x32_bf16 v[12:15], v[228:231], v[144:147], v[12:15]
    s_waitcnt vmcnt(4)
    v_mfma_f32_16x16x32_bf16 v[16:19], v[216:219], v[148:151], v[16:19]
    ds_read_b64_tr_b16 v[232:233], v248 offset:16384
    v_mfma_f32_16x16x32_bf16 v[20:23], v[220:223], v[148:151], v[20:23]
    ds_read_b64_tr_b16 v[234:235], v248 offset:18432
    v_mfma_f32_16x16x32_bf16 v[24:27], v[224:227], v[148:151], v[24:27]
    ds_read_b64_tr_b16 v[236:237], v249 offset:16384
    v_mfma_f32_16x16x32_bf16 v[28:31], v[228:231], v[148:151], v[28:31]
    ds_read_b64_tr_b16 v[238:239], v249 offset:18432
    v_mfma_f32_16x16x32_bf16 v[32:35], v[216:219], v[152:155], v[32:35]
    ds_read_b64_tr_b16 v[240:241], v250 offset:16384
    v_mfma_f32_16x16x32_bf16 v[36:39], v[220:223], v[152:155], v[36:39]
    ds_read_b64_tr_b16 v[242:243], v250 offset:18432
    v_mfma_f32_16x16x32_bf16 v[40:43], v[224:227], v[152:155], v[40:43]
    ds_read_b64_tr_b16 v[244:245], v251 offset:16384
    v_mfma_f32_16x16x32_bf16 v[44:47], v[228:231], v[152:155], v[44:47]
    ds_read_b64_tr_b16 v[246:247], v251 offset:18432
    v_mfma_f32_16x16x32_bf16 v[48:51], v[216:219], v[156:159], v[48:51]
    ds_read_b32 v255, v253 offset:96
    v_mfma_f32_16x16x32_bf16 v[52:55], v[220:223], v[156:159], v[52:55]
    v_mfma_f32_16x16x32_bf16 v[56:59], v[224:227], v[156:159], v[56:59]
    v_mfma_f32_16x16x32_bf16 v[60:63], v[228:231], v[156:159], v[60:63]
    v_mfma_f32_16x16x32_bf16 v[64:67], v[216:219], v[160:163], v[64:67]
    s_nop 0
    v_mfma_f32_16x16x32_bf16 v[68:71], v[220:223], v[160:163], v[68:71]
    s_waitcnt lgkmcnt(0)
    v_cmp_gt_u32 vcc, 4, v255
    v_mfma_f32_16x16x32_bf16 v[72:75], v[224:227], v[160:163], v[72:75]
    s_nop 0
    v_mfma_f32_16x16x32_bf16 v[76:79], v[228:231], v[160:163], v[76:79]
    s_cbranch_vccnz G0_b3
G0_b3_ret:
    v_mfma_f32_16x16x32_bf16 v[80:83], v[216:219], v[164:167], v[80:83]
    ds_read_b128 v[180:183], v254 offset:36864
    v_mfma_f32_16x16x32_bf16 v[84:87], v[220:223], v[164:167], v[84:87]
    ds_read_b128 v[184:187], v254 offset:37888
    v_mfma_f32_16x16x32_bf16 v[88:91], v[224:227], v[164:167], v[88:91]
    ds_read_b128 v[188:191], v254 offset:38912
    v_mfma_f32_16x16x32_bf16 v[92:95], v[228:231], v[164:167], v[92:95]
    v_mfma_f32_16x16x32_bf16 v[96:99], v[216:219], v[168:171], v[96:99]
    ds_read_b128 v[192:195], v254 offset:39936
    v_mfma_f32_16x16x32_bf16 v[100:103], v[220:223], v[168:171], v[100:103]
    ds_read_b128 v[196:199], v254 offset:40960
    v_mfma_f32_16x16x32_bf16 v[104:107], v[224:227], v[168:171], v[104:107]
    ds_read_b128 v[200:203], v254 offset:41984
    v_mfma_f32_16x16x32_bf16 v[108:111], v[228:231], v[168:171], v[108:111]
    v_mfma_f32_16x16x32_bf16 v[112:115], v[216:219], v[172:175], v[112:115]
    ds_read_b128 v[204:207], v254 offset:43008
    v_mfma_f32_16x16x32_bf16 v[116:119], v[220:223], v[172:175], v[116:119]
    ds_read_b128 v[208:211], v254 offset:44032
    v_mfma_f32_16x16x32_bf16 v[120:123], v[224:227], v[172:175], v[120:123]
    ds_read_b128 v[212:215], v254 offset:45056
    v_mfma_f32_16x16x32_bf16 v[124:127], v[228:231], v[172:175], v[124:127]
    v_mfma_f32_16x16x32_bf16 v[128:131], v[216:219], v[176:179], v[128:131]
    v_mov_b32 v255, 4
    v_mfma_f32_16x16x32_bf16 v[132:135], v[220:223], v[176:179], v[132:135]
    v_mfma_f32_16x16x32_bf16 v[136:139], v[224:227], v[176:179], v[136:139]
    ds_write_b32 v253, v255 offset:112
    v_mfma_f32_16x16x32_bf16 v[140:143], v[228:231], v[176:179], v[140:143]
    s_waitcnt lgkmcnt(0)
    s_add_u32 m0, s41, 16384
    s_cmp_le_u32 s53, 0
    s_cselect_b32 s46, 20, 16
    s_add_u32 s46, s46, s52
    s_lshl_b32 s46, s46, 18
    buffer_load_dwordx4 v252, s[8:11], s46 offen offset:0  lds
    s_add_u32 s46, s46, 15360
    buffer_load_dwordx4 v252, s[8:11], s46 offen offset:1024  lds
    s_add_u32 s46, s46, 15360
    buffer_load_dwordx4 v252, s[8:11], s46 offen offset:2048  lds
    s_add_u32 s46, s46, 15360
    buffer_load_dwordx4 v252, s[8:11], s46 offen offset:3072  lds
    v_mfma_f32_16x16x32_bf16 v[0:3], v[232:235], v[180:183], v[0:3]
    v_mfma_f32_16x16x32_bf16 v[4:7], v[236:239], v[180:183], v[4:7]
    v_mfma_f32_16x16x32_bf16 v[8:11], v[240:243], v[180:183], v[8:11]
    v_mfma_f32_16x16x32_bf16 v[12:15], v[244:247], v[180:183], v[12:15]
    s_waitcnt vmcnt(4)
    v_mfma_f32_16x16x32_bf16 v[16:19], v[232:235], v[184:187], v[16:19]
    ds_read_b64_tr_b16 v[216:217], v248 offset:0
    v_mfma_f32_16x16x32_bf16 v[20:23], v[236:239], v[184:187], v[20:23]
    ds_read_b64_tr_b16 v[218:219], v248 offset:2048
    v_mfma_f32_16x16x32_bf16 v[24:27], v[240:243], v[184:187], v[24:27]
    ds_read_b64_tr_b16 v[220:221], v249 offset:0
    v_mfma_f32_16x16x32_bf16 v[28:31], v[244:247], v[184:187], v[28:31]
    ds_read_b64_tr_b16 v[222:223], v249 offset:2048
    v_mfma_f32_16x16x32_bf16 v[32:35], v[232:235], v[188:191], v[32:35]
    ds_read_b64_tr_b16 v[224:225], v250 offset:0
    v_mfma_f32_16x16x32_bf16 v[36:39], v[236:239], v[188:191], v[36:39]
    ds_read_b64_tr_b16 v[226:227], v250 offset:2048
    v_mfma_f32_16x16x32_bf16 v[40:43], v[240:243], v[188:191], v[40:43]
    ds_read_b64_tr_b16 v[228:229], v251 offset:0
    v_mfma_f32_16x16x32_bf16 v[44:47], v[244:247], v[188:191], v[44:47]
    ds_read_b64_tr_b16 v[230:231], v251 offset:2048
    v_mfma_f32_16x16x32_bf16 v[48:51], v[232:235], v[192:195], v[48:51]
    ds_read_b32 v255, v253 offset:96
    v_mfma_f32_16x16x32_bf16 v[52:55], v[236:239], v[192:195], v[52:55]
    v_mfma_f32_16x16x32_bf16 v[56:59], v[240:243], v[192:195], v[56:59]
    v_mfma_f32_16x16x32_bf16 v[60:63], v[244:247], v[192:195], v[60:63]
    v_mfma_f32_16x16x32_bf16 v[64:67], v[232:235], v[196:199], v[64:67]
    s_nop 0
    v_mfma_f32_16x16x32_bf16 v[68:71], v[236:239], v[196:199], v[68:71]
    s_waitcnt lgkmcnt(0)
    v_cmp_gt_u32 vcc, 5, v255
    v_mfma_f32_16x16x32_bf16 v[72:75], v[240:243], v[196:199], v[72:75]
    s_nop 0
    v_mfma_f32_16x16x32_bf16 v[76:79], v[244:247], v[196:199], v[76:79]
    s_cbranch_vccnz G0_b4
G0_b4_ret:
    v_mfma_f32_16x16x32_bf16 v[80:83], v[232:235], v[200:203], v[80:83]
    ds_read_b128 v[144:147], v254 offset:0
    v_mfma_f32_16x16x32_bf16 v[84:87], v[236:239], v[200:203], v[84:87]
    ds_read_b128 v[148:151], v254 offset:1024
    v_mfma_f32_16x16x32_bf16 v[88:91], v[240:243], v[200:203], v[88:91]
    ds_read_b128 v[152:155], v254 offset:2048
    v_mfma_f32_16x16x32_bf16 v[92:95], v[244:247], v[200:203], v[92:95]
    v_mfma_f32_16x16x32_bf16 v[96:99], v[232:235], v[204:207], v[96:99]
    ds_read_b128 v[156:159], v254 offset:3072
    v_mfma_f32_16x16x32_bf16 v[100:103], v[236:239], v[204:207], v[100:103]
    ds_read_b128 v[160:163], v254 offset:4096
    v_mfma_f32_16x16x32_bf16 v[104:107], v[240:243], v[204:207], v[104:107]
    ds_read_b128 v[164:167], v254 offset:5120
    v_mfma_f32_16x16x32_bf16 v[108:111], v[244:247], v[204:207], v[108:111]
    v_mfma_f32_16x16x32_bf16 v[112:115], v[232:235], v[208:211], v[112:115]
    ds_read_b128 v[168:171], v254 offset:6144
    v_mfma_f32_16x16x32_bf16 v[116:119], v[236:239], v[208:211], v[116:119]
    ds_read_b128 v[172:175], v254 offset:7168
    v_mfma_f32_16x16x32_bf16 v[120:123], v[240:243], v[208:211], v[120:123]
    ds_read_b128 v[176:179], v254 offset:8192
    v_mfma_f32_16x16x32_bf16 v[124:127], v[244:247], v[208:211], v[124:127]
    v_mfma_f32_16x16x32_bf16 v[128:131], v[232:235], v[212:215], v[128:131]
    v_mov_b32 v255, 5
    v_mfma_f32_16x16x32_bf16 v[132:135], v[236:239], v[212:215], v[132:135]
    v_mfma_f32_16x16x32_bf16 v[136:139], v[240:243], v[212:215], v[136:139]
    ds_write_b32 v253, v255 offset:112
    v_mfma_f32_16x16x32_bf16 v[140:143], v[244:247], v[212:215], v[140:143]
    s_waitcnt lgkmcnt(0)
    s_add_u32 m0, s41, 0
    s_cmp_le_u32 s53, 1
    s_cselect_b32 s46, 24, 20
    s_add_u32 s46, s46, s52
    s_lshl_b32 s46, s46, 18
    buffer_load_dwordx4 v252, s[8:11], s46 offen offset:0  lds
    s_add_u32 s46, s46, 15360
    buffer_load_dwordx4 v252, s[8:11], s46 offen offset:1024  lds
    s_add_u32 s46, s46, 15360
    buffer_load_dwordx4 v252, s[8:11], s46 offen offset:2048  lds
    s_add_u32 s46, s46, 15360
    buffer_load_dwordx4 v252, s[8:11], s46 offen offset:3072  lds
    v_mfma_f32_16x16x32_bf16 v[0:3], v[216:219], v[144:147], v[0:3]
    v_mfma_f32_16x16x32_bf16 v[4:7], v[220:223], v[144:147], v[4:7]
    v_mfma_f32_16x16x32_bf16 v[8:11], v[224:227], v[144:147], v[8:11]
    v_mfma_f32_16x16x32_bf16 v[12:15], v[228:231], v[144:147], v[12:15]
    s_waitcnt vmcnt(4)
    v_mfma_f32_16x16x32_bf16 v[16:19], v[216:219], v[148:151], v[16:19]
    ds_read_b64_tr_b16 v[232:233], v248 offset:16384
    v_mfma_f32_16x16x32_bf16 v[20:23], v[220:223], v[148:151], v[20:23]
    ds_read_b64_tr_b16 v[234:235], v248 offset:18432
    v_mfma_f32_16x16x32_bf16 v[24:27], v[224:227], v[148:151], v[24:27]
    ds_read_b64_tr_b16 v[236:237], v249 offset:16384
    v_mfma_f32_16x16x32_bf16 v[28:31], v[228:231], v[148:151], v[28:31]
    ds_read_b64_tr_b16 v[238:239], v249 offset:18432
    v_mfma_f32_16x16x32_bf16 v[32:35], v[216:219], v[152:155], v[32:35]
    ds_read_b64_tr_b16 v[240:241], v250 offset:16384
    v_mfma_f32_16x16x32_bf16 v[36:39], v[220:223], v[152:155], v[36:39]
    ds_read_b64_tr_b16 v[242:243], v250 offset:18432
    v_mfma_f32_16x16x32_bf16 v[40:43], v[224:227], v[152:155], v[40:43]
    ds_read_b64_tr_b16 v[244:245], v251 offset:16384
    v_mfma_f32_16x16x32_bf16 v[44:47], v[228:231], v[152:155], v[44:47]
    ds_read_b64_tr_b16 v[246:247], v251 offset:18432
    v_mfma_f32_16x16x32_bf16 v[48:51], v[216:219], v[156:159], v[48:51]
    ds_read_b32 v255, v253 offset:96
    v_mfma_f32_16x16x32_bf16 v[52:55], v[220:223], v[156:159], v[52:55]
    v_mfma_f32_16x16x32_bf16 v[56:59], v[224:227], v[156:159], v[56:59]
    v_mfma_f32_16x16x32_bf16 v[60:63], v[228:231], v[156:159], v[60:63]
    v_mfma_f32_16x16x32_bf16 v[64:67], v[216:219], v[160:163], v[64:67]
    s_nop 0
    v_mfma_f32_16x16x32_bf16 v[68:71], v[220:223], v[160:163], v[68:71]
    s_waitcnt lgkmcnt(0)
    v_cmp_gt_u32 vcc, 6, v255
    v_mfma_f32_16x16x32_bf16 v[72:75], v[224:227], v[160:163], v[72:75]
    s_nop 0
    v_mfma_f32_16x16x32_bf16 v[76:79], v[228:231], v[160:163], v[76:79]
    s_cbranch_vccnz G0_b5
G0_b5_ret:
    v_mfma_f32_16x16x32_bf16 v[80:83], v[216:219], v[164:167], v[80:83]
    ds_read_b128 v[180:183], v254 offset:36864
    v_mfma_f32_16x16x32_bf16 v[84:87], v[220:223], v[164:167], v[84:87]
    ds_read_b128 v[184:187], v254 offset:37888
    v_mfma_f32_16x16x32_bf16 v[88:91], v[224:227], v[164:167], v[88:91]
    ds_read_b128 v[188:191], v254 offset:38912
    v_mfma_f32_16x16x32_bf16 v[92:95], v[228:231], v[164:167], v[92:95]
    v_mfma_f32_16x16x32_bf16 v[96:99], v[216:219], v[168:171], v[96:99]
    ds_read_b128 v[192:195], v254 offset:39936
    v_mfma_f32_16x16x32_bf16 v[100:103], v[220:223], v[168:171], v[100:103]
    ds_read_b128 v[196:199], v254 offset:40960
    v_mfma_f32_16x16x32_bf16 v[104:107], v[224:227], v[168:171], v[104:107]
    ds_read_b128 v[200:203], v254 offset:41984
    v_mfma_f32_16x16x32_bf16 v[108:111], v[228:231], v[168:171], v[108:111]
    v_mfma_f32_16x16x32_bf16 v[112:115], v[216:219], v[172:175], v[112:115]
    ds_read_b128 v[204:207], v254 offset:43008
    v_mfma_f32_16x16x32_bf16 v[116:119], v[220:223], v[172:175], v[116:119]
    ds_read_b128 v[208:211], v254 offset:44032
    v_mfma_f32_16x16x32_bf16 v[120:123], v[224:227], v[172:175], v[120:123]
    ds_read_b128 v[212:215], v254 offset:45056
    v_mfma_f32_16x16x32_bf16 v[124:127], v[228:231], v[172:175], v[124:127]
    v_mfma_f32_16x16x32_bf16 v[128:131], v[216:219], v[176:179], v[128:131]
    v_mov_b32 v255, 6
    v_mfma_f32_16x16x32_bf16 v[132:135], v[220:223], v[176:179], v[132:135]
    v_mfma_f32_16x16x32_bf16 v[136:139], v[224:227], v[176:179], v[136:139]
    ds_write_b32 v253, v255 offset:112
    v_mfma_f32_16x16x32_bf16 v[140:143], v[228:231], v[176:179], v[140:143]
    s_waitcnt lgkmcnt(0)
    s_add_u32 m0, s41, 16384
    s_cmp_le_u32 s53, 2
    s_cselect_b32 s46, 28, 24
    s_add_u32 s46, s46, s52
    s_lshl_b32 s46, s46, 18
    buffer_load_dwordx4 v252, s[8:11], s46 offen offset:0  lds
    s_add_u32 s46, s46, 15360
    buffer_load_dwordx4 v252, s[8:11], s46 offen offset:1024  lds
    s_add_u32 s46, s46, 15360
    buffer_load_dwordx4 v252, s[8:11], s46 offen offset:2048  lds
    s_add_u32 s46, s46, 15360
    buffer_load_dwordx4 v252, s[8:11], s46 offen offset:3072  lds
    v_mfma_f32_16x16x32_bf16 v[0:3], v[232:235], v[180:183], v[0:3]
    v_mfma_f32_16x16x32_bf16 v[4:7], v[236:239], v[180:183], v[4:7]
    v_mfma_f32_16x16x32_bf16 v[8:11], v[240:243], v[180:183], v[8:11]
    v_mfma_f32_16x16x32_bf16 v[12:15], v[244:247], v[180:183], v[12:15]
    s_waitcnt vmcnt(4)
    v_mfma_f32_16x16x32_bf16 v[16:19], v[232:235], v[184:187], v[16:19]
    ds_read_b64_tr_b16 v[216:217], v248 offset:0
    v_mfma_f32_16x16x32_bf16 v[20:23], v[236:239], v[184:187], v[20:23]
    ds_read_b64_tr_b16 v[218:219], v248 offset:2048
    v_mfma_f32_16x16x32_bf16 v[24:27], v[240:243], v[184:187], v[24:27]
    ds_read_b64_tr_b16 v[220:221], v249 offset:0
    v_mfma_f32_16x16x32_bf16 v[28:31], v[244:247], v[184:187], v[28:31]
    ds_read_b64_tr_b16 v[222:223], v249 offset:2048
    v_mfma_f32_16x16x32_bf16 v[32:35], v[232:235], v[188:191], v[32:35]
    ds_read_b64_tr_b16 v[224:225], v250 offset:0
    v_mfma_f32_16x16x32_bf16 v[36:39], v[236:239], v[188:191], v[36:39]
    ds_read_b64_tr_b16 v[226:227], v250 offset:2048
    v_mfma_f32_16x16x32_bf16 v[40:43], v[240:243], v[188:191], v[40:43]
    ds_read_b64_tr_b16 v[228:229], v251 offset:0
    v_mfma_f32_16x16x32_bf16 v[44:47], v[244:247], v[188:191], v[44:47]
    ds_read_b64_tr_b16 v[230:231], v251 offset:2048
    v_mfma_f32_16x16x32_bf16 v[48:51], v[232:235], v[192:195], v[48:51]
    ds_read_b32 v255, v253 offset:96
    v_mfma_f32_16x16x32_bf16 v[52:55], v[236:239], v[192:195], v[52:55]
    v_mfma_f32_16x16x32_bf16 v[56:59], v[240:243], v[192:195], v[56:59]
    v_mfma_f32_16x16x32_bf16 v[60:63], v[244:247], v[192:195], v[60:63]
    v_mfma_f32_16x16x32_bf16 v[64:67], v[232:235], v[196:199], v[64:67]
    s_nop 0
    v_mfma_f32_16x16x32_bf16 v[68:71], v[236:239], v[196:199], v[68:71]
    s_waitcnt lgkmcnt(0)
    v_cmp_gt_u32 vcc, 7, v255
    v_mfma_f32_16x16x32_bf16 v[72:75], v[240:243], v[196:199], v[72:75]
    s_nop 0
    v_mfma_f32_16x16x32_bf16 v[76:79], v[244:247], v[196:199], v[76:79]
    s_cbranch_vccnz G0_b6
G0_b6_ret:
    v_mfma_f32_16x16x32_bf16 v[80:83], v[232:235], v[200:203], v[80:83]
    ds_read_b128 v[144:147], v254 offset:0
    v_mfma_f32_16x16x32_bf16 v[84:87], v[236:239], v[200:203], v[84:87]
    ds_read_b128 v[148:151], v254 offset:1024
    v_mfma_f32_16x16x32_bf16 v[88:91], v[240:243], v[200:203], v[88:91]
    ds_read_b128 v[152:155], v254 offset:2048
    v_mfma_f32_16x16x32_bf16 v[92:95], v[244:247], v[200:203], v[92:95]
    v_mfma_f32_16x16x32_bf16 v[96:99], v[232:235], v[204:207], v[96:99]
    ds_read_b128 v[156:159], v254 offset:3072
    v_mfma_f32_16x16x32_bf16 v[100:103], v[236:239], v[204:207], v[100:103]
    ds_read_b128 v[160:163], v254 offset:4096
    v_mfma_f32_16x16x32_bf16 v[104:107], v[240:243], v[204:207], v[104:107]
    ds_read_b128 v[164:167], v254 offset:5120
    v_mfma_f32_16x16x32_bf16 v[108:111], v[244:247], v[204:207], v[108:111]
    v_mfma_f32_16x16x32_bf16 v[112:115], v[232:235], v[208:211], v[112:115]
    ds_read_b128 v[168:171], v254 offset:6144
    v_mfma_f32_16x16x32_bf16 v[116:119], v[236:239], v[208:211], v[116:119]
    ds_read_b128 v[172:175], v254 offset:7168
    v_mfma_f32_16x16x32_bf16 v[120:123], v[240:243], v[208:211], v[120:123]
    ds_read_b128 v[176:179], v254 offset:8192
    v_mfma_f32_16x16x32_bf16 v[124:127], v[244:247], v[208:211], v[124:127]
    v_mfma_f32_16x16x32_bf16 v[128:131], v[232:235], v[212:215], v[128:131]
    v_mov_b32 v255, 7
    v_mfma_f32_16x16x32_bf16 v[132:135], v[236:239], v[212:215], v[132:135]
    v_mfma_f32_16x16x32_bf16 v[136:139], v[240:243], v[212:215], v[136:139]
    ds_write_b32 v253, v255 offset:112
    v_mfma_f32_16x16x32_bf16 v[140:143], v[244:247], v[212:215], v[140:143]
    s_waitcnt lgkmcnt(0)
    s_add_u32 m0, s41, 0
    s_mul_i32 s46, s53, 4
    s_add_u32 s46, s46, 1
    s_add_u32 s46, s46, s52
    s_lshl_b32 s46, s46, 18
    buffer_load_dwordx4 v252, s[8:11], s46 offen offset:0  lds
    s_add_u32 s46, s46, 15360
    buffer_load_dwordx4 v252, s[8:11], s46 offen offset:1024  lds
    s_add_u32 s46, s46, 15360
    buffer_load_dwordx4 v252, s[8:11], s46 offen offset:2048  lds
    s_add_u32 s46, s46, 15360
    buffer_load_dwordx4 v252, s[8:11], s46 offen offset:3072  lds
    v_mfma_f32_16x16x32_bf16 v[0:3], v[216:219], v[144:147], v[0:3]
    v_mfma_f32_16x16x32_bf16 v[4:7], v[220:223], v[144:147], v[4:7]
    v_mfma_f32_16x16x32_bf16 v[8:11], v[224:227], v[144:147], v[8:11]
    v_mfma_f32_16x16x32_bf16 v[12:15], v[228:231], v[144:147], v[12:15]
    s_waitcnt vmcnt(4)
    v_mfma_f32_16x16x32_bf16 v[16:19], v[216:219], v[148:151], v[16:19]
    ds_read_b64_tr_b16 v[232:233], v248 offset:16384
    v_mfma_f32_16x16x32_bf16 v[20:23], v[220:223], v[148:151], v[20:23]
    ds_read_b64_tr_b16 v[234:235], v248 offset:18432
    v_mfma_f32_16x16x32_bf16 v[24:27], v[224:227], v[148:151], v[24:27]
    ds_read_b64_tr_b16 v[236:237], v249 offset:16384
    v_mfma_f32_16x16x32_bf16 v[28:31], v[228:231], v[148:151], v[28:31]
    ds_read_b64_tr_b16 v[238:239], v249 offset:18432
    v_mfma_f32_16x16x32_bf16 v[32:35], v[216:219], v[152:155], v[32:35]
    ds_read_b64_tr_b16 v[240:241], v250 offset:16384
    v_mfma_f32_16x16x32_bf16 v[36:39], v[220:223], v[152:155], v[36:39]
    ds_read_b64_tr_b16 v[242:243], v250 offset:18432
    v_mfma_f32_16x16x32_bf16 v[40:43], v[224:227], v[152:155], v[40:43]
    ds_read_b64_tr_b16 v[244:245], v251 offset:16384
    v_mfma_f32_16x16x32_bf16 v[44:47], v[228:231], v[152:155], v[44:47]
    ds_read_b64_tr_b16 v[246:247], v251 offset:18432
    v_mfma_f32_16x16x32_bf16 v[48:51], v[216:219], v[156:159], v[48:51]
    ds_read_b32 v255, v253 offset:96
    v_mfma_f32_16x16x32_bf16 v[52:55], v[220:223], v[156:159], v[52:55]
    v_mfma_f32_16x16x32_bf16 v[56:59], v[224:227], v[156:159], v[56:59]
    v_mfma_f32_16x16x32_bf16 v[60:63], v[228:231], v[156:159], v[60:63]
    v_mfma_f32_16x16x32_bf16 v[64:67], v[216:219], v[160:163], v[64:67]
    s_nop 0
    v_mfma_f32_16x16x32_bf16 v[68:71], v[220:223], v[160:163], v[68:71]
    s_waitcnt lgkmcnt(0)
    v_cmp_gt_u32 vcc, 8, v255
    v_mfma_f32_16x16x32_bf16 v[72:75], v[224:227], v[160:163], v[72:75]
    s_nop 0
    v_mfma_f32_16x16x32_bf16 v[76:79], v[228:231], v[160:163], v[76:79]
    s_cbranch_vccnz G0_b7
G0_b7_ret:
    v_mfma_f32_16x16x32_bf16 v[80:83], v[216:219], v[164:167], v[80:83]
    ds_read_b128 v[180:183], v254 offset:36864
    v_mfma_f32_16x16x32_bf16 v[84:87], v[220:223], v[164:167], v[84:87]
    ds_read_b128 v[184:187], v254 offset:37888
    v_mfma_f32_16x16x32_bf16 v[88:91], v[224:227], v[164:167], v[88:91]
    ds_read_b128 v[188:191], v254 offset:38912
    v_mfma_f32_16x16x32_bf16 v[92:95], v[228:231], v[164:167], v[92:95]
    v_mfma_f32_16x16x32_bf16 v[96:99], v[216:219], v[168:171], v[96:99]
    ds_read_b128 v[192:195], v254 offset:39936
    v_mfma_f32_16x16x32_bf16 v[100:103], v[220:223], v[168:171], v[100:103]
    ds_read_b128 v[196:199], v254 offset:40960
    v_mfma_f32_16x16x32_bf16 v[104:107], v[224:227], v[168:171], v[104:107]
    ds_read_b128 v[200:203], v254 offset:41984
    v_mfma_f32_16x16x32_bf16 v[108:111], v[228:231], v[168:171], v[108:111]
    v_mfma_f32_16x16x32_bf16 v[112:115], v[216:219], v[172:175], v[112:115]
    ds_read_b128 v[204:207], v254 offset:43008
    v_mfma_f32_16x16x32_bf16 v[116:119], v[220:223], v[172:175], v[116:119]
    ds_read_b128 v[208:211], v254 offset:44032
    v_mfma_f32_16x16x32_bf16 v[120:123], v[224:227], v[172:175], v[120:123]
    ds_read_b128 v[212:215], v254 offset:45056
    v_mfma_f32_16x16x32_bf16 v[124:127], v[228:231], v[172:175], v[124:127]
    v_mfma_f32_16x16x32_bf16 v[128:131], v[216:219], v[176:179], v[128:131]
    v_mov_b32 v255, 8
    v_mfma_f32_16x16x32_bf16 v[132:135], v[220:223], v[176:179], v[132:135]
    v_mfma_f32_16x16x32_bf16 v[136:139], v[224:227], v[176:179], v[136:139]
    ds_write_b32 v253, v255 offset:112
    v_mfma_f32_16x16x32_bf16 v[140:143], v[228:231], v[176:179], v[140:143]
    s_waitcnt lgkmcnt(0)
    s_add_u32 m0, s41, 16384
    s_cmp_le_u32 s53, 0
    s_cselect_b32 s46, 5, 1
    s_add_u32 s46, s46, s52
    s_lshl_b32 s46, s46, 18
    buffer_load_dwordx4 v252, s[8:11], s46 offen offset:0  lds
    s_add_u32 s46, s46, 15360
    buffer_load_dwordx4 v252, s[8:11], s46 offen offset:1024  lds
    s_add_u32 s46, s46, 15360
    buffer_load_dwordx4 v252, s[8:11], s46 offen offset:2048  lds
    s_add_u32 s46, s46, 15360
    buffer_load_dwordx4 v252, s[8:11], s46 offen offset:3072  lds
    v_mfma_f32_16x16x32_bf16 v[0:3], v[232:235], v[180:183], v[0:3]
    v_mfma_f32_16x16x32_bf16 v[4:7], v[236:239], v[180:183], v[4:7]
    v_mfma_f32_16x16x32_bf16 v[8:11], v[240:243], v[180:183], v[8:11]
    v_mfma_f32_16x16x32_bf16 v[12:15], v[244:247], v[180:183], v[12:15]
    s_waitcnt vmcnt(4)
    v_mfma_f32_16x16x32_bf16 v[16:19], v[232:235], v[184:187], v[16:19]
    ds_read_b64_tr_b16 v[216:217], v248 offset:0
    v_mfma_f32_16x16x32_bf16 v[20:23], v[236:239], v[184:187], v[20:23]
    ds_read_b64_tr_b16 v[218:219], v248 offset:2048
    v_mfma_f32_16x16x32_bf16 v[24:27], v[240:243], v[184:187], v[24:27]
    ds_read_b64_tr_b16 v[220:221], v249 offset:0
    v_mfma_f32_16x16x32_bf16 v[28:31], v[244:247], v[184:187], v[28:31]
    ds_read_b64_tr_b16 v[222:223], v249 offset:2048
    v_mfma_f32_16x16x32_bf16 v[32:35], v[232:235], v[188:191], v[32:35]
    ds_read_b64_tr_b16 v[224:225], v250 offset:0
    v_mfma_f32_16x16x32_bf16 v[36:39], v[236:239], v[188:191], v[36:39]
    ds_read_b64_tr_b16 v[226:227], v250 offset:2048
    v_mfma_f32_16x16x32_bf16 v[40:43], v[240:243], v[188:191], v[40:43]
    ds_read_b64_tr_b16 v[228:229], v251 offset:0
    v_mfma_f32_16x16x32_bf16 v[44:47], v[244:247], v[188:191], v[44:47]
    ds_read_b64_tr_b16 v[230:231], v251 offset:2048
    v_mfma_f32_16x16x32_bf16 v[48:51], v[232:235], v[192:195], v[48:51]
    ds_read_b32 v255, v253 offset:96
    v_mfma_f32_16x16x32_bf16 v[52:55], v[236:239], v[192:195], v[52:55]
    v_mfma_f32_16x16x32_bf16 v[56:59], v[240:243], v[192:195], v[56:59]
    v_mfma_f32_16x16x32_bf16 v[60:63], v[244:247], v[192:195], v[60:63]
    v_mfma_f32_16x16x32_bf16 v[64:67], v[232:235], v[196:199], v[64:67]
    s_nop 0
    v_mfma_f32_16x16x32_bf16 v[68:71], v[236:239], v[196:199], v[68:71]
    s_waitcnt lgkmcnt(0)
    v_cmp_gt_u32 vcc, 9, v255
    v_mfma_f32_16x16x32_bf16 v[72:75], v[240:243], v[196:199], v[72:75]
    s_nop 0
    v_mfma_f32_16x16x32_bf16 v[76:79], v[244:247], v[196:199], v[76:79]
    s_cbranch_vccnz G0_b8
G0_b8_ret:
    v_mfma_f32_16x16x32_bf16 v[80:83], v[232:235], v[200:203], v[80:83]
    ds_read_b128 v[144:147], v254 offset:0
    v_mfma_f32_16x16x32_bf16 v[84:87], v[236:239], v[200:203], v[84:87]
    ds_read_b128 v[148:151], v254 offset:1024
    v_mfma_f32_16x16x32_bf16 v[88:91], v[240:243], v[200:203], v[88:91]
    ds_read_b128 v[152:155], v254 offset:2048
    v_mfma_f32_16x16x32_bf16 v[92:95], v[244:247], v[200:203], v[92:95]
    v_mfma_f32_16x16x32_bf16 v[96:99], v[232:235], v[204:207], v[96:99]
    ds_read_b128 v[156:159], v254 offset:3072
    v_mfma_f32_16x16x32_bf16 v[100:103], v[236:239], v[204:207], v[100:103]
    ds_read_b128 v[160:163], v254 offset:4096
    v_mfma_f32_16x16x32_bf16 v[104:107], v[240:243], v[204:207], v[104:107]
    ds_read_b128 v[164:167], v254 offset:5120
    v_mfma_f32_16x16x32_bf16 v[108:111], v[244:247], v[204:207], v[108:111]
    v_mfma_f32_16x16x32_bf16 v[112:115], v[232:235], v[208:211], v[112:115]
    ds_read_b128 v[168:171], v254 offset:6144
    v_mfma_f32_16x16x32_bf16 v[116:119], v[236:239], v[208:211], v[116:119]
    ds_read_b128 v[172:175], v254 offset:7168
    v_mfma_f32_16x16x32_bf16 v[120:123], v[240:243], v[208:211], v[120:123]
    ds_read_b128 v[176:179], v254 offset:8192
    v_mfma_f32_16x16x32_bf16 v[124:127], v[244:247], v[208:211], v[124:127]
    v_mfma_f32_16x16x32_bf16 v[128:131], v[232:235], v[212:215], v[128:131]
    v_mov_b32 v255, 9
    v_mfma_f32_16x16x32_bf16 v[132:135], v[236:239], v[212:215], v[132:135]
    v_mfma_f32_16x16x32_bf16 v[136:139], v[240:243], v[212:215], v[136:139]
    ds_write_b32 v253, v255 offset:112
    v_mfma_f32_16x16x32_bf16 v[140:143], v[244:247], v[212:215], v[140:143]
    s_waitcnt lgkmcnt(0)
    s_add_u32 m0, s41, 0
    s_cmp_le_u32 s53, 1
    s_cselect_b32 s46, 9, 5
    s_add_u32 s46, s46, s52
    s_lshl_b32 s46, s46, 18
    buffer_load_dwordx4 v252, s[8:11], s46 offen offset:0  lds
    s_add_u32 s46, s46, 15360
    buffer_load_dwordx4 v252, s[8:11], s46 offen offset:1024  lds
    s_add_u32 s46, s46, 15360
    buffer_load_dwordx4 v252, s[8:11], s46 offen offset:2048  lds
    s_add_u32 s46, s46, 15360
    buffer_load_dwordx4 v252, s[8:11], s46 offen offset:3072  lds
    v_mfma_f32_16x16x32_bf16 v[0:3], v[216:219], v[144:147], v[0:3]
    v_mfma_f32_16x16x32_bf16 v[4:7], v[220:223], v[144:147], v[4:7]
    v_mfma_f32_16x16x32_bf16 v[8:11], v[224:227], v[144:147], v[8:11]
    v_mfma_f32_16x16x32_bf16 v[12:15], v[228:231], v[144:147], v[12:15]
    s_waitcnt vmcnt(4)
    v_mfma_f32_16x16x32_bf16 v[16:19], v[216:219], v[148:151], v[16:19]
    ds_read_b64_tr_b16 v[232:233], v248 offset:16384
    v_mfma_f32_16x16x32_bf16 v[20:23], v[220:223], v[148:151], v[20:23]
    ds_read_b64_tr_b16 v[234:235], v248 offset:18432
    v_mfma_f32_16x16x32_bf16 v[24:27], v[224:227], v[148:151], v[24:27]
    ds_read_b64_tr_b16 v[236:237], v249 offset:16384
    v_mfma_f32_16x16x32_bf16 v[28:31], v[228:231], v[148:151], v[28:31]
    ds_read_b64_tr_b16 v[238:239], v249 offset:18432
    v_mfma_f32_16x16x32_bf16 v[32:35], v[216:219], v[152:155], v[32:35]
    ds_read_b64_tr_b16 v[240:241], v250 offset:16384
    v_mfma_f32_16x16x32_bf16 v[36:39], v[220:223], v[152:155], v[36:39]
    ds_read_b64_tr_b16 v[242:243], v250 offset:18432
    v_mfma_f32_16x16x32_bf16 v[40:43], v[224:227], v[152:155], v[40:43]
    ds_read_b64_tr_b16 v[244:245], v251 offset:16384
    v_mfma_f32_16x16x32_bf16 v[44:47], v[228:231], v[152:155], v[44:47]
    ds_read_b64_tr_b16 v[246:247], v251 offset:18432
    v_mfma_f32_16x16x32_bf16 v[48:51], v[216:219], v[156:159], v[48:51]
    ds_read_b32 v255, v253 offset:96
    v_mfma_f32_16x16x32_bf16 v[52:55], v[220:223], v[156:159], v[52:55]
    v_mfma_f32_16x16x32_bf16 v[56:59], v[224:227], v[156:159], v[56:59]
    v_mfma_f32_16x16x32_bf16 v[60:63], v[228:231], v[156:159], v[60:63]
    v_mfma_f32_16x16x32_bf16 v[64:67], v[216:219], v[160:163], v[64:67]
    s_nop 0
    v_mfma_f32_16x16x32_bf16 v[68:71], v[220:223], v[160:163], v[68:71]
    s_waitcnt lgkmcnt(0)
    v_cmp_gt_u32 vcc, 10, v255
    v_mfma_f32_16x16x32_bf16 v[72:75], v[224:227], v[160:163], v[72:75]
    s_nop 0
    v_mfma_f32_16x16x32_bf16 v[76:79], v[228:231], v[160:163], v[76:79]
    s_cbranch_vccnz G0_b9
G0_b9_ret:
    v_mfma_f32_16x16x32_bf16 v[80:83], v[216:219], v[164:167], v[80:83]
    ds_read_b128 v[180:183], v254 offset:36864
    v_mfma_f32_16x16x32_bf16 v[84:87], v[220:223], v[164:167], v[84:87]
    ds_read_b128 v[184:187], v254 offset:37888
    v_mfma_f32_16x16x32_bf16 v[88:91], v[224:227], v[164:167], v[88:91]
    ds_read_b128 v[188:191], v254 offset:38912
    v_mfma_f32_16x16x32_bf16 v[92:95], v[228:231], v[164:167], v[92:95]
    v_mfma_f32_16x16x32_bf16 v[96:99], v[216:219], v[168:171], v[96:99]
    ds_read_b128 v[192:195], v254 offset:39936
    v_mfma_f32_16x16x32_bf16 v[100:103], v[220:223], v[168:171], v[100:103]
    ds_read_b128 v[196:199], v254 offset:40960
    v_mfma_f32_16x16x32_bf16 v[104:107], v[224:227], v[168:171], v[104:107]
    ds_read_b128 v[200:203], v254 offset:41984
    v_mfma_f32_16x16x32_bf16 v[108:111], v[228:231], v[168:171], v[108:111]
    v_mfma_f32_16x16x32_bf16 v[112:115], v[216:219], v[172:175], v[112:115]
    ds_read_b128 v[204:207], v254 offset:43008
    v_mfma_f32_16x16x32_bf16 v[116:119], v[220:223], v[172:175], v[116:119]
    ds_read_b128 v[208:211], v254 offset:44032
    v_mfma_f32_16x16x32_bf16 v[120:123], v[224:227], v[172:175], v[120:123]
    ds_read_b128 v[212:215], v254 offset:45056
    v_mfma_f32_16x16x32_bf16 v[124:127], v[228:231], v[172:175], v[124:127]
    v_mfma_f32_16x16x32_bf16 v[128:131], v[216:219], v[176:179], v[128:131]
    v_mov_b32 v255, 10
    v_mfma_f32_16x16x32_bf16 v[132:135], v[220:223], v[176:179], v[132:135]
    v_mfma_f32_16x16x32_bf16 v[136:139], v[224:227], v[176:179], v[136:139]
    ds_write_b32 v253, v255 offset:112
    v_mfma_f32_16x16x32_bf16 v[140:143], v[228:231], v[176:179], v[140:143]
    s_waitcnt lgkmcnt(0)
    s_add_u32 m0, s41, 16384
    s_cmp_le_u32 s53, 2
    s_cselect_b32 s46, 13, 9
    s_add_u32 s46, s46, s52
    s_lshl_b32 s46, s46, 18
    buffer_load_dwordx4 v252, s[8:11], s46 offen offset:0  lds
    s_add_u32 s46, s46, 15360
    buffer_load_dwordx4 v252, s[8:11], s46 offen offset:1024  lds
    s_add_u32 s46, s46, 15360
    buffer_load_dwordx4 v252, s[8:11], s46 offen offset:2048  lds
    s_add_u32 s46, s46, 15360
    buffer_load_dwordx4 v252, s[8:11], s46 offen offset:3072  lds
    v_mfma_f32_16x16x32_bf16 v[0:3], v[232:235], v[180:183], v[0:3]
    v_mfma_f32_16x16x32_bf16 v[4:7], v[236:239], v[180:183], v[4:7]
    v_mfma_f32_16x16x32_bf16 v[8:11], v[240:243], v[180:183], v[8:11]
    v_mfma_f32_16x16x32_bf16 v[12:15], v[244:247], v[180:183], v[12:15]
    s_waitcnt vmcnt(4)
    v_mfma_f32_16x16x32_bf16 v[16:19], v[232:235], v[184:187], v[16:19]
    ds_read_b64_tr_b16 v[216:217], v248 offset:0
    v_mfma_f32_16x16x32_bf16 v[20:23], v[236:239], v[184:187], v[20:23]
    ds_read_b64_tr_b16 v[218:219], v248 offset:2048
    v_mfma_f32_16x16x32_bf16 v[24:27], v[240:243], v[184:187], v[24:27]
    ds_read_b64_tr_b16 v[220:221], v249 offset:0
    v_mfma_f32_16x16x32_bf16 v[28:31], v[244:247], v[184:187], v[28:31]
    ds_read_b64_tr_b16 v[222:223], v249 offset:2048
    v_mfma_f32_16x16x32_bf16 v[32:35], v[232:235], v[188:191], v[32:35]
    ds_read_b64_tr_b16 v[224:225], v250 offset:0
    v_mfma_f32_16x16x32_bf16 v[36:39], v[236:239], v[188:191], v[36:39]
    ds_read_b64_tr_b16 v[226:227], v250 offset:2048
    v_mfma_f32_16x16x32_bf16 v[40:43], v[240:243], v[188:191], v[40:43]
    ds_read_b64_tr_b16 v[228:229], v251 offset:0
    v_mfma_f32_16x16x32_bf16 v[44:47], v[244:247], v[188:191], v[44:47]
    ds_read_b64_tr_b16 v[230:231], v251 offset:2048
    v_mfma_f32_16x16x32_bf16 v[48:51], v[232:235], v[192:195], v[48:51]
    ds_read_b32 v255, v253 offset:96
    v_mfma_f32_16x16x32_bf16 v[52:55], v[236:239], v[192:195], v[52:55]
    v_mfma_f32_16x16x32_bf16 v[56:59], v[240:243], v[192:195], v[56:59]
    v_mfma_f32_16x16x32_bf16 v[60:63], v[244:247], v[192:195], v[60:63]
    v_mfma_f32_16x16x32_bf16 v[64:67], v[232:235], v[196:199], v[64:67]
    s_nop 0
    v_mfma_f32_16x16x32_bf16 v[68:71], v[236:239], v[196:199], v[68:71]
    s_waitcnt lgkmcnt(0)
    v_cmp_gt_u32 vcc, 11, v255
    v_mfma_f32_16x16x32_bf16 v[72:75], v[240:243], v[196:199], v[72:75]
    s_nop 0
    v_mfma_f32_16x16x32_bf16 v[76:79], v[244:247], v[196:199], v[76:79]
    s_cbranch_vccnz G0_b10
G0_b10_ret:
    v_mfma_f32_16x16x32_bf16 v[80:83], v[232:235], v[200:203], v[80:83]
    ds_read_b128 v[144:147], v254 offset:0
    v_mfma_f32_16x16x32_bf16 v[84:87], v[236:239], v[200:203], v[84:87]
    ds_read_b128 v[148:151], v254 offset:1024
    v_mfma_f32_16x16x32_bf16 v[88:91], v[240:243], v[200:203], v[88:91]
    ds_read_b128 v[152:155], v254 offset:2048
    v_mfma_f32_16x16x32_bf16 v[92:95], v[244:247], v[200:203], v[92:95]
    v_mfma_f32_16x16x32_bf16 v[96:99], v[232:235], v[204:207], v[96:99]
    ds_read_b128 v[156:159], v254 offset:3072
    v_mfma_f32_16x16x32_bf16 v[100:103], v[236:239], v[204:207], v[100:103]
    ds_read_b128 v[160:163], v254 offset:4096
    v_mfma_f32_16x16x32_bf16 v[104:107], v[240:243], v[204:207], v[104:107]
    ds_read_b128 v[164:167], v254 offset:5120
    v_mfma_f32_16x16x32_bf16 v[108:111], v[244:247], v[204:207], v[108:111]
    v_mfma_f32_16x16x32_bf16 v[112:115], v[232:235], v[208:211], v[112:115]
    ds_read_b128 v[168:171], v254 offset:6144
    v_mfma_f32_16x16x32_bf16 v[116:119], v[236:239], v[208:211], v[116:119]
    ds_read_b128 v[172:175], v254 offset:7168
    v_mfma_f32_16x16x32_bf16 v[120:123], v[240:243], v[208:211], v[120:123]
    ds_read_b128 v[176:179], v254 offset:8192
    v_mfma_f32_16x16x32_bf16 v[124:127], v[244:247], v[208:211], v[124:127]
    v_mfma_f32_16x16x32_bf16 v[128:131], v[232:235], v[212:215], v[128:131]
    v_mov_b32 v255, 11
    v_mfma_f32_16x16x32_bf16 v[132:135], v[236:239], v[212:215], v[132:135]
    v_mfma_f32_16x16x32_bf16 v[136:139], v[240:243], v[212:215], v[136:139]
    ds_write_b32 v253, v255 offset:112
    v_mfma_f32_16x16x32_bf16 v[140:143], v[244:247], v[212:215], v[140:143]
    s_waitcnt lgkmcnt(0)
    v_mfma_f32_16x16x32_bf16 v[0:3], v[216:219], v[144:147], v[0:3]
    v_mfma_f32_16x16x32_bf16 v[4:7], v[220:223], v[144:147], v[4:7]
    v_mfma_f32_16x16x32_bf16 v[8:11], v[224:227], v[144:147], v[8:11]
    v_mfma_f32_16x16x32_bf16 v[12:15], v[228:231], v[144:147], v[12:15]
    s_waitcnt vmcnt(0)
    v_mfma_f32_16x16x32_bf16 v[16:19], v[216:219], v[148:151], v[16:19]
    ds_read_b64_tr_b16 v[232:233], v248 offset:16384
    v_mfma_f32_16x16x32_bf16 v[20:23], v[220:223], v[148:151], v[20:23]
    ds_read_b64_tr_b16 v[234:235], v248 offset:18432
    v_mfma_f32_16x16x32_bf16 v[24:27], v[224:227], v[148:151], v[24:27]
    ds_read_b64_tr_b16 v[236:237], v249 offset:16384
    v_mfma_f32_16x16x32_bf16 v[28:31], v[228:231], v[148:151], v[28:31]
    ds_read_b64_tr_b16 v[238:239], v249 offset:18432
    v_mfma_f32_16x16x32_bf16 v[32:35], v[216:219], v[152:155], v[32:35]
    ds_read_b64_tr_b16 v[240:241], v250 offset:16384
    v_mfma_f32_16x16x32_bf16 v[36:39], v[220:223], v[152:155], v[36:39]
    ds_read_b64_tr_b16 v[242:243], v250 offset:18432
    v_mfma_f32_16x16x32_bf16 v[40:43], v[224:227], v[152:155], v[40:43]
    ds_read_b64_tr_b16 v[244:245], v251 offset:16384
    v_mfma_f32_16x16x32_bf16 v[44:47], v[228:231], v[152:155], v[44:47]
    ds_read_b64_tr_b16 v[246:247], v251 offset:18432
    v_mfma_f32_16x16x32_bf16 v[48:51], v[216:219], v[156:159], v[48:51]
    ds_read_b32 v255, v253 offset:96
    v_mfma_f32_16x16x32_bf16 v[52:55], v[220:223], v[156:159], v[52:55]
    v_mfma_f32_16x16x32_bf16 v[56:59], v[224:227], v[156:159], v[56:59]
    v_mfma_f32_16x16x32_bf16 v[60:63], v[228:231], v[156:159], v[60:63]
    v_mfma_f32_16x16x32_bf16 v[64:67], v[216:219], v[160:163], v[64:67]
    s_nop 0
    v_mfma_f32_16x16x32_bf16 v[68:71], v[220:223], v[160:163], v[68:71]
    s_waitcnt lgkmcnt(0)
    v_cmp_gt_u32 vcc, 12, v255
    v_mfma_f32_16x16x32_bf16 v[72:75], v[224:227], v[160:163], v[72:75]
    s_nop 0
    v_mfma_f32_16x16x32_bf16 v[76:79], v[228:231], v[160:163], v[76:79]
    s_cbranch_vccnz G0_b11
G0_b11_ret:
    v_mfma_f32_16x16x32_bf16 v[80:83], v[216:219], v[164:167], v[80:83]
    ds_read_b128 v[180:183], v254 offset:36864
    v_mfma_f32_16x16x32_bf16 v[84:87], v[220:223], v[164:167], v[84:87]
    ds_read_b128 v[184:187], v254 offset:37888
    v_mfma_f32_16x16x32_bf16 v[88:91], v[224:227], v[164:167], v[88:91]
    ds_read_b128 v[188:191], v254 offset:38912
    v_mfma_f32_16x16x32_bf16 v[92:95], v[228:231], v[164:167], v[92:95]
    v_mfma_f32_16x16x32_bf16 v[96:99], v[216:219], v[168:171], v[96:99]
    ds_read_b128 v[192:195], v254 offset:39936
    v_mfma_f32_16x16x32_bf16 v[100:103], v[220:223], v[168:171], v[100:103]
    ds_read_b128 v[196:199], v254 offset:40960
    v_mfma_f32_16x16x32_bf16 v[104:107], v[224:227], v[168:171], v[104:107]
    ds_read_b128 v[200:203], v254 offset:41984
    v_mfma_f32_16x16x32_bf16 v[108:111], v[228:231], v[168:171], v[108:111]
    v_mfma_f32_16x16x32_bf16 v[112:115], v[216:219], v[172:175], v[112:115]
    ds_read_b128 v[204:207], v254 offset:43008
    v_mfma_f32_16x16x32_bf16 v[116:119], v[220:223], v[172:175], v[116:119]
    ds_read_b128 v[208:211], v254 offset:44032
    v_mfma_f32_16x16x32_bf16 v[120:123], v[224:227], v[172:175], v[120:123]
    ds_read_b128 v[212:215], v254 offset:45056
    v_mfma_f32_16x16x32_bf16 v[124:127], v[228:231], v[172:175], v[124:127]
    v_mfma_f32_16x16x32_bf16 v[128:131], v[216:219], v[176:179], v[128:131]
    v_mov_b32 v255, 12
    v_mfma_f32_16x16x32_bf16 v[132:135], v[220:223], v[176:179], v[132:135]
    v_mfma_f32_16x16x32_bf16 v[136:139], v[224:227], v[176:179], v[136:139]
    ds_write_b32 v253, v255 offset:112
    v_mfma_f32_16x16x32_bf16 v[140:143], v[228:231], v[176:179], v[140:143]
    s_waitcnt lgkmcnt(0)
    s_setprio 3
    v_mbcnt_lo_u32_b32 v216, -1, 0
    v_mbcnt_hi_u32_b32 v216, -1, v216
    v_and_b32 v217, 3, v216
    v_lshlrev_b32 v217, 2, v217
    v_add_u32 v217, 163584, v217
    s_xor_b32 s44, s24, 1
    s_mul_i32 s44, s44, 27648
    s_add_u32 s44, s44, 0
    v_lshl_add_u32 v249, v216, 4, s44
    s_xor_b32 s44, s24, 2
    s_mul_i32 s44, s44, 27648
    s_add_u32 s44, s44, 9216
    v_lshl_add_u32 v250, v216, 4, s44
    s_xor_b32 s44, s24, 3
    s_mul_i32 s44, s44, 27648
    s_add_u32 s44, s44, 18432
    v_lshl_add_u32 v251, v216, 4, s44
    s_mul_i32 s44, s24, 27648
    v_lshl_add_u32 v248, v216, 4, s44
    v_mov_b32 v255, 3
    ds_write_b32 v253, v255 offset:32
    s_mov_b32 s59, 262144
G0_gb3:
    ds_read_b32 v255, v217 offset:32
    s_waitcnt lgkmcnt(0)
    v_cmp_lt_u32 s[56:57], v255, 3
    s_nop 0
    s_cmp_eq_u64 s[56:57], 0
    s_cbranch_scc1 G0_gb3_ok
    s_sleep 1
    s_sub_u32 s59, s59, 1
    s_cmp_lg_u32 s59, 0
    s_cbranch_scc1 G0_gb3
G0_gb3_ok:
    v_mfma_f32_16x16x32_bf16 v[0:3], v[232:235], v[180:183], v[0:3]
    v_mfma_f32_16x16x32_bf16 v[4:7], v[236:239], v[180:183], v[4:7]
    v_mfma_f32_16x16x32_bf16 v[8:11], v[240:243], v[180:183], v[8:11]
    v_mfma_f32_16x16x32_bf16 v[12:15], v[244:247], v[180:183], v[12:15]
    v_mfma_f32_16x16x32_bf16 v[16:19], v[232:235], v[184:187], v[16:19]
    v_mfma_f32_16x16x32_bf16 v[20:23], v[236:239], v[184:187], v[20:23]
    v_mfma_f32_16x16x32_bf16 v[24:27], v[240:243], v[184:187], v[24:27]
    v_mfma_f32_16x16x32_bf16 v[28:31], v[244:247], v[184:187], v[28:31]
    v_mfma_f32_16x16x32_bf16 v[32:35], v[232:235], v[188:191], v[32:35]
    s_nop 0
    ds_write_b128 v249, v[4:7] offset:0
    v_mfma_f32_16x16x32_bf16 v[36:39], v[236:239], v[188:191], v[36:39]
    ds_write_b128 v250, v[8:11] offset:0
    v_mfma_f32_16x16x32_bf16 v[40:43], v[240:243], v[188:191], v[40:43]
    ds_write_b128 v251, v[12:15] offset:0
    v_mfma_f32_16x16x32_bf16 v[44:47], v[244:247], v[188:191], v[44:47]
    v_mfma_f32_16x16x32_bf16 v[48:51], v[232:235], v[192:195], v[48:51]
    ds_write_b128 v249, v[20:23] offset:1024
    v_mfma_f32_16x16x32_bf16 v[52:55], v[236:239], v[192:195], v[52:55]
    ds_write_b128 v250, v[24:27] offset:1024
    v_mfma_f32_16x16x32_bf16 v[56:59], v[240:243], v[192:195], v[56:59]
    ds_write_b128 v251, v[28:31] offset:1024
    v_mfma_f32_16x16x32_bf16 v[60:63], v[244:247], v[192:195], v[60:63]
    v_mfma_f32_16x16x32_bf16 v[64:67], v[232:235], v[196:199], v[64:67]
    ds_write_b128 v249, v[36:39] offset:2048
    v_mfma_f32_16x16x32_bf16 v[68:71], v[236:239], v[196:199], v[68:71]
    ds_write_b128 v250, v[40:43] offset:2048
    v_mfma_f32_16x16x32_bf16 v[72:75], v[240:243], v[196:199], v[72:75]
    ds_write_b128 v251, v[44:47] offset:2048
    v_mfma_f32_16x16x32_bf16 v[76:79], v[244:247], v[196:199], v[76:79]
    v_mfma_f32_16x16x32_bf16 v[80:83], v[232:235], v[200:203], v[80:83]
    ds_write_b128 v249, v[52:55] offset:3072
    v_mfma_f32_16x16x32_bf16 v[84:87], v[236:239], v[200:203], v[84:87]
    ds_write_b128 v250, v[56:59] offset:3072
    v_mfma_f32_16x16x32_bf16 v[88:91], v[240:243], v[200:203], v[88:91]
    ds_write_b128 v251, v[60:63] offset:3072
    v_mfma_f32_16x16x32_bf16 v[92:95], v[244:247], v[200:203], v[92:95]
    v_mfma_f32_16x16x32_bf16 v[96:99], v[232:235], v[204:207], v[96:99]
    ds_write_b128 v249, v[68:71] offset:4096
    v_mfma_f32_16x16x32_bf16 v[100:103], v[236:239], v[204:207], v[100:103]
    ds_write_b128 v250, v[72:75] offset:4096
    v_mfma_f32_16x16x32_bf16 v[104:107], v[240:243], v[204:207], v[104:107]
    ds_write_b128 v251, v[76:79] offset:4096
    v_mfma_f32_16x16x32_bf16 v[108:111], v[244:247], v[204:207], v[108:111]
    v_mfma_f32_16x16x32_bf16 v[112:115], v[232:235], v[208:211], v[112:115]
    ds_write_b128 v249, v[84:87] offset:5120
    v_mfma_f32_16x16x32_bf16 v[116:119], v[236:239], v[208:211], v[116:119]
    ds_write_b128 v250, v[88:91] offset:5120
    v_mfma_f32_16x16x32_bf16 v[120:123], v[240:243], v[208:211], v[120:123]
    ds_write_b128 v251, v[92:95] offset:5120
    v_mfma_f32_16x16x32_bf16 v[124:127], v[244:247], v[208:211], v[124:127]
    v_mfma_f32_16x16x32_bf16 v[128:131], v[232:235], v[212:215], v[128:131]
    ds_write_b128 v249, v[100:103] offset:6144
    v_mfma_f32_16x16x32_bf16 v[132:135], v[236:239], v[212:215], v[132:135]
    ds_write_b128 v250, v[104:107] offset:6144
    v_mfma_f32_16x16x32_bf16 v[136:139], v[240:243], v[212:215], v[136:139]
    ds_write_b128 v251, v[108:111] offset:6144
    v_mfma_f32_16x16x32_bf16 v[140:143], v[244:247], v[212:215], v[140:143]
    s_setprio 0
    ds_write_b128 v249, v[116:119] offset:7168
    ds_write_b128 v250, v[120:123] offset:7168
    ds_write_b128 v251, v[124:127] offset:7168
    ds_write_b128 v249, v[132:135] offset:8192
    s_nop 0
    ds_write_b128 v250, v[136:139] offset:8192
    s_nop 0
    ds_write_b128 v251, v[140:143] offset:8192
    v_mov_b32 v255, 4
    ds_write_b32 v253, v255 offset:32
    s_mov_b32 s59, 262144
G0_gb4:
    ds_read_b32 v255, v217 offset:32
    s_waitcnt lgkmcnt(0)
    v_cmp_lt_u32 s[56:57], v255, 4
    s_nop 0
    s_cmp_eq_u64 s[56:57], 0
    s_cbranch_scc1 G0_gb4_ok
    s_sleep 1
    s_sub_u32 s59, s59, 1
    s_cmp_lg_u32 s59, 0
    s_cbranch_scc1 G0_gb4
G0_gb4_ok:
    ds_read_b128 v[4:7], v248 offset:0
    ds_read_b128 v[8:11], v248 offset:9216
    ds_read_b128 v[12:15], v248 offset:18432
    ds_read_b128 v[20:23], v248 offset:1024
    ds_read_b128 v[24:27], v248 offset:10240
    ds_read_b128 v[28:31], v248 offset:19456
    ds_read_b128 v[36:39], v248 offset:2048
    ds_read_b128 v[40:43], v248 offset:11264
    ds_read_b128 v[44:47], v248 offset:20480
    ds_read_b128 v[52:55], v248 offset:3072
    ds_read_b128 v[56:59], v248 offset:12288
    ds_read_b128 v[60:63], v248 offset:21504
    ds_read_b128 v[68:71], v248 offset:4096
    ds_read_b128 v[72:75], v248 offset:13312
    ds_read_b128 v[76:79], v248 offset:22528
    ds_read_b128 v[84:87], v248 offset:5120
    ds_read_b128 v[88:91], v248 offset:14336
    ds_read_b128 v[92:95], v248 offset:23552
    ds_read_b128 v[100:103], v248 offset:6144
    ds_read_b128 v[104:107], v248 offset:15360
    ds_read_b128 v[108:111], v248 offset:24576
    ds_read_b128 v[116:119], v248 offset:7168
    ds_read_b128 v[120:123], v248 offset:16384
    ds_read_b128 v[124:127], v248 offset:25600
    ds_read_b128 v[132:135], v248 offset:8192
    ds_read_b128 v[136:139], v248 offset:17408
    ds_read_b128 v[140:143], v248 offset:26624
    v_mov_b32 v255, 5
    ds_write_b32 v253, v255 offset:32
    s_setprio 3
    s_mov_b32 s55, 4096
    s_waitcnt lgkmcnt(15)
    v_add_f32 v0, v0, v4
    v_add_f32 v8, v8, v12
    v_add_f32 v1, v1, v5
    v_add_f32 v9, v9, v13
    v_add_f32 v2, v2, v6
    v_add_f32 v10, v10, v14
    v_add_f32 v3, v3, v7
    v_add_f32 v11, v11, v15
    v_add_f32 v0, v0, v8
    v_add_f32 v1, v1, v9
    v_add_f32 v2, v2, v10
    v_add_f32 v3, v3, v11
    v_cvt_pk_bf16_f32 v144, v0, v1
    v_cvt_pk_bf16_f32 v145, v2, v3
    v_add_f32 v16, v16, v20
    v_add_f32 v24, v24, v28
    v_add_f32 v17, v17, v21
    v_add_f32 v25, v25, v29
    v_add_f32 v18, v18, v22
    v_add_f32 v26, v26, v30
    v_add_f32 v19, v19, v23
    v_add_f32 v27, v27, v31
    v_add_f32 v16, v16, v24
    v_add_f32 v17, v17, v25
    v_add_f32 v18, v18, v26
    v_add_f32 v19, v19, v27
    v_cvt_pk_bf16_f32 v146, v16, v17
    v_cvt_pk_bf16_f32 v147, v18, v19
    buffer_store_dwordx4 v[144:147], v254, s[12:15], 0 offen offset:0 sc1
    v_add_f32 v32, v32, v36
    v_add_f32 v40, v40, v44
    v_add_f32 v33, v33, v37
    v_add_f32 v41, v41, v45
    v_add_f32 v34, v34, v38
    v_add_f32 v42, v42, v46
    v_add_f32 v35, v35, v39
    v_add_f32 v43, v43, v47
    v_add_f32 v32, v32, v40
    v_add_f32 v33, v33, v41
    v_add_f32 v34, v34, v42
    v_add_f32 v35, v35, v43
    v_cvt_pk_bf16_f32 v148, v32, v33
    v_cvt_pk_bf16_f32 v149, v34, v35
    v_add_f32 v48, v48, v52
    v_add_f32 v56, v56, v60
    v_add_f32 v49, v49, v53
    v_add_f32 v57, v57, v61
    v_add_f32 v50, v50, v54
    v_add_f32 v58, v58, v62
    v_add_f32 v51, v51, v55
    v_add_f32 v59, v59, v63
    v_add_f32 v48, v48, v56
    v_add_f32 v49, v49, v57
    v_add_f32 v50, v50, v58
    v_add_f32 v51, v51, v59
    v_cvt_pk_bf16_f32 v150, v48, v49
    v_cvt_pk_bf16_f32 v151, v50, v51
    buffer_store_dwordx4 v[148:151], v254, s[12:15], 0 offen offset:1024 sc1
    v_add_f32 v64, v64, v68
    s_waitcnt lgkmcnt(13)
    v_add_f32 v72, v72, v76
    v_add_f32 v65, v65, v69
    v_add_f32 v73, v73, v77
    v_add_f32 v66, v66, v70
    v_add_f32 v74, v74, v78
    v_add_f32 v67, v67, v71
    v_add_f32 v75, v75, v79
    v_add_f32 v64, v64, v72
    v_add_f32 v65, v65, v73
    v_add_f32 v66, v66, v74
    v_add_f32 v67, v67, v75
    v_cvt_pk_bf16_f32 v152, v64, v65
    v_cvt_pk_bf16_f32 v153, v66, v67
    s_waitcnt lgkmcnt(12)
    v_add_f32 v80, v80, v84
    s_waitcnt lgkmcnt(10)
    v_add_f32 v88, v88, v92
    v_add_f32 v81, v81, v85
    v_add_f32 v89, v89, v93
    v_add_f32 v82, v82, v86
    v_add_f32 v90, v90, v94
    v_add_f32 v83, v83, v87
    v_add_f32 v91, v91, v95
    v_add_f32 v80, v80, v88
    v_add_f32 v81, v81, v89
    v_add_f32 v82, v82, v90
    v_add_f32 v83, v83, v91
    v_cvt_pk_bf16_f32 v154, v80, v81
    v_cvt_pk_bf16_f32 v155, v82, v83
    buffer_store_dwordx4 v[152:155], v254, s[12:15], 0 offen offset:2048 sc1
    s_waitcnt lgkmcnt(9)
    v_add_f32 v96, v96, v100
    s_waitcnt lgkmcnt(7)
    v_add_f32 v104, v104, v108
    v_add_f32 v97, v97, v101
    v_add_f32 v105, v105, v109
    v_add_f32 v98, v98, v102
    v_add_f32 v106, v106, v110
    v_add_f32 v99, v99, v103
    v_add_f32 v107, v107, v111
    v_add_f32 v96, v96, v104
    v_add_f32 v97, v97, v105
    v_add_f32 v98, v98, v106
    v_add_f32 v99, v99, v107
    v_cvt_pk_bf16_f32 v156, v96, v97
    v_cvt_pk_bf16_f32 v157, v98, v99
    s_waitcnt lgkmcnt(6)
    v_add_f32 v112, v112, v116
    s_waitcnt lgkmcnt(4)
    v_add_f32 v120, v120, v124
    v_add_f32 v113, v113, v117
    v_add_f32 v121, v121, v125
    v_add_f32 v114, v114, v118
    v_add_f32 v122, v122, v126
    v_add_f32 v115, v115, v119
    v_add_f32 v123, v123, v127
    v_add_f32 v112, v112, v120
    v_add_f32 v113, v113, v121
    v_add_f32 v114, v114, v122
    v_add_f32 v115, v115, v123
    v_cvt_pk_bf16_f32 v158, v112, v113
    v_cvt_pk_bf16_f32 v159, v114, v115
    buffer_store_dwordx4 v[156:159], v254, s[12:15], 0 offen offset:3072 sc1
    s_waitcnt lgkmcnt(3)
    v_add_f32 v128, v128, v132
    s_waitcnt lgkmcnt(1)
    v_add_f32 v136, v136, v140
    v_add_f32 v129, v129, v133
    v_add_f32 v137, v137, v141
    v_add_f32 v130, v130, v134
    v_add_f32 v138, v138, v142
    v_add_f32 v131, v131, v135
    v_add_f32 v139, v139, v143
    v_add_f32 v128, v128, v136
    v_add_f32 v129, v129, v137
    v_add_f32 v130, v130, v138
    v_add_f32 v131, v131, v139
    v_cvt_pk_bf16_f32 v160, v128, v129
    v_cvt_pk_bf16_f32 v161, v130, v131
    buffer_store_dwordx4 v[160:163], v254, s[12:15], s55 offen sc1
    s_waitcnt vmcnt(0)
    s_lshl_b32 s44, s34, 12
    s_lshl_b32 s45, s35, 7
    s_add_u32 s44, s44, s45
    s_lshl_b32 s45, s24, 2
    s_add_u32 s44, s44, s45
    s_add_u32 s44, s44, 50333696
    v_mov_b32 v0, s44
    v_mov_b32 v1, 1
    v_xor_b32 v2, 0x80, v0
    s_mov_b64 exec, 1
    global_store_dword v0, v1, s[36:37] sc1
    s_mov_b64 exec, -1
    s_mov_b32 s59, 65536
G0_gw:
    s_waitcnt lgkmcnt(0)
    global_load_dword v255, v2, s[36:37] sc1
    s_waitcnt vmcnt(0)
    v_cmp_eq_u32 vcc, 0, v255
    s_nop 1
    s_cbranch_vccz G0_gw_ok
    s_sleep 4
    s_sub_u32 s59, s59, 1
    s_cmp_lg_u32 s59, 0
    s_cbranch_scc1 G0_gw
G0_gw_ok:
    v_mov_b32 v255, 1
    ds_write_b32 v253, v255 offset:128
G0_exit:
    s_endpgm
G0_qs1:
    s_mov_b32 s59, 262144
G0_qs1_p:
    ds_read_b32 v252, v251 offset:0
    s_waitcnt lgkmcnt(0)
    v_cmp_lt_u32 s[56:57], v252, 2
    s_nop 0
    s_cmp_eq_u64 s[56:57], 0
    s_cbranch_scc1 G0_qs1_p_ok
    s_sleep 1
    s_sub_u32 s59, s59, 1
    s_cmp_lg_u32 s59, 0
    s_cbranch_scc1 G0_qs1_p
G0_qs1_p_ok:
    s_branch G0_qs1_ret
G0_qs2:
    s_mov_b32 s59, 262144
G0_qs2_p:
    ds_read_b32 v252, v251 offset:0
    s_waitcnt lgkmcnt(0)
    v_cmp_lt_u32 s[56:57], v252, 3
    s_nop 0
    s_cmp_eq_u64 s[56:57], 0
    s_cbranch_scc1 G0_qs2_p_ok
    s_sleep 1
    s_sub_u32 s59, s59, 1
    s_cmp_lg_u32 s59, 0
    s_cbranch_scc1 G0_qs2_p
G0_qs2_p_ok:
    s_branch G0_qs2_ret
G0_qs3:
    s_mov_b32 s59, 262144
G0_qs3_p:
    ds_read_b32 v252, v251 offset:0
    s_waitcnt lgkmcnt(0)
    v_cmp_lt_u32 s[56:57], v252, 4
    s_nop 0
    s_cmp_eq_u64 s[56:57], 0
    s_cbranch_scc1 G0_qs3_p_ok
    s_sleep 1
    s_sub_u32 s59, s59, 1
    s_cmp_lg_u32 s59, 0
    s_cbranch_scc1 G0_qs3_p
G0_qs3_p_ok:
    s_branch G0_qs3_ret
G0_qs4:
    s_mov_b32 s59, 262144
G0_qs4_p:
    ds_read_b32 v252, v251 offset:0
    s_waitcnt lgkmcnt(0)
    v_cmp_lt_u32 s[56:57], v252, 5
    s_nop 0
    s_cmp_eq_u64 s[56:57], 0
    s_cbranch_scc1 G0_qs4_p_ok
    s_sleep 1
    s_sub_u32 s59, s59, 1
    s_cmp_lg_u32 s59, 0
    s_cbranch_scc1 G0_qs4_p
G0_qs4_p_ok:
    s_branch G0_qs4_ret
G0_qs5:
    s_mov_b32 s59, 262144
G0_qs5_p:
    ds_read_b32 v252, v251 offset:0
    s_waitcnt lgkmcnt(0)
    v_cmp_lt_u32 s[56:57], v252, 6
    s_nop 0
    s_cmp_eq_u64 s[56:57], 0
    s_cbranch_scc1 G0_qs5_p_ok
    s_sleep 1
    s_sub_u32 s59, s59, 1
    s_cmp_lg_u32 s59, 0
    s_cbranch_scc1 G0_qs5_p
G0_qs5_p_ok:
    s_branch G0_qs5_ret
G0_qs6:
    s_mov_b32 s59, 262144
G0_qs6_p:
    ds_read_b32 v252, v251 offset:0
    s_waitcnt lgkmcnt(0)
    v_cmp_lt_u32 s[56:57], v252, 7
    s_nop 0
    s_cmp_eq_u64 s[56:57], 0
    s_cbranch_scc1 G0_qs6_p_ok
    s_sleep 1
    s_sub_u32 s59, s59, 1
    s_cmp_lg_u32 s59, 0
    s_cbranch_scc1 G0_qs6_p
G0_qs6_p_ok:
    s_branch G0_qs6_ret
G0_qs7:
    s_mov_b32 s59, 262144
G0_qs7_p:
    ds_read_b32 v252, v251 offset:0
    s_waitcnt lgkmcnt(0)
    v_cmp_lt_u32 s[56:57], v252, 8
    s_nop 0
    s_cmp_eq_u64 s[56:57], 0
    s_cbranch_scc1 G0_qs7_p_ok
    s_sleep 1
    s_sub_u32 s59, s59, 1
    s_cmp_lg_u32 s59, 0
    s_cbranch_scc1 G0_qs7_p
G0_qs7_p_ok:
    s_branch G0_qs7_ret
G0_qs8:
    s_mov_b32 s59, 262144
G0_qs8_p:
    ds_read_b32 v252, v251 offset:0
    s_waitcnt lgkmcnt(0)
    v_cmp_lt_u32 s[56:57], v252, 9
    s_nop 0
    s_cmp_eq_u64 s[56:57], 0
    s_cbranch_scc1 G0_qs8_p_ok
    s_sleep 1
    s_sub_u32 s59, s59, 1
    s_cmp_lg_u32 s59, 0
    s_cbranch_scc1 G0_qs8_p
G0_qs8_p_ok:
    s_branch G0_qs8_ret
G0_qs9:
    s_mov_b32 s59, 262144
G0_qs9_p:
    ds_read_b32 v252, v251 offset:0
    s_waitcnt lgkmcnt(0)
    v_cmp_lt_u32 s[56:57], v252, 10
    s_nop 0
    s_cmp_eq_u64 s[56:57], 0
    s_cbranch_scc1 G0_qs9_p_ok
    s_sleep 1
    s_sub_u32 s59, s59, 1
    s_cmp_lg_u32 s59, 0
    s_cbranch_scc1 G0_qs9_p
G0_qs9_p_ok:
    s_branch G0_qs9_ret
G0_qs10:
    s_mov_b32 s59, 262144
G0_qs10_p:
    ds_read_b32 v252, v251 offset:0
    s_waitcnt lgkmcnt(0)
    v_cmp_lt_u32 s[56:57], v252, 11
    s_nop 0
    s_cmp_eq_u64 s[56:57], 0
    s_cbranch_scc1 G0_qs10_p_ok
    s_sleep 1
    s_sub_u32 s59, s59, 1
    s_cmp_lg_u32 s59, 0
    s_cbranch_scc1 G0_qs10_p
G0_qs10_p_ok:
    s_branch G0_qs10_ret
G0_qs11:
    s_mov_b32 s59, 262144
G0_qs11_p:
    ds_read_b32 v252, v251 offset:0
    s_waitcnt lgkmcnt(0)
    v_cmp_lt_u32 s[56:57], v252, 12
    s_nop 0
    s_cmp_eq_u64 s[56:57], 0
    s_cbranch_scc1 G0_qs11_p_ok
    s_sleep 1
    s_sub_u32 s59, s59, 1
    s_cmp_lg_u32 s59, 0
    s_cbranch_scc1 G0_qs11_p
G0_qs11_p_ok:
    s_branch G0_qs11_ret
G0_qs12:
    s_mov_b32 s59, 262144
G0_qs12_p:
    ds_read_b32 v252, v251 offset:0
    s_waitcnt lgkmcnt(0)
    v_cmp_lt_u32 s[56:57], v252, 13
    s_nop 0
    s_cmp_eq_u64 s[56:57], 0
    s_cbranch_scc1 G0_qs12_p_ok
    s_sleep 1
    s_sub_u32 s59, s59, 1
    s_cmp_lg_u32 s59, 0
    s_cbranch_scc1 G0_qs12_p
G0_qs12_p_ok:
    s_branch G0_qs12_ret
G0_qs13:
    s_mov_b32 s59, 262144
G0_qs13_p:
    ds_read_b32 v252, v251 offset:0
    s_waitcnt lgkmcnt(0)
    v_cmp_lt_u32 s[56:57], v252, 14
    s_nop 0
    s_cmp_eq_u64 s[56:57], 0
    s_cbranch_scc1 G0_qs13_p_ok
    s_sleep 1
    s_sub_u32 s59, s59, 1
    s_cmp_lg_u32 s59, 0
    s_cbranch_scc1 G0_qs13_p
G0_qs13_p_ok:
    s_branch G0_qs13_ret
G0_qs14:
    s_mov_b32 s59, 262144
G0_qs14_p:
    ds_read_b32 v252, v251 offset:0
    s_waitcnt lgkmcnt(0)
    v_cmp_lt_u32 s[56:57], v252, 15
    s_nop 0
    s_cmp_eq_u64 s[56:57], 0
    s_cbranch_scc1 G0_qs14_p_ok
    s_sleep 1
    s_sub_u32 s59, s59, 1
    s_cmp_lg_u32 s59, 0
    s_cbranch_scc1 G0_qs14_p
G0_qs14_p_ok:
    s_branch G0_qs14_ret
G0_qs15:
    s_mov_b32 s59, 262144
G0_qs15_p:
    ds_read_b32 v252, v251 offset:0
    s_waitcnt lgkmcnt(0)
    v_cmp_lt_u32 s[56:57], v252, 16
    s_nop 0
    s_cmp_eq_u64 s[56:57], 0
    s_cbranch_scc1 G0_qs15_p_ok
    s_sleep 1
    s_sub_u32 s59, s59, 1
    s_cmp_lg_u32 s59, 0
    s_cbranch_scc1 G0_qs15_p
G0_qs15_p_ok:
    s_branch G0_qs15_ret
G0_qs16:
    s_mov_b32 s59, 262144
G0_qs16_p:
    ds_read_b32 v252, v251 offset:0
    s_waitcnt lgkmcnt(0)
    v_cmp_lt_u32 s[56:57], v252, 17
    s_nop 0
    s_cmp_eq_u64 s[56:57], 0
    s_cbranch_scc1 G0_qs16_p_ok
    s_sleep 1
    s_sub_u32 s59, s59, 1
    s_cmp_lg_u32 s59, 0
    s_cbranch_scc1 G0_qs16_p
G0_qs16_p_ok:
    s_branch G0_qs16_ret
G0_qs17:
    s_mov_b32 s59, 262144
G0_qs17_p:
    ds_read_b32 v252, v251 offset:0
    s_waitcnt lgkmcnt(0)
    v_cmp_lt_u32 s[56:57], v252, 18
    s_nop 0
    s_cmp_eq_u64 s[56:57], 0
    s_cbranch_scc1 G0_qs17_p_ok
    s_sleep 1
    s_sub_u32 s59, s59, 1
    s_cmp_lg_u32 s59, 0
    s_cbranch_scc1 G0_qs17_p
G0_qs17_p_ok:
    s_branch G0_qs17_ret
G0_qs18:
    s_mov_b32 s59, 262144
G0_qs18_p:
    ds_read_b32 v252, v251 offset:0
    s_waitcnt lgkmcnt(0)
    v_cmp_lt_u32 s[56:57], v252, 19
    s_nop 0
    s_cmp_eq_u64 s[56:57], 0
    s_cbranch_scc1 G0_qs18_p_ok
    s_sleep 1
    s_sub_u32 s59, s59, 1
    s_cmp_lg_u32 s59, 0
    s_cbranch_scc1 G0_qs18_p
G0_qs18_p_ok:
    s_branch G0_qs18_ret
G0_qs19:
    s_mov_b32 s59, 262144
G0_qs19_p:
    ds_read_b32 v252, v251 offset:0
    s_waitcnt lgkmcnt(0)
    v_cmp_lt_u32 s[56:57], v252, 20
    s_nop 0
    s_cmp_eq_u64 s[56:57], 0
    s_cbranch_scc1 G0_qs19_p_ok
    s_sleep 1
    s_sub_u32 s59, s59, 1
    s_cmp_lg_u32 s59, 0
    s_cbranch_scc1 G0_qs19_p
G0_qs19_p_ok:
    s_branch G0_qs19_ret
G0_qs20:
    s_mov_b32 s59, 262144
G0_qs20_p:
    ds_read_b32 v252, v251 offset:0
    s_waitcnt lgkmcnt(0)
    v_cmp_lt_u32 s[56:57], v252, 21
    s_nop 0
    s_cmp_eq_u64 s[56:57], 0
    s_cbranch_scc1 G0_qs20_p_ok
    s_sleep 1
    s_sub_u32 s59, s59, 1
    s_cmp_lg_u32 s59, 0
    s_cbranch_scc1 G0_qs20_p
G0_qs20_p_ok:
    s_branch G0_qs20_ret
G0_qs21:
    s_mov_b32 s59, 262144
G0_qs21_p:
    ds_read_b32 v252, v251 offset:0
    s_waitcnt lgkmcnt(0)
    v_cmp_lt_u32 s[56:57], v252, 22
    s_nop 0
    s_cmp_eq_u64 s[56:57], 0
    s_cbranch_scc1 G0_qs21_p_ok
    s_sleep 1
    s_sub_u32 s59, s59, 1
    s_cmp_lg_u32 s59, 0
    s_cbranch_scc1 G0_qs21_p
G0_qs21_p_ok:
    s_branch G0_qs21_ret
G0_qs22:
    s_mov_b32 s59, 262144
G0_qs22_p:
    ds_read_b32 v252, v251 offset:0
    s_waitcnt lgkmcnt(0)
    v_cmp_lt_u32 s[56:57], v252, 23
    s_nop 0
    s_cmp_eq_u64 s[56:57], 0
    s_cbranch_scc1 G0_qs22_p_ok
    s_sleep 1
    s_sub_u32 s59, s59, 1
    s_cmp_lg_u32 s59, 0
    s_cbranch_scc1 G0_qs22_p
G0_qs22_p_ok:
    s_branch G0_qs22_ret
G0_qs23:
    s_mov_b32 s59, 262144
G0_qs23_p:
    ds_read_b32 v252, v251 offset:0
    s_waitcnt lgkmcnt(0)
    v_cmp_lt_u32 s[56:57], v252, 24
    s_nop 0
    s_cmp_eq_u64 s[56:57], 0
    s_cbranch_scc1 G0_qs23_p_ok
    s_sleep 1
    s_sub_u32 s59, s59, 1
    s_cmp_lg_u32 s59, 0
    s_cbranch_scc1 G0_qs23_p
G0_qs23_p_ok:
    s_branch G0_qs23_ret
G0_qs24:
    s_mov_b32 s59, 262144
G0_qs24_p:
    ds_read_b32 v252, v251 offset:0
    s_waitcnt lgkmcnt(0)
    v_cmp_lt_u32 s[56:57], v252, 25
    s_nop 0
    s_cmp_eq_u64 s[56:57], 0
    s_cbranch_scc1 G0_qs24_p_ok
    s_sleep 1
    s_sub_u32 s59, s59, 1
    s_cmp_lg_u32 s59, 0
    s_cbranch_scc1 G0_qs24_p
G0_qs24_p_ok:
    s_branch G0_qs24_ret
G0_qs25:
    s_mov_b32 s59, 262144
G0_qs25_p:
    ds_read_b32 v252, v251 offset:0
    s_waitcnt lgkmcnt(0)
    v_cmp_lt_u32 s[56:57], v252, 26
    s_nop 0
    s_cmp_eq_u64 s[56:57], 0
    s_cbranch_scc1 G0_qs25_p_ok
    s_sleep 1
    s_sub_u32 s59, s59, 1
    s_cmp_lg_u32 s59, 0
    s_cbranch_scc1 G0_qs25_p
G0_qs25_p_ok:
    s_branch G0_qs25_ret
G0_qs26:
    s_mov_b32 s59, 262144
G0_qs26_p:
    ds_read_b32 v252, v251 offset:0
    s_waitcnt lgkmcnt(0)
    v_cmp_lt_u32 s[56:57], v252, 27
    s_nop 0
    s_cmp_eq_u64 s[56:57], 0
    s_cbranch_scc1 G0_qs26_p_ok
    s_sleep 1
    s_sub_u32 s59, s59, 1
    s_cmp_lg_u32 s59, 0
    s_cbranch_scc1 G0_qs26_p
G0_qs26_p_ok:
    s_branch G0_qs26_ret
G0_qs27:
    s_mov_b32 s59, 262144
G0_qs27_p:
    ds_read_b32 v252, v251 offset:0
    s_waitcnt lgkmcnt(0)
    v_cmp_lt_u32 s[56:57], v252, 28
    s_nop 0
    s_cmp_eq_u64 s[56:57], 0
    s_cbranch_scc1 G0_qs27_p_ok
    s_sleep 1
    s_sub_u32 s59, s59, 1
    s_cmp_lg_u32 s59, 0
    s_cbranch_scc1 G0_qs27_p
G0_qs27_p_ok:
    s_branch G0_qs27_ret
G0_qs28:
    s_mov_b32 s59, 262144
G0_qs28_p:
    ds_read_b32 v252, v251 offset:0
    s_waitcnt lgkmcnt(0)
    v_cmp_lt_u32 s[56:57], v252, 29
    s_nop 0
    s_cmp_eq_u64 s[56:57], 0
    s_cbranch_scc1 G0_qs28_p_ok
    s_sleep 1
    s_sub_u32 s59, s59, 1
    s_cmp_lg_u32 s59, 0
    s_cbranch_scc1 G0_qs28_p
G0_qs28_p_ok:
    s_branch G0_qs28_ret
G0_qs29:
    s_mov_b32 s59, 262144
G0_qs29_p:
    ds_read_b32 v252, v251 offset:0
    s_waitcnt lgkmcnt(0)
    v_cmp_lt_u32 s[56:57], v252, 30
    s_nop 0
    s_cmp_eq_u64 s[56:57], 0
    s_cbranch_scc1 G0_qs29_p_ok
    s_sleep 1
    s_sub_u32 s59, s59, 1
    s_cmp_lg_u32 s59, 0
    s_cbranch_scc1 G0_qs29_p
G0_qs29_p_ok:
    s_branch G0_qs29_ret
G0_qs30:
    s_mov_b32 s59, 262144
G0_qs30_p:
    ds_read_b32 v252, v251 offset:0
    s_waitcnt lgkmcnt(0)
    v_cmp_lt_u32 s[56:57], v252, 31
    s_nop 0
    s_cmp_eq_u64 s[56:57], 0
    s_cbranch_scc1 G0_qs30_p_ok
    s_sleep 1
    s_sub_u32 s59, s59, 1
    s_cmp_lg_u32 s59, 0
    s_cbranch_scc1 G0_qs30_p
G0_qs30_p_ok:
    s_branch G0_qs30_ret
G0_qs31:
    s_mov_b32 s59, 262144
G0_qs31_p:
    ds_read_b32 v252, v251 offset:0
    s_waitcnt lgkmcnt(0)
    v_cmp_lt_u32 s[56:57], v252, 32
    s_nop 0
    s_cmp_eq_u64 s[56:57], 0
    s_cbranch_scc1 G0_qs31_p_ok
    s_sleep 1
    s_sub_u32 s59, s59, 1
    s_cmp_lg_u32 s59, 0
    s_cbranch_scc1 G0_qs31_p
G0_qs31_p_ok:
    s_branch G0_qs31_ret
G0_qfree:
    s_mov_b32 s59, 262144
G0_qfree_p:
    ds_read_b32 v252, v251 offset:16
    s_waitcnt lgkmcnt(0)
    v_cmp_lt_u32 s[56:57], v252, 32
    s_nop 0
    s_cmp_eq_u64 s[56:57], 0
    s_cbranch_scc1 G0_qfree_p_ok
    s_sleep 1
    s_sub_u32 s59, s59, 1
    s_cmp_lg_u32 s59, 0
    s_cbranch_scc1 G0_qfree_p
G0_qfree_p_ok:
    s_branch G0_qfree_ret
G0_x2:
    ds_write_b32 v250, v237 offset:16
    s_mov_b32 s59, 262144
G0_x2_p:
    ds_read_b32 v252, v251 offset:0
    s_waitcnt lgkmcnt(0)
    v_cmp_lt_u32 s[56:57], v252, 35
    s_nop 0
    s_cmp_eq_u64 s[56:57], 0
    s_cbranch_scc1 G0_x2_p_ok
    s_sleep 1
    s_sub_u32 s59, s59, 1
    s_cmp_lg_u32 s59, 0
    s_cbranch_scc1 G0_x2_p
G0_x2_p_ok:
    s_branch G0_x2_ret
G0_x4:
    ds_write_b32 v250, v237 offset:16
    s_mov_b32 s59, 262144
G0_x4_p:
    ds_read_b32 v252, v251 offset:0
    s_waitcnt lgkmcnt(0)
    v_cmp_lt_u32 s[56:57], v252, 36
    s_nop 0
    s_cmp_eq_u64 s[56:57], 0
    s_cbranch_scc1 G0_x4_p_ok
    s_sleep 1
    s_sub_u32 s59, s59, 1
    s_cmp_lg_u32 s59, 0
    s_cbranch_scc1 G0_x4_p
G0_x4_p_ok:
    s_branch G0_x4_ret
G0_g0:
    s_call_b64 s[38:39], G0_slow10
    s_branch G0_g0_ret
G0_x6:
    ds_write_b32 v250, v237 offset:16
    s_mov_b32 s59, 262144
G0_x6_p:
    ds_read_b32 v252, v251 offset:0
    s_waitcnt lgkmcnt(0)
    v_cmp_lt_u32 s[56:57], v252, 37
    s_nop 0
    s_cmp_eq_u64 s[56:57], 0
    s_cbranch_scc1 G0_x6_p_ok
    s_sleep 1
    s_sub_u32 s59, s59, 1
    s_cmp_lg_u32 s59, 0
    s_cbranch_scc1 G0_x6_p
G0_x6_p_ok:
    s_branch G0_x6_ret
G0_x8:
    ds_write_b32 v250, v237 offset:16
    s_mov_b32 s59, 262144
G0_x8_p:
    ds_read_b32 v252, v251 offset:0
    s_waitcnt lgkmcnt(0)
    v_cmp_lt_u32 s[56:57], v252, 38
    s_nop 0
    s_cmp_eq_u64 s[56:57], 0
    s_cbranch_scc1 G0_x8_p_ok
    s_sleep 1
    s_sub_u32 s59, s59, 1
    s_cmp_lg_u32 s59, 0
    s_cbranch_scc1 G0_x8_p
G0_x8_p_ok:
    s_branch G0_x8_ret
G0_g1:
    s_call_b64 s[38:39], G0_slow00
    s_branch G0_g1_ret
G0_x10:
    ds_write_b32 v250, v237 offset:16
    s_mov_b32 s59, 262144
G0_x10_p:
    ds_read_b32 v252, v251 offset:0
    s_waitcnt lgkmcnt(0)
    v_cmp_lt_u32 s[56:57], v252, 39
    s_nop 0
    s_cmp_eq_u64 s[56:57], 0
    s_cbranch_scc1 G0_x10_p_ok
    s_sleep 1
    s_sub_u32 s59, s59, 1
    s_cmp_lg_u32 s59, 0
    s_cbranch_scc1 G0_x10_p
G0_x10_p_ok:
    s_branch G0_x10_ret
G0_x12:
    ds_write_b32 v250, v237 offset:16
    s_mov_b32 s59, 262144
G0_x12_p:
    ds_read_b32 v252, v251 offset:0
    s_waitcnt lgkmcnt(0)
    v_cmp_lt_u32 s[56:57], v252, 40
    s_nop 0
    s_cmp_eq_u64 s[56:57], 0
    s_cbranch_scc1 G0_x12_p_ok
    s_sleep 1
    s_sub_u32 s59, s59, 1
    s_cmp_lg_u32 s59, 0
    s_cbranch_scc1 G0_x12_p
G0_x12_p_ok:
    s_branch G0_x12_ret
G0_g2:
    s_call_b64 s[38:39], G0_slow10
    s_branch G0_g2_ret
G0_x14:
    ds_write_b32 v250, v237 offset:16
    s_mov_b32 s59, 262144
G0_x14_p:
    ds_read_b32 v252, v251 offset:0
    s_waitcnt lgkmcnt(0)
    v_cmp_lt_u32 s[56:57], v252, 41
    s_nop 0
    s_cmp_eq_u64 s[56:57], 0
    s_cbranch_scc1 G0_x14_p_ok
    s_sleep 1
    s_sub_u32 s59, s59, 1
    s_cmp_lg_u32 s59, 0
    s_cbranch_scc1 G0_x14_p
G0_x14_p_ok:
    s_branch G0_x14_ret
G0_x16:
    ds_write_b32 v250, v237 offset:16
    s_mov_b32 s59, 262144
G0_x16_p:
    ds_read_b32 v252, v251 offset:0
    s_waitcnt lgkmcnt(0)
    v_cmp_lt_u32 s[56:57], v252, 42
    s_nop 0
    s_cmp_eq_u64 s[56:57], 0
    s_cbranch_scc1 G0_x16_p_ok
    s_sleep 1
    s_sub_u32 s59, s59, 1
    s_cmp_lg_u32 s59, 0
    s_cbranch_scc1 G0_x16_p
G0_x16_p_ok:
    s_branch G0_x16_ret
G0_g3:
    s_call_b64 s[38:39], G0_slow00
    s_branch G0_g3_ret
G0_x18:
    ds_write_b32 v250, v237 offset:16
    s_mov_b32 s59, 262144
G0_x18_p:
    ds_read_b32 v252, v251 offset:0
    s_waitcnt lgkmcnt(0)
    v_cmp_lt_u32 s[56:57], v252, 43
    s_nop 0
    s_cmp_eq_u64 s[56:57], 0
    s_cbranch_scc1 G0_x18_p_ok
    s_sleep 1
    s_sub_u32 s59, s59, 1
    s_cmp_lg_u32 s59, 0
    s_cbranch_scc1 G0_x18_p
G0_x18_p_ok:
    s_branch G0_x18_ret
G0_x20:
    ds_write_b32 v250, v237 offset:16
    s_mov_b32 s59, 262144
G0_x20_p:
    ds_read_b32 v252, v251 offset:0
    s_waitcnt lgkmcnt(0)
    v_cmp_lt_u32 s[56:57], v252, 44
    s_nop 0
    s_cmp_eq_u64 s[56:57], 0
    s_cbranch_scc1 G0_x20_p_ok
    s_sleep 1
    s_sub_u32 s59, s59, 1
    s_cmp_lg_u32 s59, 0
    s_cbranch_scc1 G0_x20_p
G0_x20_p_ok:
    s_branch G0_x20_ret
G0_g4:
    s_call_b64 s[38:39], G0_slow10
    s_branch G0_g4_ret
G0_x22:
    ds_write_b32 v250, v237 offset:16
    s_mov_b32 s59, 262144
G0_x22_p:
    ds_read_b32 v252, v251 offset:0
    s_waitcnt lgkmcnt(0)
    v_cmp_lt_u32 s[56:57], v252, 45
    s_nop 0
    s_cmp_eq_u64 s[56:57], 0
    s_cbranch_scc1 G0_x22_p_ok
    s_sleep 1
    s_sub_u32 s59, s59, 1
    s_cmp_lg_u32 s59, 0
    s_cbranch_scc1 G0_x22_p
G0_x22_p_ok:
    s_branch G0_x22_ret
G0_x24:
    ds_write_b32 v250, v237 offset:16
    s_mov_b32 s59, 262144
G0_x24_p:
    ds_read_b32 v252, v251 offset:0
    s_waitcnt lgkmcnt(0)
    v_cmp_lt_u32 s[56:57], v252, 46
    s_nop 0
    s_cmp_eq_u64 s[56:57], 0
    s_cbranch_scc1 G0_x24_p_ok
    s_sleep 1
    s_sub_u32 s59, s59, 1
    s_cmp_lg_u32 s59, 0
    s_cbranch_scc1 G0_x24_p
G0_x24_p_ok:
    s_branch G0_x24_ret
G0_g5:
    s_call_b64 s[38:39], G0_slow00
    s_branch G0_g5_ret
G0_x26:
    ds_write_b32 v250, v237 offset:16
    s_mov_b32 s59, 262144
G0_x26_p:
    ds_read_b32 v252, v251 offset:0
    s_waitcnt lgkmcnt(0)
    v_cmp_lt_u32 s[56:57], v252, 47
    s_nop 0
    s_cmp_eq_u64 s[56:57], 0
    s_cbranch_scc1 G0_x26_p_ok
    s_sleep 1
    s_sub_u32 s59, s59, 1
    s_cmp_lg_u32 s59, 0
    s_cbranch_scc1 G0_x26_p
G0_x26_p_ok:
    s_branch G0_x26_ret
G0_x28:
    ds_write_b32 v250, v237 offset:16
    s_mov_b32 s59, 262144
G0_x28_p:
    ds_read_b32 v252, v251 offset:0
    s_waitcnt lgkmcnt(0)
    v_cmp_lt_u32 s[56:57], v252, 48
    s_nop 0
    s_cmp_eq_u64 s[56:57], 0
    s_cbranch_scc1 G0_x28_p_ok
    s_sleep 1
    s_sub_u32 s59, s59, 1
    s_cmp_lg_u32 s59, 0
    s_cbranch_scc1 G0_x28_p
G0_x28_p_ok:
    s_branch G0_x28_ret
G0_g6:
    s_call_b64 s[38:39], G0_slow10
    s_branch G0_g6_ret
G0_x30:
    ds_write_b32 v250, v237 offset:16
    s_mov_b32 s59, 262144
G0_x30_p:
    ds_read_b32 v252, v251 offset:0
    s_waitcnt lgkmcnt(0)
    v_cmp_lt_u32 s[56:57], v252, 49
    s_nop 0
    s_cmp_eq_u64 s[56:57], 0
    s_cbranch_scc1 G0_x30_p_ok
    s_sleep 1
    s_sub_u32 s59, s59, 1
    s_cmp_lg_u32 s59, 0
    s_cbranch_scc1 G0_x30_p
G0_x30_p_ok:
    s_branch G0_x30_ret
G0_x32:
    ds_write_b32 v250, v237 offset:16
    s_mov_b32 s59, 262144
G0_x32_p:
    ds_read_b32 v252, v251 offset:0
    s_waitcnt lgkmcnt(0)
    v_cmp_lt_u32 s[56:57], v252, 50
    s_nop 0
    s_cmp_eq_u64 s[56:57], 0
    s_cbranch_scc1 G0_x32_p_ok
    s_sleep 1
    s_sub_u32 s59, s59, 1
    s_cmp_lg_u32 s59, 0
    s_cbranch_scc1 G0_x32_p
G0_x32_p_ok:
    s_branch G0_x32_ret
G0_x34:
    ds_write_b32 v250, v237 offset:16
    s_mov_b32 s59, 262144
G0_x34_p:
    ds_read_b32 v252, v251 offset:0
    s_waitcnt lgkmcnt(0)
    v_cmp_lt_u32 s[56:57], v252, 51
    s_nop 0
    s_cmp_eq_u64 s[56:57], 0
    s_cbranch_scc1 G0_x34_p_ok
    s_sleep 1
    s_sub_u32 s59, s59, 1
    s_cmp_lg_u32 s59, 0
    s_cbranch_scc1 G0_x34_p
G0_x34_p_ok:
    s_branch G0_x34_ret
G0_x36:
    ds_write_b32 v250, v237 offset:16
    s_mov_b32 s59, 262144
G0_x36_p:
    ds_read_b32 v252, v251 offset:0
    s_waitcnt lgkmcnt(0)
    v_cmp_lt_u32 s[56:57], v252, 52
    s_nop 0
    s_cmp_eq_u64 s[56:57], 0
    s_cbranch_scc1 G0_x36_p_ok
    s_sleep 1
    s_sub_u32 s59, s59, 1
    s_cmp_lg_u32 s59, 0
    s_cbranch_scc1 G0_x36_p
G0_x36_p_ok:
    s_branch G0_x36_ret
G0_g8:
    s_call_b64 s[38:39], G0_slow11
    s_branch G0_g8_ret
G0_x38:
    ds_write_b32 v250, v237 offset:16
    s_mov_b32 s59, 262144
G0_x38_p:
    ds_read_b32 v252, v251 offset:0
    s_waitcnt lgkmcnt(0)
    v_cmp_lt_u32 s[56:57], v252, 53
    s_nop 0
    s_cmp_eq_u64 s[56:57], 0
    s_cbranch_scc1 G0_x38_p_ok
    s_sleep 1
    s_sub_u32 s59, s59, 1
    s_cmp_lg_u32 s59, 0
    s_cbranch_scc1 G0_x38_p
G0_x38_p_ok:
    s_branch G0_x38_ret
G0_x40:
    ds_write_b32 v250, v237 offset:16
    s_mov_b32 s59, 262144
G0_x40_p:
    ds_read_b32 v252, v251 offset:0
    s_waitcnt lgkmcnt(0)
    v_cmp_lt_u32 s[56:57], v252, 54
    s_nop 0
    s_cmp_eq_u64 s[56:57], 0
    s_cbranch_scc1 G0_x40_p_ok
    s_sleep 1
    s_sub_u32 s59, s59, 1
    s_cmp_lg_u32 s59, 0
    s_cbranch_scc1 G0_x40_p
G0_x40_p_ok:
    s_branch G0_x40_ret
G0_g9:
    s_call_b64 s[38:39], G0_slow01
    s_branch G0_g9_ret
G0_x42:
    ds_write_b32 v250, v237 offset:16
    s_mov_b32 s59, 262144
G0_x42_p:
    ds_read_b32 v252, v251 offset:0
    s_waitcnt lgkmcnt(0)
    v_cmp_lt_u32 s[56:57], v252, 55
    s_nop 0
    s_cmp_eq_u64 s[56:57], 0
    s_cbranch_scc1 G0_x42_p_ok
    s_sleep 1
    s_sub_u32 s59, s59, 1
    s_cmp_lg_u32 s59, 0
    s_cbranch_scc1 G0_x42_p
G0_x42_p_ok:
    s_branch G0_x42_ret
G0_x44:
    ds_write_b32 v250, v237 offset:16
    s_mov_b32 s59, 262144
G0_x44_p:
    ds_read_b32 v252, v251 offset:0
    s_waitcnt lgkmcnt(0)
    v_cmp_lt_u32 s[56:57], v252, 56
    s_nop 0
    s_cmp_eq_u64 s[56:57], 0
    s_cbranch_scc1 G0_x44_p_ok
    s_sleep 1
    s_sub_u32 s59, s59, 1
    s_cmp_lg_u32 s59, 0
    s_cbranch_scc1 G0_x44_p
G0_x44_p_ok:
    s_branch G0_x44_ret
G0_g10:
    s_call_b64 s[38:39], G0_slow11
    s_branch G0_g10_ret
G0_x46:
    ds_write_b32 v250, v237 offset:16
    s_mov_b32 s59, 262144
G0_x46_p:
    ds_read_b32 v252, v251 offset:0
    s_waitcnt lgkmcnt(0)
    v_cmp_lt_u32 s[56:57], v252, 57
    s_nop 0
    s_cmp_eq_u64 s[56:57], 0
    s_cbranch_scc1 G0_x46_p_ok
    s_sleep 1
    s_sub_u32 s59, s59, 1
    s_cmp_lg_u32 s59, 0
    s_cbranch_scc1 G0_x46_p
G0_x46_p_ok:
    s_branch G0_x46_ret
G0_x48:
    ds_write_b32 v250, v237 offset:16
    s_mov_b32 s59, 262144
G0_x48_p:
    ds_read_b32 v252, v251 offset:0
    s_waitcnt lgkmcnt(0)
    v_cmp_lt_u32 s[56:57], v252, 58
    s_nop 0
    s_cmp_eq_u64 s[56:57], 0
    s_cbranch_scc1 G0_x48_p_ok
    s_sleep 1
    s_sub_u32 s59, s59, 1
    s_cmp_lg_u32 s59, 0
    s_cbranch_scc1 G0_x48_p
G0_x48_p_ok:
    s_branch G0_x48_ret
G0_g11:
    s_call_b64 s[38:39], G0_slow01
    s_branch G0_g11_ret
G0_x50:
    ds_write_b32 v250, v237 offset:16
    s_mov_b32 s59, 262144
G0_x50_p:
    ds_read_b32 v252, v251 offset:0
    s_waitcnt lgkmcnt(0)
    v_cmp_lt_u32 s[56:57], v252, 59
    s_nop 0
    s_cmp_eq_u64 s[56:57], 0
    s_cbranch_scc1 G0_x50_p_ok
    s_sleep 1
    s_sub_u32 s59, s59, 1
    s_cmp_lg_u32 s59, 0
    s_cbranch_scc1 G0_x50_p
G0_x50_p_ok:
    s_branch G0_x50_ret
G0_x52:
    ds_write_b32 v250, v237 offset:16
    s_mov_b32 s59, 262144
G0_x52_p:
    ds_read_b32 v252, v251 offset:0
    s_waitcnt lgkmcnt(0)
    v_cmp_lt_u32 s[56:57], v252, 60
    s_nop 0
    s_cmp_eq_u64 s[56:57], 0
    s_cbranch_scc1 G0_x52_p_ok
    s_sleep 1
    s_sub_u32 s59, s59, 1
    s_cmp_lg_u32 s59, 0
    s_cbranch_scc1 G0_x52_p
G0_x52_p_ok:
    s_branch G0_x52_ret
G0_g12:
    s_call_b64 s[38:39], G0_slow11
    s_branch G0_g12_ret
G0_x54:
    ds_write_b32 v250, v237 offset:16
    s_mov_b32 s59, 262144
G0_x54_p:
    ds_read_b32 v252, v251 offset:0
    s_waitcnt lgkmcnt(0)
    v_cmp_lt_u32 s[56:57], v252, 61
    s_nop 0
    s_cmp_eq_u64 s[56:57], 0
    s_cbranch_scc1 G0_x54_p_ok
    s_sleep 1
    s_sub_u32 s59, s59, 1
    s_cmp_lg_u32 s59, 0
    s_cbranch_scc1 G0_x54_p
G0_x54_p_ok:
    s_branch G0_x54_ret
G0_x56:
    ds_write_b32 v250, v237 offset:16
    s_mov_b32 s59, 262144
G0_x56_p:
    ds_read_b32 v252, v251 offset:0
    s_waitcnt lgkmcnt(0)
    v_cmp_lt_u32 s[56:57], v252, 62
    s_nop 0
    s_cmp_eq_u64 s[56:57], 0
    s_cbranch_scc1 G0_x56_p_ok
    s_sleep 1
    s_sub_u32 s59, s59, 1
    s_cmp_lg_u32 s59, 0
    s_cbranch_scc1 G0_x56_p
G0_x56_p_ok:
    s_branch G0_x56_ret
G0_g13:
    s_call_b64 s[38:39], G0_slow01
    s_branch G0_g13_ret
G0_x58:
    ds_write_b32 v250, v237 offset:16
    s_mov_b32 s59, 262144
G0_x58_p:
    ds_read_b32 v252, v251 offset:0
    s_waitcnt lgkmcnt(0)
    v_cmp_lt_u32 s[56:57], v252, 63
    s_nop 0
    s_cmp_eq_u64 s[56:57], 0
    s_cbranch_scc1 G0_x58_p_ok
    s_sleep 1
    s_sub_u32 s59, s59, 1
    s_cmp_lg_u32 s59, 0
    s_cbranch_scc1 G0_x58_p
G0_x58_p_ok:
    s_branch G0_x58_ret
G0_x60:
    ds_write_b32 v250, v237 offset:16
    s_mov_b32 s59, 262144
G0_x60_p:
    ds_read_b32 v252, v251 offset:0
    s_waitcnt lgkmcnt(0)
    v_cmp_lt_u32 s[56:57], v252, s42
    s_nop 0
    s_cmp_eq_u64 s[56:57], 0
    s_cbranch_scc1 G0_x60_p_ok
    s_sleep 1
    s_sub_u32 s59, s59, 1
    s_cmp_lg_u32 s59, 0
    s_cbranch_scc1 G0_x60_p
G0_x60_p_ok:
    s_branch G0_x60_ret
G0_g14:
    s_call_b64 s[38:39], G0_slow11
    s_branch G0_g14_ret
G0_b1:
    s_mov_b32 s59, 262144
G0_b1_p:
    ds_read_b32 v255, v253 offset:96
    s_waitcnt lgkmcnt(0)
    v_cmp_lt_u32 s[56:57], v255, 2
    s_nop 0
    s_cmp_eq_u64 s[56:57], 0
    s_cbranch_scc1 G0_b1_p_ok
    s_sleep 1
    s_sub_u32 s59, s59, 1
    s_cmp_lg_u32 s59, 0
    s_cbranch_scc1 G0_b1_p
G0_b1_p_ok:
    s_branch G0_b1_ret
G0_b2:
    s_mov_b32 s59, 262144
G0_b2_p:
    ds_read_b32 v255, v253 offset:96
    s_waitcnt lgkmcnt(0)
    v_cmp_lt_u32 s[56:57], v255, 3
    s_nop 0
    s_cmp_eq_u64 s[56:57], 0
    s_cbranch_scc1 G0_b2_p_ok
    s_sleep 1
    s_sub_u32 s59, s59, 1
    s_cmp_lg_u32 s59, 0
    s_cbranch_scc1 G0_b2_p
G0_b2_p_ok:
    s_branch G0_b2_ret
G0_b3:
    s_mov_b32 s59, 262144
G0_b3_p:
    ds_read_b32 v255, v253 offset:96
    s_waitcnt lgkmcnt(0)
    v_cmp_lt_u32 s[56:57], v255, 4
    s_nop 0
    s_cmp_eq_u64 s[56:57], 0
    s_cbranch_scc1 G0_b3_p_ok
    s_sleep 1
    s_sub_u32 s59, s59, 1
    s_cmp_lg_u32 s59, 0
    s_cbranch_scc1 G0_b3_p
G0_b3_p_ok:
    s_branch G0_b3_ret
G0_b4:
    s_mov_b32 s59, 262144
G0_b4_p:
    ds_read_b32 v255, v253 offset:96
    s_waitcnt lgkmcnt(0)
    v_cmp_lt_u32 s[56:57], v255, 5
    s_nop 0
    s_cmp_eq_u64 s[56:57], 0
    s_cbranch_scc1 G0_b4_p_ok
    s_sleep 1
    s_sub_u32 s59, s59, 1
    s_cmp_lg_u32 s59, 0
    s_cbranch_scc1 G0_b4_p
G0_b4_p_ok:
    s_branch G0_b4_ret
G0_b5:
    s_mov_b32 s59, 262144
G0_b5_p:
    ds_read_b32 v255, v253 offset:96
    s_waitcnt lgkmcnt(0)
    v_cmp_lt_u32 s[56:57], v255, 6
    s_nop 0
    s_cmp_eq_u64 s[56:57], 0
    s_cbranch_scc1 G0_b5_p_ok
    s_sleep 1
    s_sub_u32 s59, s59, 1
    s_cmp_lg_u32 s59, 0
    s_cbranch_scc1 G0_b5_p
G0_b5_p_ok:
    s_branch G0_b5_ret
G0_b6:
    s_mov_b32 s59, 262144
G0_b6_p:
    ds_read_b32 v255, v253 offset:96
    s_waitcnt lgkmcnt(0)
    v_cmp_lt_u32 s[56:57], v255, 7
    s_nop 0
    s_cmp_eq_u64 s[56:57], 0
    s_cbranch_scc1 G0_b6_p_ok
    s_sleep 1
    s_sub_u32 s59, s59, 1
    s_cmp_lg_u32 s59, 0
    s_cbranch_scc1 G0_b6_p
G0_b6_p_ok:
    s_branch G0_b6_ret
G0_b7:
    s_mov_b32 s59, 262144
G0_b7_p:
    ds_read_b32 v255, v253 offset:96
    s_waitcnt lgkmcnt(0)
    v_cmp_lt_u32 s[56:57], v255, 8
    s_nop 0
    s_cmp_eq_u64 s[56:57], 0
    s_cbranch_scc1 G0_b7_p_ok
    s_sleep 1
    s_sub_u32 s59, s59, 1
    s_cmp_lg_u32 s59, 0
    s_cbranch_scc1 G0_b7_p
G0_b7_p_ok:
    s_branch G0_b7_ret
G0_b8:
    s_mov_b32 s59, 262144
G0_b8_p:
    ds_read_b32 v255, v253 offset:96
    s_waitcnt lgkmcnt(0)
    v_cmp_lt_u32 s[56:57], v255, 9
    s_nop 0
    s_cmp_eq_u64 s[56:57], 0
    s_cbranch_scc1 G0_b8_p_ok
    s_sleep 1
    s_sub_u32 s59, s59, 1
    s_cmp_lg_u32 s59, 0
    s_cbranch_scc1 G0_b8_p
G0_b8_p_ok:
    s_branch G0_b8_ret
G0_b9:
    s_mov_b32 s59, 262144
G0_b9_p:
    ds_read_b32 v255, v253 offset:96
    s_waitcnt lgkmcnt(0)
    v_cmp_lt_u32 s[56:57], v255, 10
    s_nop 0
    s_cmp_eq_u64 s[56:57], 0
    s_cbranch_scc1 G0_b9_p_ok
    s_sleep 1
    s_sub_u32 s59, s59, 1
    s_cmp_lg_u32 s59, 0
    s_cbranch_scc1 G0_b9_p
G0_b9_p_ok:
    s_branch G0_b9_ret
G0_b10:
    s_mov_b32 s59, 262144
G0_b10_p:
    ds_read_b32 v255, v253 offset:96
    s_waitcnt lgkmcnt(0)
    v_cmp_lt_u32 s[56:57], v255, 11
    s_nop 0
    s_cmp_eq_u64 s[56:57], 0
    s_cbranch_scc1 G0_b10_p_ok
    s_sleep 1
    s_sub_u32 s59, s59, 1
    s_cmp_lg_u32 s59, 0
    s_cbranch_scc1 G0_b10_p
G0_b10_p_ok:
    s_branch G0_b10_ret
G0_b11:
    s_mov_b32 s59, 262144
G0_b11_p:
    ds_read_b32 v255, v253 offset:96
    s_waitcnt lgkmcnt(0)
    v_cmp_lt_u32 s[56:57], v255, 12
    s_nop 0
    s_cmp_eq_u64 s[56:57], 0
    s_cbranch_scc1 G0_b11_p_ok
    s_sleep 1
    s_sub_u32 s59, s59, 1
    s_cmp_lg_u32 s59, 0
    s_cbranch_scc1 G0_b11_p
G0_b11_p_ok:
    s_branch G0_b11_ret
G0_slow00:
    v_mov_b32 v232, v234
    v_mov_b32 v233, v235
    s_nop 0
    v_permlane32_swap_b32 v232, v234
    v_permlane32_swap_b32 v233, v235
    v_max_f32 v234, v234, v232
    v_max_f32 v235, v235, v233
    v_mov_b32 v232, v234
    v_mov_b32 v233, v235
    s_nop 0
    v_permlane16_swap_b32 v232, v234
    v_permlane16_swap_b32 v233, v235
    v_max_f32 v234, v234, v232
    v_max_f32 v235, v235, v233
    v_max_f32 v234, 0, v234
    v_sub_f32 v224, v224, v234
    v_sub_f32 v225, v225, v234
    v_sub_f32 v226, v226, v234
    v_sub_f32 v227, v227, v234
    v_sub_f32 v96, v96, v234
    v_sub_f32 v97, v97, v234
    v_sub_f32 v98, v98, v234
    v_sub_f32 v99, v99, v234
    v_sub_f32 v100, v100, v234
    v_sub_f32 v101, v101, v234
    v_sub_f32 v102, v102, v234
    v_sub_f32 v103, v103, v234
    v_sub_f32 v104, v104, v234
    v_sub_f32 v105, v105, v234
    v_sub_f32 v106, v106, v234
    v_sub_f32 v107, v107, v234
    v_sub_f32 v108, v108, v234
    v_sub_f32 v109, v109, v234
    v_sub_f32 v110, v110, v234
    v_sub_f32 v111, v111, v234
    v_exp_f32 v234, -v234
    s_nop 0
    v_mul_f32 v216, v216, v234
    v_mul_f32 v0, v0, v234
    v_mul_f32 v1, v1, v234
    v_mul_f32 v2, v2, v234
    v_mul_f32 v3, v3, v234
    v_mul_f32 v4, v4, v234
    v_mul_f32 v5, v5, v234
    v_mul_f32 v6, v6, v234
    v_mul_f32 v7, v7, v234
    v_mul_f32 v8, v8, v234
    v_mul_f32 v9, v9, v234
    v_mul_f32 v10, v10, v234
    v_mul_f32 v11, v11, v234
    v_mul_f32 v12, v12, v234
    v_mul_f32 v13, v13, v234
    v_mul_f32 v14, v14, v234
    v_mul_f32 v15, v15, v234
    v_mul_f32 v16, v16, v234
    v_mul_f32 v17, v17, v234
    v_mul_f32 v18, v18, v234
    v_mul_f32 v19, v19, v234
    v_mul_f32 v20, v20, v234
    v_mul_f32 v21, v21, v234
    v_mul_f32 v22, v22, v234
    v_mul_f32 v23, v23, v234
    v_mul_f32 v24, v24, v234
    v_mul_f32 v25, v25, v234
    v_mul_f32 v26, v26, v234
    v_mul_f32 v27, v27, v234
    v_mul_f32 v28, v28, v234
    v_mul_f32 v29, v29, v234
    v_mul_f32 v30, v30, v234
    v_mul_f32 v31, v31, v234
    v_max_f32 v235, 0, v235
    v_sub_f32 v228, v228, v235
    v_sub_f32 v229, v229, v235
    v_sub_f32 v230, v230, v235
    v_sub_f32 v231, v231, v235
    v_sub_f32 v112, v112, v235
    v_sub_f32 v113, v113, v235
    v_sub_f32 v114, v114, v235
    v_sub_f32 v115, v115, v235
    v_sub_f32 v116, v116, v235
    v_sub_f32 v117, v117, v235
    v_sub_f32 v118, v118, v235
    v_sub_f32 v119, v119, v235
    v_sub_f32 v120, v120, v235
    v_sub_f32 v121, v121, v235
    v_sub_f32 v122, v122, v235
    v_sub_f32 v123, v123, v235
    v_sub_f32 v124, v124, v235
    v_sub_f32 v125, v125, v235
    v_sub_f32 v126, v126, v235
    v_sub_f32 v127, v127, v235
    v_exp_f32 v235, -v235
    s_nop 0
    v_mul_f32 v220, v220, v235
    v_mul_f32 v32, v32, v235
    v_mul_f32 v33, v33, v235
    v_mul_f32 v34, v34, v235
    v_mul_f32 v35, v35, v235
    v_mul_f32 v36, v36, v235
    v_mul_f32 v37, v37, v235
    v_mul_f32 v38, v38, v235
    v_mul_f32 v39, v39, v235
    v_mul_f32 v40, v40, v235
    v_mul_f32 v41, v41, v235
    v_mul_f32 v42, v42, v235
    v_mul_f32 v43, v43, v235
    v_mul_f32 v44, v44, v235
    v_mul_f32 v45, v45, v235
    v_mul_f32 v46, v46, v235
    v_mul_f32 v47, v47, v235
    v_mul_f32 v48, v48, v235
    v_mul_f32 v49, v49, v235
    v_mul_f32 v50, v50, v235
    v_mul_f32 v51, v51, v235
    v_mul_f32 v52, v52, v235
    v_mul_f32 v53, v53, v235
    v_mul_f32 v54, v54, v235
    v_mul_f32 v55, v55, v235
    v_mul_f32 v56, v56, v235
    v_mul_f32 v57, v57, v235
    v_mul_f32 v58, v58, v235
    v_mul_f32 v59, v59, v235
    v_mul_f32 v60, v60, v235
    v_mul_f32 v61, v61, v235
    v_mul_f32 v62, v62, v235
    v_mul_f32 v63, v63, v235
    s_nop 1
    s_setpc_b64 s[38:39]
G0_slow01:
    v_mov_b32 v232, v234
    v_mov_b32 v233, v235
    s_nop 0
    v_permlane32_swap_b32 v232, v234
    v_permlane32_swap_b32 v233, v235
    v_max_f32 v234, v234, v232
    v_max_f32 v235, v235, v233
    v_mov_b32 v232, v234
    v_mov_b32 v233, v235
    s_nop 0
    v_permlane16_swap_b32 v232, v234
    v_permlane16_swap_b32 v233, v235
    v_max_f32 v234, v234, v232
    v_max_f32 v235, v235, v233
    v_max_f32 v234, 0, v234
    v_sub_f32 v224, v224, v234
    v_sub_f32 v225, v225, v234
    v_sub_f32 v226, v226, v234
    v_sub_f32 v227, v227, v234
    v_sub_f32 v96, v96, v234
    v_sub_f32 v97, v97, v234
    v_sub_f32 v98, v98, v234
    v_sub_f32 v99, v99, v234
    v_sub_f32 v100, v100, v234
    v_sub_f32 v101, v101, v234
    v_sub_f32 v102, v102, v234
    v_sub_f32 v103, v103, v234
    v_sub_f32 v104, v104, v234
    v_sub_f32 v105, v105, v234
    v_sub_f32 v106, v106, v234
    v_sub_f32 v107, v107, v234
    v_sub_f32 v108, v108, v234
    v_sub_f32 v109, v109, v234
    v_sub_f32 v110, v110, v234
    v_sub_f32 v111, v111, v234
    v_exp_f32 v234, -v234
    s_nop 0
    v_mul_f32 v217, v217, v234
    v_mul_f32 v0, v0, v234
    v_mul_f32 v1, v1, v234
    v_mul_f32 v2, v2, v234
    v_mul_f32 v3, v3, v234
    v_mul_f32 v4, v4, v234
    v_mul_f32 v5, v5, v234
    v_mul_f32 v6, v6, v234
    v_mul_f32 v7, v7, v234
    v_mul_f32 v8, v8, v234
    v_mul_f32 v9, v9, v234
    v_mul_f32 v10, v10, v234
    v_mul_f32 v11, v11, v234
    v_mul_f32 v12, v12, v234
    v_mul_f32 v13, v13, v234
    v_mul_f32 v14, v14, v234
    v_mul_f32 v15, v15, v234
    v_mul_f32 v16, v16, v234
    v_mul_f32 v17, v17, v234
    v_mul_f32 v18, v18, v234
    v_mul_f32 v19, v19, v234
    v_mul_f32 v20, v20, v234
    v_mul_f32 v21, v21, v234
    v_mul_f32 v22, v22, v234
    v_mul_f32 v23, v23, v234
    v_mul_f32 v24, v24, v234
    v_mul_f32 v25, v25, v234
    v_mul_f32 v26, v26, v234
    v_mul_f32 v27, v27, v234
    v_mul_f32 v28, v28, v234
    v_mul_f32 v29, v29, v234
    v_mul_f32 v30, v30, v234
    v_mul_f32 v31, v31, v234
    v_max_f32 v235, 0, v235
    v_sub_f32 v228, v228, v235
    v_sub_f32 v229, v229, v235
    v_sub_f32 v230, v230, v235
    v_sub_f32 v231, v231, v235
    v_sub_f32 v112, v112, v235
    v_sub_f32 v113, v113, v235
    v_sub_f32 v114, v114, v235
    v_sub_f32 v115, v115, v235
    v_sub_f32 v116, v116, v235
    v_sub_f32 v117, v117, v235
    v_sub_f32 v118, v118, v235
    v_sub_f32 v119, v119, v235
    v_sub_f32 v120, v120, v235
    v_sub_f32 v121, v121, v235
    v_sub_f32 v122, v122, v235
    v_sub_f32 v123, v123, v235
    v_sub_f32 v124, v124, v235
    v_sub_f32 v125, v125, v235
    v_sub_f32 v126, v126, v235
    v_sub_f32 v127, v127, v235
    v_exp_f32 v235, -v235
    s_nop 0
    v_mul_f32 v221, v221, v235
    v_mul_f32 v32, v32, v235
    v_mul_f32 v33, v33, v235
    v_mul_f32 v34, v34, v235
    v_mul_f32 v35, v35, v235
    v_mul_f32 v36, v36, v235
    v_mul_f32 v37, v37, v235
    v_mul_f32 v38, v38, v235
    v_mul_f32 v39, v39, v235
    v_mul_f32 v40, v40, v235
    v_mul_f32 v41, v41, v235
    v_mul_f32 v42, v42, v235
    v_mul_f32 v43, v43, v235
    v_mul_f32 v44, v44, v235
    v_mul_f32 v45, v45, v235
    v_mul_f32 v46, v46, v235
    v_mul_f32 v47, v47, v235
    v_mul_f32 v48, v48, v235
    v_mul_f32 v49, v49, v235
    v_mul_f32 v50, v50, v235
    v_mul_f32 v51, v51, v235
    v_mul_f32 v52, v52, v235
    v_mul_f32 v53, v53, v235
    v_mul_f32 v54, v54, v235
    v_mul_f32 v55, v55, v235
    v_mul_f32 v56, v56, v235
    v_mul_f32 v57, v57, v235
    v_mul_f32 v58, v58, v235
    v_mul_f32 v59, v59, v235
    v_mul_f32 v60, v60, v235
    v_mul_f32 v61, v61, v235
    v_mul_f32 v62, v62, v235
    v_mul_f32 v63, v63, v235
    s_nop 1
    s_setpc_b64 s[38:39]
G0_slow10:
    v_mov_b32 v232, v234
    v_mov_b32 v233, v235
    s_nop 0
    v_permlane32_swap_b32 v232, v234
    v_permlane32_swap_b32 v233, v235
    v_max_f32 v234, v234, v232
    v_max_f32 v235, v235, v233
    v_mov_b32 v232, v234
    v_mov_b32 v233, v235
    s_nop 0
    v_permlane16_swap_b32 v232, v234
    v_permlane16_swap_b32 v233, v235
    v_max_f32 v234, v234, v232
    v_max_f32 v235, v235, v233
    v_max_f32 v234, 0, v234
    v_sub_f32 v224, v224, v234
    v_sub_f32 v225, v225, v234
    v_sub_f32 v226, v226, v234
    v_sub_f32 v227, v227, v234
    v_sub_f32 v128, v128, v234
    v_sub_f32 v129, v129, v234
    v_sub_f32 v130, v130, v234
    v_sub_f32 v131, v131, v234
    v_sub_f32 v132, v132, v234
    v_sub_f32 v133, v133, v234
    v_sub_f32 v134, v134, v234
    v_sub_f32 v135, v135, v234
    v_sub_f32 v136, v136, v234
    v_sub_f32 v137, v137, v234
    v_sub_f32 v138, v138, v234
    v_sub_f32 v139, v139, v234
    v_sub_f32 v140, v140, v234
    v_sub_f32 v141, v141, v234
    v_sub_f32 v142, v142, v234
    v_sub_f32 v143, v143, v234
    v_exp_f32 v234, -v234
    s_nop 0
    v_mul_f32 v216, v216, v234
    v_mul_f32 v0, v0, v234
    v_mul_f32 v1, v1, v234
    v_mul_f32 v2, v2, v234
    v_mul_f32 v3, v3, v234
    v_mul_f32 v4, v4, v234
    v_mul_f32 v5, v5, v234
    v_mul_f32 v6, v6, v234
    v_mul_f32 v7, v7, v234
    v_mul_f32 v8, v8, v234
    v_mul_f32 v9, v9, v234
    v_mul_f32 v10, v10, v234
    v_mul_f32 v11, v11, v234
    v_mul_f32 v12, v12, v234
    v_mul_f32 v13, v13, v234
    v_mul_f32 v14, v14, v234
    v_mul_f32 v15, v15, v234
    v_mul_f32 v16, v16, v234
    v_mul_f32 v17, v17, v234
    v_mul_f32 v18, v18, v234
    v_mul_f32 v19, v19, v234
    v_mul_f32 v20, v20, v234
    v_mul_f32 v21, v21, v234
    v_mul_f32 v22, v22, v234
    v_mul_f32 v23, v23, v234
    v_mul_f32 v24, v24, v234
    v_mul_f32 v25, v25, v234
    v_mul_f32 v26, v26, v234
    v_mul_f32 v27, v27, v234
    v_mul_f32 v28, v28, v234
    v_mul_f32 v29, v29, v234
    v_mul_f32 v30, v30, v234
    v_mul_f32 v31, v31, v234
    v_max_f32 v235, 0, v235
    v_sub_f32 v228, v228, v235
    v_sub_f32 v229, v229, v235
    v_sub_f32 v230, v230, v235
    v_sub_f32 v231, v231, v235
    v_sub_f32 v144, v144, v235
    v_sub_f32 v145, v145, v235
    v_sub_f32 v146, v146, v235
    v_sub_f32 v147, v147, v235
    v_sub_f32 v148, v148, v235
    v_sub_f32 v149, v149, v235
    v_sub_f32 v150, v150, v235
    v_sub_f32 v151, v151, v235
    v_sub_f32 v152, v152, v235
    v_sub_f32 v153, v153, v235
    v_sub_f32 v154, v154, v235
    v_sub_f32 v155, v155, v235
    v_sub_f32 v156, v156, v235
    v_sub_f32 v157, v157, v235
    v_sub_f32 v158, v158, v235
    v_sub_f32 v159, v159, v235
    v_exp_f32 v235, -v235
    s_nop 0
    v_mul_f32 v220, v220, v235
    v_mul_f32 v32, v32, v235
    v_mul_f32 v33, v33, v235
    v_mul_f32 v34, v34, v235
    v_mul_f32 v35, v35, v235
    v_mul_f32 v36, v36, v235
    v_mul_f32 v37, v37, v235
    v_mul_f32 v38, v38, v235
    v_mul_f32 v39, v39, v235
    v_mul_f32 v40, v40, v235
    v_mul_f32 v41, v41, v235
    v_mul_f32 v42, v42, v235
    v_mul_f32 v43, v43, v235
    v_mul_f32 v44, v44, v235
    v_mul_f32 v45, v45, v235
    v_mul_f32 v46, v46, v235
    v_mul_f32 v47, v47, v235
    v_mul_f32 v48, v48, v235
    v_mul_f32 v49, v49, v235
    v_mul_f32 v50, v50, v235
    v_mul_f32 v51, v51, v235
    v_mul_f32 v52, v52, v235
    v_mul_f32 v53, v53, v235
    v_mul_f32 v54, v54, v235
    v_mul_f32 v55, v55, v235
    v_mul_f32 v56, v56, v235
    v_mul_f32 v57, v57, v235
    v_mul_f32 v58, v58, v235
    v_mul_f32 v59, v59, v235
    v_mul_f32 v60, v60, v235
    v_mul_f32 v61, v61, v235
    v_mul_f32 v62, v62, v235
    v_mul_f32 v63, v63, v235
    s_nop 1
    s_setpc_b64 s[38:39]
G0_slow11:
    v_mov_b32 v232, v234
    v_mov_b32 v233, v235
    s_nop 0
    v_permlane32_swap_b32 v232, v234
    v_permlane32_swap_b32 v233, v235
    v_max_f32 v234, v234, v232
    v_max_f32 v235, v235, v233
    v_mov_b32 v232, v234
    v_mov_b32 v233, v235
    s_nop 0
    v_permlane16_swap_b32 v232, v234
    v_permlane16_swap_b32 v233, v235
    v_max_f32 v234, v234, v232
    v_max_f32 v235, v235, v233
    v_max_f32 v234, 0, v234
    v_sub_f32 v224, v224, v234
    v_sub_f32 v225, v225, v234
    v_sub_f32 v226, v226, v234
    v_sub_f32 v227, v227, v234
    v_sub_f32 v128, v128, v234
    v_sub_f32 v129, v129, v234
    v_sub_f32 v130, v130, v234
    v_sub_f32 v131, v131, v234
    v_sub_f32 v132, v132, v234
    v_sub_f32 v133, v133, v234
    v_sub_f32 v134, v134, v234
    v_sub_f32 v135, v135, v234
    v_sub_f32 v136, v136, v234
    v_sub_f32 v137, v137, v234
    v_sub_f32 v138, v138, v234
    v_sub_f32 v139, v139, v234
    v_sub_f32 v140, v140, v234
    v_sub_f32 v141, v141, v234
    v_sub_f32 v142, v142, v234
    v_sub_f32 v143, v143, v234
    v_exp_f32 v234, -v234
    s_nop 0
    v_mul_f32 v217, v217, v234
    v_mul_f32 v0, v0, v234
    v_mul_f32 v1, v1, v234
    v_mul_f32 v2, v2, v234
    v_mul_f32 v3, v3, v234
    v_mul_f32 v4, v4, v234
    v_mul_f32 v5, v5, v234
    v_mul_f32 v6, v6, v234
    v_mul_f32 v7, v7, v234
    v_mul_f32 v8, v8, v234
    v_mul_f32 v9, v9, v234
    v_mul_f32 v10, v10, v234
    v_mul_f32 v11, v11, v234
    v_mul_f32 v12, v12, v234
    v_mul_f32 v13, v13, v234
    v_mul_f32 v14, v14, v234
    v_mul_f32 v15, v15, v234
    v_mul_f32 v16, v16, v234
    v_mul_f32 v17, v17, v234
    v_mul_f32 v18, v18, v234
    v_mul_f32 v19, v19, v234
    v_mul_f32 v20, v20, v234
    v_mul_f32 v21, v21, v234
    v_mul_f32 v22, v22, v234
    v_mul_f32 v23, v23, v234
    v_mul_f32 v24, v24, v234
    v_mul_f32 v25, v25, v234
    v_mul_f32 v26, v26, v234
    v_mul_f32 v27, v27, v234
    v_mul_f32 v28, v28, v234
    v_mul_f32 v29, v29, v234
    v_mul_f32 v30, v30, v234
    v_mul_f32 v31, v31, v234
    v_max_f32 v235, 0, v235
    v_sub_f32 v228, v228, v235
    v_sub_f32 v229, v229, v235
    v_sub_f32 v230, v230, v235
    v_sub_f32 v231, v231, v235
    v_sub_f32 v144, v144, v235
    v_sub_f32 v145, v145, v235
    v_sub_f32 v146, v146, v235
    v_sub_f32 v147, v147, v235
    v_sub_f32 v148, v148, v235
    v_sub_f32 v149, v149, v235
    v_sub_f32 v150, v150, v235
    v_sub_f32 v151, v151, v235
    v_sub_f32 v152, v152, v235
    v_sub_f32 v153, v153, v235
    v_sub_f32 v154, v154, v235
    v_sub_f32 v155, v155, v235
    v_sub_f32 v156, v156, v235
    v_sub_f32 v157, v157, v235
    v_sub_f32 v158, v158, v235
    v_sub_f32 v159, v159, v235
    v_exp_f32 v235, -v235
    s_nop 0
    v_mul_f32 v221, v221, v235
    v_mul_f32 v32, v32, v235
    v_mul_f32 v33, v33, v235
    v_mul_f32 v34, v34, v235
    v_mul_f32 v35, v35, v235
    v_mul_f32 v36, v36, v235
    v_mul_f32 v37, v37, v235
    v_mul_f32 v38, v38, v235
    v_mul_f32 v39, v39, v235
    v_mul_f32 v40, v40, v235
    v_mul_f32 v41, v41, v235
    v_mul_f32 v42, v42, v235
    v_mul_f32 v43, v43, v235
    v_mul_f32 v44, v44, v235
    v_mul_f32 v45, v45, v235
    v_mul_f32 v46, v46, v235
    v_mul_f32 v47, v47, v235
    v_mul_f32 v48, v48, v235
    v_mul_f32 v49, v49, v235
    v_mul_f32 v50, v50, v235
    v_mul_f32 v51, v51, v235
    v_mul_f32 v52, v52, v235
    v_mul_f32 v53, v53, v235
    v_mul_f32 v54, v54, v235
    v_mul_f32 v55, v55, v235
    v_mul_f32 v56, v56, v235
    v_mul_f32 v57, v57, v235
    v_mul_f32 v58, v58, v235
    v_mul_f32 v59, v59, v235
    v_mul_f32 v60, v60, v235
    v_mul_f32 v61, v61, v235
    v_mul_f32 v62, v62, v235
    v_mul_f32 v63, v63, v235
    s_nop 1
    s_setpc_b64 s[38:39]
.p2align 8
.type cnt_table,@object
cnt_table:
.long 0
.long 1
.long 2
.long 3
.long 4
.long 5
.long 6
.long 7
.long 8
.long 9
.long 10
.long 11
.long 12
.long 13
.long 14
.long 15
.long 16
.long 17
.long 18
.long 19
.long 20
.long 21
.long 22
.long 23
.long 24
.long 25
.long 26
.long 27
.long 28
.long 29
.long 30
.long 31
.long 32
.long 33
.long 34
.long 35
.long 36
.long 37
.long 38
.long 39
.long 40
.long 41
.long 42
.long 43
.long 44
.long 45
.long 46
.long 47
.long 48
.long 49
.long 50
.long 51
.long 52
.long 53
.long 54
.long 55
.long 56
.long 57
.long 58
.long 59
.long 60
.long 61
.long 62
.long 63
.long 64
.long 65
.long 66
.long 67
.long 68
.long 69
.long 70
.long 71
.long 72
.long 73
.long 74
.long 75
.long 76
.long 77
.long 78
.long 79
.long 80
.long 81
.long 82
.long 83
.long 84
.long 85
.long 86
.long 87
.long 88
.long 89
.long 90
.long 91
.long 92
.long 93
.long 94
.long 95
.size cnt_table, 384
P_end:
.set CODE_KB_P, (P_end - standalone__mha_block_cached__near_ridge_kernel) / 1024 - 1
.section .rodata,"a"
.p2align 6
.amdhsa_kernel standalone__mha_block_cached__near_ridge_kernel
  .amdhsa_next_free_vgpr 256
  .amdhsa_next_free_sgpr 102
  .amdhsa_accum_offset 256
  .amdhsa_group_segment_fixed_size 0
  .amdhsa_kernarg_size 64
  .amdhsa_user_sgpr_count 2
  .amdhsa_user_sgpr_kernarg_segment_ptr 1
  .amdhsa_system_sgpr_workgroup_id_x 1
.end_amdhsa_kernel
```
